```python
import torch

def _softmax(x, axis=-1):
    return torch.softmax(x, dim=axis)
def _gelu(x):
    return torch.nn.functional.gelu(x, approximate="tanh")
def _silu(x):
    return torch.nn.functional.silu(x)
def _sigmoid(x):
    return torch.sigmoid(x)
def _layernorm(x, axis=-1, eps=1e-5):
    m = x.mean(dim=axis, keepdim=True)
    v = x.var(dim=axis, keepdim=True, unbiased=False)
    return (x - m) / torch.sqrt(v + eps)
def _scatter_add(tgt, idx, src, axis=0):
    return tgt.clone().index_add_(axis, idx, src)
def _segment_sum(src, seg, n):
    out = torch.zeros((n,) + src.shape[1:], dtype=src.dtype)
    return out.index_add_(0, seg, src)
def _pad(x, pw):
    flat = tuple(v for pair in reversed(pw) for v in pair)
    return torch.nn.functional.pad(x, flat)

kernel_name = 'interleave_layers__sliding_block__glu_gated_glu__prompt'

def setup_inputs():

    _w = (lambda a: (lambda t: t.to(torch.bfloat16) if t.is_floating_point() else t)(torch.as_tensor(a)))
    def _A_setup():
        B, S, D = 1, 2048, 640
        return {
            "x": _w((lambda *s: torch.randn(*s, dtype=torch.bfloat16) * 0.05)(B, S, D)),
            "wqkv": _w((lambda *s: torch.randn(*s, dtype=torch.bfloat16) * 0.05)(D, 3 * D)),
            "wo": _w((lambda *s: torch.randn(*s, dtype=torch.bfloat16) * 0.05)(D, D)),
        }
    _A_in = _A_setup()

    def _B_setup():
        B, S, D, F = 1, 2048, 640, 1536
        return {
            "x": _w((lambda *s: torch.randn(*s, dtype=torch.bfloat16) * 0.05)(B, S, D)),
            "w_gate": _w((lambda *s: torch.randn(*s, dtype=torch.bfloat16) * 0.05)(D, F)),
            "w_up": _w((lambda *s: torch.randn(*s, dtype=torch.bfloat16) * 0.05)(D, F)),
            "w_down": _w((lambda *s: torch.randn(*s, dtype=torch.bfloat16) * 0.05)(F, D)),
        }
    _B_in = _B_setup()

    return {
        "A_x": _A_in["x"],
        "A_wqkv": _A_in["wqkv"],
        "A_wo": _A_in["wo"],
        "B_x": _B_in["x"],
        "B_w_gate": _B_in["w_gate"],
        "B_w_up": _B_in["w_up"],
        "B_w_down": _B_in["w_down"],
    }

def reference(A_x, A_wqkv, A_wo, B_x, B_w_gate, B_w_up, B_w_down):
    def _A_ref(x, wqkv, wo):
        B, S, D = x.shape
        H = 32; Dh = D // H; W = 256
        qkv = (lambda x, *d: x.permute(*d))((x @ wqkv).reshape(B, S, 3, H, Dh), 2, 0, 3, 1, 4)
        q, k, v = qkv[0], qkv[1], qkv[2]
        scores = torch.einsum("bhqd,bhkd->bhqk", q, k) * (Dh ** -0.5)
        idx = torch.arange(S)
        mask = (idx[:, None] - idx[None, :] >= 0) & (idx[:, None] - idx[None, :] < W)
        scores = torch.where(mask[None, None], scores, -1e9)
        p = _softmax(scores, axis=-1)
        o = torch.einsum("bhqk,bhkd->bhqd", p, v)
        return (lambda x, *d: x.permute(*d))(o, 0, 2, 1, 3).reshape(B, S, D) @ wo

    def _B_ref(x, w_gate, w_up, w_down):
        g = torch.einsum("bsd,df->bsf", x, w_gate)
        u = torch.einsum("bsd,df->bsf", x, w_up)
        h = _sigmoid(g) * u
        return torch.einsum("bsf,fd->bsd", h, w_down)

    x = A_x
    x = x + _A_ref(_layernorm(x, axis=-1), A_wqkv, A_wo)
    x = x + _B_ref(_layernorm(x, axis=-1), B_w_gate, B_w_up, B_w_down)
    x = x + _A_ref(_layernorm(x, axis=-1), A_wqkv, A_wo)
    x = x + _B_ref(_layernorm(x, axis=-1), B_w_gate, B_w_up, B_w_down)
    return x
```

```asm
; @launch kernel=prep_kernel grid=(286,1,1) block=(256,1,1) lds=30720
; @launch kernel=qkv1_kernel grid=(240,1,1) block=(384,1,1) lds=132096
; @launch kernel=attn1_kernel grid=(512,1,1) block=(256,1,1) lds=64512
; @launch kernel=wo1_kernel grid=(256,1,1) block=(384,1,1) lds=147456
; @launch kernel=gu1_kernel grid=(256,1,1) block=(384,1,1) lds=124928
; @launch kernel=dn1_kernel grid=(256,1,1) block=(384,1,1) lds=147456
; @launch kernel=qkv2_kernel grid=(240,1,1) block=(384,1,1) lds=132096
; @launch kernel=attn_kernel grid=(512,1,1) block=(256,1,1) lds=39936
; @launch kernel=wo2_kernel grid=(256,1,1) block=(384,1,1) lds=147456
; @launch kernel=gu2_kernel grid=(256,1,1) block=(384,1,1) lds=124928
; @launch kernel=dn2_kernel grid=(256,1,1) block=(384,1,1) lds=147456
.amdgcn_target "amdgcn-amd-amdhsa--gfx950"
.text
.globl prep_kernel
.p2align 8
.type prep_kernel,@function
prep_kernel:
    s_cmp_ge_u32 s2, 286
    s_cbranch_scc1 prep_kernel_end
    s_load_dwordx2 s[4:5], s[0:1], 72
    s_cmp_ge_u32 s2, 206
    s_cbranch_scc1 prep_kernel_wqkv
    s_cmp_ge_u32 s2, 182
    s_cbranch_scc1 prep_kernel_csu
    s_cmp_ge_u32 s2, 158
    s_cbranch_scc1 prep_kernel_csg
    s_cmp_ge_u32 s2, 128
    s_cbranch_scc1 prep_kernel_csq
prep_kernel_x:
    s_load_dwordx2 s[8:9], s[0:1], 0
    v_lshrrev_b32 v2, 6, v0
    s_nop 0
    v_readfirstlane_b32 s12, v2
    v_and_b32 v1, 63, v0
    s_mov_b32 s14, s2
    v_and_b32 v3, 15, v1
    v_mul_u32_u24 v3, 1280, v3
    v_lshrrev_b32 v4, 4, v1
    v_lshlrev_b32 v4, 4, v4
    v_add_u32 v3, v3, v4
    s_mul_i32 s15, s14, 20480
    s_mul_i32 s16, s12, 320
    s_add_u32 s15, s15, s16
    v_lshlrev_b32 v5, 4, v1
    s_waitcnt lgkmcnt(0)
    s_and_b32 s5, s5, 0xffff
    s_mov_b32 s6, 268435456
    s_mov_b32 s7, 0x00020000
    s_and_b32 s9, s9, 0xffff
    s_mov_b32 s10, 2621440
    s_mov_b32 s11, 0x00020000
    buffer_load_dwordx4 v[16:19], v3, s[8:11], s15 offen offset:0
    buffer_load_dwordx4 v[20:23], v3, s[8:11], s15 offen offset:64
    buffer_load_dwordx4 v[24:27], v3, s[8:11], s15 offen offset:128
    buffer_load_dwordx4 v[28:31], v3, s[8:11], s15 offen offset:192
    buffer_load_dwordx4 v[32:35], v3, s[8:11], s15 offen offset:256
    s_mul_i32 s16, s14, 20480
    s_add_u32 s16, s16, 9437184
    s_mul_i32 s17, s12, 5120
    s_add_u32 s16, s16, s17
    s_add_u32 s17, s16, 4096
    s_lshl_b32 s18, s2, 8
    v_add_u32 v6, s18, v0
    v_lshrrev_b32 v7, 1, v6
    v_lshlrev_b32 v7, 10, v7
    v_and_b32 v6, 1, v6
    v_lshlrev_b32 v6, 4, v6
    v_add_u32 v7, v7, v6
    v_mov_b32 v40, 0x3f803f80
    v_mov_b32 v41, 0x3f803f80
    v_mov_b32 v42, 0x3f803f80
    v_mov_b32 v43, 0x3f803f80
    s_mov_b32 s18, 28312192
    s_cmp_ge_u32 s2, 32
    s_nop 2
    s_cbranch_scc1 noones_1
    buffer_store_dwordx4 v[40:43], v7, s[4:7], s18 offen
    s_nop 1
noones_1:
    v_mov_b32 v8, 0
    v_mov_b32 v9, 0
    s_waitcnt vmcnt(0)
    buffer_store_dwordx4 v[16:19], v5, s[4:7], s16 offen offset:0
    v_lshlrev_b32 v12, 16, v16
    v_and_b32 v13, 0xffff0000, v16
    v_add_f32 v8, v8, v12
    v_fma_f32 v9, v12, v12, v9
    v_add_f32 v8, v8, v13
    v_fma_f32 v9, v13, v13, v9
    v_lshlrev_b32 v12, 16, v17
    v_and_b32 v13, 0xffff0000, v17
    v_add_f32 v8, v8, v12
    v_fma_f32 v9, v12, v12, v9
    v_add_f32 v8, v8, v13
    v_fma_f32 v9, v13, v13, v9
    v_lshlrev_b32 v12, 16, v18
    v_and_b32 v13, 0xffff0000, v18
    v_add_f32 v8, v8, v12
    v_fma_f32 v9, v12, v12, v9
    v_add_f32 v8, v8, v13
    v_fma_f32 v9, v13, v13, v9
    v_lshlrev_b32 v12, 16, v19
    v_and_b32 v13, 0xffff0000, v19
    v_add_f32 v8, v8, v12
    v_fma_f32 v9, v12, v12, v9
    v_add_f32 v8, v8, v13
    v_fma_f32 v9, v13, v13, v9
    buffer_store_dwordx4 v[20:23], v5, s[4:7], s16 offen offset:1024
    v_lshlrev_b32 v12, 16, v20
    v_and_b32 v13, 0xffff0000, v20
    v_add_f32 v8, v8, v12
    v_fma_f32 v9, v12, v12, v9
    v_add_f32 v8, v8, v13
    v_fma_f32 v9, v13, v13, v9
    v_lshlrev_b32 v12, 16, v21
    v_and_b32 v13, 0xffff0000, v21
    v_add_f32 v8, v8, v12
    v_fma_f32 v9, v12, v12, v9
    v_add_f32 v8, v8, v13
    v_fma_f32 v9, v13, v13, v9
    v_lshlrev_b32 v12, 16, v22
    v_and_b32 v13, 0xffff0000, v22
    v_add_f32 v8, v8, v12
    v_fma_f32 v9, v12, v12, v9
    v_add_f32 v8, v8, v13
    v_fma_f32 v9, v13, v13, v9
    v_lshlrev_b32 v12, 16, v23
    v_and_b32 v13, 0xffff0000, v23
    v_add_f32 v8, v8, v12
    v_fma_f32 v9, v12, v12, v9
    v_add_f32 v8, v8, v13
    v_fma_f32 v9, v13, v13, v9
    buffer_store_dwordx4 v[24:27], v5, s[4:7], s16 offen offset:2048
    v_lshlrev_b32 v12, 16, v24
    v_and_b32 v13, 0xffff0000, v24
    v_add_f32 v8, v8, v12
    v_fma_f32 v9, v12, v12, v9
    v_add_f32 v8, v8, v13
    v_fma_f32 v9, v13, v13, v9
    v_lshlrev_b32 v12, 16, v25
    v_and_b32 v13, 0xffff0000, v25
    v_add_f32 v8, v8, v12
    v_fma_f32 v9, v12, v12, v9
    v_add_f32 v8, v8, v13
    v_fma_f32 v9, v13, v13, v9
    v_lshlrev_b32 v12, 16, v26
    v_and_b32 v13, 0xffff0000, v26
    v_add_f32 v8, v8, v12
    v_fma_f32 v9, v12, v12, v9
    v_add_f32 v8, v8, v13
    v_fma_f32 v9, v13, v13, v9
    v_lshlrev_b32 v12, 16, v27
    v_and_b32 v13, 0xffff0000, v27
    v_add_f32 v8, v8, v12
    v_fma_f32 v9, v12, v12, v9
    v_add_f32 v8, v8, v13
    v_fma_f32 v9, v13, v13, v9
    buffer_store_dwordx4 v[28:31], v5, s[4:7], s16 offen offset:3072
    v_lshlrev_b32 v12, 16, v28
    v_and_b32 v13, 0xffff0000, v28
    v_add_f32 v8, v8, v12
    v_fma_f32 v9, v12, v12, v9
    v_add_f32 v8, v8, v13
    v_fma_f32 v9, v13, v13, v9
    v_lshlrev_b32 v12, 16, v29
    v_and_b32 v13, 0xffff0000, v29
    v_add_f32 v8, v8, v12
    v_fma_f32 v9, v12, v12, v9
    v_add_f32 v8, v8, v13
    v_fma_f32 v9, v13, v13, v9
    v_lshlrev_b32 v12, 16, v30
    v_and_b32 v13, 0xffff0000, v30
    v_add_f32 v8, v8, v12
    v_fma_f32 v9, v12, v12, v9
    v_add_f32 v8, v8, v13
    v_fma_f32 v9, v13, v13, v9
    v_lshlrev_b32 v12, 16, v31
    v_and_b32 v13, 0xffff0000, v31
    v_add_f32 v8, v8, v12
    v_fma_f32 v9, v12, v12, v9
    v_add_f32 v8, v8, v13
    v_fma_f32 v9, v13, v13, v9
    buffer_store_dwordx4 v[32:35], v5, s[4:7], s17 offen
    v_lshlrev_b32 v12, 16, v32
    v_and_b32 v13, 0xffff0000, v32
    v_add_f32 v8, v8, v12
    v_fma_f32 v9, v12, v12, v9
    v_add_f32 v8, v8, v13
    v_fma_f32 v9, v13, v13, v9
    v_lshlrev_b32 v12, 16, v33
    v_and_b32 v13, 0xffff0000, v33
    v_add_f32 v8, v8, v12
    v_fma_f32 v9, v12, v12, v9
    v_add_f32 v8, v8, v13
    v_fma_f32 v9, v13, v13, v9
    v_lshlrev_b32 v12, 16, v34
    v_and_b32 v13, 0xffff0000, v34
    v_add_f32 v8, v8, v12
    v_fma_f32 v9, v12, v12, v9
    v_add_f32 v8, v8, v13
    v_fma_f32 v9, v13, v13, v9
    v_lshlrev_b32 v12, 16, v35
    v_and_b32 v13, 0xffff0000, v35
    v_add_f32 v8, v8, v12
    v_fma_f32 v9, v12, v12, v9
    v_add_f32 v8, v8, v13
    v_fma_f32 v9, v13, v13, v9
    v_mov_b32 v12, v8
    s_nop 1
    v_permlane16_swap_b32 v12, v8
    v_add_f32 v8, v8, v12
    v_mov_b32 v12, v9
    s_nop 1
    v_permlane16_swap_b32 v12, v9
    v_add_f32 v9, v9, v12
    v_mov_b32 v12, v8
    s_nop 1
    v_permlane32_swap_b32 v12, v8
    v_add_f32 v8, v8, v12
    v_mov_b32 v12, v9
    s_nop 1
    v_permlane32_swap_b32 v12, v9
    v_add_f32 v9, v9, v12
    v_mov_b32 v10, 0
    v_mov_b32 v11, 0
    v_lshlrev_b32 v6, 6, v1
    s_lshl_b32 s17, s14, 10
    s_lshl_b32 s18, s12, 3
    s_add_u32 s17, s17, s18
    s_add_u32 s17, s17, 22020096
    s_mov_b64 exec, 0xffff
    buffer_store_dwordx2 v[8:9], v6, s[4:7], s17 offen
    buffer_store_dwordx2 v[10:11], v6, s[4:7], s17 offen offset:32
    s_endpgm
prep_kernel_wqkv:
    s_load_dwordx2 s[8:9], s[0:1], 8
    v_lshrrev_b32 v2, 6, v0
    s_nop 0
    v_readfirstlane_b32 s12, v2
    v_and_b32 v1, 63, v0
    v_lshlrev_b32 v3, 4, v1
    s_sub_u32 s13, s2, 206
    s_lshl_b32 s14, s13, 3
    s_add_u32 s15, s14, 4
    s_mul_i32 s14, s14, 3840
    s_mul_i32 s15, s15, 3840
    s_waitcnt lgkmcnt(0)
    s_and_b32 s5, s5, 0xffff
    s_mov_b32 s6, 268435456
    s_mov_b32 s7, 0x00020000
    s_and_b32 s9, s9, 0xffff
    s_mov_b32 s10, 2457600
    s_mov_b32 s11, 0x00020000
    s_lshl_b32 s16, s12, 10
    s_add_u32 s17, s16, 0
    s_mov_b32 m0, s17
    s_sub_u32 s18, s17, 15360
    s_add_u32 s18, s18, s15
    s_add_u32 s19, s17, s14
    s_cmp_lt_u32 s17, 15360
    s_cselect_b32 s18, s19, s18
    buffer_load_dwordx4 v3, s[8:11], s18 offen lds
    s_add_u32 s17, s16, 4096
    s_mov_b32 m0, s17
    s_sub_u32 s18, s17, 15360
    s_add_u32 s18, s18, s15
    s_add_u32 s19, s17, s14
    s_cmp_lt_u32 s17, 15360
    s_cselect_b32 s18, s19, s18
    buffer_load_dwordx4 v3, s[8:11], s18 offen lds
    s_add_u32 s17, s16, 8192
    s_mov_b32 m0, s17
    s_sub_u32 s18, s17, 15360
    s_add_u32 s18, s18, s15
    s_add_u32 s19, s17, s14
    s_cmp_lt_u32 s17, 15360
    s_cselect_b32 s18, s19, s18
    buffer_load_dwordx4 v3, s[8:11], s18 offen lds
    s_add_u32 s17, s16, 12288
    s_mov_b32 m0, s17
    s_sub_u32 s18, s17, 15360
    s_add_u32 s18, s18, s15
    s_add_u32 s19, s17, s14
    s_cmp_lt_u32 s17, 15360
    s_cselect_b32 s18, s19, s18
    buffer_load_dwordx4 v3, s[8:11], s18 offen lds
    s_add_u32 s17, s16, 16384
    s_mov_b32 m0, s17
    s_sub_u32 s18, s17, 15360
    s_add_u32 s18, s18, s15
    s_add_u32 s19, s17, s14
    s_cmp_lt_u32 s17, 15360
    s_cselect_b32 s18, s19, s18
    buffer_load_dwordx4 v3, s[8:11], s18 offen lds
    s_add_u32 s17, s16, 20480
    s_mov_b32 m0, s17
    s_sub_u32 s18, s17, 15360
    s_add_u32 s18, s18, s15
    s_add_u32 s19, s17, s14
    s_cmp_lt_u32 s17, 15360
    s_cselect_b32 s18, s19, s18
    buffer_load_dwordx4 v3, s[8:11], s18 offen lds
    s_add_u32 s17, s16, 24576
    s_mov_b32 m0, s17
    s_sub_u32 s18, s17, 15360
    s_add_u32 s18, s18, s15
    s_add_u32 s19, s17, s14
    s_cmp_lt_u32 s17, 15360
    s_cselect_b32 s18, s19, s18
    buffer_load_dwordx4 v3, s[8:11], s18 offen lds
    s_add_u32 s17, s16, 28672
    s_min_u32 s17, s17, 29696
    s_mov_b32 m0, s17
    s_sub_u32 s18, s17, 15360
    s_add_u32 s18, s18, s15
    s_add_u32 s19, s17, s14
    s_cmp_lt_u32 s17, 15360
    s_cselect_b32 s18, s19, s18
    buffer_load_dwordx4 v3, s[8:11], s18 offen lds
    v_lshrrev_b32 v4, 4, v1
    v_bfe_u32 v5, v1, 2, 2
    v_and_b32 v6, 3, v1
    v_mul_u32_u24 v5, 3840, v5
    v_and_b32 v7, 15, v1
    v_lshlrev_b32 v7, 4, v7
    s_lshr_b32 s20, s13, 2
    s_lshl_b32 s20, s20, 10
    s_and_b32 s21, s13, 3
    s_lshl_b32 s21, s21, 8
    s_add_u32 s20, s20, s21
    s_add_u32 s20, s20, 0
    s_lshl_b32 s21, s12, 2
    v_add_u32 v4, s21, v4
    s_waitcnt vmcnt(0)
    s_barrier
    v_add_u32 v16, 0, v4
    v_cmp_le_u32 vcc, 40, v16
    s_nop 1
    v_cndmask_b32_e64 v18, 0, 1, vcc
    v_cmp_le_u32 vcc, 80, v16
    s_nop 1
    v_cndmask_b32_e64 v18, v18, 2, vcc
    v_mul_u32_u24 v19, 40, v18
    v_sub_u32 v19, v16, v19
    v_and_b32 v20, 1, v19
    v_lshlrev_b32 v20, 2, v20
    v_lshl_add_u32 v20, v6, 3, v20
    v_and_b32 v17, -2, v19
    v_lshrrev_b32 v21, 4, v20
    v_add_u32 v17, v17, v21
    v_mul_u32_u24 v17, 20, v17
    v_and_b32 v21, 15, v20
    v_add_u32 v17, v17, v21
    v_lshrrev_b32 v21, 1, v19
    v_subrev_u32 v21, 16, v21
    v_lshlrev_b32 v21, 3, v21
    v_lshrrev_b32 v20, 2, v20
    v_add_u32 v21, v21, v20
    v_mul_u32_u24 v21, 20, v21
    v_add_u32 v21, 16, v21
    v_cmp_le_u32 vcc, 32, v19
    s_nop 1
    v_cndmask_b32 v17, v17, v21, vcc
    v_lshlrev_b32 v21, 4, v19
    v_lshl_add_u32 v21, v6, 2, v21
    v_cmp_eq_u32 vcc, 2, v18
    s_nop 1
    v_cndmask_b32 v17, v17, v21, vcc
    v_mul_u32_u24 v18, 640, v18
    v_add_u32 v17, v17, v18
    v_lshl_add_u32 v17, v17, 1, v5
    ds_read_b64_tr_b16 v[24:25], v17
    ds_read_b64_tr_b16 v[26:27], v17 offset:15360
    v_mul_u32_u24 v16, 20480, v16
    v_add_u32 v16, v16, v7
    s_waitcnt lgkmcnt(0)
    buffer_store_dwordx4 v[24:27], v16, s[4:7], s20 offen
    v_add_u32 v28, 16, v4
    v_cmp_le_u32 vcc, 40, v28
    s_nop 1
    v_cndmask_b32_e64 v30, 0, 1, vcc
    v_cmp_le_u32 vcc, 80, v28
    s_nop 1
    v_cndmask_b32_e64 v30, v30, 2, vcc
    v_mul_u32_u24 v31, 40, v30
    v_sub_u32 v31, v28, v31
    v_and_b32 v32, 1, v31
    v_lshlrev_b32 v32, 2, v32
    v_lshl_add_u32 v32, v6, 3, v32
    v_and_b32 v29, -2, v31
    v_lshrrev_b32 v33, 4, v32
    v_add_u32 v29, v29, v33
    v_mul_u32_u24 v29, 20, v29
    v_and_b32 v33, 15, v32
    v_add_u32 v29, v29, v33
    v_lshrrev_b32 v33, 1, v31
    v_subrev_u32 v33, 16, v33
    v_lshlrev_b32 v33, 3, v33
    v_lshrrev_b32 v32, 2, v32
    v_add_u32 v33, v33, v32
    v_mul_u32_u24 v33, 20, v33
    v_add_u32 v33, 16, v33
    v_cmp_le_u32 vcc, 32, v31
    s_nop 1
    v_cndmask_b32 v29, v29, v33, vcc
    v_lshlrev_b32 v33, 4, v31
    v_lshl_add_u32 v33, v6, 2, v33
    v_cmp_eq_u32 vcc, 2, v30
    s_nop 1
    v_cndmask_b32 v29, v29, v33, vcc
    v_mul_u32_u24 v30, 640, v30
    v_add_u32 v29, v29, v30
    v_lshl_add_u32 v29, v29, 1, v5
    ds_read_b64_tr_b16 v[36:37], v29
    ds_read_b64_tr_b16 v[38:39], v29 offset:15360
    v_mul_u32_u24 v28, 20480, v28
    v_add_u32 v28, v28, v7
    s_waitcnt lgkmcnt(0)
    buffer_store_dwordx4 v[36:39], v28, s[4:7], s20 offen
    v_add_u32 v16, 32, v4
    v_cmp_le_u32 vcc, 40, v16
    s_nop 1
    v_cndmask_b32_e64 v18, 0, 1, vcc
    v_cmp_le_u32 vcc, 80, v16
    s_nop 1
    v_cndmask_b32_e64 v18, v18, 2, vcc
    v_mul_u32_u24 v19, 40, v18
    v_sub_u32 v19, v16, v19
    v_and_b32 v20, 1, v19
    v_lshlrev_b32 v20, 2, v20
    v_lshl_add_u32 v20, v6, 3, v20
    v_and_b32 v17, -2, v19
    v_lshrrev_b32 v21, 4, v20
    v_add_u32 v17, v17, v21
    v_mul_u32_u24 v17, 20, v17
    v_and_b32 v21, 15, v20
    v_add_u32 v17, v17, v21
    v_lshrrev_b32 v21, 1, v19
    v_subrev_u32 v21, 16, v21
    v_lshlrev_b32 v21, 3, v21
    v_lshrrev_b32 v20, 2, v20
    v_add_u32 v21, v21, v20
    v_mul_u32_u24 v21, 20, v21
    v_add_u32 v21, 16, v21
    v_cmp_le_u32 vcc, 32, v19
    s_nop 1
    v_cndmask_b32 v17, v17, v21, vcc
    v_lshlrev_b32 v21, 4, v19
    v_lshl_add_u32 v21, v6, 2, v21
    v_cmp_eq_u32 vcc, 2, v18
    s_nop 1
    v_cndmask_b32 v17, v17, v21, vcc
    v_mul_u32_u24 v18, 640, v18
    v_add_u32 v17, v17, v18
    v_lshl_add_u32 v17, v17, 1, v5
    ds_read_b64_tr_b16 v[24:25], v17
    ds_read_b64_tr_b16 v[26:27], v17 offset:15360
    v_mul_u32_u24 v16, 20480, v16
    v_add_u32 v16, v16, v7
    s_waitcnt lgkmcnt(0)
    buffer_store_dwordx4 v[24:27], v16, s[4:7], s20 offen
    v_add_u32 v28, 48, v4
    v_cmp_le_u32 vcc, 40, v28
    s_nop 1
    v_cndmask_b32_e64 v30, 0, 1, vcc
    v_cmp_le_u32 vcc, 80, v28
    s_nop 1
    v_cndmask_b32_e64 v30, v30, 2, vcc
    v_mul_u32_u24 v31, 40, v30
    v_sub_u32 v31, v28, v31
    v_and_b32 v32, 1, v31
    v_lshlrev_b32 v32, 2, v32
    v_lshl_add_u32 v32, v6, 3, v32
    v_and_b32 v29, -2, v31
    v_lshrrev_b32 v33, 4, v32
    v_add_u32 v29, v29, v33
    v_mul_u32_u24 v29, 20, v29
    v_and_b32 v33, 15, v32
    v_add_u32 v29, v29, v33
    v_lshrrev_b32 v33, 1, v31
    v_subrev_u32 v33, 16, v33
    v_lshlrev_b32 v33, 3, v33
    v_lshrrev_b32 v32, 2, v32
    v_add_u32 v33, v33, v32
    v_mul_u32_u24 v33, 20, v33
    v_add_u32 v33, 16, v33
    v_cmp_le_u32 vcc, 32, v31
    s_nop 1
    v_cndmask_b32 v29, v29, v33, vcc
    v_lshlrev_b32 v33, 4, v31
    v_lshl_add_u32 v33, v6, 2, v33
    v_cmp_eq_u32 vcc, 2, v30
    s_nop 1
    v_cndmask_b32 v29, v29, v33, vcc
    v_mul_u32_u24 v30, 640, v30
    v_add_u32 v29, v29, v30
    v_lshl_add_u32 v29, v29, 1, v5
    ds_read_b64_tr_b16 v[36:37], v29
    ds_read_b64_tr_b16 v[38:39], v29 offset:15360
    v_mul_u32_u24 v28, 20480, v28
    v_add_u32 v28, v28, v7
    s_waitcnt lgkmcnt(0)
    buffer_store_dwordx4 v[36:39], v28, s[4:7], s20 offen
    v_add_u32 v16, 64, v4
    v_cmp_le_u32 vcc, 40, v16
    s_nop 1
    v_cndmask_b32_e64 v18, 0, 1, vcc
    v_cmp_le_u32 vcc, 80, v16
    s_nop 1
    v_cndmask_b32_e64 v18, v18, 2, vcc
    v_mul_u32_u24 v19, 40, v18
    v_sub_u32 v19, v16, v19
    v_and_b32 v20, 1, v19
    v_lshlrev_b32 v20, 2, v20
    v_lshl_add_u32 v20, v6, 3, v20
    v_and_b32 v17, -2, v19
    v_lshrrev_b32 v21, 4, v20
    v_add_u32 v17, v17, v21
    v_mul_u32_u24 v17, 20, v17
    v_and_b32 v21, 15, v20
    v_add_u32 v17, v17, v21
    v_lshrrev_b32 v21, 1, v19
    v_subrev_u32 v21, 16, v21
    v_lshlrev_b32 v21, 3, v21
    v_lshrrev_b32 v20, 2, v20
    v_add_u32 v21, v21, v20
    v_mul_u32_u24 v21, 20, v21
    v_add_u32 v21, 16, v21
    v_cmp_le_u32 vcc, 32, v19
    s_nop 1
    v_cndmask_b32 v17, v17, v21, vcc
    v_lshlrev_b32 v21, 4, v19
    v_lshl_add_u32 v21, v6, 2, v21
    v_cmp_eq_u32 vcc, 2, v18
    s_nop 1
    v_cndmask_b32 v17, v17, v21, vcc
    v_mul_u32_u24 v18, 640, v18
    v_add_u32 v17, v17, v18
    v_lshl_add_u32 v17, v17, 1, v5
    ds_read_b64_tr_b16 v[24:25], v17
    ds_read_b64_tr_b16 v[26:27], v17 offset:15360
    v_mul_u32_u24 v16, 20480, v16
    v_add_u32 v16, v16, v7
    s_waitcnt lgkmcnt(0)
    buffer_store_dwordx4 v[24:27], v16, s[4:7], s20 offen
    v_add_u32 v28, 80, v4
    v_cmp_le_u32 vcc, 40, v28
    s_nop 1
    v_cndmask_b32_e64 v30, 0, 1, vcc
    v_cmp_le_u32 vcc, 80, v28
    s_nop 1
    v_cndmask_b32_e64 v30, v30, 2, vcc
    v_mul_u32_u24 v31, 40, v30
    v_sub_u32 v31, v28, v31
    v_and_b32 v32, 1, v31
    v_lshlrev_b32 v32, 2, v32
    v_lshl_add_u32 v32, v6, 3, v32
    v_and_b32 v29, -2, v31
    v_lshrrev_b32 v33, 4, v32
    v_add_u32 v29, v29, v33
    v_mul_u32_u24 v29, 20, v29
    v_and_b32 v33, 15, v32
    v_add_u32 v29, v29, v33
    v_lshrrev_b32 v33, 1, v31
    v_subrev_u32 v33, 16, v33
    v_lshlrev_b32 v33, 3, v33
    v_lshrrev_b32 v32, 2, v32
    v_add_u32 v33, v33, v32
    v_mul_u32_u24 v33, 20, v33
    v_add_u32 v33, 16, v33
    v_cmp_le_u32 vcc, 32, v31
    s_nop 1
    v_cndmask_b32 v29, v29, v33, vcc
    v_lshlrev_b32 v33, 4, v31
    v_lshl_add_u32 v33, v6, 2, v33
    v_cmp_eq_u32 vcc, 2, v30
    s_nop 1
    v_cndmask_b32 v29, v29, v33, vcc
    v_mul_u32_u24 v30, 640, v30
    v_add_u32 v29, v29, v30
    v_lshl_add_u32 v29, v29, 1, v5
    ds_read_b64_tr_b16 v[36:37], v29
    ds_read_b64_tr_b16 v[38:39], v29 offset:15360
    v_mul_u32_u24 v28, 20480, v28
    v_add_u32 v28, v28, v7
    s_waitcnt lgkmcnt(0)
    buffer_store_dwordx4 v[36:39], v28, s[4:7], s20 offen
    v_add_u32 v16, 96, v4
    v_cmp_le_u32 vcc, 40, v16
    s_nop 1
    v_cndmask_b32_e64 v18, 0, 1, vcc
    v_cmp_le_u32 vcc, 80, v16
    s_nop 1
    v_cndmask_b32_e64 v18, v18, 2, vcc
    v_mul_u32_u24 v19, 40, v18
    v_sub_u32 v19, v16, v19
    v_and_b32 v20, 1, v19
    v_lshlrev_b32 v20, 2, v20
    v_lshl_add_u32 v20, v6, 3, v20
    v_and_b32 v17, -2, v19
    v_lshrrev_b32 v21, 4, v20
    v_add_u32 v17, v17, v21
    v_mul_u32_u24 v17, 20, v17
    v_and_b32 v21, 15, v20
    v_add_u32 v17, v17, v21
    v_lshrrev_b32 v21, 1, v19
    v_subrev_u32 v21, 16, v21
    v_lshlrev_b32 v21, 3, v21
    v_lshrrev_b32 v20, 2, v20
    v_add_u32 v21, v21, v20
    v_mul_u32_u24 v21, 20, v21
    v_add_u32 v21, 16, v21
    v_cmp_le_u32 vcc, 32, v19
    s_nop 1
    v_cndmask_b32 v17, v17, v21, vcc
    v_lshlrev_b32 v21, 4, v19
    v_lshl_add_u32 v21, v6, 2, v21
    v_cmp_eq_u32 vcc, 2, v18
    s_nop 1
    v_cndmask_b32 v17, v17, v21, vcc
    v_mul_u32_u24 v18, 640, v18
    v_add_u32 v17, v17, v18
    v_lshl_add_u32 v17, v17, 1, v5
    ds_read_b64_tr_b16 v[24:25], v17
    ds_read_b64_tr_b16 v[26:27], v17 offset:15360
    v_mul_u32_u24 v16, 20480, v16
    v_add_u32 v16, v16, v7
    s_waitcnt lgkmcnt(0)
    buffer_store_dwordx4 v[24:27], v16, s[4:7], s20 offen
    v_add_u32 v28, 112, v4
    v_min_u32 v28, 119, v28
    v_cmp_le_u32 vcc, 40, v28
    s_nop 1
    v_cndmask_b32_e64 v30, 0, 1, vcc
    v_cmp_le_u32 vcc, 80, v28
    s_nop 1
    v_cndmask_b32_e64 v30, v30, 2, vcc
    v_mul_u32_u24 v31, 40, v30
    v_sub_u32 v31, v28, v31
    v_and_b32 v32, 1, v31
    v_lshlrev_b32 v32, 2, v32
    v_lshl_add_u32 v32, v6, 3, v32
    v_and_b32 v29, -2, v31
    v_lshrrev_b32 v33, 4, v32
    v_add_u32 v29, v29, v33
    v_mul_u32_u24 v29, 20, v29
    v_and_b32 v33, 15, v32
    v_add_u32 v29, v29, v33
    v_lshrrev_b32 v33, 1, v31
    v_subrev_u32 v33, 16, v33
    v_lshlrev_b32 v33, 3, v33
    v_lshrrev_b32 v32, 2, v32
    v_add_u32 v33, v33, v32
    v_mul_u32_u24 v33, 20, v33
    v_add_u32 v33, 16, v33
    v_cmp_le_u32 vcc, 32, v31
    s_nop 1
    v_cndmask_b32 v29, v29, v33, vcc
    v_lshlrev_b32 v33, 4, v31
    v_lshl_add_u32 v33, v6, 2, v33
    v_cmp_eq_u32 vcc, 2, v30
    s_nop 1
    v_cndmask_b32 v29, v29, v33, vcc
    v_mul_u32_u24 v30, 640, v30
    v_add_u32 v29, v29, v30
    v_lshl_add_u32 v29, v29, 1, v5
    ds_read_b64_tr_b16 v[36:37], v29
    ds_read_b64_tr_b16 v[38:39], v29 offset:15360
    v_mul_u32_u24 v28, 20480, v28
    v_add_u32 v28, v28, v7
    s_waitcnt lgkmcnt(0)
    buffer_store_dwordx4 v[36:39], v28, s[4:7], s20 offen
    s_endpgm
    s_nop 1
prep_kernel_csq:
    s_load_dwordx2 s[8:9], s[0:1], 8
    s_sub_u32 s12, s2, 128
    s_lshl_b32 s12, s12, 6
    v_lshrrev_b32 v1, 4, v0
    v_and_b32 v2, 15, v0
    v_mul_u32_u24 v3, 40, v1
    s_mov_b32 s13, 3840
    v_mul_lo_u32 v3, v3, s13
    v_lshlrev_b32 v4, 3, v2
    v_add_u32 v3, v3, v4
    s_lshl_b32 s14, s12, 1
    v_add_u32 v3, s14, v3
    s_waitcnt lgkmcnt(0)
    s_and_b32 s5, s5, 0xffff
    s_mov_b32 s6, 268435456
    s_mov_b32 s7, 0x00020000
    s_and_b32 s9, s9, 0xffff
    s_mov_b32 s10, 2457600
    s_mov_b32 s11, 0x00020000
    s_mov_b32 s14, 0
    buffer_load_dwordx2 v[16:17], v3, s[8:11], s14 offen
    s_mov_b32 s15, 3840
    buffer_load_dwordx2 v[18:19], v3, s[8:11], s15 offen
    s_mov_b32 s16, 7680
    buffer_load_dwordx2 v[20:21], v3, s[8:11], s16 offen
    s_mov_b32 s17, 11520
    buffer_load_dwordx2 v[22:23], v3, s[8:11], s17 offen
    s_mov_b32 s14, 15360
    buffer_load_dwordx2 v[24:25], v3, s[8:11], s14 offen
    s_mov_b32 s15, 19200
    buffer_load_dwordx2 v[26:27], v3, s[8:11], s15 offen
    s_mov_b32 s16, 23040
    buffer_load_dwordx2 v[28:29], v3, s[8:11], s16 offen
    s_mov_b32 s17, 26880
    buffer_load_dwordx2 v[30:31], v3, s[8:11], s17 offen
    s_mov_b32 s14, 30720
    buffer_load_dwordx2 v[32:33], v3, s[8:11], s14 offen
    s_mov_b32 s15, 34560
    buffer_load_dwordx2 v[34:35], v3, s[8:11], s15 offen
    s_mov_b32 s16, 38400
    buffer_load_dwordx2 v[36:37], v3, s[8:11], s16 offen
    s_mov_b32 s17, 42240
    buffer_load_dwordx2 v[38:39], v3, s[8:11], s17 offen
    s_mov_b32 s14, 46080
    buffer_load_dwordx2 v[40:41], v3, s[8:11], s14 offen
    s_mov_b32 s15, 49920
    buffer_load_dwordx2 v[42:43], v3, s[8:11], s15 offen
    s_mov_b32 s16, 53760
    buffer_load_dwordx2 v[44:45], v3, s[8:11], s16 offen
    s_mov_b32 s17, 57600
    buffer_load_dwordx2 v[46:47], v3, s[8:11], s17 offen
    s_mov_b32 s14, 61440
    buffer_load_dwordx2 v[48:49], v3, s[8:11], s14 offen
    s_mov_b32 s15, 65280
    buffer_load_dwordx2 v[50:51], v3, s[8:11], s15 offen
    s_mov_b32 s16, 69120
    buffer_load_dwordx2 v[52:53], v3, s[8:11], s16 offen
    s_mov_b32 s17, 72960
    buffer_load_dwordx2 v[54:55], v3, s[8:11], s17 offen
    s_mov_b32 s14, 76800
    buffer_load_dwordx2 v[56:57], v3, s[8:11], s14 offen
    s_mov_b32 s15, 80640
    buffer_load_dwordx2 v[58:59], v3, s[8:11], s15 offen
    s_mov_b32 s16, 84480
    buffer_load_dwordx2 v[60:61], v3, s[8:11], s16 offen
    s_mov_b32 s17, 88320
    buffer_load_dwordx2 v[62:63], v3, s[8:11], s17 offen
    s_mov_b32 s14, 92160
    buffer_load_dwordx2 v[64:65], v3, s[8:11], s14 offen
    s_mov_b32 s15, 96000
    buffer_load_dwordx2 v[66:67], v3, s[8:11], s15 offen
    s_mov_b32 s16, 99840
    buffer_load_dwordx2 v[68:69], v3, s[8:11], s16 offen
    s_mov_b32 s17, 103680
    buffer_load_dwordx2 v[70:71], v3, s[8:11], s17 offen
    s_mov_b32 s14, 107520
    buffer_load_dwordx2 v[72:73], v3, s[8:11], s14 offen
    s_mov_b32 s15, 111360
    buffer_load_dwordx2 v[74:75], v3, s[8:11], s15 offen
    s_mov_b32 s16, 115200
    buffer_load_dwordx2 v[76:77], v3, s[8:11], s16 offen
    s_mov_b32 s17, 119040
    buffer_load_dwordx2 v[78:79], v3, s[8:11], s17 offen
    s_mov_b32 s14, 122880
    buffer_load_dwordx2 v[80:81], v3, s[8:11], s14 offen
    s_mov_b32 s15, 126720
    buffer_load_dwordx2 v[82:83], v3, s[8:11], s15 offen
    s_mov_b32 s16, 130560
    buffer_load_dwordx2 v[84:85], v3, s[8:11], s16 offen
    s_mov_b32 s17, 134400
    buffer_load_dwordx2 v[86:87], v3, s[8:11], s17 offen
    s_mov_b32 s14, 138240
    buffer_load_dwordx2 v[88:89], v3, s[8:11], s14 offen
    s_mov_b32 s15, 142080
    buffer_load_dwordx2 v[90:91], v3, s[8:11], s15 offen
    s_mov_b32 s16, 145920
    buffer_load_dwordx2 v[92:93], v3, s[8:11], s16 offen
    s_mov_b32 s17, 149760
    buffer_load_dwordx2 v[94:95], v3, s[8:11], s17 offen
    v_mov_b32 v8, 0
    v_mov_b32 v9, 0
    v_mov_b32 v10, 0
    v_mov_b32 v11, 0
    s_waitcnt vmcnt(39)
    v_lshlrev_b32 v12, 16, v16
    v_and_b32 v13, 0xffff0000, v16
    v_add_f32 v8, v8, v12
    v_add_f32 v9, v9, v13
    v_lshlrev_b32 v12, 16, v17
    v_and_b32 v13, 0xffff0000, v17
    v_add_f32 v10, v10, v12
    v_add_f32 v11, v11, v13
    s_waitcnt vmcnt(38)
    v_lshlrev_b32 v12, 16, v18
    v_and_b32 v13, 0xffff0000, v18
    v_add_f32 v8, v8, v12
    v_add_f32 v9, v9, v13
    v_lshlrev_b32 v12, 16, v19
    v_and_b32 v13, 0xffff0000, v19
    v_add_f32 v10, v10, v12
    v_add_f32 v11, v11, v13
    s_waitcnt vmcnt(37)
    v_lshlrev_b32 v12, 16, v20
    v_and_b32 v13, 0xffff0000, v20
    v_add_f32 v8, v8, v12
    v_add_f32 v9, v9, v13
    v_lshlrev_b32 v12, 16, v21
    v_and_b32 v13, 0xffff0000, v21
    v_add_f32 v10, v10, v12
    v_add_f32 v11, v11, v13
    s_waitcnt vmcnt(36)
    v_lshlrev_b32 v12, 16, v22
    v_and_b32 v13, 0xffff0000, v22
    v_add_f32 v8, v8, v12
    v_add_f32 v9, v9, v13
    v_lshlrev_b32 v12, 16, v23
    v_and_b32 v13, 0xffff0000, v23
    v_add_f32 v10, v10, v12
    v_add_f32 v11, v11, v13
    s_waitcnt vmcnt(35)
    v_lshlrev_b32 v12, 16, v24
    v_and_b32 v13, 0xffff0000, v24
    v_add_f32 v8, v8, v12
    v_add_f32 v9, v9, v13
    v_lshlrev_b32 v12, 16, v25
    v_and_b32 v13, 0xffff0000, v25
    v_add_f32 v10, v10, v12
    v_add_f32 v11, v11, v13
    s_waitcnt vmcnt(34)
    v_lshlrev_b32 v12, 16, v26
    v_and_b32 v13, 0xffff0000, v26
    v_add_f32 v8, v8, v12
    v_add_f32 v9, v9, v13
    v_lshlrev_b32 v12, 16, v27
    v_and_b32 v13, 0xffff0000, v27
    v_add_f32 v10, v10, v12
    v_add_f32 v11, v11, v13
    s_waitcnt vmcnt(33)
    v_lshlrev_b32 v12, 16, v28
    v_and_b32 v13, 0xffff0000, v28
    v_add_f32 v8, v8, v12
    v_add_f32 v9, v9, v13
    v_lshlrev_b32 v12, 16, v29
    v_and_b32 v13, 0xffff0000, v29
    v_add_f32 v10, v10, v12
    v_add_f32 v11, v11, v13
    s_waitcnt vmcnt(32)
    v_lshlrev_b32 v12, 16, v30
    v_and_b32 v13, 0xffff0000, v30
    v_add_f32 v8, v8, v12
    v_add_f32 v9, v9, v13
    v_lshlrev_b32 v12, 16, v31
    v_and_b32 v13, 0xffff0000, v31
    v_add_f32 v10, v10, v12
    v_add_f32 v11, v11, v13
    s_waitcnt vmcnt(31)
    v_lshlrev_b32 v12, 16, v32
    v_and_b32 v13, 0xffff0000, v32
    v_add_f32 v8, v8, v12
    v_add_f32 v9, v9, v13
    v_lshlrev_b32 v12, 16, v33
    v_and_b32 v13, 0xffff0000, v33
    v_add_f32 v10, v10, v12
    v_add_f32 v11, v11, v13
    s_waitcnt vmcnt(30)
    v_lshlrev_b32 v12, 16, v34
    v_and_b32 v13, 0xffff0000, v34
    v_add_f32 v8, v8, v12
    v_add_f32 v9, v9, v13
    v_lshlrev_b32 v12, 16, v35
    v_and_b32 v13, 0xffff0000, v35
    v_add_f32 v10, v10, v12
    v_add_f32 v11, v11, v13
    s_waitcnt vmcnt(29)
    v_lshlrev_b32 v12, 16, v36
    v_and_b32 v13, 0xffff0000, v36
    v_add_f32 v8, v8, v12
    v_add_f32 v9, v9, v13
    v_lshlrev_b32 v12, 16, v37
    v_and_b32 v13, 0xffff0000, v37
    v_add_f32 v10, v10, v12
    v_add_f32 v11, v11, v13
    s_waitcnt vmcnt(28)
    v_lshlrev_b32 v12, 16, v38
    v_and_b32 v13, 0xffff0000, v38
    v_add_f32 v8, v8, v12
    v_add_f32 v9, v9, v13
    v_lshlrev_b32 v12, 16, v39
    v_and_b32 v13, 0xffff0000, v39
    v_add_f32 v10, v10, v12
    v_add_f32 v11, v11, v13
    s_waitcnt vmcnt(27)
    v_lshlrev_b32 v12, 16, v40
    v_and_b32 v13, 0xffff0000, v40
    v_add_f32 v8, v8, v12
    v_add_f32 v9, v9, v13
    v_lshlrev_b32 v12, 16, v41
    v_and_b32 v13, 0xffff0000, v41
    v_add_f32 v10, v10, v12
    v_add_f32 v11, v11, v13
    s_waitcnt vmcnt(26)
    v_lshlrev_b32 v12, 16, v42
    v_and_b32 v13, 0xffff0000, v42
    v_add_f32 v8, v8, v12
    v_add_f32 v9, v9, v13
    v_lshlrev_b32 v12, 16, v43
    v_and_b32 v13, 0xffff0000, v43
    v_add_f32 v10, v10, v12
    v_add_f32 v11, v11, v13
    s_waitcnt vmcnt(25)
    v_lshlrev_b32 v12, 16, v44
    v_and_b32 v13, 0xffff0000, v44
    v_add_f32 v8, v8, v12
    v_add_f32 v9, v9, v13
    v_lshlrev_b32 v12, 16, v45
    v_and_b32 v13, 0xffff0000, v45
    v_add_f32 v10, v10, v12
    v_add_f32 v11, v11, v13
    s_waitcnt vmcnt(24)
    v_lshlrev_b32 v12, 16, v46
    v_and_b32 v13, 0xffff0000, v46
    v_add_f32 v8, v8, v12
    v_add_f32 v9, v9, v13
    v_lshlrev_b32 v12, 16, v47
    v_and_b32 v13, 0xffff0000, v47
    v_add_f32 v10, v10, v12
    v_add_f32 v11, v11, v13
    s_waitcnt vmcnt(23)
    v_lshlrev_b32 v12, 16, v48
    v_and_b32 v13, 0xffff0000, v48
    v_add_f32 v8, v8, v12
    v_add_f32 v9, v9, v13
    v_lshlrev_b32 v12, 16, v49
    v_and_b32 v13, 0xffff0000, v49
    v_add_f32 v10, v10, v12
    v_add_f32 v11, v11, v13
    s_waitcnt vmcnt(22)
    v_lshlrev_b32 v12, 16, v50
    v_and_b32 v13, 0xffff0000, v50
    v_add_f32 v8, v8, v12
    v_add_f32 v9, v9, v13
    v_lshlrev_b32 v12, 16, v51
    v_and_b32 v13, 0xffff0000, v51
    v_add_f32 v10, v10, v12
    v_add_f32 v11, v11, v13
    s_waitcnt vmcnt(21)
    v_lshlrev_b32 v12, 16, v52
    v_and_b32 v13, 0xffff0000, v52
    v_add_f32 v8, v8, v12
    v_add_f32 v9, v9, v13
    v_lshlrev_b32 v12, 16, v53
    v_and_b32 v13, 0xffff0000, v53
    v_add_f32 v10, v10, v12
    v_add_f32 v11, v11, v13
    s_waitcnt vmcnt(20)
    v_lshlrev_b32 v12, 16, v54
    v_and_b32 v13, 0xffff0000, v54
    v_add_f32 v8, v8, v12
    v_add_f32 v9, v9, v13
    v_lshlrev_b32 v12, 16, v55
    v_and_b32 v13, 0xffff0000, v55
    v_add_f32 v10, v10, v12
    v_add_f32 v11, v11, v13
    s_waitcnt vmcnt(19)
    v_lshlrev_b32 v12, 16, v56
    v_and_b32 v13, 0xffff0000, v56
    v_add_f32 v8, v8, v12
    v_add_f32 v9, v9, v13
    v_lshlrev_b32 v12, 16, v57
    v_and_b32 v13, 0xffff0000, v57
    v_add_f32 v10, v10, v12
    v_add_f32 v11, v11, v13
    s_waitcnt vmcnt(18)
    v_lshlrev_b32 v12, 16, v58
    v_and_b32 v13, 0xffff0000, v58
    v_add_f32 v8, v8, v12
    v_add_f32 v9, v9, v13
    v_lshlrev_b32 v12, 16, v59
    v_and_b32 v13, 0xffff0000, v59
    v_add_f32 v10, v10, v12
    v_add_f32 v11, v11, v13
    s_waitcnt vmcnt(17)
    v_lshlrev_b32 v12, 16, v60
    v_and_b32 v13, 0xffff0000, v60
    v_add_f32 v8, v8, v12
    v_add_f32 v9, v9, v13
    v_lshlrev_b32 v12, 16, v61
    v_and_b32 v13, 0xffff0000, v61
    v_add_f32 v10, v10, v12
    v_add_f32 v11, v11, v13
    s_waitcnt vmcnt(16)
    v_lshlrev_b32 v12, 16, v62
    v_and_b32 v13, 0xffff0000, v62
    v_add_f32 v8, v8, v12
    v_add_f32 v9, v9, v13
    v_lshlrev_b32 v12, 16, v63
    v_and_b32 v13, 0xffff0000, v63
    v_add_f32 v10, v10, v12
    v_add_f32 v11, v11, v13
    s_waitcnt vmcnt(15)
    v_lshlrev_b32 v12, 16, v64
    v_and_b32 v13, 0xffff0000, v64
    v_add_f32 v8, v8, v12
    v_add_f32 v9, v9, v13
    v_lshlrev_b32 v12, 16, v65
    v_and_b32 v13, 0xffff0000, v65
    v_add_f32 v10, v10, v12
    v_add_f32 v11, v11, v13
    s_waitcnt vmcnt(14)
    v_lshlrev_b32 v12, 16, v66
    v_and_b32 v13, 0xffff0000, v66
    v_add_f32 v8, v8, v12
    v_add_f32 v9, v9, v13
    v_lshlrev_b32 v12, 16, v67
    v_and_b32 v13, 0xffff0000, v67
    v_add_f32 v10, v10, v12
    v_add_f32 v11, v11, v13
    s_waitcnt vmcnt(13)
    v_lshlrev_b32 v12, 16, v68
    v_and_b32 v13, 0xffff0000, v68
    v_add_f32 v8, v8, v12
    v_add_f32 v9, v9, v13
    v_lshlrev_b32 v12, 16, v69
    v_and_b32 v13, 0xffff0000, v69
    v_add_f32 v10, v10, v12
    v_add_f32 v11, v11, v13
    s_waitcnt vmcnt(12)
    v_lshlrev_b32 v12, 16, v70
    v_and_b32 v13, 0xffff0000, v70
    v_add_f32 v8, v8, v12
    v_add_f32 v9, v9, v13
    v_lshlrev_b32 v12, 16, v71
    v_and_b32 v13, 0xffff0000, v71
    v_add_f32 v10, v10, v12
    v_add_f32 v11, v11, v13
    s_waitcnt vmcnt(11)
    v_lshlrev_b32 v12, 16, v72
    v_and_b32 v13, 0xffff0000, v72
    v_add_f32 v8, v8, v12
    v_add_f32 v9, v9, v13
    v_lshlrev_b32 v12, 16, v73
    v_and_b32 v13, 0xffff0000, v73
    v_add_f32 v10, v10, v12
    v_add_f32 v11, v11, v13
    s_waitcnt vmcnt(10)
    v_lshlrev_b32 v12, 16, v74
    v_and_b32 v13, 0xffff0000, v74
    v_add_f32 v8, v8, v12
    v_add_f32 v9, v9, v13
    v_lshlrev_b32 v12, 16, v75
    v_and_b32 v13, 0xffff0000, v75
    v_add_f32 v10, v10, v12
    v_add_f32 v11, v11, v13
    s_waitcnt vmcnt(9)
    v_lshlrev_b32 v12, 16, v76
    v_and_b32 v13, 0xffff0000, v76
    v_add_f32 v8, v8, v12
    v_add_f32 v9, v9, v13
    v_lshlrev_b32 v12, 16, v77
    v_and_b32 v13, 0xffff0000, v77
    v_add_f32 v10, v10, v12
    v_add_f32 v11, v11, v13
    s_waitcnt vmcnt(8)
    v_lshlrev_b32 v12, 16, v78
    v_and_b32 v13, 0xffff0000, v78
    v_add_f32 v8, v8, v12
    v_add_f32 v9, v9, v13
    v_lshlrev_b32 v12, 16, v79
    v_and_b32 v13, 0xffff0000, v79
    v_add_f32 v10, v10, v12
    v_add_f32 v11, v11, v13
    s_waitcnt vmcnt(7)
    v_lshlrev_b32 v12, 16, v80
    v_and_b32 v13, 0xffff0000, v80
    v_add_f32 v8, v8, v12
    v_add_f32 v9, v9, v13
    v_lshlrev_b32 v12, 16, v81
    v_and_b32 v13, 0xffff0000, v81
    v_add_f32 v10, v10, v12
    v_add_f32 v11, v11, v13
    s_waitcnt vmcnt(6)
    v_lshlrev_b32 v12, 16, v82
    v_and_b32 v13, 0xffff0000, v82
    v_add_f32 v8, v8, v12
    v_add_f32 v9, v9, v13
    v_lshlrev_b32 v12, 16, v83
    v_and_b32 v13, 0xffff0000, v83
    v_add_f32 v10, v10, v12
    v_add_f32 v11, v11, v13
    s_waitcnt vmcnt(5)
    v_lshlrev_b32 v12, 16, v84
    v_and_b32 v13, 0xffff0000, v84
    v_add_f32 v8, v8, v12
    v_add_f32 v9, v9, v13
    v_lshlrev_b32 v12, 16, v85
    v_and_b32 v13, 0xffff0000, v85
    v_add_f32 v10, v10, v12
    v_add_f32 v11, v11, v13
    s_waitcnt vmcnt(4)
    v_lshlrev_b32 v12, 16, v86
    v_and_b32 v13, 0xffff0000, v86
    v_add_f32 v8, v8, v12
    v_add_f32 v9, v9, v13
    v_lshlrev_b32 v12, 16, v87
    v_and_b32 v13, 0xffff0000, v87
    v_add_f32 v10, v10, v12
    v_add_f32 v11, v11, v13
    s_waitcnt vmcnt(3)
    v_lshlrev_b32 v12, 16, v88
    v_and_b32 v13, 0xffff0000, v88
    v_add_f32 v8, v8, v12
    v_add_f32 v9, v9, v13
    v_lshlrev_b32 v12, 16, v89
    v_and_b32 v13, 0xffff0000, v89
    v_add_f32 v10, v10, v12
    v_add_f32 v11, v11, v13
    s_waitcnt vmcnt(2)
    v_lshlrev_b32 v12, 16, v90
    v_and_b32 v13, 0xffff0000, v90
    v_add_f32 v8, v8, v12
    v_add_f32 v9, v9, v13
    v_lshlrev_b32 v12, 16, v91
    v_and_b32 v13, 0xffff0000, v91
    v_add_f32 v10, v10, v12
    v_add_f32 v11, v11, v13
    s_waitcnt vmcnt(1)
    v_lshlrev_b32 v12, 16, v92
    v_and_b32 v13, 0xffff0000, v92
    v_add_f32 v8, v8, v12
    v_add_f32 v9, v9, v13
    v_lshlrev_b32 v12, 16, v93
    v_and_b32 v13, 0xffff0000, v93
    v_add_f32 v10, v10, v12
    v_add_f32 v11, v11, v13
    s_waitcnt vmcnt(0)
    v_lshlrev_b32 v12, 16, v94
    v_and_b32 v13, 0xffff0000, v94
    v_add_f32 v8, v8, v12
    v_add_f32 v9, v9, v13
    v_lshlrev_b32 v12, 16, v95
    v_and_b32 v13, 0xffff0000, v95
    v_add_f32 v10, v10, v12
    v_add_f32 v11, v11, v13
    v_lshlrev_b32 v4, 4, v0
    ds_write_b128 v4, v[8:11]
    s_waitcnt lgkmcnt(0)
    s_barrier
    v_lshlrev_b32 v4, 2, v0
    ds_read_b32 v16, v4 offset:0
    ds_read_b32 v17, v4 offset:256
    ds_read_b32 v18, v4 offset:512
    ds_read_b32 v19, v4 offset:768
    ds_read_b32 v20, v4 offset:1024
    ds_read_b32 v21, v4 offset:1280
    ds_read_b32 v22, v4 offset:1536
    ds_read_b32 v23, v4 offset:1792
    ds_read_b32 v24, v4 offset:2048
    ds_read_b32 v25, v4 offset:2304
    ds_read_b32 v26, v4 offset:2560
    ds_read_b32 v27, v4 offset:2816
    ds_read_b32 v28, v4 offset:3072
    ds_read_b32 v29, v4 offset:3328
    ds_read_b32 v30, v4 offset:3584
    ds_read_b32 v31, v4 offset:3840
    v_lshrrev_b32 v2, 2, v0
    v_lshlrev_b32 v2, 2, v2
    v_add_u32 v2, s12, v2
    s_mov_b32 s30, 6710887
    v_mul_hi_u32 v7, v2, s30
    v_mul_u32_u24 v8, 640, v7
    v_sub_u32 v8, v2, v8
    s_mov_b32 s30, 3277
    v_mul_lo_u32 v9, v8, s30
    v_lshrrev_b32 v9, 16, v9
    v_mul_u32_u24 v6, 20, v9
    v_sub_u32 v6, v8, v6
    v_cmp_gt_u32 vcc, 16, v6
    v_and_b32 v5, 1, v9
    v_lshlrev_b32 v5, 4, v5
    v_add_u32 v6, v6, v5
    v_and_b32 v5, 7, v9
    v_lshlrev_b32 v5, 2, v5
    v_cndmask_b32 v6, v5, v6, vcc
    v_lshrrev_b32 v5, 3, v9
    v_add_u32 v5, 16, v5
    v_lshrrev_b32 v9, 1, v9
    v_cndmask_b32 v9, v5, v9, vcc
    v_lshlrev_b32 v5, 1, v9
    v_bfe_u32 v9, v6, 2, 1
    v_add_u32 v5, v5, v9
    v_mul_u32_u24 v9, 40, v7
    v_add_u32 v5, v5, v9
    v_lshrrev_b32 v6, 3, v6
    v_lshlrev_b32 v6, 2, v6
    v_cmp_eq_u32 vcc, 2, v7
    v_lshrrev_b32 v9, 4, v8
    v_add_u32 v9, 80, v9
    v_cndmask_b32 v5, v5, v9, vcc
    v_and_b32 v9, 15, v8
    v_cndmask_b32 v6, v6, v9, vcc
    v_lshlrev_b32 v5, 4, v5
    v_add_u32 v5, v5, v6
    v_and_b32 v6, 3, v0
    v_add_u32 v5, v5, v6
    v_lshlrev_b32 v5, 2, v5
    s_waitcnt lgkmcnt(0)
    v_add_f32 v16, v16, v17
    v_add_f32 v16, v16, v18
    v_add_f32 v16, v16, v19
    v_add_f32 v16, v16, v20
    v_add_f32 v16, v16, v21
    v_add_f32 v16, v16, v22
    v_add_f32 v16, v16, v23
    v_add_f32 v16, v16, v24
    v_add_f32 v16, v16, v25
    v_add_f32 v16, v16, v26
    v_add_f32 v16, v16, v27
    v_add_f32 v16, v16, v28
    v_add_f32 v16, v16, v29
    v_add_f32 v16, v16, v30
    v_add_f32 v16, v16, v31
    s_mov_b32 s22, 9240576
    v_cmp_gt_u32 vcc, 64, v0
    s_nop 1
    s_and_saveexec_b64 s[24:25], vcc
    s_nop 1
    s_cbranch_execz prep_kernel_end
    buffer_store_dword v16, v5, s[4:7], s22 offen
    s_endpgm
prep_kernel_csg:
    s_load_dwordx2 s[8:9], s[0:1], 32
    s_sub_u32 s12, s2, 158
    s_lshl_b32 s12, s12, 6
    v_lshrrev_b32 v1, 4, v0
    v_and_b32 v2, 15, v0
    v_mul_u32_u24 v3, 40, v1
    s_mov_b32 s13, 3072
    v_mul_lo_u32 v3, v3, s13
    v_lshlrev_b32 v4, 3, v2
    v_add_u32 v3, v3, v4
    s_lshl_b32 s14, s12, 1
    v_add_u32 v3, s14, v3
    s_waitcnt lgkmcnt(0)
    s_and_b32 s5, s5, 0xffff
    s_mov_b32 s6, 268435456
    s_mov_b32 s7, 0x00020000
    s_and_b32 s9, s9, 0xffff
    s_mov_b32 s10, 1966080
    s_mov_b32 s11, 0x00020000
    s_mov_b32 s14, 0
    buffer_load_dwordx2 v[16:17], v3, s[8:11], s14 offen
    s_mov_b32 s15, 3072
    buffer_load_dwordx2 v[18:19], v3, s[8:11], s15 offen
    s_mov_b32 s16, 6144
    buffer_load_dwordx2 v[20:21], v3, s[8:11], s16 offen
    s_mov_b32 s17, 9216
    buffer_load_dwordx2 v[22:23], v3, s[8:11], s17 offen
    s_mov_b32 s14, 12288
    buffer_load_dwordx2 v[24:25], v3, s[8:11], s14 offen
    s_mov_b32 s15, 15360
    buffer_load_dwordx2 v[26:27], v3, s[8:11], s15 offen
    s_mov_b32 s16, 18432
    buffer_load_dwordx2 v[28:29], v3, s[8:11], s16 offen
    s_mov_b32 s17, 21504
    buffer_load_dwordx2 v[30:31], v3, s[8:11], s17 offen
    s_mov_b32 s14, 24576
    buffer_load_dwordx2 v[32:33], v3, s[8:11], s14 offen
    s_mov_b32 s15, 27648
    buffer_load_dwordx2 v[34:35], v3, s[8:11], s15 offen
    s_mov_b32 s16, 30720
    buffer_load_dwordx2 v[36:37], v3, s[8:11], s16 offen
    s_mov_b32 s17, 33792
    buffer_load_dwordx2 v[38:39], v3, s[8:11], s17 offen
    s_mov_b32 s14, 36864
    buffer_load_dwordx2 v[40:41], v3, s[8:11], s14 offen
    s_mov_b32 s15, 39936
    buffer_load_dwordx2 v[42:43], v3, s[8:11], s15 offen
    s_mov_b32 s16, 43008
    buffer_load_dwordx2 v[44:45], v3, s[8:11], s16 offen
    s_mov_b32 s17, 46080
    buffer_load_dwordx2 v[46:47], v3, s[8:11], s17 offen
    s_mov_b32 s14, 49152
    buffer_load_dwordx2 v[48:49], v3, s[8:11], s14 offen
    s_mov_b32 s15, 52224
    buffer_load_dwordx2 v[50:51], v3, s[8:11], s15 offen
    s_mov_b32 s16, 55296
    buffer_load_dwordx2 v[52:53], v3, s[8:11], s16 offen
    s_mov_b32 s17, 58368
    buffer_load_dwordx2 v[54:55], v3, s[8:11], s17 offen
    s_mov_b32 s14, 61440
    buffer_load_dwordx2 v[56:57], v3, s[8:11], s14 offen
    s_mov_b32 s15, 64512
    buffer_load_dwordx2 v[58:59], v3, s[8:11], s15 offen
    s_mov_b32 s16, 67584
    buffer_load_dwordx2 v[60:61], v3, s[8:11], s16 offen
    s_mov_b32 s17, 70656
    buffer_load_dwordx2 v[62:63], v3, s[8:11], s17 offen
    s_mov_b32 s14, 73728
    buffer_load_dwordx2 v[64:65], v3, s[8:11], s14 offen
    s_mov_b32 s15, 76800
    buffer_load_dwordx2 v[66:67], v3, s[8:11], s15 offen
    s_mov_b32 s16, 79872
    buffer_load_dwordx2 v[68:69], v3, s[8:11], s16 offen
    s_mov_b32 s17, 82944
    buffer_load_dwordx2 v[70:71], v3, s[8:11], s17 offen
    s_mov_b32 s14, 86016
    buffer_load_dwordx2 v[72:73], v3, s[8:11], s14 offen
    s_mov_b32 s15, 89088
    buffer_load_dwordx2 v[74:75], v3, s[8:11], s15 offen
    s_mov_b32 s16, 92160
    buffer_load_dwordx2 v[76:77], v3, s[8:11], s16 offen
    s_mov_b32 s17, 95232
    buffer_load_dwordx2 v[78:79], v3, s[8:11], s17 offen
    s_mov_b32 s14, 98304
    buffer_load_dwordx2 v[80:81], v3, s[8:11], s14 offen
    s_mov_b32 s15, 101376
    buffer_load_dwordx2 v[82:83], v3, s[8:11], s15 offen
    s_mov_b32 s16, 104448
    buffer_load_dwordx2 v[84:85], v3, s[8:11], s16 offen
    s_mov_b32 s17, 107520
    buffer_load_dwordx2 v[86:87], v3, s[8:11], s17 offen
    s_mov_b32 s14, 110592
    buffer_load_dwordx2 v[88:89], v3, s[8:11], s14 offen
    s_mov_b32 s15, 113664
    buffer_load_dwordx2 v[90:91], v3, s[8:11], s15 offen
    s_mov_b32 s16, 116736
    buffer_load_dwordx2 v[92:93], v3, s[8:11], s16 offen
    s_mov_b32 s17, 119808
    buffer_load_dwordx2 v[94:95], v3, s[8:11], s17 offen
    v_mov_b32 v8, 0
    v_mov_b32 v9, 0
    v_mov_b32 v10, 0
    v_mov_b32 v11, 0
    s_waitcnt vmcnt(39)
    v_lshlrev_b32 v12, 16, v16
    v_and_b32 v13, 0xffff0000, v16
    v_add_f32 v8, v8, v12
    v_add_f32 v9, v9, v13
    v_lshlrev_b32 v12, 16, v17
    v_and_b32 v13, 0xffff0000, v17
    v_add_f32 v10, v10, v12
    v_add_f32 v11, v11, v13
    s_waitcnt vmcnt(38)
    v_lshlrev_b32 v12, 16, v18
    v_and_b32 v13, 0xffff0000, v18
    v_add_f32 v8, v8, v12
    v_add_f32 v9, v9, v13
    v_lshlrev_b32 v12, 16, v19
    v_and_b32 v13, 0xffff0000, v19
    v_add_f32 v10, v10, v12
    v_add_f32 v11, v11, v13
    s_waitcnt vmcnt(37)
    v_lshlrev_b32 v12, 16, v20
    v_and_b32 v13, 0xffff0000, v20
    v_add_f32 v8, v8, v12
    v_add_f32 v9, v9, v13
    v_lshlrev_b32 v12, 16, v21
    v_and_b32 v13, 0xffff0000, v21
    v_add_f32 v10, v10, v12
    v_add_f32 v11, v11, v13
    s_waitcnt vmcnt(36)
    v_lshlrev_b32 v12, 16, v22
    v_and_b32 v13, 0xffff0000, v22
    v_add_f32 v8, v8, v12
    v_add_f32 v9, v9, v13
    v_lshlrev_b32 v12, 16, v23
    v_and_b32 v13, 0xffff0000, v23
    v_add_f32 v10, v10, v12
    v_add_f32 v11, v11, v13
    s_waitcnt vmcnt(35)
    v_lshlrev_b32 v12, 16, v24
    v_and_b32 v13, 0xffff0000, v24
    v_add_f32 v8, v8, v12
    v_add_f32 v9, v9, v13
    v_lshlrev_b32 v12, 16, v25
    v_and_b32 v13, 0xffff0000, v25
    v_add_f32 v10, v10, v12
    v_add_f32 v11, v11, v13
    s_waitcnt vmcnt(34)
    v_lshlrev_b32 v12, 16, v26
    v_and_b32 v13, 0xffff0000, v26
    v_add_f32 v8, v8, v12
    v_add_f32 v9, v9, v13
    v_lshlrev_b32 v12, 16, v27
    v_and_b32 v13, 0xffff0000, v27
    v_add_f32 v10, v10, v12
    v_add_f32 v11, v11, v13
    s_waitcnt vmcnt(33)
    v_lshlrev_b32 v12, 16, v28
    v_and_b32 v13, 0xffff0000, v28
    v_add_f32 v8, v8, v12
    v_add_f32 v9, v9, v13
    v_lshlrev_b32 v12, 16, v29
    v_and_b32 v13, 0xffff0000, v29
    v_add_f32 v10, v10, v12
    v_add_f32 v11, v11, v13
    s_waitcnt vmcnt(32)
    v_lshlrev_b32 v12, 16, v30
    v_and_b32 v13, 0xffff0000, v30
    v_add_f32 v8, v8, v12
    v_add_f32 v9, v9, v13
    v_lshlrev_b32 v12, 16, v31
    v_and_b32 v13, 0xffff0000, v31
    v_add_f32 v10, v10, v12
    v_add_f32 v11, v11, v13
    s_waitcnt vmcnt(31)
    v_lshlrev_b32 v12, 16, v32
    v_and_b32 v13, 0xffff0000, v32
    v_add_f32 v8, v8, v12
    v_add_f32 v9, v9, v13
    v_lshlrev_b32 v12, 16, v33
    v_and_b32 v13, 0xffff0000, v33
    v_add_f32 v10, v10, v12
    v_add_f32 v11, v11, v13
    s_waitcnt vmcnt(30)
    v_lshlrev_b32 v12, 16, v34
    v_and_b32 v13, 0xffff0000, v34
    v_add_f32 v8, v8, v12
    v_add_f32 v9, v9, v13
    v_lshlrev_b32 v12, 16, v35
    v_and_b32 v13, 0xffff0000, v35
    v_add_f32 v10, v10, v12
    v_add_f32 v11, v11, v13
    s_waitcnt vmcnt(29)
    v_lshlrev_b32 v12, 16, v36
    v_and_b32 v13, 0xffff0000, v36
    v_add_f32 v8, v8, v12
    v_add_f32 v9, v9, v13
    v_lshlrev_b32 v12, 16, v37
    v_and_b32 v13, 0xffff0000, v37
    v_add_f32 v10, v10, v12
    v_add_f32 v11, v11, v13
    s_waitcnt vmcnt(28)
    v_lshlrev_b32 v12, 16, v38
    v_and_b32 v13, 0xffff0000, v38
    v_add_f32 v8, v8, v12
    v_add_f32 v9, v9, v13
    v_lshlrev_b32 v12, 16, v39
    v_and_b32 v13, 0xffff0000, v39
    v_add_f32 v10, v10, v12
    v_add_f32 v11, v11, v13
    s_waitcnt vmcnt(27)
    v_lshlrev_b32 v12, 16, v40
    v_and_b32 v13, 0xffff0000, v40
    v_add_f32 v8, v8, v12
    v_add_f32 v9, v9, v13
    v_lshlrev_b32 v12, 16, v41
    v_and_b32 v13, 0xffff0000, v41
    v_add_f32 v10, v10, v12
    v_add_f32 v11, v11, v13
    s_waitcnt vmcnt(26)
    v_lshlrev_b32 v12, 16, v42
    v_and_b32 v13, 0xffff0000, v42
    v_add_f32 v8, v8, v12
    v_add_f32 v9, v9, v13
    v_lshlrev_b32 v12, 16, v43
    v_and_b32 v13, 0xffff0000, v43
    v_add_f32 v10, v10, v12
    v_add_f32 v11, v11, v13
    s_waitcnt vmcnt(25)
    v_lshlrev_b32 v12, 16, v44
    v_and_b32 v13, 0xffff0000, v44
    v_add_f32 v8, v8, v12
    v_add_f32 v9, v9, v13
    v_lshlrev_b32 v12, 16, v45
    v_and_b32 v13, 0xffff0000, v45
    v_add_f32 v10, v10, v12
    v_add_f32 v11, v11, v13
    s_waitcnt vmcnt(24)
    v_lshlrev_b32 v12, 16, v46
    v_and_b32 v13, 0xffff0000, v46
    v_add_f32 v8, v8, v12
    v_add_f32 v9, v9, v13
    v_lshlrev_b32 v12, 16, v47
    v_and_b32 v13, 0xffff0000, v47
    v_add_f32 v10, v10, v12
    v_add_f32 v11, v11, v13
    s_waitcnt vmcnt(23)
    v_lshlrev_b32 v12, 16, v48
    v_and_b32 v13, 0xffff0000, v48
    v_add_f32 v8, v8, v12
    v_add_f32 v9, v9, v13
    v_lshlrev_b32 v12, 16, v49
    v_and_b32 v13, 0xffff0000, v49
    v_add_f32 v10, v10, v12
    v_add_f32 v11, v11, v13
    s_waitcnt vmcnt(22)
    v_lshlrev_b32 v12, 16, v50
    v_and_b32 v13, 0xffff0000, v50
    v_add_f32 v8, v8, v12
    v_add_f32 v9, v9, v13
    v_lshlrev_b32 v12, 16, v51
    v_and_b32 v13, 0xffff0000, v51
    v_add_f32 v10, v10, v12
    v_add_f32 v11, v11, v13
    s_waitcnt vmcnt(21)
    v_lshlrev_b32 v12, 16, v52
    v_and_b32 v13, 0xffff0000, v52
    v_add_f32 v8, v8, v12
    v_add_f32 v9, v9, v13
    v_lshlrev_b32 v12, 16, v53
    v_and_b32 v13, 0xffff0000, v53
    v_add_f32 v10, v10, v12
    v_add_f32 v11, v11, v13
    s_waitcnt vmcnt(20)
    v_lshlrev_b32 v12, 16, v54
    v_and_b32 v13, 0xffff0000, v54
    v_add_f32 v8, v8, v12
    v_add_f32 v9, v9, v13
    v_lshlrev_b32 v12, 16, v55
    v_and_b32 v13, 0xffff0000, v55
    v_add_f32 v10, v10, v12
    v_add_f32 v11, v11, v13
    s_waitcnt vmcnt(19)
    v_lshlrev_b32 v12, 16, v56
    v_and_b32 v13, 0xffff0000, v56
    v_add_f32 v8, v8, v12
    v_add_f32 v9, v9, v13
    v_lshlrev_b32 v12, 16, v57
    v_and_b32 v13, 0xffff0000, v57
    v_add_f32 v10, v10, v12
    v_add_f32 v11, v11, v13
    s_waitcnt vmcnt(18)
    v_lshlrev_b32 v12, 16, v58
    v_and_b32 v13, 0xffff0000, v58
    v_add_f32 v8, v8, v12
    v_add_f32 v9, v9, v13
    v_lshlrev_b32 v12, 16, v59
    v_and_b32 v13, 0xffff0000, v59
    v_add_f32 v10, v10, v12
    v_add_f32 v11, v11, v13
    s_waitcnt vmcnt(17)
    v_lshlrev_b32 v12, 16, v60
    v_and_b32 v13, 0xffff0000, v60
    v_add_f32 v8, v8, v12
    v_add_f32 v9, v9, v13
    v_lshlrev_b32 v12, 16, v61
    v_and_b32 v13, 0xffff0000, v61
    v_add_f32 v10, v10, v12
    v_add_f32 v11, v11, v13
    s_waitcnt vmcnt(16)
    v_lshlrev_b32 v12, 16, v62
    v_and_b32 v13, 0xffff0000, v62
    v_add_f32 v8, v8, v12
    v_add_f32 v9, v9, v13
    v_lshlrev_b32 v12, 16, v63
    v_and_b32 v13, 0xffff0000, v63
    v_add_f32 v10, v10, v12
    v_add_f32 v11, v11, v13
    s_waitcnt vmcnt(15)
    v_lshlrev_b32 v12, 16, v64
    v_and_b32 v13, 0xffff0000, v64
    v_add_f32 v8, v8, v12
    v_add_f32 v9, v9, v13
    v_lshlrev_b32 v12, 16, v65
    v_and_b32 v13, 0xffff0000, v65
    v_add_f32 v10, v10, v12
    v_add_f32 v11, v11, v13
    s_waitcnt vmcnt(14)
    v_lshlrev_b32 v12, 16, v66
    v_and_b32 v13, 0xffff0000, v66
    v_add_f32 v8, v8, v12
    v_add_f32 v9, v9, v13
    v_lshlrev_b32 v12, 16, v67
    v_and_b32 v13, 0xffff0000, v67
    v_add_f32 v10, v10, v12
    v_add_f32 v11, v11, v13
    s_waitcnt vmcnt(13)
    v_lshlrev_b32 v12, 16, v68
    v_and_b32 v13, 0xffff0000, v68
    v_add_f32 v8, v8, v12
    v_add_f32 v9, v9, v13
    v_lshlrev_b32 v12, 16, v69
    v_and_b32 v13, 0xffff0000, v69
    v_add_f32 v10, v10, v12
    v_add_f32 v11, v11, v13
    s_waitcnt vmcnt(12)
    v_lshlrev_b32 v12, 16, v70
    v_and_b32 v13, 0xffff0000, v70
    v_add_f32 v8, v8, v12
    v_add_f32 v9, v9, v13
    v_lshlrev_b32 v12, 16, v71
    v_and_b32 v13, 0xffff0000, v71
    v_add_f32 v10, v10, v12
    v_add_f32 v11, v11, v13
    s_waitcnt vmcnt(11)
    v_lshlrev_b32 v12, 16, v72
    v_and_b32 v13, 0xffff0000, v72
    v_add_f32 v8, v8, v12
    v_add_f32 v9, v9, v13
    v_lshlrev_b32 v12, 16, v73
    v_and_b32 v13, 0xffff0000, v73
    v_add_f32 v10, v10, v12
    v_add_f32 v11, v11, v13
    s_waitcnt vmcnt(10)
    v_lshlrev_b32 v12, 16, v74
    v_and_b32 v13, 0xffff0000, v74
    v_add_f32 v8, v8, v12
    v_add_f32 v9, v9, v13
    v_lshlrev_b32 v12, 16, v75
    v_and_b32 v13, 0xffff0000, v75
    v_add_f32 v10, v10, v12
    v_add_f32 v11, v11, v13
    s_waitcnt vmcnt(9)
    v_lshlrev_b32 v12, 16, v76
    v_and_b32 v13, 0xffff0000, v76
    v_add_f32 v8, v8, v12
    v_add_f32 v9, v9, v13
    v_lshlrev_b32 v12, 16, v77
    v_and_b32 v13, 0xffff0000, v77
    v_add_f32 v10, v10, v12
    v_add_f32 v11, v11, v13
    s_waitcnt vmcnt(8)
    v_lshlrev_b32 v12, 16, v78
    v_and_b32 v13, 0xffff0000, v78
    v_add_f32 v8, v8, v12
    v_add_f32 v9, v9, v13
    v_lshlrev_b32 v12, 16, v79
    v_and_b32 v13, 0xffff0000, v79
    v_add_f32 v10, v10, v12
    v_add_f32 v11, v11, v13
    s_waitcnt vmcnt(7)
    v_lshlrev_b32 v12, 16, v80
    v_and_b32 v13, 0xffff0000, v80
    v_add_f32 v8, v8, v12
    v_add_f32 v9, v9, v13
    v_lshlrev_b32 v12, 16, v81
    v_and_b32 v13, 0xffff0000, v81
    v_add_f32 v10, v10, v12
    v_add_f32 v11, v11, v13
    s_waitcnt vmcnt(6)
    v_lshlrev_b32 v12, 16, v82
    v_and_b32 v13, 0xffff0000, v82
    v_add_f32 v8, v8, v12
    v_add_f32 v9, v9, v13
    v_lshlrev_b32 v12, 16, v83
    v_and_b32 v13, 0xffff0000, v83
    v_add_f32 v10, v10, v12
    v_add_f32 v11, v11, v13
    s_waitcnt vmcnt(5)
    v_lshlrev_b32 v12, 16, v84
    v_and_b32 v13, 0xffff0000, v84
    v_add_f32 v8, v8, v12
    v_add_f32 v9, v9, v13
    v_lshlrev_b32 v12, 16, v85
    v_and_b32 v13, 0xffff0000, v85
    v_add_f32 v10, v10, v12
    v_add_f32 v11, v11, v13
    s_waitcnt vmcnt(4)
    v_lshlrev_b32 v12, 16, v86
    v_and_b32 v13, 0xffff0000, v86
    v_add_f32 v8, v8, v12
    v_add_f32 v9, v9, v13
    v_lshlrev_b32 v12, 16, v87
    v_and_b32 v13, 0xffff0000, v87
    v_add_f32 v10, v10, v12
    v_add_f32 v11, v11, v13
    s_waitcnt vmcnt(3)
    v_lshlrev_b32 v12, 16, v88
    v_and_b32 v13, 0xffff0000, v88
    v_add_f32 v8, v8, v12
    v_add_f32 v9, v9, v13
    v_lshlrev_b32 v12, 16, v89
    v_and_b32 v13, 0xffff0000, v89
    v_add_f32 v10, v10, v12
    v_add_f32 v11, v11, v13
    s_waitcnt vmcnt(2)
    v_lshlrev_b32 v12, 16, v90
    v_and_b32 v13, 0xffff0000, v90
    v_add_f32 v8, v8, v12
    v_add_f32 v9, v9, v13
    v_lshlrev_b32 v12, 16, v91
    v_and_b32 v13, 0xffff0000, v91
    v_add_f32 v10, v10, v12
    v_add_f32 v11, v11, v13
    s_waitcnt vmcnt(1)
    v_lshlrev_b32 v12, 16, v92
    v_and_b32 v13, 0xffff0000, v92
    v_add_f32 v8, v8, v12
    v_add_f32 v9, v9, v13
    v_lshlrev_b32 v12, 16, v93
    v_and_b32 v13, 0xffff0000, v93
    v_add_f32 v10, v10, v12
    v_add_f32 v11, v11, v13
    s_waitcnt vmcnt(0)
    v_lshlrev_b32 v12, 16, v94
    v_and_b32 v13, 0xffff0000, v94
    v_add_f32 v8, v8, v12
    v_add_f32 v9, v9, v13
    v_lshlrev_b32 v12, 16, v95
    v_and_b32 v13, 0xffff0000, v95
    v_add_f32 v10, v10, v12
    v_add_f32 v11, v11, v13
    v_lshlrev_b32 v4, 4, v0
    ds_write_b128 v4, v[8:11]
    s_waitcnt lgkmcnt(0)
    s_barrier
    v_lshlrev_b32 v4, 2, v0
    ds_read_b32 v16, v4 offset:0
    ds_read_b32 v17, v4 offset:256
    ds_read_b32 v18, v4 offset:512
    ds_read_b32 v19, v4 offset:768
    ds_read_b32 v20, v4 offset:1024
    ds_read_b32 v21, v4 offset:1280
    ds_read_b32 v22, v4 offset:1536
    ds_read_b32 v23, v4 offset:1792
    ds_read_b32 v24, v4 offset:2048
    ds_read_b32 v25, v4 offset:2304
    ds_read_b32 v26, v4 offset:2560
    ds_read_b32 v27, v4 offset:2816
    ds_read_b32 v28, v4 offset:3072
    ds_read_b32 v29, v4 offset:3328
    ds_read_b32 v30, v4 offset:3584
    ds_read_b32 v31, v4 offset:3840
    v_lshrrev_b32 v2, 2, v0
    v_lshlrev_b32 v2, 2, v2
    v_add_u32 v2, s12, v2
    v_lshrrev_b32 v7, 5, v2
    v_bfe_u32 v8, v2, 2, 1
    v_bfe_u32 v6, v2, 3, 2
    v_lshlrev_b32 v6, 2, v6
    v_lshlrev_b32 v5, 2, v7
    v_add_u32 v5, v5, v8
    v_lshlrev_b32 v5, 4, v5
    v_add_u32 v5, v5, v6
    v_and_b32 v6, 3, v0
    v_add_u32 v5, v5, v6
    v_lshlrev_b32 v5, 2, v5
    s_waitcnt lgkmcnt(0)
    v_add_f32 v16, v16, v17
    v_add_f32 v16, v16, v18
    v_add_f32 v16, v16, v19
    v_add_f32 v16, v16, v20
    v_add_f32 v16, v16, v21
    v_add_f32 v16, v16, v22
    v_add_f32 v16, v16, v23
    v_add_f32 v16, v16, v24
    v_add_f32 v16, v16, v25
    v_add_f32 v16, v16, v26
    v_add_f32 v16, v16, v27
    v_add_f32 v16, v16, v28
    v_add_f32 v16, v16, v29
    v_add_f32 v16, v16, v30
    v_add_f32 v16, v16, v31
    s_mov_b32 s22, 9248768
    v_cmp_gt_u32 vcc, 64, v0
    s_nop 1
    s_and_saveexec_b64 s[24:25], vcc
    s_nop 1
    s_cbranch_execz prep_kernel_end
    buffer_store_dword v16, v5, s[4:7], s22 offen
    s_endpgm
prep_kernel_csu:
    s_load_dwordx2 s[8:9], s[0:1], 40
    s_sub_u32 s12, s2, 182
    s_lshl_b32 s12, s12, 6
    v_lshrrev_b32 v1, 4, v0
    v_and_b32 v2, 15, v0
    v_mul_u32_u24 v3, 40, v1
    s_mov_b32 s13, 3072
    v_mul_lo_u32 v3, v3, s13
    v_lshlrev_b32 v4, 3, v2
    v_add_u32 v3, v3, v4
    s_lshl_b32 s14, s12, 1
    v_add_u32 v3, s14, v3
    s_waitcnt lgkmcnt(0)
    s_and_b32 s5, s5, 0xffff
    s_mov_b32 s6, 268435456
    s_mov_b32 s7, 0x00020000
    s_and_b32 s9, s9, 0xffff
    s_mov_b32 s10, 1966080
    s_mov_b32 s11, 0x00020000
    s_mov_b32 s14, 0
    buffer_load_dwordx2 v[16:17], v3, s[8:11], s14 offen
    s_mov_b32 s15, 3072
    buffer_load_dwordx2 v[18:19], v3, s[8:11], s15 offen
    s_mov_b32 s16, 6144
    buffer_load_dwordx2 v[20:21], v3, s[8:11], s16 offen
    s_mov_b32 s17, 9216
    buffer_load_dwordx2 v[22:23], v3, s[8:11], s17 offen
    s_mov_b32 s14, 12288
    buffer_load_dwordx2 v[24:25], v3, s[8:11], s14 offen
    s_mov_b32 s15, 15360
    buffer_load_dwordx2 v[26:27], v3, s[8:11], s15 offen
    s_mov_b32 s16, 18432
    buffer_load_dwordx2 v[28:29], v3, s[8:11], s16 offen
    s_mov_b32 s17, 21504
    buffer_load_dwordx2 v[30:31], v3, s[8:11], s17 offen
    s_mov_b32 s14, 24576
    buffer_load_dwordx2 v[32:33], v3, s[8:11], s14 offen
    s_mov_b32 s15, 27648
    buffer_load_dwordx2 v[34:35], v3, s[8:11], s15 offen
    s_mov_b32 s16, 30720
    buffer_load_dwordx2 v[36:37], v3, s[8:11], s16 offen
    s_mov_b32 s17, 33792
    buffer_load_dwordx2 v[38:39], v3, s[8:11], s17 offen
    s_mov_b32 s14, 36864
    buffer_load_dwordx2 v[40:41], v3, s[8:11], s14 offen
    s_mov_b32 s15, 39936
    buffer_load_dwordx2 v[42:43], v3, s[8:11], s15 offen
    s_mov_b32 s16, 43008
    buffer_load_dwordx2 v[44:45], v3, s[8:11], s16 offen
    s_mov_b32 s17, 46080
    buffer_load_dwordx2 v[46:47], v3, s[8:11], s17 offen
    s_mov_b32 s14, 49152
    buffer_load_dwordx2 v[48:49], v3, s[8:11], s14 offen
    s_mov_b32 s15, 52224
    buffer_load_dwordx2 v[50:51], v3, s[8:11], s15 offen
    s_mov_b32 s16, 55296
    buffer_load_dwordx2 v[52:53], v3, s[8:11], s16 offen
    s_mov_b32 s17, 58368
    buffer_load_dwordx2 v[54:55], v3, s[8:11], s17 offen
    s_mov_b32 s14, 61440
    buffer_load_dwordx2 v[56:57], v3, s[8:11], s14 offen
    s_mov_b32 s15, 64512
    buffer_load_dwordx2 v[58:59], v3, s[8:11], s15 offen
    s_mov_b32 s16, 67584
    buffer_load_dwordx2 v[60:61], v3, s[8:11], s16 offen
    s_mov_b32 s17, 70656
    buffer_load_dwordx2 v[62:63], v3, s[8:11], s17 offen
    s_mov_b32 s14, 73728
    buffer_load_dwordx2 v[64:65], v3, s[8:11], s14 offen
    s_mov_b32 s15, 76800
    buffer_load_dwordx2 v[66:67], v3, s[8:11], s15 offen
    s_mov_b32 s16, 79872
    buffer_load_dwordx2 v[68:69], v3, s[8:11], s16 offen
    s_mov_b32 s17, 82944
    buffer_load_dwordx2 v[70:71], v3, s[8:11], s17 offen
    s_mov_b32 s14, 86016
    buffer_load_dwordx2 v[72:73], v3, s[8:11], s14 offen
    s_mov_b32 s15, 89088
    buffer_load_dwordx2 v[74:75], v3, s[8:11], s15 offen
    s_mov_b32 s16, 92160
    buffer_load_dwordx2 v[76:77], v3, s[8:11], s16 offen
    s_mov_b32 s17, 95232
    buffer_load_dwordx2 v[78:79], v3, s[8:11], s17 offen
    s_mov_b32 s14, 98304
    buffer_load_dwordx2 v[80:81], v3, s[8:11], s14 offen
    s_mov_b32 s15, 101376
    buffer_load_dwordx2 v[82:83], v3, s[8:11], s15 offen
    s_mov_b32 s16, 104448
    buffer_load_dwordx2 v[84:85], v3, s[8:11], s16 offen
    s_mov_b32 s17, 107520
    buffer_load_dwordx2 v[86:87], v3, s[8:11], s17 offen
    s_mov_b32 s14, 110592
    buffer_load_dwordx2 v[88:89], v3, s[8:11], s14 offen
    s_mov_b32 s15, 113664
    buffer_load_dwordx2 v[90:91], v3, s[8:11], s15 offen
    s_mov_b32 s16, 116736
    buffer_load_dwordx2 v[92:93], v3, s[8:11], s16 offen
    s_mov_b32 s17, 119808
    buffer_load_dwordx2 v[94:95], v3, s[8:11], s17 offen
    v_mov_b32 v8, 0
    v_mov_b32 v9, 0
    v_mov_b32 v10, 0
    v_mov_b32 v11, 0
    s_waitcnt vmcnt(39)
    v_lshlrev_b32 v12, 16, v16
    v_and_b32 v13, 0xffff0000, v16
    v_add_f32 v8, v8, v12
    v_add_f32 v9, v9, v13
    v_lshlrev_b32 v12, 16, v17
    v_and_b32 v13, 0xffff0000, v17
    v_add_f32 v10, v10, v12
    v_add_f32 v11, v11, v13
    s_waitcnt vmcnt(38)
    v_lshlrev_b32 v12, 16, v18
    v_and_b32 v13, 0xffff0000, v18
    v_add_f32 v8, v8, v12
    v_add_f32 v9, v9, v13
    v_lshlrev_b32 v12, 16, v19
    v_and_b32 v13, 0xffff0000, v19
    v_add_f32 v10, v10, v12
    v_add_f32 v11, v11, v13
    s_waitcnt vmcnt(37)
    v_lshlrev_b32 v12, 16, v20
    v_and_b32 v13, 0xffff0000, v20
    v_add_f32 v8, v8, v12
    v_add_f32 v9, v9, v13
    v_lshlrev_b32 v12, 16, v21
    v_and_b32 v13, 0xffff0000, v21
    v_add_f32 v10, v10, v12
    v_add_f32 v11, v11, v13
    s_waitcnt vmcnt(36)
    v_lshlrev_b32 v12, 16, v22
    v_and_b32 v13, 0xffff0000, v22
    v_add_f32 v8, v8, v12
    v_add_f32 v9, v9, v13
    v_lshlrev_b32 v12, 16, v23
    v_and_b32 v13, 0xffff0000, v23
    v_add_f32 v10, v10, v12
    v_add_f32 v11, v11, v13
    s_waitcnt vmcnt(35)
    v_lshlrev_b32 v12, 16, v24
    v_and_b32 v13, 0xffff0000, v24
    v_add_f32 v8, v8, v12
    v_add_f32 v9, v9, v13
    v_lshlrev_b32 v12, 16, v25
    v_and_b32 v13, 0xffff0000, v25
    v_add_f32 v10, v10, v12
    v_add_f32 v11, v11, v13
    s_waitcnt vmcnt(34)
    v_lshlrev_b32 v12, 16, v26
    v_and_b32 v13, 0xffff0000, v26
    v_add_f32 v8, v8, v12
    v_add_f32 v9, v9, v13
    v_lshlrev_b32 v12, 16, v27
    v_and_b32 v13, 0xffff0000, v27
    v_add_f32 v10, v10, v12
    v_add_f32 v11, v11, v13
    s_waitcnt vmcnt(33)
    v_lshlrev_b32 v12, 16, v28
    v_and_b32 v13, 0xffff0000, v28
    v_add_f32 v8, v8, v12
    v_add_f32 v9, v9, v13
    v_lshlrev_b32 v12, 16, v29
    v_and_b32 v13, 0xffff0000, v29
    v_add_f32 v10, v10, v12
    v_add_f32 v11, v11, v13
    s_waitcnt vmcnt(32)
    v_lshlrev_b32 v12, 16, v30
    v_and_b32 v13, 0xffff0000, v30
    v_add_f32 v8, v8, v12
    v_add_f32 v9, v9, v13
    v_lshlrev_b32 v12, 16, v31
    v_and_b32 v13, 0xffff0000, v31
    v_add_f32 v10, v10, v12
    v_add_f32 v11, v11, v13
    s_waitcnt vmcnt(31)
    v_lshlrev_b32 v12, 16, v32
    v_and_b32 v13, 0xffff0000, v32
    v_add_f32 v8, v8, v12
    v_add_f32 v9, v9, v13
    v_lshlrev_b32 v12, 16, v33
    v_and_b32 v13, 0xffff0000, v33
    v_add_f32 v10, v10, v12
    v_add_f32 v11, v11, v13
    s_waitcnt vmcnt(30)
    v_lshlrev_b32 v12, 16, v34
    v_and_b32 v13, 0xffff0000, v34
    v_add_f32 v8, v8, v12
    v_add_f32 v9, v9, v13
    v_lshlrev_b32 v12, 16, v35
    v_and_b32 v13, 0xffff0000, v35
    v_add_f32 v10, v10, v12
    v_add_f32 v11, v11, v13
    s_waitcnt vmcnt(29)
    v_lshlrev_b32 v12, 16, v36
    v_and_b32 v13, 0xffff0000, v36
    v_add_f32 v8, v8, v12
    v_add_f32 v9, v9, v13
    v_lshlrev_b32 v12, 16, v37
    v_and_b32 v13, 0xffff0000, v37
    v_add_f32 v10, v10, v12
    v_add_f32 v11, v11, v13
    s_waitcnt vmcnt(28)
    v_lshlrev_b32 v12, 16, v38
    v_and_b32 v13, 0xffff0000, v38
    v_add_f32 v8, v8, v12
    v_add_f32 v9, v9, v13
    v_lshlrev_b32 v12, 16, v39
    v_and_b32 v13, 0xffff0000, v39
    v_add_f32 v10, v10, v12
    v_add_f32 v11, v11, v13
    s_waitcnt vmcnt(27)
    v_lshlrev_b32 v12, 16, v40
    v_and_b32 v13, 0xffff0000, v40
    v_add_f32 v8, v8, v12
    v_add_f32 v9, v9, v13
    v_lshlrev_b32 v12, 16, v41
    v_and_b32 v13, 0xffff0000, v41
    v_add_f32 v10, v10, v12
    v_add_f32 v11, v11, v13
    s_waitcnt vmcnt(26)
    v_lshlrev_b32 v12, 16, v42
    v_and_b32 v13, 0xffff0000, v42
    v_add_f32 v8, v8, v12
    v_add_f32 v9, v9, v13
    v_lshlrev_b32 v12, 16, v43
    v_and_b32 v13, 0xffff0000, v43
    v_add_f32 v10, v10, v12
    v_add_f32 v11, v11, v13
    s_waitcnt vmcnt(25)
    v_lshlrev_b32 v12, 16, v44
    v_and_b32 v13, 0xffff0000, v44
    v_add_f32 v8, v8, v12
    v_add_f32 v9, v9, v13
    v_lshlrev_b32 v12, 16, v45
    v_and_b32 v13, 0xffff0000, v45
    v_add_f32 v10, v10, v12
    v_add_f32 v11, v11, v13
    s_waitcnt vmcnt(24)
    v_lshlrev_b32 v12, 16, v46
    v_and_b32 v13, 0xffff0000, v46
    v_add_f32 v8, v8, v12
    v_add_f32 v9, v9, v13
    v_lshlrev_b32 v12, 16, v47
    v_and_b32 v13, 0xffff0000, v47
    v_add_f32 v10, v10, v12
    v_add_f32 v11, v11, v13
    s_waitcnt vmcnt(23)
    v_lshlrev_b32 v12, 16, v48
    v_and_b32 v13, 0xffff0000, v48
    v_add_f32 v8, v8, v12
    v_add_f32 v9, v9, v13
    v_lshlrev_b32 v12, 16, v49
    v_and_b32 v13, 0xffff0000, v49
    v_add_f32 v10, v10, v12
    v_add_f32 v11, v11, v13
    s_waitcnt vmcnt(22)
    v_lshlrev_b32 v12, 16, v50
    v_and_b32 v13, 0xffff0000, v50
    v_add_f32 v8, v8, v12
    v_add_f32 v9, v9, v13
    v_lshlrev_b32 v12, 16, v51
    v_and_b32 v13, 0xffff0000, v51
    v_add_f32 v10, v10, v12
    v_add_f32 v11, v11, v13
    s_waitcnt vmcnt(21)
    v_lshlrev_b32 v12, 16, v52
    v_and_b32 v13, 0xffff0000, v52
    v_add_f32 v8, v8, v12
    v_add_f32 v9, v9, v13
    v_lshlrev_b32 v12, 16, v53
    v_and_b32 v13, 0xffff0000, v53
    v_add_f32 v10, v10, v12
    v_add_f32 v11, v11, v13
    s_waitcnt vmcnt(20)
    v_lshlrev_b32 v12, 16, v54
    v_and_b32 v13, 0xffff0000, v54
    v_add_f32 v8, v8, v12
    v_add_f32 v9, v9, v13
    v_lshlrev_b32 v12, 16, v55
    v_and_b32 v13, 0xffff0000, v55
    v_add_f32 v10, v10, v12
    v_add_f32 v11, v11, v13
    s_waitcnt vmcnt(19)
    v_lshlrev_b32 v12, 16, v56
    v_and_b32 v13, 0xffff0000, v56
    v_add_f32 v8, v8, v12
    v_add_f32 v9, v9, v13
    v_lshlrev_b32 v12, 16, v57
    v_and_b32 v13, 0xffff0000, v57
    v_add_f32 v10, v10, v12
    v_add_f32 v11, v11, v13
    s_waitcnt vmcnt(18)
    v_lshlrev_b32 v12, 16, v58
    v_and_b32 v13, 0xffff0000, v58
    v_add_f32 v8, v8, v12
    v_add_f32 v9, v9, v13
    v_lshlrev_b32 v12, 16, v59
    v_and_b32 v13, 0xffff0000, v59
    v_add_f32 v10, v10, v12
    v_add_f32 v11, v11, v13
    s_waitcnt vmcnt(17)
    v_lshlrev_b32 v12, 16, v60
    v_and_b32 v13, 0xffff0000, v60
    v_add_f32 v8, v8, v12
    v_add_f32 v9, v9, v13
    v_lshlrev_b32 v12, 16, v61
    v_and_b32 v13, 0xffff0000, v61
    v_add_f32 v10, v10, v12
    v_add_f32 v11, v11, v13
    s_waitcnt vmcnt(16)
    v_lshlrev_b32 v12, 16, v62
    v_and_b32 v13, 0xffff0000, v62
    v_add_f32 v8, v8, v12
    v_add_f32 v9, v9, v13
    v_lshlrev_b32 v12, 16, v63
    v_and_b32 v13, 0xffff0000, v63
    v_add_f32 v10, v10, v12
    v_add_f32 v11, v11, v13
    s_waitcnt vmcnt(15)
    v_lshlrev_b32 v12, 16, v64
    v_and_b32 v13, 0xffff0000, v64
    v_add_f32 v8, v8, v12
    v_add_f32 v9, v9, v13
    v_lshlrev_b32 v12, 16, v65
    v_and_b32 v13, 0xffff0000, v65
    v_add_f32 v10, v10, v12
    v_add_f32 v11, v11, v13
    s_waitcnt vmcnt(14)
    v_lshlrev_b32 v12, 16, v66
    v_and_b32 v13, 0xffff0000, v66
    v_add_f32 v8, v8, v12
    v_add_f32 v9, v9, v13
    v_lshlrev_b32 v12, 16, v67
    v_and_b32 v13, 0xffff0000, v67
    v_add_f32 v10, v10, v12
    v_add_f32 v11, v11, v13
    s_waitcnt vmcnt(13)
    v_lshlrev_b32 v12, 16, v68
    v_and_b32 v13, 0xffff0000, v68
    v_add_f32 v8, v8, v12
    v_add_f32 v9, v9, v13
    v_lshlrev_b32 v12, 16, v69
    v_and_b32 v13, 0xffff0000, v69
    v_add_f32 v10, v10, v12
    v_add_f32 v11, v11, v13
    s_waitcnt vmcnt(12)
    v_lshlrev_b32 v12, 16, v70
    v_and_b32 v13, 0xffff0000, v70
    v_add_f32 v8, v8, v12
    v_add_f32 v9, v9, v13
    v_lshlrev_b32 v12, 16, v71
    v_and_b32 v13, 0xffff0000, v71
    v_add_f32 v10, v10, v12
    v_add_f32 v11, v11, v13
    s_waitcnt vmcnt(11)
    v_lshlrev_b32 v12, 16, v72
    v_and_b32 v13, 0xffff0000, v72
    v_add_f32 v8, v8, v12
    v_add_f32 v9, v9, v13
    v_lshlrev_b32 v12, 16, v73
    v_and_b32 v13, 0xffff0000, v73
    v_add_f32 v10, v10, v12
    v_add_f32 v11, v11, v13
    s_waitcnt vmcnt(10)
    v_lshlrev_b32 v12, 16, v74
    v_and_b32 v13, 0xffff0000, v74
    v_add_f32 v8, v8, v12
    v_add_f32 v9, v9, v13
    v_lshlrev_b32 v12, 16, v75
    v_and_b32 v13, 0xffff0000, v75
    v_add_f32 v10, v10, v12
    v_add_f32 v11, v11, v13
    s_waitcnt vmcnt(9)
    v_lshlrev_b32 v12, 16, v76
    v_and_b32 v13, 0xffff0000, v76
    v_add_f32 v8, v8, v12
    v_add_f32 v9, v9, v13
    v_lshlrev_b32 v12, 16, v77
    v_and_b32 v13, 0xffff0000, v77
    v_add_f32 v10, v10, v12
    v_add_f32 v11, v11, v13
    s_waitcnt vmcnt(8)
    v_lshlrev_b32 v12, 16, v78
    v_and_b32 v13, 0xffff0000, v78
    v_add_f32 v8, v8, v12
    v_add_f32 v9, v9, v13
    v_lshlrev_b32 v12, 16, v79
    v_and_b32 v13, 0xffff0000, v79
    v_add_f32 v10, v10, v12
    v_add_f32 v11, v11, v13
    s_waitcnt vmcnt(7)
    v_lshlrev_b32 v12, 16, v80
    v_and_b32 v13, 0xffff0000, v80
    v_add_f32 v8, v8, v12
    v_add_f32 v9, v9, v13
    v_lshlrev_b32 v12, 16, v81
    v_and_b32 v13, 0xffff0000, v81
    v_add_f32 v10, v10, v12
    v_add_f32 v11, v11, v13
    s_waitcnt vmcnt(6)
    v_lshlrev_b32 v12, 16, v82
    v_and_b32 v13, 0xffff0000, v82
    v_add_f32 v8, v8, v12
    v_add_f32 v9, v9, v13
    v_lshlrev_b32 v12, 16, v83
    v_and_b32 v13, 0xffff0000, v83
    v_add_f32 v10, v10, v12
    v_add_f32 v11, v11, v13
    s_waitcnt vmcnt(5)
    v_lshlrev_b32 v12, 16, v84
    v_and_b32 v13, 0xffff0000, v84
    v_add_f32 v8, v8, v12
    v_add_f32 v9, v9, v13
    v_lshlrev_b32 v12, 16, v85
    v_and_b32 v13, 0xffff0000, v85
    v_add_f32 v10, v10, v12
    v_add_f32 v11, v11, v13
    s_waitcnt vmcnt(4)
    v_lshlrev_b32 v12, 16, v86
    v_and_b32 v13, 0xffff0000, v86
    v_add_f32 v8, v8, v12
    v_add_f32 v9, v9, v13
    v_lshlrev_b32 v12, 16, v87
    v_and_b32 v13, 0xffff0000, v87
    v_add_f32 v10, v10, v12
    v_add_f32 v11, v11, v13
    s_waitcnt vmcnt(3)
    v_lshlrev_b32 v12, 16, v88
    v_and_b32 v13, 0xffff0000, v88
    v_add_f32 v8, v8, v12
    v_add_f32 v9, v9, v13
    v_lshlrev_b32 v12, 16, v89
    v_and_b32 v13, 0xffff0000, v89
    v_add_f32 v10, v10, v12
    v_add_f32 v11, v11, v13
    s_waitcnt vmcnt(2)
    v_lshlrev_b32 v12, 16, v90
    v_and_b32 v13, 0xffff0000, v90
    v_add_f32 v8, v8, v12
    v_add_f32 v9, v9, v13
    v_lshlrev_b32 v12, 16, v91
    v_and_b32 v13, 0xffff0000, v91
    v_add_f32 v10, v10, v12
    v_add_f32 v11, v11, v13
    s_waitcnt vmcnt(1)
    v_lshlrev_b32 v12, 16, v92
    v_and_b32 v13, 0xffff0000, v92
    v_add_f32 v8, v8, v12
    v_add_f32 v9, v9, v13
    v_lshlrev_b32 v12, 16, v93
    v_and_b32 v13, 0xffff0000, v93
    v_add_f32 v10, v10, v12
    v_add_f32 v11, v11, v13
    s_waitcnt vmcnt(0)
    v_lshlrev_b32 v12, 16, v94
    v_and_b32 v13, 0xffff0000, v94
    v_add_f32 v8, v8, v12
    v_add_f32 v9, v9, v13
    v_lshlrev_b32 v12, 16, v95
    v_and_b32 v13, 0xffff0000, v95
    v_add_f32 v10, v10, v12
    v_add_f32 v11, v11, v13
    v_lshlrev_b32 v4, 4, v0
    ds_write_b128 v4, v[8:11]
    s_waitcnt lgkmcnt(0)
    s_barrier
    v_lshlrev_b32 v4, 2, v0
    ds_read_b32 v16, v4 offset:0
    ds_read_b32 v17, v4 offset:256
    ds_read_b32 v18, v4 offset:512
    ds_read_b32 v19, v4 offset:768
    ds_read_b32 v20, v4 offset:1024
    ds_read_b32 v21, v4 offset:1280
    ds_read_b32 v22, v4 offset:1536
    ds_read_b32 v23, v4 offset:1792
    ds_read_b32 v24, v4 offset:2048
    ds_read_b32 v25, v4 offset:2304
    ds_read_b32 v26, v4 offset:2560
    ds_read_b32 v27, v4 offset:2816
    ds_read_b32 v28, v4 offset:3072
    ds_read_b32 v29, v4 offset:3328
    ds_read_b32 v30, v4 offset:3584
    ds_read_b32 v31, v4 offset:3840
    v_lshrrev_b32 v2, 2, v0
    v_lshlrev_b32 v2, 2, v2
    v_add_u32 v2, s12, v2
    v_lshrrev_b32 v7, 5, v2
    v_bfe_u32 v8, v2, 2, 1
    v_bfe_u32 v6, v2, 3, 2
    v_lshlrev_b32 v6, 2, v6
    v_lshlrev_b32 v5, 2, v7
    v_add_u32 v5, v5, v8
    v_add_u32 v5, 2, v5
    v_lshlrev_b32 v5, 4, v5
    v_add_u32 v5, v5, v6
    v_and_b32 v6, 3, v0
    v_add_u32 v5, v5, v6
    v_lshlrev_b32 v5, 2, v5
    s_waitcnt lgkmcnt(0)
    v_add_f32 v16, v16, v17
    v_add_f32 v16, v16, v18
    v_add_f32 v16, v16, v19
    v_add_f32 v16, v16, v20
    v_add_f32 v16, v16, v21
    v_add_f32 v16, v16, v22
    v_add_f32 v16, v16, v23
    v_add_f32 v16, v16, v24
    v_add_f32 v16, v16, v25
    v_add_f32 v16, v16, v26
    v_add_f32 v16, v16, v27
    v_add_f32 v16, v16, v28
    v_add_f32 v16, v16, v29
    v_add_f32 v16, v16, v30
    v_add_f32 v16, v16, v31
    s_mov_b32 s22, 9248768
    v_cmp_gt_u32 vcc, 64, v0
    s_nop 1
    s_and_saveexec_b64 s[24:25], vcc
    s_nop 1
    s_cbranch_execz prep_kernel_end
    buffer_store_dword v16, v5, s[4:7], s22 offen
    s_endpgm
prep_kernel_end:
    s_endpgm

.text
.globl qkv1_kernel
.p2align 8
.type qkv1_kernel,@function
qkv1_kernel:
    s_cmp_ge_u32 s2, 240
    s_cbranch_scc1 qkv1_kernel_end
    s_load_dwordx2 s[4:5], s[0:1], 72
    v_lshrrev_b32 v2, 6, v0
    s_nop 0
    v_readfirstlane_b32 s12, v2
    v_and_b32 v1, 63, v0
    v_lshlrev_b32 v3, 4, v1
    s_and_b32 s17, s2, 7
    s_lshr_b32 s18, s2, 3
    s_and_b32 s19, s17, 1
    s_lshr_b32 s17, s17, 1
    s_mul_i32 s19, s19, 30
    s_add_u32 s18, s18, s19
    s_and_b32 s13, s18, 3
    s_lshl_b32 s17, s17, 2
    s_add_u32 s13, s13, s17
    s_lshr_b32 s14, s18, 2
    s_cmp_lt_u32 s12, 4
    s_cbranch_scc1 qkv1_kernel_comp
    s_sub_u32 s12, s12, 4
    s_add_u32 s18, s12, 0
    s_mul_i32 s56, s18, 2048
    s_mul_i32 s20, s13, 8
    s_add_u32 s20, s20, s18
    s_mul_i32 s20, s20, 20480
    s_add_u32 s20, s20, 9437184
    s_mul_i32 s21, s14, 8
    s_add_u32 s21, s21, s18
    s_sub_u32 s21, s21, 8
    s_mul_i32 s21, s21, 20480
    s_add_u32 s21, s21, 0
    s_cmp_lt_u32 s18, 8
    s_cselect_b32 s24, s20, s21
    s_add_u32 s18, s12, 2
    s_mul_i32 s57, s18, 2048
    s_mul_i32 s20, s13, 8
    s_add_u32 s20, s20, s18
    s_mul_i32 s20, s20, 20480
    s_add_u32 s20, s20, 9437184
    s_mul_i32 s21, s14, 8
    s_add_u32 s21, s21, s18
    s_sub_u32 s21, s21, 8
    s_mul_i32 s21, s21, 20480
    s_add_u32 s21, s21, 0
    s_cmp_lt_u32 s18, 8
    s_cselect_b32 s25, s20, s21
    s_add_u32 s18, s12, 4
    s_mul_i32 s58, s18, 2048
    s_mul_i32 s20, s13, 8
    s_add_u32 s20, s20, s18
    s_mul_i32 s20, s20, 20480
    s_add_u32 s20, s20, 9437184
    s_mul_i32 s21, s14, 8
    s_add_u32 s21, s21, s18
    s_sub_u32 s21, s21, 8
    s_mul_i32 s21, s21, 20480
    s_add_u32 s21, s21, 0
    s_cmp_lt_u32 s18, 8
    s_cselect_b32 s26, s20, s21
    s_add_u32 s18, s12, 6
    s_mul_i32 s59, s18, 2048
    s_mul_i32 s20, s13, 8
    s_add_u32 s20, s20, s18
    s_mul_i32 s20, s20, 20480
    s_add_u32 s20, s20, 9437184
    s_mul_i32 s21, s14, 8
    s_add_u32 s21, s21, s18
    s_sub_u32 s21, s21, 8
    s_mul_i32 s21, s21, 20480
    s_add_u32 s21, s21, 0
    s_cmp_lt_u32 s18, 8
    s_cselect_b32 s27, s20, s21
    s_add_u32 s18, s12, 8
    s_mul_i32 s60, s18, 2048
    s_mul_i32 s20, s13, 8
    s_add_u32 s20, s20, s18
    s_mul_i32 s20, s20, 20480
    s_add_u32 s20, s20, 9437184
    s_mul_i32 s21, s14, 8
    s_add_u32 s21, s21, s18
    s_sub_u32 s21, s21, 8
    s_mul_i32 s21, s21, 20480
    s_add_u32 s21, s21, 0
    s_cmp_lt_u32 s18, 8
    s_cselect_b32 s28, s20, s21
    s_add_u32 s18, s12, 10
    s_mul_i32 s61, s18, 2048
    s_mul_i32 s20, s13, 8
    s_add_u32 s20, s20, s18
    s_mul_i32 s20, s20, 20480
    s_add_u32 s20, s20, 9437184
    s_mul_i32 s21, s14, 8
    s_add_u32 s21, s21, s18
    s_sub_u32 s21, s21, 8
    s_mul_i32 s21, s21, 20480
    s_add_u32 s21, s21, 0
    s_cmp_lt_u32 s18, 8
    s_cselect_b32 s29, s20, s21
    s_add_u32 s18, s12, 12
    s_mul_i32 s62, s18, 2048
    s_mul_i32 s20, s13, 8
    s_add_u32 s20, s20, s18
    s_mul_i32 s20, s20, 20480
    s_add_u32 s20, s20, 9437184
    s_mul_i32 s21, s14, 8
    s_add_u32 s21, s21, s18
    s_sub_u32 s21, s21, 8
    s_mul_i32 s21, s21, 20480
    s_add_u32 s21, s21, 0
    s_cmp_lt_u32 s18, 8
    s_cselect_b32 s30, s20, s21
    s_add_u32 s18, s12, 14
    s_mul_i32 s63, s18, 2048
    s_mul_i32 s20, s13, 8
    s_add_u32 s20, s20, s18
    s_mul_i32 s20, s20, 20480
    s_add_u32 s20, s20, 9437184
    s_mul_i32 s21, s14, 8
    s_add_u32 s21, s21, s18
    s_sub_u32 s21, s21, 8
    s_mul_i32 s21, s21, 20480
    s_add_u32 s21, s21, 0
    s_cmp_lt_u32 s18, 8
    s_cselect_b32 s31, s20, s21
    s_waitcnt lgkmcnt(0)
    s_and_b32 s5, s5, 0xffff
    s_mov_b32 s6, 268435456
    s_mov_b32 s7, 0x00020000
    s_add_u32 m0, s56, 0
    s_add_u32 s22, s24, 0
    buffer_load_dwordx4 v3, s[4:7], s22 offen offset:0 lds
    buffer_load_dwordx4 v3, s[4:7], s22 offen offset:1024 lds
    s_add_u32 m0, s57, 0
    s_add_u32 s23, s25, 0
    buffer_load_dwordx4 v3, s[4:7], s23 offen offset:0 lds
    buffer_load_dwordx4 v3, s[4:7], s23 offen offset:1024 lds
    s_add_u32 m0, s58, 0
    s_add_u32 s22, s26, 0
    buffer_load_dwordx4 v3, s[4:7], s22 offen offset:0 lds
    buffer_load_dwordx4 v3, s[4:7], s22 offen offset:1024 lds
    s_add_u32 m0, s59, 0
    s_add_u32 s23, s27, 0
    buffer_load_dwordx4 v3, s[4:7], s23 offen offset:0 lds
    buffer_load_dwordx4 v3, s[4:7], s23 offen offset:1024 lds
    s_add_u32 m0, s60, 0
    s_add_u32 s22, s28, 0
    buffer_load_dwordx4 v3, s[4:7], s22 offen offset:0 lds
    buffer_load_dwordx4 v3, s[4:7], s22 offen offset:1024 lds
    s_add_u32 m0, s61, 0
    s_add_u32 s23, s29, 0
    buffer_load_dwordx4 v3, s[4:7], s23 offen offset:0 lds
    buffer_load_dwordx4 v3, s[4:7], s23 offen offset:1024 lds
    s_add_u32 m0, s62, 0
    s_add_u32 s22, s30, 0
    buffer_load_dwordx4 v3, s[4:7], s22 offen offset:0 lds
    buffer_load_dwordx4 v3, s[4:7], s22 offen offset:1024 lds
    s_add_u32 m0, s63, 0
    s_add_u32 s23, s31, 0
    buffer_load_dwordx4 v3, s[4:7], s23 offen offset:0 lds
    buffer_load_dwordx4 v3, s[4:7], s23 offen offset:1024 lds
    s_add_u32 m0, s56, 32768
    s_add_u32 s22, s24, 2048
    buffer_load_dwordx4 v3, s[4:7], s22 offen offset:0 lds
    buffer_load_dwordx4 v3, s[4:7], s22 offen offset:1024 lds
    s_add_u32 m0, s57, 32768
    s_add_u32 s23, s25, 2048
    buffer_load_dwordx4 v3, s[4:7], s23 offen offset:0 lds
    buffer_load_dwordx4 v3, s[4:7], s23 offen offset:1024 lds
    s_add_u32 m0, s58, 32768
    s_add_u32 s22, s26, 2048
    buffer_load_dwordx4 v3, s[4:7], s22 offen offset:0 lds
    buffer_load_dwordx4 v3, s[4:7], s22 offen offset:1024 lds
    s_add_u32 m0, s59, 32768
    s_add_u32 s23, s27, 2048
    buffer_load_dwordx4 v3, s[4:7], s23 offen offset:0 lds
    buffer_load_dwordx4 v3, s[4:7], s23 offen offset:1024 lds
    s_add_u32 m0, s60, 32768
    s_add_u32 s22, s28, 2048
    buffer_load_dwordx4 v3, s[4:7], s22 offen offset:0 lds
    buffer_load_dwordx4 v3, s[4:7], s22 offen offset:1024 lds
    s_add_u32 m0, s61, 32768
    s_add_u32 s23, s29, 2048
    buffer_load_dwordx4 v3, s[4:7], s23 offen offset:0 lds
    buffer_load_dwordx4 v3, s[4:7], s23 offen offset:1024 lds
    s_add_u32 m0, s62, 32768
    s_add_u32 s22, s30, 2048
    buffer_load_dwordx4 v3, s[4:7], s22 offen offset:0 lds
    buffer_load_dwordx4 v3, s[4:7], s22 offen offset:1024 lds
    s_add_u32 m0, s63, 32768
    s_add_u32 s23, s31, 2048
    buffer_load_dwordx4 v3, s[4:7], s23 offen offset:0 lds
    buffer_load_dwordx4 v3, s[4:7], s23 offen offset:1024 lds
    s_waitcnt vmcnt(16)
    s_barrier
    s_add_u32 m0, s56, 65536
    s_add_u32 s22, s24, 4096
    buffer_load_dwordx4 v3, s[4:7], s22 offen offset:0 lds
    buffer_load_dwordx4 v3, s[4:7], s22 offen offset:1024 lds
    s_add_u32 m0, s57, 65536
    s_add_u32 s23, s25, 4096
    buffer_load_dwordx4 v3, s[4:7], s23 offen offset:0 lds
    buffer_load_dwordx4 v3, s[4:7], s23 offen offset:1024 lds
    s_add_u32 m0, s58, 65536
    s_add_u32 s22, s26, 4096
    buffer_load_dwordx4 v3, s[4:7], s22 offen offset:0 lds
    buffer_load_dwordx4 v3, s[4:7], s22 offen offset:1024 lds
    s_add_u32 m0, s59, 65536
    s_add_u32 s23, s27, 4096
    buffer_load_dwordx4 v3, s[4:7], s23 offen offset:0 lds
    buffer_load_dwordx4 v3, s[4:7], s23 offen offset:1024 lds
    s_add_u32 m0, s60, 65536
    s_add_u32 s22, s28, 4096
    buffer_load_dwordx4 v3, s[4:7], s22 offen offset:0 lds
    buffer_load_dwordx4 v3, s[4:7], s22 offen offset:1024 lds
    s_add_u32 m0, s61, 65536
    s_add_u32 s23, s29, 4096
    buffer_load_dwordx4 v3, s[4:7], s23 offen offset:0 lds
    buffer_load_dwordx4 v3, s[4:7], s23 offen offset:1024 lds
    s_add_u32 m0, s62, 65536
    s_add_u32 s22, s30, 4096
    buffer_load_dwordx4 v3, s[4:7], s22 offen offset:0 lds
    buffer_load_dwordx4 v3, s[4:7], s22 offen offset:1024 lds
    s_add_u32 m0, s63, 65536
    s_add_u32 s23, s31, 4096
    buffer_load_dwordx4 v3, s[4:7], s23 offen offset:0 lds
    buffer_load_dwordx4 v3, s[4:7], s23 offen offset:1024 lds
    s_waitcnt vmcnt(16)
    s_barrier
    s_add_u32 m0, s56, 98304
    s_add_u32 s22, s24, 6144
    buffer_load_dwordx4 v3, s[4:7], s22 offen offset:0 lds
    buffer_load_dwordx4 v3, s[4:7], s22 offen offset:1024 lds
    s_add_u32 m0, s57, 98304
    s_add_u32 s23, s25, 6144
    buffer_load_dwordx4 v3, s[4:7], s23 offen offset:0 lds
    buffer_load_dwordx4 v3, s[4:7], s23 offen offset:1024 lds
    s_add_u32 m0, s58, 98304
    s_add_u32 s22, s26, 6144
    buffer_load_dwordx4 v3, s[4:7], s22 offen offset:0 lds
    buffer_load_dwordx4 v3, s[4:7], s22 offen offset:1024 lds
    s_add_u32 m0, s59, 98304
    s_add_u32 s23, s27, 6144
    buffer_load_dwordx4 v3, s[4:7], s23 offen offset:0 lds
    buffer_load_dwordx4 v3, s[4:7], s23 offen offset:1024 lds
    s_add_u32 m0, s60, 98304
    s_add_u32 s22, s28, 6144
    buffer_load_dwordx4 v3, s[4:7], s22 offen offset:0 lds
    buffer_load_dwordx4 v3, s[4:7], s22 offen offset:1024 lds
    s_add_u32 m0, s61, 98304
    s_add_u32 s23, s29, 6144
    buffer_load_dwordx4 v3, s[4:7], s23 offen offset:0 lds
    buffer_load_dwordx4 v3, s[4:7], s23 offen offset:1024 lds
    s_add_u32 m0, s62, 98304
    s_add_u32 s22, s30, 6144
    buffer_load_dwordx4 v3, s[4:7], s22 offen offset:0 lds
    buffer_load_dwordx4 v3, s[4:7], s22 offen offset:1024 lds
    s_add_u32 m0, s63, 98304
    s_add_u32 s23, s31, 6144
    buffer_load_dwordx4 v3, s[4:7], s23 offen offset:0 lds
    buffer_load_dwordx4 v3, s[4:7], s23 offen offset:1024 lds
    s_waitcnt vmcnt(16)
    s_barrier
    s_add_u32 m0, s56, 0
    s_add_u32 s22, s24, 8192
    buffer_load_dwordx4 v3, s[4:7], s22 offen offset:0 lds
    buffer_load_dwordx4 v3, s[4:7], s22 offen offset:1024 lds
    s_add_u32 m0, s57, 0
    s_add_u32 s23, s25, 8192
    buffer_load_dwordx4 v3, s[4:7], s23 offen offset:0 lds
    buffer_load_dwordx4 v3, s[4:7], s23 offen offset:1024 lds
    s_add_u32 m0, s58, 0
    s_add_u32 s22, s26, 8192
    buffer_load_dwordx4 v3, s[4:7], s22 offen offset:0 lds
    buffer_load_dwordx4 v3, s[4:7], s22 offen offset:1024 lds
    s_add_u32 m0, s59, 0
    s_add_u32 s23, s27, 8192
    buffer_load_dwordx4 v3, s[4:7], s23 offen offset:0 lds
    buffer_load_dwordx4 v3, s[4:7], s23 offen offset:1024 lds
    s_add_u32 m0, s60, 0
    s_add_u32 s22, s28, 8192
    buffer_load_dwordx4 v3, s[4:7], s22 offen offset:0 lds
    buffer_load_dwordx4 v3, s[4:7], s22 offen offset:1024 lds
    s_add_u32 m0, s61, 0
    s_add_u32 s23, s29, 8192
    buffer_load_dwordx4 v3, s[4:7], s23 offen offset:0 lds
    buffer_load_dwordx4 v3, s[4:7], s23 offen offset:1024 lds
    s_add_u32 m0, s62, 0
    s_add_u32 s22, s30, 8192
    buffer_load_dwordx4 v3, s[4:7], s22 offen offset:0 lds
    buffer_load_dwordx4 v3, s[4:7], s22 offen offset:1024 lds
    s_add_u32 m0, s63, 0
    s_add_u32 s23, s31, 8192
    buffer_load_dwordx4 v3, s[4:7], s23 offen offset:0 lds
    buffer_load_dwordx4 v3, s[4:7], s23 offen offset:1024 lds
    s_waitcnt vmcnt(16)
    s_barrier
    s_add_u32 m0, s56, 32768
    s_add_u32 s22, s24, 10240
    buffer_load_dwordx4 v3, s[4:7], s22 offen offset:0 lds
    buffer_load_dwordx4 v3, s[4:7], s22 offen offset:1024 lds
    s_add_u32 m0, s57, 32768
    s_add_u32 s23, s25, 10240
    buffer_load_dwordx4 v3, s[4:7], s23 offen offset:0 lds
    buffer_load_dwordx4 v3, s[4:7], s23 offen offset:1024 lds
    s_add_u32 m0, s58, 32768
    s_add_u32 s22, s26, 10240
    buffer_load_dwordx4 v3, s[4:7], s22 offen offset:0 lds
    buffer_load_dwordx4 v3, s[4:7], s22 offen offset:1024 lds
    s_add_u32 m0, s59, 32768
    s_add_u32 s23, s27, 10240
    buffer_load_dwordx4 v3, s[4:7], s23 offen offset:0 lds
    buffer_load_dwordx4 v3, s[4:7], s23 offen offset:1024 lds
    s_add_u32 m0, s60, 32768
    s_add_u32 s22, s28, 10240
    buffer_load_dwordx4 v3, s[4:7], s22 offen offset:0 lds
    buffer_load_dwordx4 v3, s[4:7], s22 offen offset:1024 lds
    s_add_u32 m0, s61, 32768
    s_add_u32 s23, s29, 10240
    buffer_load_dwordx4 v3, s[4:7], s23 offen offset:0 lds
    buffer_load_dwordx4 v3, s[4:7], s23 offen offset:1024 lds
    s_add_u32 m0, s62, 32768
    s_add_u32 s22, s30, 10240
    buffer_load_dwordx4 v3, s[4:7], s22 offen offset:0 lds
    buffer_load_dwordx4 v3, s[4:7], s22 offen offset:1024 lds
    s_add_u32 m0, s63, 32768
    s_add_u32 s23, s31, 10240
    buffer_load_dwordx4 v3, s[4:7], s23 offen offset:0 lds
    buffer_load_dwordx4 v3, s[4:7], s23 offen offset:1024 lds
    s_waitcnt vmcnt(16)
    s_barrier
    s_add_u32 m0, s56, 65536
    s_add_u32 s22, s24, 12288
    buffer_load_dwordx4 v3, s[4:7], s22 offen offset:0 lds
    buffer_load_dwordx4 v3, s[4:7], s22 offen offset:1024 lds
    s_add_u32 m0, s57, 65536
    s_add_u32 s23, s25, 12288
    buffer_load_dwordx4 v3, s[4:7], s23 offen offset:0 lds
    buffer_load_dwordx4 v3, s[4:7], s23 offen offset:1024 lds
    s_add_u32 m0, s58, 65536
    s_add_u32 s22, s26, 12288
    buffer_load_dwordx4 v3, s[4:7], s22 offen offset:0 lds
    buffer_load_dwordx4 v3, s[4:7], s22 offen offset:1024 lds
    s_add_u32 m0, s59, 65536
    s_add_u32 s23, s27, 12288
    buffer_load_dwordx4 v3, s[4:7], s23 offen offset:0 lds
    buffer_load_dwordx4 v3, s[4:7], s23 offen offset:1024 lds
    s_add_u32 m0, s60, 65536
    s_add_u32 s22, s28, 12288
    buffer_load_dwordx4 v3, s[4:7], s22 offen offset:0 lds
    buffer_load_dwordx4 v3, s[4:7], s22 offen offset:1024 lds
    s_add_u32 m0, s61, 65536
    s_add_u32 s23, s29, 12288
    buffer_load_dwordx4 v3, s[4:7], s23 offen offset:0 lds
    buffer_load_dwordx4 v3, s[4:7], s23 offen offset:1024 lds
    s_add_u32 m0, s62, 65536
    s_add_u32 s22, s30, 12288
    buffer_load_dwordx4 v3, s[4:7], s22 offen offset:0 lds
    buffer_load_dwordx4 v3, s[4:7], s22 offen offset:1024 lds
    s_add_u32 m0, s63, 65536
    s_add_u32 s23, s31, 12288
    buffer_load_dwordx4 v3, s[4:7], s23 offen offset:0 lds
    buffer_load_dwordx4 v3, s[4:7], s23 offen offset:1024 lds
    s_waitcnt vmcnt(16)
    s_barrier
    s_add_u32 m0, s56, 98304
    s_add_u32 s22, s24, 14336
    buffer_load_dwordx4 v3, s[4:7], s22 offen offset:0 lds
    buffer_load_dwordx4 v3, s[4:7], s22 offen offset:1024 lds
    s_add_u32 m0, s57, 98304
    s_add_u32 s23, s25, 14336
    buffer_load_dwordx4 v3, s[4:7], s23 offen offset:0 lds
    buffer_load_dwordx4 v3, s[4:7], s23 offen offset:1024 lds
    s_add_u32 m0, s58, 98304
    s_add_u32 s22, s26, 14336
    buffer_load_dwordx4 v3, s[4:7], s22 offen offset:0 lds
    buffer_load_dwordx4 v3, s[4:7], s22 offen offset:1024 lds
    s_add_u32 m0, s59, 98304
    s_add_u32 s23, s27, 14336
    buffer_load_dwordx4 v3, s[4:7], s23 offen offset:0 lds
    buffer_load_dwordx4 v3, s[4:7], s23 offen offset:1024 lds
    s_add_u32 m0, s60, 98304
    s_add_u32 s22, s28, 14336
    buffer_load_dwordx4 v3, s[4:7], s22 offen offset:0 lds
    buffer_load_dwordx4 v3, s[4:7], s22 offen offset:1024 lds
    s_add_u32 m0, s61, 98304
    s_add_u32 s23, s29, 14336
    buffer_load_dwordx4 v3, s[4:7], s23 offen offset:0 lds
    buffer_load_dwordx4 v3, s[4:7], s23 offen offset:1024 lds
    s_add_u32 m0, s62, 98304
    s_add_u32 s22, s30, 14336
    buffer_load_dwordx4 v3, s[4:7], s22 offen offset:0 lds
    buffer_load_dwordx4 v3, s[4:7], s22 offen offset:1024 lds
    s_add_u32 m0, s63, 98304
    s_add_u32 s23, s31, 14336
    buffer_load_dwordx4 v3, s[4:7], s23 offen offset:0 lds
    buffer_load_dwordx4 v3, s[4:7], s23 offen offset:1024 lds
    s_waitcnt vmcnt(16)
    s_barrier
    s_add_u32 m0, s56, 0
    s_add_u32 s22, s24, 16384
    buffer_load_dwordx4 v3, s[4:7], s22 offen offset:0 lds
    buffer_load_dwordx4 v3, s[4:7], s22 offen offset:1024 lds
    s_add_u32 m0, s57, 0
    s_add_u32 s23, s25, 16384
    buffer_load_dwordx4 v3, s[4:7], s23 offen offset:0 lds
    buffer_load_dwordx4 v3, s[4:7], s23 offen offset:1024 lds
    s_add_u32 m0, s58, 0
    s_add_u32 s22, s26, 16384
    buffer_load_dwordx4 v3, s[4:7], s22 offen offset:0 lds
    buffer_load_dwordx4 v3, s[4:7], s22 offen offset:1024 lds
    s_add_u32 m0, s59, 0
    s_add_u32 s23, s27, 16384
    buffer_load_dwordx4 v3, s[4:7], s23 offen offset:0 lds
    buffer_load_dwordx4 v3, s[4:7], s23 offen offset:1024 lds
    s_add_u32 m0, s60, 0
    s_add_u32 s22, s28, 16384
    buffer_load_dwordx4 v3, s[4:7], s22 offen offset:0 lds
    buffer_load_dwordx4 v3, s[4:7], s22 offen offset:1024 lds
    s_add_u32 m0, s61, 0
    s_add_u32 s23, s29, 16384
    buffer_load_dwordx4 v3, s[4:7], s23 offen offset:0 lds
    buffer_load_dwordx4 v3, s[4:7], s23 offen offset:1024 lds
    s_add_u32 m0, s62, 0
    s_add_u32 s22, s30, 16384
    buffer_load_dwordx4 v3, s[4:7], s22 offen offset:0 lds
    buffer_load_dwordx4 v3, s[4:7], s22 offen offset:1024 lds
    s_add_u32 m0, s63, 0
    s_add_u32 s23, s31, 16384
    buffer_load_dwordx4 v3, s[4:7], s23 offen offset:0 lds
    buffer_load_dwordx4 v3, s[4:7], s23 offen offset:1024 lds
    s_waitcnt vmcnt(16)
    s_barrier
    s_add_u32 m0, s56, 32768
    s_add_u32 s22, s24, 18432
    buffer_load_dwordx4 v3, s[4:7], s22 offen offset:0 lds
    buffer_load_dwordx4 v3, s[4:7], s22 offen offset:1024 lds
    s_add_u32 m0, s57, 32768
    s_add_u32 s23, s25, 18432
    buffer_load_dwordx4 v3, s[4:7], s23 offen offset:0 lds
    buffer_load_dwordx4 v3, s[4:7], s23 offen offset:1024 lds
    s_add_u32 m0, s58, 32768
    s_add_u32 s22, s26, 18432
    buffer_load_dwordx4 v3, s[4:7], s22 offen offset:0 lds
    buffer_load_dwordx4 v3, s[4:7], s22 offen offset:1024 lds
    s_add_u32 m0, s59, 32768
    s_add_u32 s23, s27, 18432
    buffer_load_dwordx4 v3, s[4:7], s23 offen offset:0 lds
    buffer_load_dwordx4 v3, s[4:7], s23 offen offset:1024 lds
    s_add_u32 m0, s60, 32768
    s_add_u32 s22, s28, 18432
    buffer_load_dwordx4 v3, s[4:7], s22 offen offset:0 lds
    buffer_load_dwordx4 v3, s[4:7], s22 offen offset:1024 lds
    s_add_u32 m0, s61, 32768
    s_add_u32 s23, s29, 18432
    buffer_load_dwordx4 v3, s[4:7], s23 offen offset:0 lds
    buffer_load_dwordx4 v3, s[4:7], s23 offen offset:1024 lds
    s_add_u32 m0, s62, 32768
    s_add_u32 s22, s30, 18432
    buffer_load_dwordx4 v3, s[4:7], s22 offen offset:0 lds
    buffer_load_dwordx4 v3, s[4:7], s22 offen offset:1024 lds
    s_add_u32 m0, s63, 32768
    s_add_u32 s23, s31, 18432
    buffer_load_dwordx4 v3, s[4:7], s23 offen offset:0 lds
    buffer_load_dwordx4 v3, s[4:7], s23 offen offset:1024 lds
    s_waitcnt vmcnt(16)
    s_barrier
    s_waitcnt vmcnt(0)
    s_barrier
    s_endpgm
qkv1_kernel_comp:
    s_lshr_b32 s15, s12, 1
    s_and_b32 s16, s12, 1
    s_mul_i32 s17, s15, 8192
    s_mul_i32 s18, s16, 8192
    v_add_u32 v4, s17, v3
    v_add_u32 v7, s18, v3
    v_add_u32 v5, s17, v3
    v_add_u32 v8, s18, v3
    v_add_u32 v5, 65536, v5
    v_add_u32 v8, 65536, v8
    v_add_u32 v6, s17, v3
    v_add_u32 v9, s18, v3
    v_add_u32 v6, 131072, v6
    v_add_u32 v9, 131072, v9
    s_waitcnt lgkmcnt(0)
    s_and_b32 s5, s5, 0xffff
    s_mov_b32 s6, 268435456
    s_mov_b32 s7, 0x00020000
    v_and_b32 v2, 127, v0
    v_lshlrev_b32 v2, 6, v2
    s_lshl_b32 s17, s13, 13
    s_add_u32 s17, s17, 22020096
    buffer_load_dwordx4 v[10:13], v2, s[4:7], s17 offen offset:0
    buffer_load_dwordx4 v[14:17], v2, s[4:7], s17 offen offset:16
    buffer_load_dwordx4 v[18:21], v2, s[4:7], s17 offen offset:32
    buffer_load_dwordx4 v[22:25], v2, s[4:7], s17 offen offset:48
    v_lshrrev_b32 v2, 4, v1
    s_cmp_ge_u32 s14, 10
    s_nop 3
    s_cbranch_scc1 qkv1_kernel_v
    v_lshlrev_b32 v42, 4, v2
    s_lshl_b32 s17, s14, 9
    s_lshl_b32 s18, s16, 8
    s_add_u32 s17, s17, s18
    s_add_u32 s17, s17, 9240576
    buffer_load_dwordx4 v[26:29], v42, s[4:7], s17 offen offset:0
    buffer_load_dwordx4 v[30:33], v42, s[4:7], s17 offen offset:64
    buffer_load_dwordx4 v[34:37], v42, s[4:7], s17 offen offset:128
    buffer_load_dwordx4 v[38:41], v42, s[4:7], s17 offen offset:192
    s_waitcnt vmcnt(4)
    v_add_f32 v10, v10, v12
    v_add_f32 v11, v11, v13
    v_add_f32 v10, v10, v14
    v_add_f32 v11, v11, v15
    v_add_f32 v10, v10, v16
    v_add_f32 v11, v11, v17
    v_add_f32 v10, v10, v18
    v_add_f32 v11, v11, v19
    v_add_f32 v10, v10, v20
    v_add_f32 v11, v11, v21
    v_add_f32 v10, v10, v22
    v_add_f32 v11, v11, v23
    v_add_f32 v10, v10, v24
    v_add_f32 v11, v11, v25
    v_mul_f32 v10, 0x3acccccd, v10
    v_mul_f32 v11, 0x3acccccd, v11
    v_fma_f32 v11, -v10, v10, v11
    v_max_f32 v11, 0, v11
    v_cvt_pk_bf16_f32 v10, v10, v10
    v_lshlrev_b32 v10, 16, v10
    v_cvt_pk_bf16_f32 v11, v11, v11
    v_lshlrev_b32 v11, 16, v11
    v_add_f32 v11, 0x3727c5ac, v11
    v_cvt_pk_bf16_f32 v11, v11, v11
    v_lshlrev_b32 v11, 16, v11
    v_sqrt_f32 v11, v11
    s_nop 0
    v_cvt_pk_bf16_f32 v11, v11, v11
    v_lshlrev_b32 v11, 16, v11
    v_rcp_f32 v11, v11
    v_and_b32 v12, 127, v0
    v_lshlrev_b32 v12, 3, v12
    v_add_u32 v12, 131072, v12
    ds_write_b64 v12, v[10:11]
    s_waitcnt lgkmcnt(0)
    s_barrier
    ds_read_b128 v[112:115], v4 offset:0
    ds_read_b128 v[116:119], v4 offset:2048
    ds_read_b128 v[120:123], v4 offset:4096
    ds_read_b128 v[124:127], v4 offset:6144
    ds_read_b128 v[128:131], v7 offset:16384
    ds_read_b128 v[132:135], v7 offset:18432
    ds_read_b128 v[136:139], v7 offset:20480
    ds_read_b128 v[140:143], v7 offset:22528
    s_waitcnt lgkmcnt(0)
    v_mfma_f32_16x16x32_bf16 v[48:51], v[128:131], v[112:115], 0
    ds_read_b128 v[144:147], v4 offset:1024
    v_mfma_f32_16x16x32_bf16 v[52:55], v[132:135], v[112:115], 0
    ds_read_b128 v[148:151], v4 offset:3072
    v_mfma_f32_16x16x32_bf16 v[56:59], v[136:139], v[112:115], 0
    ds_read_b128 v[152:155], v4 offset:5120
    v_mfma_f32_16x16x32_bf16 v[60:63], v[140:143], v[112:115], 0
    ds_read_b128 v[156:159], v4 offset:7168
    v_mfma_f32_16x16x32_bf16 v[64:67], v[128:131], v[116:119], 0
    ds_read_b128 v[160:163], v7 offset:17408
    v_mfma_f32_16x16x32_bf16 v[68:71], v[132:135], v[116:119], 0
    ds_read_b128 v[164:167], v7 offset:19456
    v_mfma_f32_16x16x32_bf16 v[72:75], v[136:139], v[116:119], 0
    ds_read_b128 v[168:171], v7 offset:21504
    v_mfma_f32_16x16x32_bf16 v[76:79], v[140:143], v[116:119], 0
    ds_read_b128 v[172:175], v7 offset:23552
    v_mfma_f32_16x16x32_bf16 v[80:83], v[128:131], v[120:123], 0
    v_mfma_f32_16x16x32_bf16 v[84:87], v[132:135], v[120:123], 0
    v_mfma_f32_16x16x32_bf16 v[88:91], v[136:139], v[120:123], 0
    v_mfma_f32_16x16x32_bf16 v[92:95], v[140:143], v[120:123], 0
    v_mfma_f32_16x16x32_bf16 v[96:99], v[128:131], v[124:127], 0
    v_mfma_f32_16x16x32_bf16 v[100:103], v[132:135], v[124:127], 0
    v_mfma_f32_16x16x32_bf16 v[104:107], v[136:139], v[124:127], 0
    v_mfma_f32_16x16x32_bf16 v[108:111], v[140:143], v[124:127], 0
    s_waitcnt lgkmcnt(0)
    s_barrier
    v_mfma_f32_16x16x32_bf16 v[48:51], v[160:163], v[144:147], v[48:51]
    ds_read_b128 v[112:115], v4 offset:32768
    v_mfma_f32_16x16x32_bf16 v[52:55], v[164:167], v[144:147], v[52:55]
    ds_read_b128 v[116:119], v4 offset:34816
    v_mfma_f32_16x16x32_bf16 v[56:59], v[168:171], v[144:147], v[56:59]
    ds_read_b128 v[120:123], v4 offset:36864
    v_mfma_f32_16x16x32_bf16 v[60:63], v[172:175], v[144:147], v[60:63]
    ds_read_b128 v[124:127], v4 offset:38912
    v_mfma_f32_16x16x32_bf16 v[64:67], v[160:163], v[148:151], v[64:67]
    ds_read_b128 v[128:131], v7 offset:49152
    v_mfma_f32_16x16x32_bf16 v[68:71], v[164:167], v[148:151], v[68:71]
    ds_read_b128 v[132:135], v7 offset:51200
    v_mfma_f32_16x16x32_bf16 v[72:75], v[168:171], v[148:151], v[72:75]
    ds_read_b128 v[136:139], v7 offset:53248
    v_mfma_f32_16x16x32_bf16 v[76:79], v[172:175], v[148:151], v[76:79]
    ds_read_b128 v[140:143], v7 offset:55296
    v_mfma_f32_16x16x32_bf16 v[80:83], v[160:163], v[152:155], v[80:83]
    v_mfma_f32_16x16x32_bf16 v[84:87], v[164:167], v[152:155], v[84:87]
    v_mfma_f32_16x16x32_bf16 v[88:91], v[168:171], v[152:155], v[88:91]
    v_mfma_f32_16x16x32_bf16 v[92:95], v[172:175], v[152:155], v[92:95]
    v_mfma_f32_16x16x32_bf16 v[96:99], v[160:163], v[156:159], v[96:99]
    v_mfma_f32_16x16x32_bf16 v[100:103], v[164:167], v[156:159], v[100:103]
    v_mfma_f32_16x16x32_bf16 v[104:107], v[168:171], v[156:159], v[104:107]
    v_mfma_f32_16x16x32_bf16 v[108:111], v[172:175], v[156:159], v[108:111]
    s_waitcnt lgkmcnt(0)
    v_mfma_f32_16x16x32_bf16 v[48:51], v[128:131], v[112:115], v[48:51]
    ds_read_b128 v[144:147], v4 offset:33792
    v_mfma_f32_16x16x32_bf16 v[52:55], v[132:135], v[112:115], v[52:55]
    ds_read_b128 v[148:151], v4 offset:35840
    v_mfma_f32_16x16x32_bf16 v[56:59], v[136:139], v[112:115], v[56:59]
    ds_read_b128 v[152:155], v4 offset:37888
    v_mfma_f32_16x16x32_bf16 v[60:63], v[140:143], v[112:115], v[60:63]
    ds_read_b128 v[156:159], v4 offset:39936
    v_mfma_f32_16x16x32_bf16 v[64:67], v[128:131], v[116:119], v[64:67]
    ds_read_b128 v[160:163], v7 offset:50176
    v_mfma_f32_16x16x32_bf16 v[68:71], v[132:135], v[116:119], v[68:71]
    ds_read_b128 v[164:167], v7 offset:52224
    v_mfma_f32_16x16x32_bf16 v[72:75], v[136:139], v[116:119], v[72:75]
    ds_read_b128 v[168:171], v7 offset:54272
    v_mfma_f32_16x16x32_bf16 v[76:79], v[140:143], v[116:119], v[76:79]
    ds_read_b128 v[172:175], v7 offset:56320
    v_mfma_f32_16x16x32_bf16 v[80:83], v[128:131], v[120:123], v[80:83]
    v_mfma_f32_16x16x32_bf16 v[84:87], v[132:135], v[120:123], v[84:87]
    v_mfma_f32_16x16x32_bf16 v[88:91], v[136:139], v[120:123], v[88:91]
    v_mfma_f32_16x16x32_bf16 v[92:95], v[140:143], v[120:123], v[92:95]
    v_mfma_f32_16x16x32_bf16 v[96:99], v[128:131], v[124:127], v[96:99]
    v_mfma_f32_16x16x32_bf16 v[100:103], v[132:135], v[124:127], v[100:103]
    v_mfma_f32_16x16x32_bf16 v[104:107], v[136:139], v[124:127], v[104:107]
    v_mfma_f32_16x16x32_bf16 v[108:111], v[140:143], v[124:127], v[108:111]
    s_waitcnt lgkmcnt(0)
    s_barrier
    v_mfma_f32_16x16x32_bf16 v[48:51], v[160:163], v[144:147], v[48:51]
    ds_read_b128 v[112:115], v5 offset:0
    v_mfma_f32_16x16x32_bf16 v[52:55], v[164:167], v[144:147], v[52:55]
    ds_read_b128 v[116:119], v5 offset:2048
    v_mfma_f32_16x16x32_bf16 v[56:59], v[168:171], v[144:147], v[56:59]
    ds_read_b128 v[120:123], v5 offset:4096
    v_mfma_f32_16x16x32_bf16 v[60:63], v[172:175], v[144:147], v[60:63]
    ds_read_b128 v[124:127], v5 offset:6144
    v_mfma_f32_16x16x32_bf16 v[64:67], v[160:163], v[148:151], v[64:67]
    ds_read_b128 v[128:131], v8 offset:16384
    v_mfma_f32_16x16x32_bf16 v[68:71], v[164:167], v[148:151], v[68:71]
    ds_read_b128 v[132:135], v8 offset:18432
    v_mfma_f32_16x16x32_bf16 v[72:75], v[168:171], v[148:151], v[72:75]
    ds_read_b128 v[136:139], v8 offset:20480
    v_mfma_f32_16x16x32_bf16 v[76:79], v[172:175], v[148:151], v[76:79]
    ds_read_b128 v[140:143], v8 offset:22528
    v_mfma_f32_16x16x32_bf16 v[80:83], v[160:163], v[152:155], v[80:83]
    v_mfma_f32_16x16x32_bf16 v[84:87], v[164:167], v[152:155], v[84:87]
    v_mfma_f32_16x16x32_bf16 v[88:91], v[168:171], v[152:155], v[88:91]
    v_mfma_f32_16x16x32_bf16 v[92:95], v[172:175], v[152:155], v[92:95]
    v_mfma_f32_16x16x32_bf16 v[96:99], v[160:163], v[156:159], v[96:99]
    v_mfma_f32_16x16x32_bf16 v[100:103], v[164:167], v[156:159], v[100:103]
    v_mfma_f32_16x16x32_bf16 v[104:107], v[168:171], v[156:159], v[104:107]
    v_mfma_f32_16x16x32_bf16 v[108:111], v[172:175], v[156:159], v[108:111]
    s_waitcnt lgkmcnt(0)
    v_mfma_f32_16x16x32_bf16 v[48:51], v[128:131], v[112:115], v[48:51]
    ds_read_b128 v[144:147], v5 offset:1024
    v_mfma_f32_16x16x32_bf16 v[52:55], v[132:135], v[112:115], v[52:55]
    ds_read_b128 v[148:151], v5 offset:3072
    v_mfma_f32_16x16x32_bf16 v[56:59], v[136:139], v[112:115], v[56:59]
    ds_read_b128 v[152:155], v5 offset:5120
    v_mfma_f32_16x16x32_bf16 v[60:63], v[140:143], v[112:115], v[60:63]
    ds_read_b128 v[156:159], v5 offset:7168
    v_mfma_f32_16x16x32_bf16 v[64:67], v[128:131], v[116:119], v[64:67]
    ds_read_b128 v[160:163], v8 offset:17408
    v_mfma_f32_16x16x32_bf16 v[68:71], v[132:135], v[116:119], v[68:71]
    ds_read_b128 v[164:167], v8 offset:19456
    v_mfma_f32_16x16x32_bf16 v[72:75], v[136:139], v[116:119], v[72:75]
    ds_read_b128 v[168:171], v8 offset:21504
    v_mfma_f32_16x16x32_bf16 v[76:79], v[140:143], v[116:119], v[76:79]
    ds_read_b128 v[172:175], v8 offset:23552
    v_mfma_f32_16x16x32_bf16 v[80:83], v[128:131], v[120:123], v[80:83]
    v_mfma_f32_16x16x32_bf16 v[84:87], v[132:135], v[120:123], v[84:87]
    v_mfma_f32_16x16x32_bf16 v[88:91], v[136:139], v[120:123], v[88:91]
    v_mfma_f32_16x16x32_bf16 v[92:95], v[140:143], v[120:123], v[92:95]
    v_mfma_f32_16x16x32_bf16 v[96:99], v[128:131], v[124:127], v[96:99]
    v_mfma_f32_16x16x32_bf16 v[100:103], v[132:135], v[124:127], v[100:103]
    v_mfma_f32_16x16x32_bf16 v[104:107], v[136:139], v[124:127], v[104:107]
    v_mfma_f32_16x16x32_bf16 v[108:111], v[140:143], v[124:127], v[108:111]
    s_waitcnt lgkmcnt(0)
    s_barrier
    v_mfma_f32_16x16x32_bf16 v[48:51], v[160:163], v[144:147], v[48:51]
    ds_read_b128 v[112:115], v5 offset:32768
    v_mfma_f32_16x16x32_bf16 v[52:55], v[164:167], v[144:147], v[52:55]
    ds_read_b128 v[116:119], v5 offset:34816
    v_mfma_f32_16x16x32_bf16 v[56:59], v[168:171], v[144:147], v[56:59]
    ds_read_b128 v[120:123], v5 offset:36864
    v_mfma_f32_16x16x32_bf16 v[60:63], v[172:175], v[144:147], v[60:63]
    ds_read_b128 v[124:127], v5 offset:38912
    v_mfma_f32_16x16x32_bf16 v[64:67], v[160:163], v[148:151], v[64:67]
    ds_read_b128 v[128:131], v8 offset:49152
    v_mfma_f32_16x16x32_bf16 v[68:71], v[164:167], v[148:151], v[68:71]
    ds_read_b128 v[132:135], v8 offset:51200
    v_mfma_f32_16x16x32_bf16 v[72:75], v[168:171], v[148:151], v[72:75]
    ds_read_b128 v[136:139], v8 offset:53248
    v_mfma_f32_16x16x32_bf16 v[76:79], v[172:175], v[148:151], v[76:79]
    ds_read_b128 v[140:143], v8 offset:55296
    v_mfma_f32_16x16x32_bf16 v[80:83], v[160:163], v[152:155], v[80:83]
    v_mfma_f32_16x16x32_bf16 v[84:87], v[164:167], v[152:155], v[84:87]
    v_mfma_f32_16x16x32_bf16 v[88:91], v[168:171], v[152:155], v[88:91]
    v_mfma_f32_16x16x32_bf16 v[92:95], v[172:175], v[152:155], v[92:95]
    v_mfma_f32_16x16x32_bf16 v[96:99], v[160:163], v[156:159], v[96:99]
    v_mfma_f32_16x16x32_bf16 v[100:103], v[164:167], v[156:159], v[100:103]
    v_mfma_f32_16x16x32_bf16 v[104:107], v[168:171], v[156:159], v[104:107]
    v_mfma_f32_16x16x32_bf16 v[108:111], v[172:175], v[156:159], v[108:111]
    s_waitcnt lgkmcnt(0)
    v_mfma_f32_16x16x32_bf16 v[48:51], v[128:131], v[112:115], v[48:51]
    ds_read_b128 v[144:147], v5 offset:33792
    v_mfma_f32_16x16x32_bf16 v[52:55], v[132:135], v[112:115], v[52:55]
    ds_read_b128 v[148:151], v5 offset:35840
    v_mfma_f32_16x16x32_bf16 v[56:59], v[136:139], v[112:115], v[56:59]
    ds_read_b128 v[152:155], v5 offset:37888
    v_mfma_f32_16x16x32_bf16 v[60:63], v[140:143], v[112:115], v[60:63]
    ds_read_b128 v[156:159], v5 offset:39936
    v_mfma_f32_16x16x32_bf16 v[64:67], v[128:131], v[116:119], v[64:67]
    ds_read_b128 v[160:163], v8 offset:50176
    v_mfma_f32_16x16x32_bf16 v[68:71], v[132:135], v[116:119], v[68:71]
    ds_read_b128 v[164:167], v8 offset:52224
    v_mfma_f32_16x16x32_bf16 v[72:75], v[136:139], v[116:119], v[72:75]
    ds_read_b128 v[168:171], v8 offset:54272
    v_mfma_f32_16x16x32_bf16 v[76:79], v[140:143], v[116:119], v[76:79]
    ds_read_b128 v[172:175], v8 offset:56320
    v_mfma_f32_16x16x32_bf16 v[80:83], v[128:131], v[120:123], v[80:83]
    v_mfma_f32_16x16x32_bf16 v[84:87], v[132:135], v[120:123], v[84:87]
    v_mfma_f32_16x16x32_bf16 v[88:91], v[136:139], v[120:123], v[88:91]
    v_mfma_f32_16x16x32_bf16 v[92:95], v[140:143], v[120:123], v[92:95]
    v_mfma_f32_16x16x32_bf16 v[96:99], v[128:131], v[124:127], v[96:99]
    v_mfma_f32_16x16x32_bf16 v[100:103], v[132:135], v[124:127], v[100:103]
    v_mfma_f32_16x16x32_bf16 v[104:107], v[136:139], v[124:127], v[104:107]
    v_mfma_f32_16x16x32_bf16 v[108:111], v[140:143], v[124:127], v[108:111]
    s_waitcnt lgkmcnt(0)
    s_barrier
    v_mfma_f32_16x16x32_bf16 v[48:51], v[160:163], v[144:147], v[48:51]
    ds_read_b128 v[112:115], v4 offset:0
    v_mfma_f32_16x16x32_bf16 v[52:55], v[164:167], v[144:147], v[52:55]
    ds_read_b128 v[116:119], v4 offset:2048
    v_mfma_f32_16x16x32_bf16 v[56:59], v[168:171], v[144:147], v[56:59]
    ds_read_b128 v[120:123], v4 offset:4096
    v_mfma_f32_16x16x32_bf16 v[60:63], v[172:175], v[144:147], v[60:63]
    ds_read_b128 v[124:127], v4 offset:6144
    v_mfma_f32_16x16x32_bf16 v[64:67], v[160:163], v[148:151], v[64:67]
    ds_read_b128 v[128:131], v7 offset:16384
    v_mfma_f32_16x16x32_bf16 v[68:71], v[164:167], v[148:151], v[68:71]
    ds_read_b128 v[132:135], v7 offset:18432
    v_mfma_f32_16x16x32_bf16 v[72:75], v[168:171], v[148:151], v[72:75]
    ds_read_b128 v[136:139], v7 offset:20480
    v_mfma_f32_16x16x32_bf16 v[76:79], v[172:175], v[148:151], v[76:79]
    ds_read_b128 v[140:143], v7 offset:22528
    v_mfma_f32_16x16x32_bf16 v[80:83], v[160:163], v[152:155], v[80:83]
    v_mfma_f32_16x16x32_bf16 v[84:87], v[164:167], v[152:155], v[84:87]
    v_mfma_f32_16x16x32_bf16 v[88:91], v[168:171], v[152:155], v[88:91]
    v_mfma_f32_16x16x32_bf16 v[92:95], v[172:175], v[152:155], v[92:95]
    v_mfma_f32_16x16x32_bf16 v[96:99], v[160:163], v[156:159], v[96:99]
    v_mfma_f32_16x16x32_bf16 v[100:103], v[164:167], v[156:159], v[100:103]
    v_mfma_f32_16x16x32_bf16 v[104:107], v[168:171], v[156:159], v[104:107]
    v_mfma_f32_16x16x32_bf16 v[108:111], v[172:175], v[156:159], v[108:111]
    s_waitcnt lgkmcnt(0)
    v_mfma_f32_16x16x32_bf16 v[48:51], v[128:131], v[112:115], v[48:51]
    ds_read_b128 v[144:147], v4 offset:1024
    v_mfma_f32_16x16x32_bf16 v[52:55], v[132:135], v[112:115], v[52:55]
    ds_read_b128 v[148:151], v4 offset:3072
    v_mfma_f32_16x16x32_bf16 v[56:59], v[136:139], v[112:115], v[56:59]
    ds_read_b128 v[152:155], v4 offset:5120
    v_mfma_f32_16x16x32_bf16 v[60:63], v[140:143], v[112:115], v[60:63]
    ds_read_b128 v[156:159], v4 offset:7168
    v_mfma_f32_16x16x32_bf16 v[64:67], v[128:131], v[116:119], v[64:67]
    ds_read_b128 v[160:163], v7 offset:17408
    v_mfma_f32_16x16x32_bf16 v[68:71], v[132:135], v[116:119], v[68:71]
    ds_read_b128 v[164:167], v7 offset:19456
    v_mfma_f32_16x16x32_bf16 v[72:75], v[136:139], v[116:119], v[72:75]
    ds_read_b128 v[168:171], v7 offset:21504
    v_mfma_f32_16x16x32_bf16 v[76:79], v[140:143], v[116:119], v[76:79]
    ds_read_b128 v[172:175], v7 offset:23552
    v_mfma_f32_16x16x32_bf16 v[80:83], v[128:131], v[120:123], v[80:83]
    v_mfma_f32_16x16x32_bf16 v[84:87], v[132:135], v[120:123], v[84:87]
    v_mfma_f32_16x16x32_bf16 v[88:91], v[136:139], v[120:123], v[88:91]
    v_mfma_f32_16x16x32_bf16 v[92:95], v[140:143], v[120:123], v[92:95]
    v_mfma_f32_16x16x32_bf16 v[96:99], v[128:131], v[124:127], v[96:99]
    v_mfma_f32_16x16x32_bf16 v[100:103], v[132:135], v[124:127], v[100:103]
    v_mfma_f32_16x16x32_bf16 v[104:107], v[136:139], v[124:127], v[104:107]
    v_mfma_f32_16x16x32_bf16 v[108:111], v[140:143], v[124:127], v[108:111]
    s_waitcnt lgkmcnt(0)
    s_barrier
    v_mfma_f32_16x16x32_bf16 v[48:51], v[160:163], v[144:147], v[48:51]
    ds_read_b128 v[112:115], v4 offset:32768
    v_mfma_f32_16x16x32_bf16 v[52:55], v[164:167], v[144:147], v[52:55]
    ds_read_b128 v[116:119], v4 offset:34816
    v_mfma_f32_16x16x32_bf16 v[56:59], v[168:171], v[144:147], v[56:59]
    ds_read_b128 v[120:123], v4 offset:36864
    v_mfma_f32_16x16x32_bf16 v[60:63], v[172:175], v[144:147], v[60:63]
    ds_read_b128 v[124:127], v4 offset:38912
    v_mfma_f32_16x16x32_bf16 v[64:67], v[160:163], v[148:151], v[64:67]
    ds_read_b128 v[128:131], v7 offset:49152
    v_mfma_f32_16x16x32_bf16 v[68:71], v[164:167], v[148:151], v[68:71]
    ds_read_b128 v[132:135], v7 offset:51200
    v_mfma_f32_16x16x32_bf16 v[72:75], v[168:171], v[148:151], v[72:75]
    ds_read_b128 v[136:139], v7 offset:53248
    v_mfma_f32_16x16x32_bf16 v[76:79], v[172:175], v[148:151], v[76:79]
    ds_read_b128 v[140:143], v7 offset:55296
    v_mfma_f32_16x16x32_bf16 v[80:83], v[160:163], v[152:155], v[80:83]
    v_mfma_f32_16x16x32_bf16 v[84:87], v[164:167], v[152:155], v[84:87]
    v_mfma_f32_16x16x32_bf16 v[88:91], v[168:171], v[152:155], v[88:91]
    v_mfma_f32_16x16x32_bf16 v[92:95], v[172:175], v[152:155], v[92:95]
    v_mfma_f32_16x16x32_bf16 v[96:99], v[160:163], v[156:159], v[96:99]
    v_mfma_f32_16x16x32_bf16 v[100:103], v[164:167], v[156:159], v[100:103]
    v_mfma_f32_16x16x32_bf16 v[104:107], v[168:171], v[156:159], v[104:107]
    v_mfma_f32_16x16x32_bf16 v[108:111], v[172:175], v[156:159], v[108:111]
    s_waitcnt lgkmcnt(0)
    v_mfma_f32_16x16x32_bf16 v[48:51], v[128:131], v[112:115], v[48:51]
    ds_read_b128 v[144:147], v4 offset:33792
    v_mfma_f32_16x16x32_bf16 v[52:55], v[132:135], v[112:115], v[52:55]
    ds_read_b128 v[148:151], v4 offset:35840
    v_mfma_f32_16x16x32_bf16 v[56:59], v[136:139], v[112:115], v[56:59]
    ds_read_b128 v[152:155], v4 offset:37888
    v_mfma_f32_16x16x32_bf16 v[60:63], v[140:143], v[112:115], v[60:63]
    ds_read_b128 v[156:159], v4 offset:39936
    v_mfma_f32_16x16x32_bf16 v[64:67], v[128:131], v[116:119], v[64:67]
    ds_read_b128 v[160:163], v7 offset:50176
    v_mfma_f32_16x16x32_bf16 v[68:71], v[132:135], v[116:119], v[68:71]
    ds_read_b128 v[164:167], v7 offset:52224
    v_mfma_f32_16x16x32_bf16 v[72:75], v[136:139], v[116:119], v[72:75]
    ds_read_b128 v[168:171], v7 offset:54272
    v_mfma_f32_16x16x32_bf16 v[76:79], v[140:143], v[116:119], v[76:79]
    ds_read_b128 v[172:175], v7 offset:56320
    v_mfma_f32_16x16x32_bf16 v[80:83], v[128:131], v[120:123], v[80:83]
    v_mfma_f32_16x16x32_bf16 v[84:87], v[132:135], v[120:123], v[84:87]
    v_mfma_f32_16x16x32_bf16 v[88:91], v[136:139], v[120:123], v[88:91]
    v_mfma_f32_16x16x32_bf16 v[92:95], v[140:143], v[120:123], v[92:95]
    v_mfma_f32_16x16x32_bf16 v[96:99], v[128:131], v[124:127], v[96:99]
    v_mfma_f32_16x16x32_bf16 v[100:103], v[132:135], v[124:127], v[100:103]
    v_mfma_f32_16x16x32_bf16 v[104:107], v[136:139], v[124:127], v[104:107]
    v_mfma_f32_16x16x32_bf16 v[108:111], v[140:143], v[124:127], v[108:111]
    s_waitcnt lgkmcnt(0)
    s_barrier
    v_mfma_f32_16x16x32_bf16 v[48:51], v[160:163], v[144:147], v[48:51]
    ds_read_b128 v[112:115], v5 offset:0
    v_mfma_f32_16x16x32_bf16 v[52:55], v[164:167], v[144:147], v[52:55]
    ds_read_b128 v[116:119], v5 offset:2048
    v_mfma_f32_16x16x32_bf16 v[56:59], v[168:171], v[144:147], v[56:59]
    ds_read_b128 v[120:123], v5 offset:4096
    v_mfma_f32_16x16x32_bf16 v[60:63], v[172:175], v[144:147], v[60:63]
    ds_read_b128 v[124:127], v5 offset:6144
    v_mfma_f32_16x16x32_bf16 v[64:67], v[160:163], v[148:151], v[64:67]
    ds_read_b128 v[128:131], v8 offset:16384
    v_mfma_f32_16x16x32_bf16 v[68:71], v[164:167], v[148:151], v[68:71]
    ds_read_b128 v[132:135], v8 offset:18432
    v_mfma_f32_16x16x32_bf16 v[72:75], v[168:171], v[148:151], v[72:75]
    ds_read_b128 v[136:139], v8 offset:20480
    v_mfma_f32_16x16x32_bf16 v[76:79], v[172:175], v[148:151], v[76:79]
    ds_read_b128 v[140:143], v8 offset:22528
    v_mfma_f32_16x16x32_bf16 v[80:83], v[160:163], v[152:155], v[80:83]
    v_mfma_f32_16x16x32_bf16 v[84:87], v[164:167], v[152:155], v[84:87]
    v_mfma_f32_16x16x32_bf16 v[88:91], v[168:171], v[152:155], v[88:91]
    v_mfma_f32_16x16x32_bf16 v[92:95], v[172:175], v[152:155], v[92:95]
    v_mfma_f32_16x16x32_bf16 v[96:99], v[160:163], v[156:159], v[96:99]
    v_mfma_f32_16x16x32_bf16 v[100:103], v[164:167], v[156:159], v[100:103]
    v_mfma_f32_16x16x32_bf16 v[104:107], v[168:171], v[156:159], v[104:107]
    v_mfma_f32_16x16x32_bf16 v[108:111], v[172:175], v[156:159], v[108:111]
    s_waitcnt lgkmcnt(0)
    v_mfma_f32_16x16x32_bf16 v[48:51], v[128:131], v[112:115], v[48:51]
    ds_read_b128 v[144:147], v5 offset:1024
    v_mfma_f32_16x16x32_bf16 v[52:55], v[132:135], v[112:115], v[52:55]
    ds_read_b128 v[148:151], v5 offset:3072
    v_mfma_f32_16x16x32_bf16 v[56:59], v[136:139], v[112:115], v[56:59]
    ds_read_b128 v[152:155], v5 offset:5120
    v_mfma_f32_16x16x32_bf16 v[60:63], v[140:143], v[112:115], v[60:63]
    ds_read_b128 v[156:159], v5 offset:7168
    v_mfma_f32_16x16x32_bf16 v[64:67], v[128:131], v[116:119], v[64:67]
    ds_read_b128 v[160:163], v8 offset:17408
    v_mfma_f32_16x16x32_bf16 v[68:71], v[132:135], v[116:119], v[68:71]
    ds_read_b128 v[164:167], v8 offset:19456
    v_mfma_f32_16x16x32_bf16 v[72:75], v[136:139], v[116:119], v[72:75]
    ds_read_b128 v[168:171], v8 offset:21504
    v_mfma_f32_16x16x32_bf16 v[76:79], v[140:143], v[116:119], v[76:79]
    ds_read_b128 v[172:175], v8 offset:23552
    v_mfma_f32_16x16x32_bf16 v[80:83], v[128:131], v[120:123], v[80:83]
    v_mfma_f32_16x16x32_bf16 v[84:87], v[132:135], v[120:123], v[84:87]
    v_mfma_f32_16x16x32_bf16 v[88:91], v[136:139], v[120:123], v[88:91]
    v_mfma_f32_16x16x32_bf16 v[92:95], v[140:143], v[120:123], v[92:95]
    v_mfma_f32_16x16x32_bf16 v[96:99], v[128:131], v[124:127], v[96:99]
    v_mfma_f32_16x16x32_bf16 v[100:103], v[132:135], v[124:127], v[100:103]
    v_mfma_f32_16x16x32_bf16 v[104:107], v[136:139], v[124:127], v[104:107]
    v_mfma_f32_16x16x32_bf16 v[108:111], v[140:143], v[124:127], v[108:111]
    s_waitcnt lgkmcnt(0)
    s_barrier
    v_mfma_f32_16x16x32_bf16 v[48:51], v[160:163], v[144:147], v[48:51]
    ds_read_b128 v[112:115], v5 offset:32768
    v_mfma_f32_16x16x32_bf16 v[52:55], v[164:167], v[144:147], v[52:55]
    ds_read_b128 v[116:119], v5 offset:34816
    v_mfma_f32_16x16x32_bf16 v[56:59], v[168:171], v[144:147], v[56:59]
    ds_read_b128 v[120:123], v5 offset:36864
    v_mfma_f32_16x16x32_bf16 v[60:63], v[172:175], v[144:147], v[60:63]
    ds_read_b128 v[124:127], v5 offset:38912
    v_mfma_f32_16x16x32_bf16 v[64:67], v[160:163], v[148:151], v[64:67]
    ds_read_b128 v[128:131], v8 offset:49152
    v_mfma_f32_16x16x32_bf16 v[68:71], v[164:167], v[148:151], v[68:71]
    ds_read_b128 v[132:135], v8 offset:51200
    v_mfma_f32_16x16x32_bf16 v[72:75], v[168:171], v[148:151], v[72:75]
    ds_read_b128 v[136:139], v8 offset:53248
    v_mfma_f32_16x16x32_bf16 v[76:79], v[172:175], v[148:151], v[76:79]
    ds_read_b128 v[140:143], v8 offset:55296
    v_mfma_f32_16x16x32_bf16 v[80:83], v[160:163], v[152:155], v[80:83]
    v_mfma_f32_16x16x32_bf16 v[84:87], v[164:167], v[152:155], v[84:87]
    v_mfma_f32_16x16x32_bf16 v[88:91], v[168:171], v[152:155], v[88:91]
    v_mfma_f32_16x16x32_bf16 v[92:95], v[172:175], v[152:155], v[92:95]
    v_mfma_f32_16x16x32_bf16 v[96:99], v[160:163], v[156:159], v[96:99]
    v_mfma_f32_16x16x32_bf16 v[100:103], v[164:167], v[156:159], v[100:103]
    v_mfma_f32_16x16x32_bf16 v[104:107], v[168:171], v[156:159], v[104:107]
    v_mfma_f32_16x16x32_bf16 v[108:111], v[172:175], v[156:159], v[108:111]
    s_waitcnt lgkmcnt(0)
    v_mfma_f32_16x16x32_bf16 v[48:51], v[128:131], v[112:115], v[48:51]
    ds_read_b128 v[144:147], v5 offset:33792
    v_mfma_f32_16x16x32_bf16 v[52:55], v[132:135], v[112:115], v[52:55]
    ds_read_b128 v[148:151], v5 offset:35840
    v_mfma_f32_16x16x32_bf16 v[56:59], v[136:139], v[112:115], v[56:59]
    ds_read_b128 v[152:155], v5 offset:37888
    v_mfma_f32_16x16x32_bf16 v[60:63], v[140:143], v[112:115], v[60:63]
    ds_read_b128 v[156:159], v5 offset:39936
    v_mfma_f32_16x16x32_bf16 v[64:67], v[128:131], v[116:119], v[64:67]
    ds_read_b128 v[160:163], v8 offset:50176
    v_mfma_f32_16x16x32_bf16 v[68:71], v[132:135], v[116:119], v[68:71]
    ds_read_b128 v[164:167], v8 offset:52224
    v_mfma_f32_16x16x32_bf16 v[72:75], v[136:139], v[116:119], v[72:75]
    ds_read_b128 v[168:171], v8 offset:54272
    v_mfma_f32_16x16x32_bf16 v[76:79], v[140:143], v[116:119], v[76:79]
    ds_read_b128 v[172:175], v8 offset:56320
    v_mfma_f32_16x16x32_bf16 v[80:83], v[128:131], v[120:123], v[80:83]
    v_mfma_f32_16x16x32_bf16 v[84:87], v[132:135], v[120:123], v[84:87]
    v_mfma_f32_16x16x32_bf16 v[88:91], v[136:139], v[120:123], v[88:91]
    v_mfma_f32_16x16x32_bf16 v[92:95], v[140:143], v[120:123], v[92:95]
    v_mfma_f32_16x16x32_bf16 v[96:99], v[128:131], v[124:127], v[96:99]
    v_mfma_f32_16x16x32_bf16 v[100:103], v[132:135], v[124:127], v[100:103]
    v_mfma_f32_16x16x32_bf16 v[104:107], v[136:139], v[124:127], v[104:107]
    v_mfma_f32_16x16x32_bf16 v[108:111], v[140:143], v[124:127], v[108:111]
    s_waitcnt lgkmcnt(0)
    s_barrier
    v_mfma_f32_16x16x32_bf16 v[48:51], v[160:163], v[144:147], v[48:51]
    ds_read_b128 v[112:115], v4 offset:0
    v_mfma_f32_16x16x32_bf16 v[52:55], v[164:167], v[144:147], v[52:55]
    ds_read_b128 v[116:119], v4 offset:2048
    v_mfma_f32_16x16x32_bf16 v[56:59], v[168:171], v[144:147], v[56:59]
    ds_read_b128 v[120:123], v4 offset:4096
    v_mfma_f32_16x16x32_bf16 v[60:63], v[172:175], v[144:147], v[60:63]
    ds_read_b128 v[124:127], v4 offset:6144
    v_mfma_f32_16x16x32_bf16 v[64:67], v[160:163], v[148:151], v[64:67]
    ds_read_b128 v[128:131], v7 offset:16384
    v_mfma_f32_16x16x32_bf16 v[68:71], v[164:167], v[148:151], v[68:71]
    ds_read_b128 v[132:135], v7 offset:18432
    v_mfma_f32_16x16x32_bf16 v[72:75], v[168:171], v[148:151], v[72:75]
    ds_read_b128 v[136:139], v7 offset:20480
    v_mfma_f32_16x16x32_bf16 v[76:79], v[172:175], v[148:151], v[76:79]
    ds_read_b128 v[140:143], v7 offset:22528
    v_mfma_f32_16x16x32_bf16 v[80:83], v[160:163], v[152:155], v[80:83]
    v_mfma_f32_16x16x32_bf16 v[84:87], v[164:167], v[152:155], v[84:87]
    v_mfma_f32_16x16x32_bf16 v[88:91], v[168:171], v[152:155], v[88:91]
    v_mfma_f32_16x16x32_bf16 v[92:95], v[172:175], v[152:155], v[92:95]
    v_mfma_f32_16x16x32_bf16 v[96:99], v[160:163], v[156:159], v[96:99]
    v_mfma_f32_16x16x32_bf16 v[100:103], v[164:167], v[156:159], v[100:103]
    v_mfma_f32_16x16x32_bf16 v[104:107], v[168:171], v[156:159], v[104:107]
    v_mfma_f32_16x16x32_bf16 v[108:111], v[172:175], v[156:159], v[108:111]
    s_waitcnt lgkmcnt(0)
    v_mfma_f32_16x16x32_bf16 v[48:51], v[128:131], v[112:115], v[48:51]
    ds_read_b128 v[144:147], v4 offset:1024
    v_mfma_f32_16x16x32_bf16 v[52:55], v[132:135], v[112:115], v[52:55]
    ds_read_b128 v[148:151], v4 offset:3072
    v_mfma_f32_16x16x32_bf16 v[56:59], v[136:139], v[112:115], v[56:59]
    ds_read_b128 v[152:155], v4 offset:5120
    v_mfma_f32_16x16x32_bf16 v[60:63], v[140:143], v[112:115], v[60:63]
    ds_read_b128 v[156:159], v4 offset:7168
    v_mfma_f32_16x16x32_bf16 v[64:67], v[128:131], v[116:119], v[64:67]
    ds_read_b128 v[160:163], v7 offset:17408
    v_mfma_f32_16x16x32_bf16 v[68:71], v[132:135], v[116:119], v[68:71]
    ds_read_b128 v[164:167], v7 offset:19456
    v_mfma_f32_16x16x32_bf16 v[72:75], v[136:139], v[116:119], v[72:75]
    ds_read_b128 v[168:171], v7 offset:21504
    v_mfma_f32_16x16x32_bf16 v[76:79], v[140:143], v[116:119], v[76:79]
    ds_read_b128 v[172:175], v7 offset:23552
    v_mfma_f32_16x16x32_bf16 v[80:83], v[128:131], v[120:123], v[80:83]
    v_mfma_f32_16x16x32_bf16 v[84:87], v[132:135], v[120:123], v[84:87]
    v_mfma_f32_16x16x32_bf16 v[88:91], v[136:139], v[120:123], v[88:91]
    v_mfma_f32_16x16x32_bf16 v[92:95], v[140:143], v[120:123], v[92:95]
    v_mfma_f32_16x16x32_bf16 v[96:99], v[128:131], v[124:127], v[96:99]
    v_mfma_f32_16x16x32_bf16 v[100:103], v[132:135], v[124:127], v[100:103]
    v_mfma_f32_16x16x32_bf16 v[104:107], v[136:139], v[124:127], v[104:107]
    v_mfma_f32_16x16x32_bf16 v[108:111], v[140:143], v[124:127], v[108:111]
    s_waitcnt lgkmcnt(0)
    s_barrier
    v_mfma_f32_16x16x32_bf16 v[48:51], v[160:163], v[144:147], v[48:51]
    ds_read_b128 v[112:115], v4 offset:32768
    v_mfma_f32_16x16x32_bf16 v[52:55], v[164:167], v[144:147], v[52:55]
    ds_read_b128 v[116:119], v4 offset:34816
    v_mfma_f32_16x16x32_bf16 v[56:59], v[168:171], v[144:147], v[56:59]
    ds_read_b128 v[120:123], v4 offset:36864
    v_mfma_f32_16x16x32_bf16 v[60:63], v[172:175], v[144:147], v[60:63]
    ds_read_b128 v[124:127], v4 offset:38912
    v_mfma_f32_16x16x32_bf16 v[64:67], v[160:163], v[148:151], v[64:67]
    ds_read_b128 v[128:131], v7 offset:49152
    v_mfma_f32_16x16x32_bf16 v[68:71], v[164:167], v[148:151], v[68:71]
    ds_read_b128 v[132:135], v7 offset:51200
    v_mfma_f32_16x16x32_bf16 v[72:75], v[168:171], v[148:151], v[72:75]
    ds_read_b128 v[136:139], v7 offset:53248
    v_mfma_f32_16x16x32_bf16 v[76:79], v[172:175], v[148:151], v[76:79]
    ds_read_b128 v[140:143], v7 offset:55296
    v_mfma_f32_16x16x32_bf16 v[80:83], v[160:163], v[152:155], v[80:83]
    v_mfma_f32_16x16x32_bf16 v[84:87], v[164:167], v[152:155], v[84:87]
    v_mfma_f32_16x16x32_bf16 v[88:91], v[168:171], v[152:155], v[88:91]
    v_mfma_f32_16x16x32_bf16 v[92:95], v[172:175], v[152:155], v[92:95]
    v_mfma_f32_16x16x32_bf16 v[96:99], v[160:163], v[156:159], v[96:99]
    v_mfma_f32_16x16x32_bf16 v[100:103], v[164:167], v[156:159], v[100:103]
    v_mfma_f32_16x16x32_bf16 v[104:107], v[168:171], v[156:159], v[104:107]
    v_mfma_f32_16x16x32_bf16 v[108:111], v[172:175], v[156:159], v[108:111]
    s_waitcnt lgkmcnt(0)
    v_mfma_f32_16x16x32_bf16 v[48:51], v[128:131], v[112:115], v[48:51]
    ds_read_b128 v[144:147], v4 offset:33792
    v_mfma_f32_16x16x32_bf16 v[52:55], v[132:135], v[112:115], v[52:55]
    ds_read_b128 v[148:151], v4 offset:35840
    v_mfma_f32_16x16x32_bf16 v[56:59], v[136:139], v[112:115], v[56:59]
    ds_read_b128 v[152:155], v4 offset:37888
    v_mfma_f32_16x16x32_bf16 v[60:63], v[140:143], v[112:115], v[60:63]
    ds_read_b128 v[156:159], v4 offset:39936
    v_mfma_f32_16x16x32_bf16 v[64:67], v[128:131], v[116:119], v[64:67]
    ds_read_b128 v[160:163], v7 offset:50176
    v_mfma_f32_16x16x32_bf16 v[68:71], v[132:135], v[116:119], v[68:71]
    ds_read_b128 v[164:167], v7 offset:52224
    v_mfma_f32_16x16x32_bf16 v[72:75], v[136:139], v[116:119], v[72:75]
    ds_read_b128 v[168:171], v7 offset:54272
    v_mfma_f32_16x16x32_bf16 v[76:79], v[140:143], v[116:119], v[76:79]
    ds_read_b128 v[172:175], v7 offset:56320
    v_mfma_f32_16x16x32_bf16 v[80:83], v[128:131], v[120:123], v[80:83]
    v_mfma_f32_16x16x32_bf16 v[84:87], v[132:135], v[120:123], v[84:87]
    v_mfma_f32_16x16x32_bf16 v[88:91], v[136:139], v[120:123], v[88:91]
    v_mfma_f32_16x16x32_bf16 v[92:95], v[140:143], v[120:123], v[92:95]
    v_mfma_f32_16x16x32_bf16 v[96:99], v[128:131], v[124:127], v[96:99]
    v_mfma_f32_16x16x32_bf16 v[100:103], v[132:135], v[124:127], v[100:103]
    v_mfma_f32_16x16x32_bf16 v[104:107], v[136:139], v[124:127], v[104:107]
    v_mfma_f32_16x16x32_bf16 v[108:111], v[140:143], v[124:127], v[108:111]
    s_waitcnt lgkmcnt(0)
    v_mfma_f32_16x16x32_bf16 v[48:51], v[160:163], v[144:147], v[48:51]
    v_mfma_f32_16x16x32_bf16 v[52:55], v[164:167], v[144:147], v[52:55]
    v_mfma_f32_16x16x32_bf16 v[56:59], v[168:171], v[144:147], v[56:59]
    v_mfma_f32_16x16x32_bf16 v[60:63], v[172:175], v[144:147], v[60:63]
    v_mfma_f32_16x16x32_bf16 v[64:67], v[160:163], v[148:151], v[64:67]
    v_mfma_f32_16x16x32_bf16 v[68:71], v[164:167], v[148:151], v[68:71]
    v_mfma_f32_16x16x32_bf16 v[72:75], v[168:171], v[148:151], v[72:75]
    v_mfma_f32_16x16x32_bf16 v[76:79], v[172:175], v[148:151], v[76:79]
    v_mfma_f32_16x16x32_bf16 v[80:83], v[160:163], v[152:155], v[80:83]
    v_mfma_f32_16x16x32_bf16 v[84:87], v[164:167], v[152:155], v[84:87]
    v_mfma_f32_16x16x32_bf16 v[88:91], v[168:171], v[152:155], v[88:91]
    v_mfma_f32_16x16x32_bf16 v[92:95], v[172:175], v[152:155], v[92:95]
    v_mfma_f32_16x16x32_bf16 v[96:99], v[160:163], v[156:159], v[96:99]
    v_mfma_f32_16x16x32_bf16 v[100:103], v[164:167], v[156:159], v[100:103]
    v_mfma_f32_16x16x32_bf16 v[104:107], v[168:171], v[156:159], v[104:107]
    v_mfma_f32_16x16x32_bf16 v[108:111], v[172:175], v[156:159], v[108:111]
    s_waitcnt vmcnt(0)
    v_and_b32 v43, 15, v1
    v_lshlrev_b32 v44, 3, v43
    s_lshl_b32 s17, s15, 9
    s_add_u32 s17, s17, 131072
    v_add_u32 v44, s17, v44
    ds_read_b64 v[10:11], v44 offset:0
    ds_read_b64 v[12:13], v44 offset:128
    ds_read_b64 v[14:15], v44 offset:256
    ds_read_b64 v[16:17], v44 offset:384
    s_waitcnt lgkmcnt(0)
    v_pk_fma_f32 v[48:49], v[10:11], v[26:27], v[48:49] op_sel_hi:[0,1,1] neg_lo:[1,0,0] neg_hi:[1,0,0]
    v_pk_mul_f32 v[48:49], v[10:11], v[48:49] op_sel:[1,0] op_sel_hi:[1,1]
    v_pk_fma_f32 v[50:51], v[10:11], v[28:29], v[50:51] op_sel_hi:[0,1,1] neg_lo:[1,0,0] neg_hi:[1,0,0]
    v_pk_mul_f32 v[50:51], v[10:11], v[50:51] op_sel:[1,0] op_sel_hi:[1,1]
    v_pk_fma_f32 v[52:53], v[10:11], v[30:31], v[52:53] op_sel_hi:[0,1,1] neg_lo:[1,0,0] neg_hi:[1,0,0]
    v_pk_mul_f32 v[52:53], v[10:11], v[52:53] op_sel:[1,0] op_sel_hi:[1,1]
    v_pk_fma_f32 v[54:55], v[10:11], v[32:33], v[54:55] op_sel_hi:[0,1,1] neg_lo:[1,0,0] neg_hi:[1,0,0]
    v_pk_mul_f32 v[54:55], v[10:11], v[54:55] op_sel:[1,0] op_sel_hi:[1,1]
    v_pk_fma_f32 v[56:57], v[10:11], v[34:35], v[56:57] op_sel_hi:[0,1,1] neg_lo:[1,0,0] neg_hi:[1,0,0]
    v_pk_mul_f32 v[56:57], v[10:11], v[56:57] op_sel:[1,0] op_sel_hi:[1,1]
    v_pk_fma_f32 v[58:59], v[10:11], v[36:37], v[58:59] op_sel_hi:[0,1,1] neg_lo:[1,0,0] neg_hi:[1,0,0]
    v_pk_mul_f32 v[58:59], v[10:11], v[58:59] op_sel:[1,0] op_sel_hi:[1,1]
    v_pk_fma_f32 v[60:61], v[10:11], v[38:39], v[60:61] op_sel_hi:[0,1,1] neg_lo:[1,0,0] neg_hi:[1,0,0]
    v_pk_mul_f32 v[60:61], v[10:11], v[60:61] op_sel:[1,0] op_sel_hi:[1,1]
    v_pk_fma_f32 v[62:63], v[10:11], v[40:41], v[62:63] op_sel_hi:[0,1,1] neg_lo:[1,0,0] neg_hi:[1,0,0]
    v_pk_mul_f32 v[62:63], v[10:11], v[62:63] op_sel:[1,0] op_sel_hi:[1,1]
    v_pk_fma_f32 v[64:65], v[12:13], v[26:27], v[64:65] op_sel_hi:[0,1,1] neg_lo:[1,0,0] neg_hi:[1,0,0]
    v_pk_mul_f32 v[64:65], v[12:13], v[64:65] op_sel:[1,0] op_sel_hi:[1,1]
    v_pk_fma_f32 v[66:67], v[12:13], v[28:29], v[66:67] op_sel_hi:[0,1,1] neg_lo:[1,0,0] neg_hi:[1,0,0]
    v_pk_mul_f32 v[66:67], v[12:13], v[66:67] op_sel:[1,0] op_sel_hi:[1,1]
    v_pk_fma_f32 v[68:69], v[12:13], v[30:31], v[68:69] op_sel_hi:[0,1,1] neg_lo:[1,0,0] neg_hi:[1,0,0]
    v_pk_mul_f32 v[68:69], v[12:13], v[68:69] op_sel:[1,0] op_sel_hi:[1,1]
    v_pk_fma_f32 v[70:71], v[12:13], v[32:33], v[70:71] op_sel_hi:[0,1,1] neg_lo:[1,0,0] neg_hi:[1,0,0]
    v_pk_mul_f32 v[70:71], v[12:13], v[70:71] op_sel:[1,0] op_sel_hi:[1,1]
    v_pk_fma_f32 v[72:73], v[12:13], v[34:35], v[72:73] op_sel_hi:[0,1,1] neg_lo:[1,0,0] neg_hi:[1,0,0]
    v_pk_mul_f32 v[72:73], v[12:13], v[72:73] op_sel:[1,0] op_sel_hi:[1,1]
    v_pk_fma_f32 v[74:75], v[12:13], v[36:37], v[74:75] op_sel_hi:[0,1,1] neg_lo:[1,0,0] neg_hi:[1,0,0]
    v_pk_mul_f32 v[74:75], v[12:13], v[74:75] op_sel:[1,0] op_sel_hi:[1,1]
    v_pk_fma_f32 v[76:77], v[12:13], v[38:39], v[76:77] op_sel_hi:[0,1,1] neg_lo:[1,0,0] neg_hi:[1,0,0]
    v_pk_mul_f32 v[76:77], v[12:13], v[76:77] op_sel:[1,0] op_sel_hi:[1,1]
    v_pk_fma_f32 v[78:79], v[12:13], v[40:41], v[78:79] op_sel_hi:[0,1,1] neg_lo:[1,0,0] neg_hi:[1,0,0]
    v_pk_mul_f32 v[78:79], v[12:13], v[78:79] op_sel:[1,0] op_sel_hi:[1,1]
    v_pk_fma_f32 v[80:81], v[14:15], v[26:27], v[80:81] op_sel_hi:[0,1,1] neg_lo:[1,0,0] neg_hi:[1,0,0]
    v_pk_mul_f32 v[80:81], v[14:15], v[80:81] op_sel:[1,0] op_sel_hi:[1,1]
    v_pk_fma_f32 v[82:83], v[14:15], v[28:29], v[82:83] op_sel_hi:[0,1,1] neg_lo:[1,0,0] neg_hi:[1,0,0]
    v_pk_mul_f32 v[82:83], v[14:15], v[82:83] op_sel:[1,0] op_sel_hi:[1,1]
    v_pk_fma_f32 v[84:85], v[14:15], v[30:31], v[84:85] op_sel_hi:[0,1,1] neg_lo:[1,0,0] neg_hi:[1,0,0]
    v_pk_mul_f32 v[84:85], v[14:15], v[84:85] op_sel:[1,0] op_sel_hi:[1,1]
    v_pk_fma_f32 v[86:87], v[14:15], v[32:33], v[86:87] op_sel_hi:[0,1,1] neg_lo:[1,0,0] neg_hi:[1,0,0]
    v_pk_mul_f32 v[86:87], v[14:15], v[86:87] op_sel:[1,0] op_sel_hi:[1,1]
    v_pk_fma_f32 v[88:89], v[14:15], v[34:35], v[88:89] op_sel_hi:[0,1,1] neg_lo:[1,0,0] neg_hi:[1,0,0]
    v_pk_mul_f32 v[88:89], v[14:15], v[88:89] op_sel:[1,0] op_sel_hi:[1,1]
    v_pk_fma_f32 v[90:91], v[14:15], v[36:37], v[90:91] op_sel_hi:[0,1,1] neg_lo:[1,0,0] neg_hi:[1,0,0]
    v_pk_mul_f32 v[90:91], v[14:15], v[90:91] op_sel:[1,0] op_sel_hi:[1,1]
    v_pk_fma_f32 v[92:93], v[14:15], v[38:39], v[92:93] op_sel_hi:[0,1,1] neg_lo:[1,0,0] neg_hi:[1,0,0]
    v_pk_mul_f32 v[92:93], v[14:15], v[92:93] op_sel:[1,0] op_sel_hi:[1,1]
    v_pk_fma_f32 v[94:95], v[14:15], v[40:41], v[94:95] op_sel_hi:[0,1,1] neg_lo:[1,0,0] neg_hi:[1,0,0]
    v_pk_mul_f32 v[94:95], v[14:15], v[94:95] op_sel:[1,0] op_sel_hi:[1,1]
    v_pk_fma_f32 v[96:97], v[16:17], v[26:27], v[96:97] op_sel_hi:[0,1,1] neg_lo:[1,0,0] neg_hi:[1,0,0]
    v_pk_mul_f32 v[96:97], v[16:17], v[96:97] op_sel:[1,0] op_sel_hi:[1,1]
    v_pk_fma_f32 v[98:99], v[16:17], v[28:29], v[98:99] op_sel_hi:[0,1,1] neg_lo:[1,0,0] neg_hi:[1,0,0]
    v_pk_mul_f32 v[98:99], v[16:17], v[98:99] op_sel:[1,0] op_sel_hi:[1,1]
    v_pk_fma_f32 v[100:101], v[16:17], v[30:31], v[100:101] op_sel_hi:[0,1,1] neg_lo:[1,0,0] neg_hi:[1,0,0]
    v_pk_mul_f32 v[100:101], v[16:17], v[100:101] op_sel:[1,0] op_sel_hi:[1,1]
    v_pk_fma_f32 v[102:103], v[16:17], v[32:33], v[102:103] op_sel_hi:[0,1,1] neg_lo:[1,0,0] neg_hi:[1,0,0]
    v_pk_mul_f32 v[102:103], v[16:17], v[102:103] op_sel:[1,0] op_sel_hi:[1,1]
    v_pk_fma_f32 v[104:105], v[16:17], v[34:35], v[104:105] op_sel_hi:[0,1,1] neg_lo:[1,0,0] neg_hi:[1,0,0]
    v_pk_mul_f32 v[104:105], v[16:17], v[104:105] op_sel:[1,0] op_sel_hi:[1,1]
    v_pk_fma_f32 v[106:107], v[16:17], v[36:37], v[106:107] op_sel_hi:[0,1,1] neg_lo:[1,0,0] neg_hi:[1,0,0]
    v_pk_mul_f32 v[106:107], v[16:17], v[106:107] op_sel:[1,0] op_sel_hi:[1,1]
    v_pk_fma_f32 v[108:109], v[16:17], v[38:39], v[108:109] op_sel_hi:[0,1,1] neg_lo:[1,0,0] neg_hi:[1,0,0]
    v_pk_mul_f32 v[108:109], v[16:17], v[108:109] op_sel:[1,0] op_sel_hi:[1,1]
    v_pk_fma_f32 v[110:111], v[16:17], v[40:41], v[110:111] op_sel_hi:[0,1,1] neg_lo:[1,0,0] neg_hi:[1,0,0]
    v_pk_mul_f32 v[110:111], v[16:17], v[110:111] op_sel:[1,0] op_sel_hi:[1,1]
    s_cmp_ge_u32 s14, 5
    s_cselect_b32 s17, 1, 0
    s_mul_i32 s18, s17, 5
    s_sub_u32 s18, s14, s18
    s_lshl_b32 s19, s13, 7
    s_lshl_b32 s20, s15, 6
    s_add_u32 s19, s19, s20
    s_cmp_eq_u32 s18, 4
    s_cbranch_scc1 qkv1_kernel_tail
    v_lshrrev_b32 v44, 1, v2
    v_lshlrev_b32 v44, 16, v44
    v_lshlrev_b32 v45, 5, v43
    v_add_u32 v44, v44, v45
    v_and_b32 v45, 1, v2
    v_lshlrev_b32 v45, 4, v45
    v_add_u32 v44, v44, v45
    s_lshl_b32 s20, s17, 21
    s_add_u32 s20, s20, 23068672
    s_lshl_b32 s21, s18, 19
    s_add_u32 s20, s20, s21
    s_lshl_b32 s21, s16, 18
    s_add_u32 s20, s20, s21
    s_lshl_b32 s21, s19, 5
    s_add_u32 s20, s20, s21
    s_add_u32 s21, s20, 131072
    v_cvt_pk_bf16_f32 v18, v48, v49
    v_cvt_pk_bf16_f32 v19, v50, v51
    v_cvt_pk_bf16_f32 v20, v52, v53
    v_cvt_pk_bf16_f32 v21, v54, v55
    buffer_store_dwordx4 v[18:21], v44, s[4:7], s20 offen offset:0
    v_cvt_pk_bf16_f32 v22, v56, v57
    v_cvt_pk_bf16_f32 v23, v58, v59
    v_cvt_pk_bf16_f32 v24, v60, v61
    v_cvt_pk_bf16_f32 v25, v62, v63
    buffer_store_dwordx4 v[22:25], v44, s[4:7], s21 offen offset:0
    v_cvt_pk_bf16_f32 v18, v64, v65
    v_cvt_pk_bf16_f32 v19, v66, v67
    v_cvt_pk_bf16_f32 v20, v68, v69
    v_cvt_pk_bf16_f32 v21, v70, v71
    buffer_store_dwordx4 v[18:21], v44, s[4:7], s20 offen offset:512
    v_cvt_pk_bf16_f32 v22, v72, v73
    v_cvt_pk_bf16_f32 v23, v74, v75
    v_cvt_pk_bf16_f32 v24, v76, v77
    v_cvt_pk_bf16_f32 v25, v78, v79
    buffer_store_dwordx4 v[22:25], v44, s[4:7], s21 offen offset:512
    v_cvt_pk_bf16_f32 v18, v80, v81
    v_cvt_pk_bf16_f32 v19, v82, v83
    v_cvt_pk_bf16_f32 v20, v84, v85
    v_cvt_pk_bf16_f32 v21, v86, v87
    buffer_store_dwordx4 v[18:21], v44, s[4:7], s20 offen offset:1024
    v_cvt_pk_bf16_f32 v22, v88, v89
    v_cvt_pk_bf16_f32 v23, v90, v91
    v_cvt_pk_bf16_f32 v24, v92, v93
    v_cvt_pk_bf16_f32 v25, v94, v95
    buffer_store_dwordx4 v[22:25], v44, s[4:7], s21 offen offset:1024
    v_cvt_pk_bf16_f32 v18, v96, v97
    v_cvt_pk_bf16_f32 v19, v98, v99
    v_cvt_pk_bf16_f32 v20, v100, v101
    v_cvt_pk_bf16_f32 v21, v102, v103
    buffer_store_dwordx4 v[18:21], v44, s[4:7], s20 offen offset:1536
    v_cvt_pk_bf16_f32 v22, v104, v105
    v_cvt_pk_bf16_f32 v23, v106, v107
    v_cvt_pk_bf16_f32 v24, v108, v109
    v_cvt_pk_bf16_f32 v25, v110, v111
    buffer_store_dwordx4 v[22:25], v44, s[4:7], s21 offen offset:1536
    s_endpgm
    s_nop 2
qkv1_kernel_tail:
    v_lshlrev_b32 v44, 15, v2
    v_lshlrev_b32 v45, 3, v43
    v_add_u32 v44, v44, v45
    s_lshl_b32 s20, s17, 19
    s_add_u32 s20, s20, 27262976
    s_lshl_b32 s21, s16, 18
    s_add_u32 s20, s20, s21
    s_lshl_b32 s21, s19, 3
    s_add_u32 s20, s20, s21
    s_add_u32 s40, s20, 0
    s_add_u32 s41, s20, 16384
    s_add_u32 s42, s20, 131072
    s_add_u32 s43, s20, 147456
    v_cvt_pk_bf16_f32 v18, v48, v49
    v_cvt_pk_bf16_f32 v19, v50, v51
    buffer_store_dwordx2 v[18:19], v44, s[4:7], s40 offen offset:0
    v_cvt_pk_bf16_f32 v20, v52, v53
    v_cvt_pk_bf16_f32 v21, v54, v55
    buffer_store_dwordx2 v[20:21], v44, s[4:7], s41 offen offset:0
    v_cvt_pk_bf16_f32 v22, v56, v57
    v_cvt_pk_bf16_f32 v23, v58, v59
    buffer_store_dwordx2 v[22:23], v44, s[4:7], s42 offen offset:0
    v_cvt_pk_bf16_f32 v24, v60, v61
    v_cvt_pk_bf16_f32 v25, v62, v63
    buffer_store_dwordx2 v[24:25], v44, s[4:7], s43 offen offset:0
    v_cvt_pk_bf16_f32 v18, v64, v65
    v_cvt_pk_bf16_f32 v19, v66, v67
    buffer_store_dwordx2 v[18:19], v44, s[4:7], s40 offen offset:128
    v_cvt_pk_bf16_f32 v20, v68, v69
    v_cvt_pk_bf16_f32 v21, v70, v71
    buffer_store_dwordx2 v[20:21], v44, s[4:7], s41 offen offset:128
    v_cvt_pk_bf16_f32 v22, v72, v73
    v_cvt_pk_bf16_f32 v23, v74, v75
    buffer_store_dwordx2 v[22:23], v44, s[4:7], s42 offen offset:128
    v_cvt_pk_bf16_f32 v24, v76, v77
    v_cvt_pk_bf16_f32 v25, v78, v79
    buffer_store_dwordx2 v[24:25], v44, s[4:7], s43 offen offset:128
    v_cvt_pk_bf16_f32 v18, v80, v81
    v_cvt_pk_bf16_f32 v19, v82, v83
    buffer_store_dwordx2 v[18:19], v44, s[4:7], s40 offen offset:256
    v_cvt_pk_bf16_f32 v20, v84, v85
    v_cvt_pk_bf16_f32 v21, v86, v87
    buffer_store_dwordx2 v[20:21], v44, s[4:7], s41 offen offset:256
    v_cvt_pk_bf16_f32 v22, v88, v89
    v_cvt_pk_bf16_f32 v23, v90, v91
    buffer_store_dwordx2 v[22:23], v44, s[4:7], s42 offen offset:256
    v_cvt_pk_bf16_f32 v24, v92, v93
    v_cvt_pk_bf16_f32 v25, v94, v95
    buffer_store_dwordx2 v[24:25], v44, s[4:7], s43 offen offset:256
    v_cvt_pk_bf16_f32 v18, v96, v97
    v_cvt_pk_bf16_f32 v19, v98, v99
    buffer_store_dwordx2 v[18:19], v44, s[4:7], s40 offen offset:384
    v_cvt_pk_bf16_f32 v20, v100, v101
    v_cvt_pk_bf16_f32 v21, v102, v103
    buffer_store_dwordx2 v[20:21], v44, s[4:7], s41 offen offset:384
    v_cvt_pk_bf16_f32 v22, v104, v105
    v_cvt_pk_bf16_f32 v23, v106, v107
    buffer_store_dwordx2 v[22:23], v44, s[4:7], s42 offen offset:384
    v_cvt_pk_bf16_f32 v24, v108, v109
    v_cvt_pk_bf16_f32 v25, v110, v111
    buffer_store_dwordx2 v[24:25], v44, s[4:7], s43 offen offset:384
    s_endpgm
    s_nop 2
qkv1_kernel_v:
    v_and_b32 v43, 15, v1
    v_lshlrev_b32 v42, 2, v43
    s_lshl_b32 s17, s14, 9
    s_lshl_b32 s18, s16, 8
    s_add_u32 s17, s17, s18
    s_add_u32 s17, s17, 9240576
    buffer_load_dword v26, v42, s[4:7], s17 offen offset:0
    buffer_load_dword v27, v42, s[4:7], s17 offen offset:64
    buffer_load_dword v28, v42, s[4:7], s17 offen offset:128
    buffer_load_dword v29, v42, s[4:7], s17 offen offset:192
    s_waitcnt vmcnt(4)
    v_add_f32 v10, v10, v12
    v_add_f32 v11, v11, v13
    v_add_f32 v10, v10, v14
    v_add_f32 v11, v11, v15
    v_add_f32 v10, v10, v16
    v_add_f32 v11, v11, v17
    v_add_f32 v10, v10, v18
    v_add_f32 v11, v11, v19
    v_add_f32 v10, v10, v20
    v_add_f32 v11, v11, v21
    v_add_f32 v10, v10, v22
    v_add_f32 v11, v11, v23
    v_add_f32 v10, v10, v24
    v_add_f32 v11, v11, v25
    v_mul_f32 v10, 0x3acccccd, v10
    v_mul_f32 v11, 0x3acccccd, v11
    v_fma_f32 v11, -v10, v10, v11
    v_max_f32 v11, 0, v11
    v_cvt_pk_bf16_f32 v10, v10, v10
    v_lshlrev_b32 v10, 16, v10
    v_cvt_pk_bf16_f32 v11, v11, v11
    v_lshlrev_b32 v11, 16, v11
    v_add_f32 v11, 0x3727c5ac, v11
    v_cvt_pk_bf16_f32 v11, v11, v11
    v_lshlrev_b32 v11, 16, v11
    v_sqrt_f32 v11, v11
    s_nop 0
    v_cvt_pk_bf16_f32 v11, v11, v11
    v_lshlrev_b32 v11, 16, v11
    v_rcp_f32 v11, v11
    v_and_b32 v12, 127, v0
    v_lshlrev_b32 v12, 3, v12
    v_add_u32 v12, 131072, v12
    ds_write_b64 v12, v[10:11]
    s_waitcnt lgkmcnt(0)
    s_barrier
    ds_read_b128 v[112:115], v4 offset:0
    ds_read_b128 v[116:119], v4 offset:2048
    ds_read_b128 v[120:123], v4 offset:4096
    ds_read_b128 v[124:127], v4 offset:6144
    ds_read_b128 v[128:131], v7 offset:16384
    ds_read_b128 v[132:135], v7 offset:18432
    ds_read_b128 v[136:139], v7 offset:20480
    ds_read_b128 v[140:143], v7 offset:22528
    s_waitcnt lgkmcnt(0)
    v_mfma_f32_16x16x32_bf16 v[48:51], v[112:115], v[128:131], 0
    ds_read_b128 v[144:147], v4 offset:1024
    v_mfma_f32_16x16x32_bf16 v[52:55], v[112:115], v[132:135], 0
    ds_read_b128 v[148:151], v4 offset:3072
    v_mfma_f32_16x16x32_bf16 v[56:59], v[112:115], v[136:139], 0
    ds_read_b128 v[152:155], v4 offset:5120
    v_mfma_f32_16x16x32_bf16 v[60:63], v[112:115], v[140:143], 0
    ds_read_b128 v[156:159], v4 offset:7168
    v_mfma_f32_16x16x32_bf16 v[64:67], v[116:119], v[128:131], 0
    ds_read_b128 v[160:163], v7 offset:17408
    v_mfma_f32_16x16x32_bf16 v[68:71], v[116:119], v[132:135], 0
    ds_read_b128 v[164:167], v7 offset:19456
    v_mfma_f32_16x16x32_bf16 v[72:75], v[116:119], v[136:139], 0
    ds_read_b128 v[168:171], v7 offset:21504
    v_mfma_f32_16x16x32_bf16 v[76:79], v[116:119], v[140:143], 0
    ds_read_b128 v[172:175], v7 offset:23552
    v_mfma_f32_16x16x32_bf16 v[80:83], v[120:123], v[128:131], 0
    v_mfma_f32_16x16x32_bf16 v[84:87], v[120:123], v[132:135], 0
    v_mfma_f32_16x16x32_bf16 v[88:91], v[120:123], v[136:139], 0
    v_mfma_f32_16x16x32_bf16 v[92:95], v[120:123], v[140:143], 0
    v_mfma_f32_16x16x32_bf16 v[96:99], v[124:127], v[128:131], 0
    v_mfma_f32_16x16x32_bf16 v[100:103], v[124:127], v[132:135], 0
    v_mfma_f32_16x16x32_bf16 v[104:107], v[124:127], v[136:139], 0
    v_mfma_f32_16x16x32_bf16 v[108:111], v[124:127], v[140:143], 0
    s_waitcnt lgkmcnt(0)
    s_barrier
    v_mfma_f32_16x16x32_bf16 v[48:51], v[144:147], v[160:163], v[48:51]
    ds_read_b128 v[112:115], v4 offset:32768
    v_mfma_f32_16x16x32_bf16 v[52:55], v[144:147], v[164:167], v[52:55]
    ds_read_b128 v[116:119], v4 offset:34816
    v_mfma_f32_16x16x32_bf16 v[56:59], v[144:147], v[168:171], v[56:59]
    ds_read_b128 v[120:123], v4 offset:36864
    v_mfma_f32_16x16x32_bf16 v[60:63], v[144:147], v[172:175], v[60:63]
    ds_read_b128 v[124:127], v4 offset:38912
    v_mfma_f32_16x16x32_bf16 v[64:67], v[148:151], v[160:163], v[64:67]
    ds_read_b128 v[128:131], v7 offset:49152
    v_mfma_f32_16x16x32_bf16 v[68:71], v[148:151], v[164:167], v[68:71]
    ds_read_b128 v[132:135], v7 offset:51200
    v_mfma_f32_16x16x32_bf16 v[72:75], v[148:151], v[168:171], v[72:75]
    ds_read_b128 v[136:139], v7 offset:53248
    v_mfma_f32_16x16x32_bf16 v[76:79], v[148:151], v[172:175], v[76:79]
    ds_read_b128 v[140:143], v7 offset:55296
    v_mfma_f32_16x16x32_bf16 v[80:83], v[152:155], v[160:163], v[80:83]
    v_mfma_f32_16x16x32_bf16 v[84:87], v[152:155], v[164:167], v[84:87]
    v_mfma_f32_16x16x32_bf16 v[88:91], v[152:155], v[168:171], v[88:91]
    v_mfma_f32_16x16x32_bf16 v[92:95], v[152:155], v[172:175], v[92:95]
    v_mfma_f32_16x16x32_bf16 v[96:99], v[156:159], v[160:163], v[96:99]
    v_mfma_f32_16x16x32_bf16 v[100:103], v[156:159], v[164:167], v[100:103]
    v_mfma_f32_16x16x32_bf16 v[104:107], v[156:159], v[168:171], v[104:107]
    v_mfma_f32_16x16x32_bf16 v[108:111], v[156:159], v[172:175], v[108:111]
    s_waitcnt lgkmcnt(0)
    v_mfma_f32_16x16x32_bf16 v[48:51], v[112:115], v[128:131], v[48:51]
    ds_read_b128 v[144:147], v4 offset:33792
    v_mfma_f32_16x16x32_bf16 v[52:55], v[112:115], v[132:135], v[52:55]
    ds_read_b128 v[148:151], v4 offset:35840
    v_mfma_f32_16x16x32_bf16 v[56:59], v[112:115], v[136:139], v[56:59]
    ds_read_b128 v[152:155], v4 offset:37888
    v_mfma_f32_16x16x32_bf16 v[60:63], v[112:115], v[140:143], v[60:63]
    ds_read_b128 v[156:159], v4 offset:39936
    v_mfma_f32_16x16x32_bf16 v[64:67], v[116:119], v[128:131], v[64:67]
    ds_read_b128 v[160:163], v7 offset:50176
    v_mfma_f32_16x16x32_bf16 v[68:71], v[116:119], v[132:135], v[68:71]
    ds_read_b128 v[164:167], v7 offset:52224
    v_mfma_f32_16x16x32_bf16 v[72:75], v[116:119], v[136:139], v[72:75]
    ds_read_b128 v[168:171], v7 offset:54272
    v_mfma_f32_16x16x32_bf16 v[76:79], v[116:119], v[140:143], v[76:79]
    ds_read_b128 v[172:175], v7 offset:56320
    v_mfma_f32_16x16x32_bf16 v[80:83], v[120:123], v[128:131], v[80:83]
    v_mfma_f32_16x16x32_bf16 v[84:87], v[120:123], v[132:135], v[84:87]
    v_mfma_f32_16x16x32_bf16 v[88:91], v[120:123], v[136:139], v[88:91]
    v_mfma_f32_16x16x32_bf16 v[92:95], v[120:123], v[140:143], v[92:95]
    v_mfma_f32_16x16x32_bf16 v[96:99], v[124:127], v[128:131], v[96:99]
    v_mfma_f32_16x16x32_bf16 v[100:103], v[124:127], v[132:135], v[100:103]
    v_mfma_f32_16x16x32_bf16 v[104:107], v[124:127], v[136:139], v[104:107]
    v_mfma_f32_16x16x32_bf16 v[108:111], v[124:127], v[140:143], v[108:111]
    s_waitcnt lgkmcnt(0)
    s_barrier
    v_mfma_f32_16x16x32_bf16 v[48:51], v[144:147], v[160:163], v[48:51]
    ds_read_b128 v[112:115], v5 offset:0
    v_mfma_f32_16x16x32_bf16 v[52:55], v[144:147], v[164:167], v[52:55]
    ds_read_b128 v[116:119], v5 offset:2048
    v_mfma_f32_16x16x32_bf16 v[56:59], v[144:147], v[168:171], v[56:59]
    ds_read_b128 v[120:123], v5 offset:4096
    v_mfma_f32_16x16x32_bf16 v[60:63], v[144:147], v[172:175], v[60:63]
    ds_read_b128 v[124:127], v5 offset:6144
    v_mfma_f32_16x16x32_bf16 v[64:67], v[148:151], v[160:163], v[64:67]
    ds_read_b128 v[128:131], v8 offset:16384
    v_mfma_f32_16x16x32_bf16 v[68:71], v[148:151], v[164:167], v[68:71]
    ds_read_b128 v[132:135], v8 offset:18432
    v_mfma_f32_16x16x32_bf16 v[72:75], v[148:151], v[168:171], v[72:75]
    ds_read_b128 v[136:139], v8 offset:20480
    v_mfma_f32_16x16x32_bf16 v[76:79], v[148:151], v[172:175], v[76:79]
    ds_read_b128 v[140:143], v8 offset:22528
    v_mfma_f32_16x16x32_bf16 v[80:83], v[152:155], v[160:163], v[80:83]
    v_mfma_f32_16x16x32_bf16 v[84:87], v[152:155], v[164:167], v[84:87]
    v_mfma_f32_16x16x32_bf16 v[88:91], v[152:155], v[168:171], v[88:91]
    v_mfma_f32_16x16x32_bf16 v[92:95], v[152:155], v[172:175], v[92:95]
    v_mfma_f32_16x16x32_bf16 v[96:99], v[156:159], v[160:163], v[96:99]
    v_mfma_f32_16x16x32_bf16 v[100:103], v[156:159], v[164:167], v[100:103]
    v_mfma_f32_16x16x32_bf16 v[104:107], v[156:159], v[168:171], v[104:107]
    v_mfma_f32_16x16x32_bf16 v[108:111], v[156:159], v[172:175], v[108:111]
    s_waitcnt lgkmcnt(0)
    v_mfma_f32_16x16x32_bf16 v[48:51], v[112:115], v[128:131], v[48:51]
    ds_read_b128 v[144:147], v5 offset:1024
    v_mfma_f32_16x16x32_bf16 v[52:55], v[112:115], v[132:135], v[52:55]
    ds_read_b128 v[148:151], v5 offset:3072
    v_mfma_f32_16x16x32_bf16 v[56:59], v[112:115], v[136:139], v[56:59]
    ds_read_b128 v[152:155], v5 offset:5120
    v_mfma_f32_16x16x32_bf16 v[60:63], v[112:115], v[140:143], v[60:63]
    ds_read_b128 v[156:159], v5 offset:7168
    v_mfma_f32_16x16x32_bf16 v[64:67], v[116:119], v[128:131], v[64:67]
    ds_read_b128 v[160:163], v8 offset:17408
    v_mfma_f32_16x16x32_bf16 v[68:71], v[116:119], v[132:135], v[68:71]
    ds_read_b128 v[164:167], v8 offset:19456
    v_mfma_f32_16x16x32_bf16 v[72:75], v[116:119], v[136:139], v[72:75]
    ds_read_b128 v[168:171], v8 offset:21504
    v_mfma_f32_16x16x32_bf16 v[76:79], v[116:119], v[140:143], v[76:79]
    ds_read_b128 v[172:175], v8 offset:23552
    v_mfma_f32_16x16x32_bf16 v[80:83], v[120:123], v[128:131], v[80:83]
    v_mfma_f32_16x16x32_bf16 v[84:87], v[120:123], v[132:135], v[84:87]
    v_mfma_f32_16x16x32_bf16 v[88:91], v[120:123], v[136:139], v[88:91]
    v_mfma_f32_16x16x32_bf16 v[92:95], v[120:123], v[140:143], v[92:95]
    v_mfma_f32_16x16x32_bf16 v[96:99], v[124:127], v[128:131], v[96:99]
    v_mfma_f32_16x16x32_bf16 v[100:103], v[124:127], v[132:135], v[100:103]
    v_mfma_f32_16x16x32_bf16 v[104:107], v[124:127], v[136:139], v[104:107]
    v_mfma_f32_16x16x32_bf16 v[108:111], v[124:127], v[140:143], v[108:111]
    s_waitcnt lgkmcnt(0)
    s_barrier
    v_mfma_f32_16x16x32_bf16 v[48:51], v[144:147], v[160:163], v[48:51]
    ds_read_b128 v[112:115], v5 offset:32768
    v_mfma_f32_16x16x32_bf16 v[52:55], v[144:147], v[164:167], v[52:55]
    ds_read_b128 v[116:119], v5 offset:34816
    v_mfma_f32_16x16x32_bf16 v[56:59], v[144:147], v[168:171], v[56:59]
    ds_read_b128 v[120:123], v5 offset:36864
    v_mfma_f32_16x16x32_bf16 v[60:63], v[144:147], v[172:175], v[60:63]
    ds_read_b128 v[124:127], v5 offset:38912
    v_mfma_f32_16x16x32_bf16 v[64:67], v[148:151], v[160:163], v[64:67]
    ds_read_b128 v[128:131], v8 offset:49152
    v_mfma_f32_16x16x32_bf16 v[68:71], v[148:151], v[164:167], v[68:71]
    ds_read_b128 v[132:135], v8 offset:51200
    v_mfma_f32_16x16x32_bf16 v[72:75], v[148:151], v[168:171], v[72:75]
    ds_read_b128 v[136:139], v8 offset:53248
    v_mfma_f32_16x16x32_bf16 v[76:79], v[148:151], v[172:175], v[76:79]
    ds_read_b128 v[140:143], v8 offset:55296
    v_mfma_f32_16x16x32_bf16 v[80:83], v[152:155], v[160:163], v[80:83]
    v_mfma_f32_16x16x32_bf16 v[84:87], v[152:155], v[164:167], v[84:87]
    v_mfma_f32_16x16x32_bf16 v[88:91], v[152:155], v[168:171], v[88:91]
    v_mfma_f32_16x16x32_bf16 v[92:95], v[152:155], v[172:175], v[92:95]
    v_mfma_f32_16x16x32_bf16 v[96:99], v[156:159], v[160:163], v[96:99]
    v_mfma_f32_16x16x32_bf16 v[100:103], v[156:159], v[164:167], v[100:103]
    v_mfma_f32_16x16x32_bf16 v[104:107], v[156:159], v[168:171], v[104:107]
    v_mfma_f32_16x16x32_bf16 v[108:111], v[156:159], v[172:175], v[108:111]
    s_waitcnt lgkmcnt(0)
    v_mfma_f32_16x16x32_bf16 v[48:51], v[112:115], v[128:131], v[48:51]
    ds_read_b128 v[144:147], v5 offset:33792
    v_mfma_f32_16x16x32_bf16 v[52:55], v[112:115], v[132:135], v[52:55]
    ds_read_b128 v[148:151], v5 offset:35840
    v_mfma_f32_16x16x32_bf16 v[56:59], v[112:115], v[136:139], v[56:59]
    ds_read_b128 v[152:155], v5 offset:37888
    v_mfma_f32_16x16x32_bf16 v[60:63], v[112:115], v[140:143], v[60:63]
    ds_read_b128 v[156:159], v5 offset:39936
    v_mfma_f32_16x16x32_bf16 v[64:67], v[116:119], v[128:131], v[64:67]
    ds_read_b128 v[160:163], v8 offset:50176
    v_mfma_f32_16x16x32_bf16 v[68:71], v[116:119], v[132:135], v[68:71]
    ds_read_b128 v[164:167], v8 offset:52224
    v_mfma_f32_16x16x32_bf16 v[72:75], v[116:119], v[136:139], v[72:75]
    ds_read_b128 v[168:171], v8 offset:54272
    v_mfma_f32_16x16x32_bf16 v[76:79], v[116:119], v[140:143], v[76:79]
    ds_read_b128 v[172:175], v8 offset:56320
    v_mfma_f32_16x16x32_bf16 v[80:83], v[120:123], v[128:131], v[80:83]
    v_mfma_f32_16x16x32_bf16 v[84:87], v[120:123], v[132:135], v[84:87]
    v_mfma_f32_16x16x32_bf16 v[88:91], v[120:123], v[136:139], v[88:91]
    v_mfma_f32_16x16x32_bf16 v[92:95], v[120:123], v[140:143], v[92:95]
    v_mfma_f32_16x16x32_bf16 v[96:99], v[124:127], v[128:131], v[96:99]
    v_mfma_f32_16x16x32_bf16 v[100:103], v[124:127], v[132:135], v[100:103]
    v_mfma_f32_16x16x32_bf16 v[104:107], v[124:127], v[136:139], v[104:107]
    v_mfma_f32_16x16x32_bf16 v[108:111], v[124:127], v[140:143], v[108:111]
    s_waitcnt lgkmcnt(0)
    s_barrier
    v_mfma_f32_16x16x32_bf16 v[48:51], v[144:147], v[160:163], v[48:51]
    ds_read_b128 v[112:115], v4 offset:0
    v_mfma_f32_16x16x32_bf16 v[52:55], v[144:147], v[164:167], v[52:55]
    ds_read_b128 v[116:119], v4 offset:2048
    v_mfma_f32_16x16x32_bf16 v[56:59], v[144:147], v[168:171], v[56:59]
    ds_read_b128 v[120:123], v4 offset:4096
    v_mfma_f32_16x16x32_bf16 v[60:63], v[144:147], v[172:175], v[60:63]
    ds_read_b128 v[124:127], v4 offset:6144
    v_mfma_f32_16x16x32_bf16 v[64:67], v[148:151], v[160:163], v[64:67]
    ds_read_b128 v[128:131], v7 offset:16384
    v_mfma_f32_16x16x32_bf16 v[68:71], v[148:151], v[164:167], v[68:71]
    ds_read_b128 v[132:135], v7 offset:18432
    v_mfma_f32_16x16x32_bf16 v[72:75], v[148:151], v[168:171], v[72:75]
    ds_read_b128 v[136:139], v7 offset:20480
    v_mfma_f32_16x16x32_bf16 v[76:79], v[148:151], v[172:175], v[76:79]
    ds_read_b128 v[140:143], v7 offset:22528
    v_mfma_f32_16x16x32_bf16 v[80:83], v[152:155], v[160:163], v[80:83]
    v_mfma_f32_16x16x32_bf16 v[84:87], v[152:155], v[164:167], v[84:87]
    v_mfma_f32_16x16x32_bf16 v[88:91], v[152:155], v[168:171], v[88:91]
    v_mfma_f32_16x16x32_bf16 v[92:95], v[152:155], v[172:175], v[92:95]
    v_mfma_f32_16x16x32_bf16 v[96:99], v[156:159], v[160:163], v[96:99]
    v_mfma_f32_16x16x32_bf16 v[100:103], v[156:159], v[164:167], v[100:103]
    v_mfma_f32_16x16x32_bf16 v[104:107], v[156:159], v[168:171], v[104:107]
    v_mfma_f32_16x16x32_bf16 v[108:111], v[156:159], v[172:175], v[108:111]
    s_waitcnt lgkmcnt(0)
    v_mfma_f32_16x16x32_bf16 v[48:51], v[112:115], v[128:131], v[48:51]
    ds_read_b128 v[144:147], v4 offset:1024
    v_mfma_f32_16x16x32_bf16 v[52:55], v[112:115], v[132:135], v[52:55]
    ds_read_b128 v[148:151], v4 offset:3072
    v_mfma_f32_16x16x32_bf16 v[56:59], v[112:115], v[136:139], v[56:59]
    ds_read_b128 v[152:155], v4 offset:5120
    v_mfma_f32_16x16x32_bf16 v[60:63], v[112:115], v[140:143], v[60:63]
    ds_read_b128 v[156:159], v4 offset:7168
    v_mfma_f32_16x16x32_bf16 v[64:67], v[116:119], v[128:131], v[64:67]
    ds_read_b128 v[160:163], v7 offset:17408
    v_mfma_f32_16x16x32_bf16 v[68:71], v[116:119], v[132:135], v[68:71]
    ds_read_b128 v[164:167], v7 offset:19456
    v_mfma_f32_16x16x32_bf16 v[72:75], v[116:119], v[136:139], v[72:75]
    ds_read_b128 v[168:171], v7 offset:21504
    v_mfma_f32_16x16x32_bf16 v[76:79], v[116:119], v[140:143], v[76:79]
    ds_read_b128 v[172:175], v7 offset:23552
    v_mfma_f32_16x16x32_bf16 v[80:83], v[120:123], v[128:131], v[80:83]
    v_mfma_f32_16x16x32_bf16 v[84:87], v[120:123], v[132:135], v[84:87]
    v_mfma_f32_16x16x32_bf16 v[88:91], v[120:123], v[136:139], v[88:91]
    v_mfma_f32_16x16x32_bf16 v[92:95], v[120:123], v[140:143], v[92:95]
    v_mfma_f32_16x16x32_bf16 v[96:99], v[124:127], v[128:131], v[96:99]
    v_mfma_f32_16x16x32_bf16 v[100:103], v[124:127], v[132:135], v[100:103]
    v_mfma_f32_16x16x32_bf16 v[104:107], v[124:127], v[136:139], v[104:107]
    v_mfma_f32_16x16x32_bf16 v[108:111], v[124:127], v[140:143], v[108:111]
    s_waitcnt lgkmcnt(0)
    s_barrier
    v_mfma_f32_16x16x32_bf16 v[48:51], v[144:147], v[160:163], v[48:51]
    ds_read_b128 v[112:115], v4 offset:32768
    v_mfma_f32_16x16x32_bf16 v[52:55], v[144:147], v[164:167], v[52:55]
    ds_read_b128 v[116:119], v4 offset:34816
    v_mfma_f32_16x16x32_bf16 v[56:59], v[144:147], v[168:171], v[56:59]
    ds_read_b128 v[120:123], v4 offset:36864
    v_mfma_f32_16x16x32_bf16 v[60:63], v[144:147], v[172:175], v[60:63]
    ds_read_b128 v[124:127], v4 offset:38912
    v_mfma_f32_16x16x32_bf16 v[64:67], v[148:151], v[160:163], v[64:67]
    ds_read_b128 v[128:131], v7 offset:49152
    v_mfma_f32_16x16x32_bf16 v[68:71], v[148:151], v[164:167], v[68:71]
    ds_read_b128 v[132:135], v7 offset:51200
    v_mfma_f32_16x16x32_bf16 v[72:75], v[148:151], v[168:171], v[72:75]
    ds_read_b128 v[136:139], v7 offset:53248
    v_mfma_f32_16x16x32_bf16 v[76:79], v[148:151], v[172:175], v[76:79]
    ds_read_b128 v[140:143], v7 offset:55296
    v_mfma_f32_16x16x32_bf16 v[80:83], v[152:155], v[160:163], v[80:83]
    v_mfma_f32_16x16x32_bf16 v[84:87], v[152:155], v[164:167], v[84:87]
    v_mfma_f32_16x16x32_bf16 v[88:91], v[152:155], v[168:171], v[88:91]
    v_mfma_f32_16x16x32_bf16 v[92:95], v[152:155], v[172:175], v[92:95]
    v_mfma_f32_16x16x32_bf16 v[96:99], v[156:159], v[160:163], v[96:99]
    v_mfma_f32_16x16x32_bf16 v[100:103], v[156:159], v[164:167], v[100:103]
    v_mfma_f32_16x16x32_bf16 v[104:107], v[156:159], v[168:171], v[104:107]
    v_mfma_f32_16x16x32_bf16 v[108:111], v[156:159], v[172:175], v[108:111]
    s_waitcnt lgkmcnt(0)
    v_mfma_f32_16x16x32_bf16 v[48:51], v[112:115], v[128:131], v[48:51]
    ds_read_b128 v[144:147], v4 offset:33792
    v_mfma_f32_16x16x32_bf16 v[52:55], v[112:115], v[132:135], v[52:55]
    ds_read_b128 v[148:151], v4 offset:35840
    v_mfma_f32_16x16x32_bf16 v[56:59], v[112:115], v[136:139], v[56:59]
    ds_read_b128 v[152:155], v4 offset:37888
    v_mfma_f32_16x16x32_bf16 v[60:63], v[112:115], v[140:143], v[60:63]
    ds_read_b128 v[156:159], v4 offset:39936
    v_mfma_f32_16x16x32_bf16 v[64:67], v[116:119], v[128:131], v[64:67]
    ds_read_b128 v[160:163], v7 offset:50176
    v_mfma_f32_16x16x32_bf16 v[68:71], v[116:119], v[132:135], v[68:71]
    ds_read_b128 v[164:167], v7 offset:52224
    v_mfma_f32_16x16x32_bf16 v[72:75], v[116:119], v[136:139], v[72:75]
    ds_read_b128 v[168:171], v7 offset:54272
    v_mfma_f32_16x16x32_bf16 v[76:79], v[116:119], v[140:143], v[76:79]
    ds_read_b128 v[172:175], v7 offset:56320
    v_mfma_f32_16x16x32_bf16 v[80:83], v[120:123], v[128:131], v[80:83]
    v_mfma_f32_16x16x32_bf16 v[84:87], v[120:123], v[132:135], v[84:87]
    v_mfma_f32_16x16x32_bf16 v[88:91], v[120:123], v[136:139], v[88:91]
    v_mfma_f32_16x16x32_bf16 v[92:95], v[120:123], v[140:143], v[92:95]
    v_mfma_f32_16x16x32_bf16 v[96:99], v[124:127], v[128:131], v[96:99]
    v_mfma_f32_16x16x32_bf16 v[100:103], v[124:127], v[132:135], v[100:103]
    v_mfma_f32_16x16x32_bf16 v[104:107], v[124:127], v[136:139], v[104:107]
    v_mfma_f32_16x16x32_bf16 v[108:111], v[124:127], v[140:143], v[108:111]
    s_waitcnt lgkmcnt(0)
    s_barrier
    v_mfma_f32_16x16x32_bf16 v[48:51], v[144:147], v[160:163], v[48:51]
    ds_read_b128 v[112:115], v5 offset:0
    v_mfma_f32_16x16x32_bf16 v[52:55], v[144:147], v[164:167], v[52:55]
    ds_read_b128 v[116:119], v5 offset:2048
    v_mfma_f32_16x16x32_bf16 v[56:59], v[144:147], v[168:171], v[56:59]
    ds_read_b128 v[120:123], v5 offset:4096
    v_mfma_f32_16x16x32_bf16 v[60:63], v[144:147], v[172:175], v[60:63]
    ds_read_b128 v[124:127], v5 offset:6144
    v_mfma_f32_16x16x32_bf16 v[64:67], v[148:151], v[160:163], v[64:67]
    ds_read_b128 v[128:131], v8 offset:16384
    v_mfma_f32_16x16x32_bf16 v[68:71], v[148:151], v[164:167], v[68:71]
    ds_read_b128 v[132:135], v8 offset:18432
    v_mfma_f32_16x16x32_bf16 v[72:75], v[148:151], v[168:171], v[72:75]
    ds_read_b128 v[136:139], v8 offset:20480
    v_mfma_f32_16x16x32_bf16 v[76:79], v[148:151], v[172:175], v[76:79]
    ds_read_b128 v[140:143], v8 offset:22528
    v_mfma_f32_16x16x32_bf16 v[80:83], v[152:155], v[160:163], v[80:83]
    v_mfma_f32_16x16x32_bf16 v[84:87], v[152:155], v[164:167], v[84:87]
    v_mfma_f32_16x16x32_bf16 v[88:91], v[152:155], v[168:171], v[88:91]
    v_mfma_f32_16x16x32_bf16 v[92:95], v[152:155], v[172:175], v[92:95]
    v_mfma_f32_16x16x32_bf16 v[96:99], v[156:159], v[160:163], v[96:99]
    v_mfma_f32_16x16x32_bf16 v[100:103], v[156:159], v[164:167], v[100:103]
    v_mfma_f32_16x16x32_bf16 v[104:107], v[156:159], v[168:171], v[104:107]
    v_mfma_f32_16x16x32_bf16 v[108:111], v[156:159], v[172:175], v[108:111]
    s_waitcnt lgkmcnt(0)
    v_mfma_f32_16x16x32_bf16 v[48:51], v[112:115], v[128:131], v[48:51]
    ds_read_b128 v[144:147], v5 offset:1024
    v_mfma_f32_16x16x32_bf16 v[52:55], v[112:115], v[132:135], v[52:55]
    ds_read_b128 v[148:151], v5 offset:3072
    v_mfma_f32_16x16x32_bf16 v[56:59], v[112:115], v[136:139], v[56:59]
    ds_read_b128 v[152:155], v5 offset:5120
    v_mfma_f32_16x16x32_bf16 v[60:63], v[112:115], v[140:143], v[60:63]
    ds_read_b128 v[156:159], v5 offset:7168
    v_mfma_f32_16x16x32_bf16 v[64:67], v[116:119], v[128:131], v[64:67]
    ds_read_b128 v[160:163], v8 offset:17408
    v_mfma_f32_16x16x32_bf16 v[68:71], v[116:119], v[132:135], v[68:71]
    ds_read_b128 v[164:167], v8 offset:19456
    v_mfma_f32_16x16x32_bf16 v[72:75], v[116:119], v[136:139], v[72:75]
    ds_read_b128 v[168:171], v8 offset:21504
    v_mfma_f32_16x16x32_bf16 v[76:79], v[116:119], v[140:143], v[76:79]
    ds_read_b128 v[172:175], v8 offset:23552
    v_mfma_f32_16x16x32_bf16 v[80:83], v[120:123], v[128:131], v[80:83]
    v_mfma_f32_16x16x32_bf16 v[84:87], v[120:123], v[132:135], v[84:87]
    v_mfma_f32_16x16x32_bf16 v[88:91], v[120:123], v[136:139], v[88:91]
    v_mfma_f32_16x16x32_bf16 v[92:95], v[120:123], v[140:143], v[92:95]
    v_mfma_f32_16x16x32_bf16 v[96:99], v[124:127], v[128:131], v[96:99]
    v_mfma_f32_16x16x32_bf16 v[100:103], v[124:127], v[132:135], v[100:103]
    v_mfma_f32_16x16x32_bf16 v[104:107], v[124:127], v[136:139], v[104:107]
    v_mfma_f32_16x16x32_bf16 v[108:111], v[124:127], v[140:143], v[108:111]
    s_waitcnt lgkmcnt(0)
    s_barrier
    v_mfma_f32_16x16x32_bf16 v[48:51], v[144:147], v[160:163], v[48:51]
    ds_read_b128 v[112:115], v5 offset:32768
    v_mfma_f32_16x16x32_bf16 v[52:55], v[144:147], v[164:167], v[52:55]
    ds_read_b128 v[116:119], v5 offset:34816
    v_mfma_f32_16x16x32_bf16 v[56:59], v[144:147], v[168:171], v[56:59]
    ds_read_b128 v[120:123], v5 offset:36864
    v_mfma_f32_16x16x32_bf16 v[60:63], v[144:147], v[172:175], v[60:63]
    ds_read_b128 v[124:127], v5 offset:38912
    v_mfma_f32_16x16x32_bf16 v[64:67], v[148:151], v[160:163], v[64:67]
    ds_read_b128 v[128:131], v8 offset:49152
    v_mfma_f32_16x16x32_bf16 v[68:71], v[148:151], v[164:167], v[68:71]
    ds_read_b128 v[132:135], v8 offset:51200
    v_mfma_f32_16x16x32_bf16 v[72:75], v[148:151], v[168:171], v[72:75]
    ds_read_b128 v[136:139], v8 offset:53248
    v_mfma_f32_16x16x32_bf16 v[76:79], v[148:151], v[172:175], v[76:79]
    ds_read_b128 v[140:143], v8 offset:55296
    v_mfma_f32_16x16x32_bf16 v[80:83], v[152:155], v[160:163], v[80:83]
    v_mfma_f32_16x16x32_bf16 v[84:87], v[152:155], v[164:167], v[84:87]
    v_mfma_f32_16x16x32_bf16 v[88:91], v[152:155], v[168:171], v[88:91]
    v_mfma_f32_16x16x32_bf16 v[92:95], v[152:155], v[172:175], v[92:95]
    v_mfma_f32_16x16x32_bf16 v[96:99], v[156:159], v[160:163], v[96:99]
    v_mfma_f32_16x16x32_bf16 v[100:103], v[156:159], v[164:167], v[100:103]
    v_mfma_f32_16x16x32_bf16 v[104:107], v[156:159], v[168:171], v[104:107]
    v_mfma_f32_16x16x32_bf16 v[108:111], v[156:159], v[172:175], v[108:111]
    s_waitcnt lgkmcnt(0)
    v_mfma_f32_16x16x32_bf16 v[48:51], v[112:115], v[128:131], v[48:51]
    ds_read_b128 v[144:147], v5 offset:33792
    v_mfma_f32_16x16x32_bf16 v[52:55], v[112:115], v[132:135], v[52:55]
    ds_read_b128 v[148:151], v5 offset:35840
    v_mfma_f32_16x16x32_bf16 v[56:59], v[112:115], v[136:139], v[56:59]
    ds_read_b128 v[152:155], v5 offset:37888
    v_mfma_f32_16x16x32_bf16 v[60:63], v[112:115], v[140:143], v[60:63]
    ds_read_b128 v[156:159], v5 offset:39936
    v_mfma_f32_16x16x32_bf16 v[64:67], v[116:119], v[128:131], v[64:67]
    ds_read_b128 v[160:163], v8 offset:50176
    v_mfma_f32_16x16x32_bf16 v[68:71], v[116:119], v[132:135], v[68:71]
    ds_read_b128 v[164:167], v8 offset:52224
    v_mfma_f32_16x16x32_bf16 v[72:75], v[116:119], v[136:139], v[72:75]
    ds_read_b128 v[168:171], v8 offset:54272
    v_mfma_f32_16x16x32_bf16 v[76:79], v[116:119], v[140:143], v[76:79]
    ds_read_b128 v[172:175], v8 offset:56320
    v_mfma_f32_16x16x32_bf16 v[80:83], v[120:123], v[128:131], v[80:83]
    v_mfma_f32_16x16x32_bf16 v[84:87], v[120:123], v[132:135], v[84:87]
    v_mfma_f32_16x16x32_bf16 v[88:91], v[120:123], v[136:139], v[88:91]
    v_mfma_f32_16x16x32_bf16 v[92:95], v[120:123], v[140:143], v[92:95]
    v_mfma_f32_16x16x32_bf16 v[96:99], v[124:127], v[128:131], v[96:99]
    v_mfma_f32_16x16x32_bf16 v[100:103], v[124:127], v[132:135], v[100:103]
    v_mfma_f32_16x16x32_bf16 v[104:107], v[124:127], v[136:139], v[104:107]
    v_mfma_f32_16x16x32_bf16 v[108:111], v[124:127], v[140:143], v[108:111]
    s_waitcnt lgkmcnt(0)
    s_barrier
    v_mfma_f32_16x16x32_bf16 v[48:51], v[144:147], v[160:163], v[48:51]
    ds_read_b128 v[112:115], v4 offset:0
    v_mfma_f32_16x16x32_bf16 v[52:55], v[144:147], v[164:167], v[52:55]
    ds_read_b128 v[116:119], v4 offset:2048
    v_mfma_f32_16x16x32_bf16 v[56:59], v[144:147], v[168:171], v[56:59]
    ds_read_b128 v[120:123], v4 offset:4096
    v_mfma_f32_16x16x32_bf16 v[60:63], v[144:147], v[172:175], v[60:63]
    ds_read_b128 v[124:127], v4 offset:6144
    v_mfma_f32_16x16x32_bf16 v[64:67], v[148:151], v[160:163], v[64:67]
    ds_read_b128 v[128:131], v7 offset:16384
    v_mfma_f32_16x16x32_bf16 v[68:71], v[148:151], v[164:167], v[68:71]
    ds_read_b128 v[132:135], v7 offset:18432
    v_mfma_f32_16x16x32_bf16 v[72:75], v[148:151], v[168:171], v[72:75]
    ds_read_b128 v[136:139], v7 offset:20480
    v_mfma_f32_16x16x32_bf16 v[76:79], v[148:151], v[172:175], v[76:79]
    ds_read_b128 v[140:143], v7 offset:22528
    v_mfma_f32_16x16x32_bf16 v[80:83], v[152:155], v[160:163], v[80:83]
    v_mfma_f32_16x16x32_bf16 v[84:87], v[152:155], v[164:167], v[84:87]
    v_mfma_f32_16x16x32_bf16 v[88:91], v[152:155], v[168:171], v[88:91]
    v_mfma_f32_16x16x32_bf16 v[92:95], v[152:155], v[172:175], v[92:95]
    v_mfma_f32_16x16x32_bf16 v[96:99], v[156:159], v[160:163], v[96:99]
    v_mfma_f32_16x16x32_bf16 v[100:103], v[156:159], v[164:167], v[100:103]
    v_mfma_f32_16x16x32_bf16 v[104:107], v[156:159], v[168:171], v[104:107]
    v_mfma_f32_16x16x32_bf16 v[108:111], v[156:159], v[172:175], v[108:111]
    s_waitcnt lgkmcnt(0)
    v_mfma_f32_16x16x32_bf16 v[48:51], v[112:115], v[128:131], v[48:51]
    ds_read_b128 v[144:147], v4 offset:1024
    v_mfma_f32_16x16x32_bf16 v[52:55], v[112:115], v[132:135], v[52:55]
    ds_read_b128 v[148:151], v4 offset:3072
    v_mfma_f32_16x16x32_bf16 v[56:59], v[112:115], v[136:139], v[56:59]
    ds_read_b128 v[152:155], v4 offset:5120
    v_mfma_f32_16x16x32_bf16 v[60:63], v[112:115], v[140:143], v[60:63]
    ds_read_b128 v[156:159], v4 offset:7168
    v_mfma_f32_16x16x32_bf16 v[64:67], v[116:119], v[128:131], v[64:67]
    ds_read_b128 v[160:163], v7 offset:17408
    v_mfma_f32_16x16x32_bf16 v[68:71], v[116:119], v[132:135], v[68:71]
    ds_read_b128 v[164:167], v7 offset:19456
    v_mfma_f32_16x16x32_bf16 v[72:75], v[116:119], v[136:139], v[72:75]
    ds_read_b128 v[168:171], v7 offset:21504
    v_mfma_f32_16x16x32_bf16 v[76:79], v[116:119], v[140:143], v[76:79]
    ds_read_b128 v[172:175], v7 offset:23552
    v_mfma_f32_16x16x32_bf16 v[80:83], v[120:123], v[128:131], v[80:83]
    v_mfma_f32_16x16x32_bf16 v[84:87], v[120:123], v[132:135], v[84:87]
    v_mfma_f32_16x16x32_bf16 v[88:91], v[120:123], v[136:139], v[88:91]
    v_mfma_f32_16x16x32_bf16 v[92:95], v[120:123], v[140:143], v[92:95]
    v_mfma_f32_16x16x32_bf16 v[96:99], v[124:127], v[128:131], v[96:99]
    v_mfma_f32_16x16x32_bf16 v[100:103], v[124:127], v[132:135], v[100:103]
    v_mfma_f32_16x16x32_bf16 v[104:107], v[124:127], v[136:139], v[104:107]
    v_mfma_f32_16x16x32_bf16 v[108:111], v[124:127], v[140:143], v[108:111]
    s_waitcnt lgkmcnt(0)
    s_barrier
    v_mfma_f32_16x16x32_bf16 v[48:51], v[144:147], v[160:163], v[48:51]
    ds_read_b128 v[112:115], v4 offset:32768
    v_mfma_f32_16x16x32_bf16 v[52:55], v[144:147], v[164:167], v[52:55]
    ds_read_b128 v[116:119], v4 offset:34816
    v_mfma_f32_16x16x32_bf16 v[56:59], v[144:147], v[168:171], v[56:59]
    ds_read_b128 v[120:123], v4 offset:36864
    v_mfma_f32_16x16x32_bf16 v[60:63], v[144:147], v[172:175], v[60:63]
    ds_read_b128 v[124:127], v4 offset:38912
    v_mfma_f32_16x16x32_bf16 v[64:67], v[148:151], v[160:163], v[64:67]
    ds_read_b128 v[128:131], v7 offset:49152
    v_mfma_f32_16x16x32_bf16 v[68:71], v[148:151], v[164:167], v[68:71]
    ds_read_b128 v[132:135], v7 offset:51200
    v_mfma_f32_16x16x32_bf16 v[72:75], v[148:151], v[168:171], v[72:75]
    ds_read_b128 v[136:139], v7 offset:53248
    v_mfma_f32_16x16x32_bf16 v[76:79], v[148:151], v[172:175], v[76:79]
    ds_read_b128 v[140:143], v7 offset:55296
    v_mfma_f32_16x16x32_bf16 v[80:83], v[152:155], v[160:163], v[80:83]
    v_mfma_f32_16x16x32_bf16 v[84:87], v[152:155], v[164:167], v[84:87]
    v_mfma_f32_16x16x32_bf16 v[88:91], v[152:155], v[168:171], v[88:91]
    v_mfma_f32_16x16x32_bf16 v[92:95], v[152:155], v[172:175], v[92:95]
    v_mfma_f32_16x16x32_bf16 v[96:99], v[156:159], v[160:163], v[96:99]
    v_mfma_f32_16x16x32_bf16 v[100:103], v[156:159], v[164:167], v[100:103]
    v_mfma_f32_16x16x32_bf16 v[104:107], v[156:159], v[168:171], v[104:107]
    v_mfma_f32_16x16x32_bf16 v[108:111], v[156:159], v[172:175], v[108:111]
    s_waitcnt lgkmcnt(0)
    v_mfma_f32_16x16x32_bf16 v[48:51], v[112:115], v[128:131], v[48:51]
    ds_read_b128 v[144:147], v4 offset:33792
    v_mfma_f32_16x16x32_bf16 v[52:55], v[112:115], v[132:135], v[52:55]
    ds_read_b128 v[148:151], v4 offset:35840
    v_mfma_f32_16x16x32_bf16 v[56:59], v[112:115], v[136:139], v[56:59]
    ds_read_b128 v[152:155], v4 offset:37888
    v_mfma_f32_16x16x32_bf16 v[60:63], v[112:115], v[140:143], v[60:63]
    ds_read_b128 v[156:159], v4 offset:39936
    v_mfma_f32_16x16x32_bf16 v[64:67], v[116:119], v[128:131], v[64:67]
    ds_read_b128 v[160:163], v7 offset:50176
    v_mfma_f32_16x16x32_bf16 v[68:71], v[116:119], v[132:135], v[68:71]
    ds_read_b128 v[164:167], v7 offset:52224
    v_mfma_f32_16x16x32_bf16 v[72:75], v[116:119], v[136:139], v[72:75]
    ds_read_b128 v[168:171], v7 offset:54272
    v_mfma_f32_16x16x32_bf16 v[76:79], v[116:119], v[140:143], v[76:79]
    ds_read_b128 v[172:175], v7 offset:56320
    v_mfma_f32_16x16x32_bf16 v[80:83], v[120:123], v[128:131], v[80:83]
    v_mfma_f32_16x16x32_bf16 v[84:87], v[120:123], v[132:135], v[84:87]
    v_mfma_f32_16x16x32_bf16 v[88:91], v[120:123], v[136:139], v[88:91]
    v_mfma_f32_16x16x32_bf16 v[92:95], v[120:123], v[140:143], v[92:95]
    v_mfma_f32_16x16x32_bf16 v[96:99], v[124:127], v[128:131], v[96:99]
    v_mfma_f32_16x16x32_bf16 v[100:103], v[124:127], v[132:135], v[100:103]
    v_mfma_f32_16x16x32_bf16 v[104:107], v[124:127], v[136:139], v[104:107]
    v_mfma_f32_16x16x32_bf16 v[108:111], v[124:127], v[140:143], v[108:111]
    s_waitcnt lgkmcnt(0)
    v_mfma_f32_16x16x32_bf16 v[48:51], v[144:147], v[160:163], v[48:51]
    v_mfma_f32_16x16x32_bf16 v[52:55], v[144:147], v[164:167], v[52:55]
    v_mfma_f32_16x16x32_bf16 v[56:59], v[144:147], v[168:171], v[56:59]
    v_mfma_f32_16x16x32_bf16 v[60:63], v[144:147], v[172:175], v[60:63]
    v_mfma_f32_16x16x32_bf16 v[64:67], v[148:151], v[160:163], v[64:67]
    v_mfma_f32_16x16x32_bf16 v[68:71], v[148:151], v[164:167], v[68:71]
    v_mfma_f32_16x16x32_bf16 v[72:75], v[148:151], v[168:171], v[72:75]
    v_mfma_f32_16x16x32_bf16 v[76:79], v[148:151], v[172:175], v[76:79]
    v_mfma_f32_16x16x32_bf16 v[80:83], v[152:155], v[160:163], v[80:83]
    v_mfma_f32_16x16x32_bf16 v[84:87], v[152:155], v[164:167], v[84:87]
    v_mfma_f32_16x16x32_bf16 v[88:91], v[152:155], v[168:171], v[88:91]
    v_mfma_f32_16x16x32_bf16 v[92:95], v[152:155], v[172:175], v[92:95]
    v_mfma_f32_16x16x32_bf16 v[96:99], v[156:159], v[160:163], v[96:99]
    v_mfma_f32_16x16x32_bf16 v[100:103], v[156:159], v[164:167], v[100:103]
    v_mfma_f32_16x16x32_bf16 v[104:107], v[156:159], v[168:171], v[104:107]
    v_mfma_f32_16x16x32_bf16 v[108:111], v[156:159], v[172:175], v[108:111]
    s_waitcnt vmcnt(0)
    s_sub_u32 s17, s14, 10
    s_lshl_b32 s17, s17, 7
    s_lshl_b32 s18, s16, 6
    s_add_u32 s17, s17, s18
    v_add_u32 v44, s17, v43
    v_and_b32 v45, 1, v2
    v_lshlrev_b32 v45, 4, v45
    v_lshrrev_b32 v46, 1, v2
    v_lshlrev_b32 v46, 3, v46
    v_add_u32 v45, v45, v46
    s_mov_b32 s18, 3277
    v_add_u32 v46, 0, v44
    v_mul_lo_u32 v47, v46, s18
    v_lshrrev_b32 v47, 16, v47
    v_mul_u32_u24 v30, 20, v47
    v_sub_u32 v30, v46, v30
    v_lshlrev_b32 v30, 5, v30
    v_lshlrev_b32 v47, 17, v47
    v_add_u32 v30, v30, v47
    v_add_u32 v30, v30, v45
    v_add_u32 v46, 16, v44
    v_mul_lo_u32 v47, v46, s18
    v_lshrrev_b32 v47, 16, v47
    v_mul_u32_u24 v31, 20, v47
    v_sub_u32 v31, v46, v31
    v_lshlrev_b32 v31, 5, v31
    v_lshlrev_b32 v47, 17, v47
    v_add_u32 v31, v31, v47
    v_add_u32 v31, v31, v45
    v_add_u32 v46, 32, v44
    v_mul_lo_u32 v47, v46, s18
    v_lshrrev_b32 v47, 16, v47
    v_mul_u32_u24 v32, 20, v47
    v_sub_u32 v32, v46, v32
    v_lshlrev_b32 v32, 5, v32
    v_lshlrev_b32 v47, 17, v47
    v_add_u32 v32, v32, v47
    v_add_u32 v32, v32, v45
    v_add_u32 v46, 48, v44
    v_mul_lo_u32 v47, v46, s18
    v_lshrrev_b32 v47, 16, v47
    v_mul_u32_u24 v33, 20, v47
    v_sub_u32 v33, v46, v33
    v_lshlrev_b32 v33, 5, v33
    v_lshlrev_b32 v47, 17, v47
    v_add_u32 v33, v33, v47
    v_add_u32 v33, v33, v45
    s_lshl_b32 s20, s13, 13
    s_lshl_b32 s21, s15, 12
    s_add_u32 s20, s20, s21
    s_add_u32 s20, s20, 28311552
    v_lshlrev_b32 v44, 5, v2
    s_lshl_b32 s17, s15, 9
    s_add_u32 s17, s17, 131072
    v_add_u32 v44, s17, v44
    ds_read_b128 v[10:13], v44 offset:0
    ds_read_b128 v[14:17], v44 offset:16
    s_waitcnt lgkmcnt(0)
    v_fma_f32 v48, -v10, v26, v48
    v_mul_f32 v48, v11, v48
    v_fma_f32 v49, -v12, v26, v49
    v_mul_f32 v49, v13, v49
    v_fma_f32 v50, -v14, v26, v50
    v_mul_f32 v50, v15, v50
    v_fma_f32 v51, -v16, v26, v51
    v_mul_f32 v51, v17, v51
    v_cvt_pk_bf16_f32 v18, v48, v49
    v_cvt_pk_bf16_f32 v19, v50, v51
    buffer_store_dwordx2 v[18:19], v30, s[4:7], s20 offen offset:0
    v_fma_f32 v52, -v10, v27, v52
    v_mul_f32 v52, v11, v52
    v_fma_f32 v53, -v12, v27, v53
    v_mul_f32 v53, v13, v53
    v_fma_f32 v54, -v14, v27, v54
    v_mul_f32 v54, v15, v54
    v_fma_f32 v55, -v16, v27, v55
    v_mul_f32 v55, v17, v55
    v_cvt_pk_bf16_f32 v20, v52, v53
    v_cvt_pk_bf16_f32 v21, v54, v55
    buffer_store_dwordx2 v[20:21], v31, s[4:7], s20 offen offset:0
    v_fma_f32 v56, -v10, v28, v56
    v_mul_f32 v56, v11, v56
    v_fma_f32 v57, -v12, v28, v57
    v_mul_f32 v57, v13, v57
    v_fma_f32 v58, -v14, v28, v58
    v_mul_f32 v58, v15, v58
    v_fma_f32 v59, -v16, v28, v59
    v_mul_f32 v59, v17, v59
    v_cvt_pk_bf16_f32 v22, v56, v57
    v_cvt_pk_bf16_f32 v23, v58, v59
    buffer_store_dwordx2 v[22:23], v32, s[4:7], s20 offen offset:0
    v_fma_f32 v60, -v10, v29, v60
    v_mul_f32 v60, v11, v60
    v_fma_f32 v61, -v12, v29, v61
    v_mul_f32 v61, v13, v61
    v_fma_f32 v62, -v14, v29, v62
    v_mul_f32 v62, v15, v62
    v_fma_f32 v63, -v16, v29, v63
    v_mul_f32 v63, v17, v63
    v_cvt_pk_bf16_f32 v24, v60, v61
    v_cvt_pk_bf16_f32 v25, v62, v63
    buffer_store_dwordx2 v[24:25], v33, s[4:7], s20 offen offset:0
    ds_read_b128 v[10:13], v44 offset:128
    ds_read_b128 v[14:17], v44 offset:144
    s_waitcnt lgkmcnt(0)
    v_fma_f32 v64, -v10, v26, v64
    v_mul_f32 v64, v11, v64
    v_fma_f32 v65, -v12, v26, v65
    v_mul_f32 v65, v13, v65
    v_fma_f32 v66, -v14, v26, v66
    v_mul_f32 v66, v15, v66
    v_fma_f32 v67, -v16, v26, v67
    v_mul_f32 v67, v17, v67
    v_cvt_pk_bf16_f32 v18, v64, v65
    v_cvt_pk_bf16_f32 v19, v66, v67
    buffer_store_dwordx2 v[18:19], v30, s[4:7], s20 offen offset:1024
    v_fma_f32 v68, -v10, v27, v68
    v_mul_f32 v68, v11, v68
    v_fma_f32 v69, -v12, v27, v69
    v_mul_f32 v69, v13, v69
    v_fma_f32 v70, -v14, v27, v70
    v_mul_f32 v70, v15, v70
    v_fma_f32 v71, -v16, v27, v71
    v_mul_f32 v71, v17, v71
    v_cvt_pk_bf16_f32 v20, v68, v69
    v_cvt_pk_bf16_f32 v21, v70, v71
    buffer_store_dwordx2 v[20:21], v31, s[4:7], s20 offen offset:1024
    v_fma_f32 v72, -v10, v28, v72
    v_mul_f32 v72, v11, v72
    v_fma_f32 v73, -v12, v28, v73
    v_mul_f32 v73, v13, v73
    v_fma_f32 v74, -v14, v28, v74
    v_mul_f32 v74, v15, v74
    v_fma_f32 v75, -v16, v28, v75
    v_mul_f32 v75, v17, v75
    v_cvt_pk_bf16_f32 v22, v72, v73
    v_cvt_pk_bf16_f32 v23, v74, v75
    buffer_store_dwordx2 v[22:23], v32, s[4:7], s20 offen offset:1024
    v_fma_f32 v76, -v10, v29, v76
    v_mul_f32 v76, v11, v76
    v_fma_f32 v77, -v12, v29, v77
    v_mul_f32 v77, v13, v77
    v_fma_f32 v78, -v14, v29, v78
    v_mul_f32 v78, v15, v78
    v_fma_f32 v79, -v16, v29, v79
    v_mul_f32 v79, v17, v79
    v_cvt_pk_bf16_f32 v24, v76, v77
    v_cvt_pk_bf16_f32 v25, v78, v79
    buffer_store_dwordx2 v[24:25], v33, s[4:7], s20 offen offset:1024
    ds_read_b128 v[10:13], v44 offset:256
    ds_read_b128 v[14:17], v44 offset:272
    s_waitcnt lgkmcnt(0)
    v_fma_f32 v80, -v10, v26, v80
    v_mul_f32 v80, v11, v80
    v_fma_f32 v81, -v12, v26, v81
    v_mul_f32 v81, v13, v81
    v_fma_f32 v82, -v14, v26, v82
    v_mul_f32 v82, v15, v82
    v_fma_f32 v83, -v16, v26, v83
    v_mul_f32 v83, v17, v83
    v_cvt_pk_bf16_f32 v18, v80, v81
    v_cvt_pk_bf16_f32 v19, v82, v83
    buffer_store_dwordx2 v[18:19], v30, s[4:7], s20 offen offset:2048
    v_fma_f32 v84, -v10, v27, v84
    v_mul_f32 v84, v11, v84
    v_fma_f32 v85, -v12, v27, v85
    v_mul_f32 v85, v13, v85
    v_fma_f32 v86, -v14, v27, v86
    v_mul_f32 v86, v15, v86
    v_fma_f32 v87, -v16, v27, v87
    v_mul_f32 v87, v17, v87
    v_cvt_pk_bf16_f32 v20, v84, v85
    v_cvt_pk_bf16_f32 v21, v86, v87
    buffer_store_dwordx2 v[20:21], v31, s[4:7], s20 offen offset:2048
    v_fma_f32 v88, -v10, v28, v88
    v_mul_f32 v88, v11, v88
    v_fma_f32 v89, -v12, v28, v89
    v_mul_f32 v89, v13, v89
    v_fma_f32 v90, -v14, v28, v90
    v_mul_f32 v90, v15, v90
    v_fma_f32 v91, -v16, v28, v91
    v_mul_f32 v91, v17, v91
    v_cvt_pk_bf16_f32 v22, v88, v89
    v_cvt_pk_bf16_f32 v23, v90, v91
    buffer_store_dwordx2 v[22:23], v32, s[4:7], s20 offen offset:2048
    v_fma_f32 v92, -v10, v29, v92
    v_mul_f32 v92, v11, v92
    v_fma_f32 v93, -v12, v29, v93
    v_mul_f32 v93, v13, v93
    v_fma_f32 v94, -v14, v29, v94
    v_mul_f32 v94, v15, v94
    v_fma_f32 v95, -v16, v29, v95
    v_mul_f32 v95, v17, v95
    v_cvt_pk_bf16_f32 v24, v92, v93
    v_cvt_pk_bf16_f32 v25, v94, v95
    buffer_store_dwordx2 v[24:25], v33, s[4:7], s20 offen offset:2048
    ds_read_b128 v[10:13], v44 offset:384
    ds_read_b128 v[14:17], v44 offset:400
    s_waitcnt lgkmcnt(0)
    v_fma_f32 v96, -v10, v26, v96
    v_mul_f32 v96, v11, v96
    v_fma_f32 v97, -v12, v26, v97
    v_mul_f32 v97, v13, v97
    v_fma_f32 v98, -v14, v26, v98
    v_mul_f32 v98, v15, v98
    v_fma_f32 v99, -v16, v26, v99
    v_mul_f32 v99, v17, v99
    v_cvt_pk_bf16_f32 v18, v96, v97
    v_cvt_pk_bf16_f32 v19, v98, v99
    buffer_store_dwordx2 v[18:19], v30, s[4:7], s20 offen offset:3072
    v_fma_f32 v100, -v10, v27, v100
    v_mul_f32 v100, v11, v100
    v_fma_f32 v101, -v12, v27, v101
    v_mul_f32 v101, v13, v101
    v_fma_f32 v102, -v14, v27, v102
    v_mul_f32 v102, v15, v102
    v_fma_f32 v103, -v16, v27, v103
    v_mul_f32 v103, v17, v103
    v_cvt_pk_bf16_f32 v20, v100, v101
    v_cvt_pk_bf16_f32 v21, v102, v103
    buffer_store_dwordx2 v[20:21], v31, s[4:7], s20 offen offset:3072
    v_fma_f32 v104, -v10, v28, v104
    v_mul_f32 v104, v11, v104
    v_fma_f32 v105, -v12, v28, v105
    v_mul_f32 v105, v13, v105
    v_fma_f32 v106, -v14, v28, v106
    v_mul_f32 v106, v15, v106
    v_fma_f32 v107, -v16, v28, v107
    v_mul_f32 v107, v17, v107
    v_cvt_pk_bf16_f32 v22, v104, v105
    v_cvt_pk_bf16_f32 v23, v106, v107
    buffer_store_dwordx2 v[22:23], v32, s[4:7], s20 offen offset:3072
    v_fma_f32 v108, -v10, v29, v108
    v_mul_f32 v108, v11, v108
    v_fma_f32 v109, -v12, v29, v109
    v_mul_f32 v109, v13, v109
    v_fma_f32 v110, -v14, v29, v110
    v_mul_f32 v110, v15, v110
    v_fma_f32 v111, -v16, v29, v111
    v_mul_f32 v111, v17, v111
    v_cvt_pk_bf16_f32 v24, v108, v109
    v_cvt_pk_bf16_f32 v25, v110, v111
    buffer_store_dwordx2 v[24:25], v33, s[4:7], s20 offen offset:3072
    s_nop 3
qkv1_kernel_end:
    s_endpgm

.text
.globl attn1_kernel
.p2align 8
.type attn1_kernel,@function
attn1_kernel:
    s_cmp_ge_u32 s2, 512
    s_cbranch_scc1 attn1_kernel_end
    s_load_dwordx2 s[4:5], s[0:1], 72
    v_lshrrev_b32 v2, 6, v0
    s_nop 0
    v_readfirstlane_b32 s12, v2
    v_and_b32 v1, 63, v0
    v_and_b32 v3, 31, v1
    v_lshrrev_b32 v4, 5, v1
    v_lshlrev_b32 v5, 5, v3
    v_lshlrev_b32 v6, 4, v4
    v_add_u32 v5, v5, v6
    v_lshlrev_b32 v7, 3, v3
    v_min_u32 v8, 20, v3
    v_lshlrev_b32 v8, 5, v8
    v_add_u32 v8, v8, v6
    v_lshlrev_b32 v15, 4, v1
    s_and_b32 s13, s2, 7
    s_lshl_b32 s13, s13, 2
    s_lshr_b32 s14, s2, 7
    s_add_u32 s13, s13, s14
    s_lshr_b32 s14, s2, 3
    s_and_b32 s14, s14, 15
    s_lshl_b32 s23, s14, 7
    s_lshl_b32 s15, s12, 5
    s_add_u32 s15, s15, s23
    s_lshl_b32 s16, s13, 11
    s_waitcnt lgkmcnt(0)
    s_and_b32 s5, s5, 0xffff
    s_mov_b32 s6, 268435456
    s_mov_b32 s7, 0x00020000
    s_add_i32 s19, s15, -256
    s_max_i32 s19, s19, 0
    s_add_u32 s19, s19, s16
    s_lshl_b32 s20, s19, 5
    s_add_u32 s20, s20, 25165824
    s_lshl_b32 s21, s12, 10
    s_add_u32 m0, s21, 0
    s_nop 0
    buffer_load_dwordx4 v5, s[4:7], s20 offen lds
    s_add_i32 s19, s15, -128
    s_max_i32 s19, s19, 0
    s_add_u32 s19, s19, s16
    s_lshl_b32 s20, s19, 5
    s_add_u32 s20, s20, 25165824
    s_lshl_b32 s21, s12, 10
    s_add_u32 m0, s21, 4096
    s_nop 0
    buffer_load_dwordx4 v5, s[4:7], s20 offen lds
    s_add_i32 s19, s15, 0
    s_max_i32 s19, s19, 0
    s_add_u32 s19, s19, s16
    s_lshl_b32 s20, s19, 5
    s_add_u32 s20, s20, 25165824
    s_lshl_b32 s21, s12, 10
    s_add_u32 m0, s21, 8192
    s_nop 0
    buffer_load_dwordx4 v5, s[4:7], s20 offen lds
    s_min_u32 s21, s12, 2
    s_lshl_b32 s19, s21, 7
    s_add_u32 s19, s19, s23
    s_add_i32 s19, s19, -256
    s_max_i32 s19, s19, 0
    s_add_u32 s19, s19, s16
    s_lshl_b32 s20, s19, 3
    s_add_u32 s20, s20, 27787264
    s_lshl_b32 s21, s21, 10
    s_add_u32 m0, s21, 12288
    s_nop 0
    buffer_load_dwordx4 v15, s[4:7], s20 offen lds
    s_add_u32 s17, s16, s15
    s_lshl_b32 s18, s17, 5
    s_add_u32 s18, s18, 23068672
    buffer_load_dwordx4 v[248:251], v5, s[4:7], s18 offen
    s_lshl_b32 s18, s17, 3
    s_add_u32 s18, s18, 27262976
    buffer_load_dwordx2 v[252:253], v7, s[4:7], s18 offen
    s_lshl_b32 s24, s13, 17
    s_add_u32 s24, s24, 28311552
    s_lshl_b32 s25, s12, 4
    s_add_u32 s25, s25, s23
    s_add_i32 s19, s25, -256
    s_max_i32 s19, s19, 0
    s_lshl_b32 s19, s19, 6
    s_add_u32 s19, s19, s24
    s_lshl_b32 s21, s12, 10
    s_add_u32 m0, s21, 15360
    s_nop 0
    buffer_load_dwordx4 v8, s[4:7], s19 offen lds
    s_add_i32 s19, s25, -192
    s_max_i32 s19, s19, 0
    s_lshl_b32 s19, s19, 6
    s_add_u32 s19, s19, s24
    s_lshl_b32 s21, s12, 10
    s_add_u32 m0, s21, 19456
    s_nop 0
    buffer_load_dwordx4 v8, s[4:7], s19 offen lds
    s_add_i32 s19, s25, -128
    s_max_i32 s19, s19, 0
    s_lshl_b32 s19, s19, 6
    s_add_u32 s19, s19, s24
    s_lshl_b32 s21, s12, 10
    s_add_u32 m0, s21, 23552
    s_nop 0
    buffer_load_dwordx4 v8, s[4:7], s19 offen lds
    s_add_i32 s19, s25, -64
    s_max_i32 s19, s19, 0
    s_lshl_b32 s19, s19, 6
    s_add_u32 s19, s19, s24
    s_lshl_b32 s21, s12, 10
    s_add_u32 m0, s21, 27648
    s_nop 0
    buffer_load_dwordx4 v8, s[4:7], s19 offen lds
    s_add_i32 s19, s25, 0
    s_max_i32 s19, s19, 0
    s_lshl_b32 s19, s19, 6
    s_add_u32 s19, s19, s24
    s_lshl_b32 s21, s12, 10
    s_add_u32 m0, s21, 31744
    s_nop 0
    buffer_load_dwordx4 v8, s[4:7], s19 offen lds
    s_add_i32 s19, s25, 64
    s_max_i32 s19, s19, 0
    s_lshl_b32 s19, s19, 6
    s_add_u32 s19, s19, s24
    s_lshl_b32 s21, s12, 10
    s_add_u32 m0, s21, 35840
    s_nop 0
    buffer_load_dwordx4 v8, s[4:7], s19 offen lds
    v_lshlrev_b32 v9, 2, v4
    v_sub_u32 v9, v3, v9
    v_mov_b32 v10, 0xff7fffff
    v_cmp_le_i32 vcc, 0, v9
    s_nop 1
    v_cndmask_b32_e64 v144, v10, 0, vcc
    v_cndmask_b32_e64 v16, 0, v10, vcc
    v_cmp_le_i32 vcc, 1, v9
    s_nop 1
    v_cndmask_b32_e64 v145, v10, 0, vcc
    v_cndmask_b32_e64 v17, 0, v10, vcc
    v_cmp_le_i32 vcc, 2, v9
    s_nop 1
    v_cndmask_b32_e64 v146, v10, 0, vcc
    v_cndmask_b32_e64 v18, 0, v10, vcc
    v_cmp_le_i32 vcc, 3, v9
    s_nop 1
    v_cndmask_b32_e64 v147, v10, 0, vcc
    v_cndmask_b32_e64 v19, 0, v10, vcc
    v_cmp_le_i32 vcc, 8, v9
    s_nop 1
    v_cndmask_b32_e64 v148, v10, 0, vcc
    v_cndmask_b32_e64 v20, 0, v10, vcc
    v_cmp_le_i32 vcc, 9, v9
    s_nop 1
    v_cndmask_b32_e64 v149, v10, 0, vcc
    v_cndmask_b32_e64 v21, 0, v10, vcc
    v_cmp_le_i32 vcc, 10, v9
    s_nop 1
    v_cndmask_b32_e64 v150, v10, 0, vcc
    v_cndmask_b32_e64 v22, 0, v10, vcc
    v_cmp_le_i32 vcc, 11, v9
    s_nop 1
    v_cndmask_b32_e64 v151, v10, 0, vcc
    v_cndmask_b32_e64 v23, 0, v10, vcc
    v_cmp_le_i32 vcc, 16, v9
    s_nop 1
    v_cndmask_b32_e64 v152, v10, 0, vcc
    v_cndmask_b32_e64 v24, 0, v10, vcc
    v_cmp_le_i32 vcc, 17, v9
    s_nop 1
    v_cndmask_b32_e64 v153, v10, 0, vcc
    v_cndmask_b32_e64 v25, 0, v10, vcc
    v_cmp_le_i32 vcc, 18, v9
    s_nop 1
    v_cndmask_b32_e64 v154, v10, 0, vcc
    v_cndmask_b32_e64 v26, 0, v10, vcc
    v_cmp_le_i32 vcc, 19, v9
    s_nop 1
    v_cndmask_b32_e64 v155, v10, 0, vcc
    v_cndmask_b32_e64 v27, 0, v10, vcc
    v_cmp_le_i32 vcc, 24, v9
    s_nop 1
    v_cndmask_b32_e64 v156, v10, 0, vcc
    v_cndmask_b32_e64 v28, 0, v10, vcc
    v_cmp_le_i32 vcc, 25, v9
    s_nop 1
    v_cndmask_b32_e64 v157, v10, 0, vcc
    v_cndmask_b32_e64 v29, 0, v10, vcc
    v_cmp_le_i32 vcc, 26, v9
    s_nop 1
    v_cndmask_b32_e64 v158, v10, 0, vcc
    v_cndmask_b32_e64 v30, 0, v10, vcc
    v_cmp_le_i32 vcc, 27, v9
    s_nop 1
    v_cndmask_b32_e64 v159, v10, 0, vcc
    v_cndmask_b32_e64 v31, 0, v10, vcc
    s_lshl_b32 s21, s12, 10
    v_add_u32 v13, s21, v15
    s_lshl_b32 s21, s12, 8
    v_add_u32 v14, s21, v7
    s_lshl_b32 s21, s12, 11
    v_add_u32 v2, s21, v15
    s_waitcnt vmcnt(6)
    s_barrier
    s_cmp_ge_u32 s2, 432
    s_nop 1
    s_cbranch_scc1 attn1_kernel_d_end
    s_cmp_ge_u32 s2, 240
    s_cbranch_scc1 attn1_kernel_d_wd
    s_cmp_ge_u32 s2, 160
    s_cbranch_scc1 attn1_kernel_d_wu
    s_cmp_ge_u32 s2, 80
    s_cbranch_scc1 attn1_kernel_d_wg
attn1_kernel_d_wo:
    s_load_dwordx2 s[40:41], s[0:1], 16
    s_sub_u32 s44, s2, 0
    s_lshr_b32 s45, s44, 1
    s_mul_i32 s45, s45, 20
    s_and_b32 s46, s44, 1
    s_lshl_b32 s46, s46, 2
    s_add_u32 s45, s45, s46
    s_add_u32 s46, s45, 8
    s_sub_u32 s47, s44, 64
    s_mul_i32 s47, s47, 40
    s_add_u32 s47, s47, 16
    s_add_u32 s48, s47, 20
    s_cmp_lt_u32 s44, 64
    s_cselect_b32 s45, s45, s47
    s_cselect_b32 s46, s46, s48
    s_mul_i32 s45, s45, 1280
    s_mul_i32 s46, s46, 1280
    s_waitcnt lgkmcnt(0)
    s_and_b32 s41, s41, 0xffff
    s_mov_b32 s42, 819200
    s_mov_b32 s43, 0x00020000
    s_lshl_b32 s47, s12, 10
    s_add_u32 s48, s47, 0
    s_add_u32 m0, s48, 39936
    s_sub_u32 s49, s48, 5120
    s_add_u32 s49, s49, s46
    s_add_u32 s50, s48, s45
    s_cmp_lt_u32 s48, 5120
    s_cselect_b32 s49, s50, s49
    buffer_load_dwordx4 v15, s[40:43], s49 offen lds
    s_add_u32 s48, s47, 4096
    s_add_u32 m0, s48, 39936
    s_sub_u32 s49, s48, 5120
    s_add_u32 s49, s49, s46
    s_add_u32 s50, s48, s45
    s_cmp_lt_u32 s48, 5120
    s_cselect_b32 s49, s50, s49
    buffer_load_dwordx4 v15, s[40:43], s49 offen lds
    s_add_u32 s48, s47, 8192
    s_min_u32 s48, s48, 9216
    s_add_u32 m0, s48, 39936
    s_sub_u32 s49, s48, 5120
    s_add_u32 s49, s49, s46
    s_add_u32 s50, s48, s45
    s_cmp_lt_u32 s48, 5120
    s_cselect_b32 s49, s50, s49
    buffer_load_dwordx4 v15, s[40:43], s49 offen lds
    s_branch attn1_kernel_d_end
attn1_kernel_d_wg:
    s_load_dwordx2 s[40:41], s[0:1], 32
    s_sub_u32 s44, s2, 80
    s_lshl_b32 s45, s44, 3
    s_add_u32 s46, s45, 4
    s_mul_i32 s45, s45, 3072
    s_mul_i32 s46, s46, 3072
    s_waitcnt lgkmcnt(0)
    s_and_b32 s41, s41, 0xffff
    s_mov_b32 s42, 1966080
    s_mov_b32 s43, 0x00020000
    s_lshl_b32 s47, s12, 10
    s_add_u32 s48, s47, 0
    s_add_u32 m0, s48, 39936
    s_sub_u32 s49, s48, 12288
    s_add_u32 s49, s49, s46
    s_add_u32 s50, s48, s45
    s_cmp_lt_u32 s48, 12288
    s_cselect_b32 s49, s50, s49
    buffer_load_dwordx4 v15, s[40:43], s49 offen lds
    s_add_u32 s48, s47, 4096
    s_add_u32 m0, s48, 39936
    s_sub_u32 s49, s48, 12288
    s_add_u32 s49, s49, s46
    s_add_u32 s50, s48, s45
    s_cmp_lt_u32 s48, 12288
    s_cselect_b32 s49, s50, s49
    buffer_load_dwordx4 v15, s[40:43], s49 offen lds
    s_add_u32 s48, s47, 8192
    s_add_u32 m0, s48, 39936
    s_sub_u32 s49, s48, 12288
    s_add_u32 s49, s49, s46
    s_add_u32 s50, s48, s45
    s_cmp_lt_u32 s48, 12288
    s_cselect_b32 s49, s50, s49
    buffer_load_dwordx4 v15, s[40:43], s49 offen lds
    s_add_u32 s48, s47, 12288
    s_add_u32 m0, s48, 39936
    s_sub_u32 s49, s48, 12288
    s_add_u32 s49, s49, s46
    s_add_u32 s50, s48, s45
    s_cmp_lt_u32 s48, 12288
    s_cselect_b32 s49, s50, s49
    buffer_load_dwordx4 v15, s[40:43], s49 offen lds
    s_add_u32 s48, s47, 16384
    s_add_u32 m0, s48, 39936
    s_sub_u32 s49, s48, 12288
    s_add_u32 s49, s49, s46
    s_add_u32 s50, s48, s45
    s_cmp_lt_u32 s48, 12288
    s_cselect_b32 s49, s50, s49
    buffer_load_dwordx4 v15, s[40:43], s49 offen lds
    s_add_u32 s48, s47, 20480
    s_add_u32 m0, s48, 39936
    s_sub_u32 s49, s48, 12288
    s_add_u32 s49, s49, s46
    s_add_u32 s50, s48, s45
    s_cmp_lt_u32 s48, 12288
    s_cselect_b32 s49, s50, s49
    buffer_load_dwordx4 v15, s[40:43], s49 offen lds
    s_branch attn1_kernel_d_end
attn1_kernel_d_wu:
    s_load_dwordx2 s[40:41], s[0:1], 40
    s_sub_u32 s44, s2, 160
    s_lshl_b32 s45, s44, 3
    s_add_u32 s46, s45, 4
    s_mul_i32 s45, s45, 3072
    s_mul_i32 s46, s46, 3072
    s_waitcnt lgkmcnt(0)
    s_and_b32 s41, s41, 0xffff
    s_mov_b32 s42, 1966080
    s_mov_b32 s43, 0x00020000
    s_lshl_b32 s47, s12, 10
    s_add_u32 s48, s47, 0
    s_add_u32 m0, s48, 39936
    s_sub_u32 s49, s48, 12288
    s_add_u32 s49, s49, s46
    s_add_u32 s50, s48, s45
    s_cmp_lt_u32 s48, 12288
    s_cselect_b32 s49, s50, s49
    buffer_load_dwordx4 v15, s[40:43], s49 offen lds
    s_add_u32 s48, s47, 4096
    s_add_u32 m0, s48, 39936
    s_sub_u32 s49, s48, 12288
    s_add_u32 s49, s49, s46
    s_add_u32 s50, s48, s45
    s_cmp_lt_u32 s48, 12288
    s_cselect_b32 s49, s50, s49
    buffer_load_dwordx4 v15, s[40:43], s49 offen lds
    s_add_u32 s48, s47, 8192
    s_add_u32 m0, s48, 39936
    s_sub_u32 s49, s48, 12288
    s_add_u32 s49, s49, s46
    s_add_u32 s50, s48, s45
    s_cmp_lt_u32 s48, 12288
    s_cselect_b32 s49, s50, s49
    buffer_load_dwordx4 v15, s[40:43], s49 offen lds
    s_add_u32 s48, s47, 12288
    s_add_u32 m0, s48, 39936
    s_sub_u32 s49, s48, 12288
    s_add_u32 s49, s49, s46
    s_add_u32 s50, s48, s45
    s_cmp_lt_u32 s48, 12288
    s_cselect_b32 s49, s50, s49
    buffer_load_dwordx4 v15, s[40:43], s49 offen lds
    s_add_u32 s48, s47, 16384
    s_add_u32 m0, s48, 39936
    s_sub_u32 s49, s48, 12288
    s_add_u32 s49, s49, s46
    s_add_u32 s50, s48, s45
    s_cmp_lt_u32 s48, 12288
    s_cselect_b32 s49, s50, s49
    buffer_load_dwordx4 v15, s[40:43], s49 offen lds
    s_add_u32 s48, s47, 20480
    s_add_u32 m0, s48, 39936
    s_sub_u32 s49, s48, 12288
    s_add_u32 s49, s49, s46
    s_add_u32 s50, s48, s45
    s_cmp_lt_u32 s48, 12288
    s_cselect_b32 s49, s50, s49
    buffer_load_dwordx4 v15, s[40:43], s49 offen lds
    s_branch attn1_kernel_d_end
attn1_kernel_d_wd:
    s_load_dwordx2 s[40:41], s[0:1], 48
    s_sub_u32 s44, s2, 240
    s_lshl_b32 s45, s44, 3
    s_add_u32 s46, s45, 4
    s_mul_i32 s45, s45, 1280
    s_mul_i32 s46, s46, 1280
    s_waitcnt lgkmcnt(0)
    s_and_b32 s41, s41, 0xffff
    s_mov_b32 s42, 1966080
    s_mov_b32 s43, 0x00020000
    s_lshl_b32 s47, s12, 10
    s_add_u32 s48, s47, 0
    s_add_u32 m0, s48, 39936
    s_sub_u32 s49, s48, 5120
    s_add_u32 s49, s49, s46
    s_add_u32 s50, s48, s45
    s_cmp_lt_u32 s48, 5120
    s_cselect_b32 s49, s50, s49
    buffer_load_dwordx4 v15, s[40:43], s49 offen lds
    s_add_u32 s48, s47, 4096
    s_add_u32 m0, s48, 39936
    s_sub_u32 s49, s48, 5120
    s_add_u32 s49, s49, s46
    s_add_u32 s50, s48, s45
    s_cmp_lt_u32 s48, 5120
    s_cselect_b32 s49, s50, s49
    buffer_load_dwordx4 v15, s[40:43], s49 offen lds
    s_add_u32 s48, s47, 8192
    s_min_u32 s48, s48, 9216
    s_add_u32 m0, s48, 39936
    s_sub_u32 s49, s48, 5120
    s_add_u32 s49, s49, s46
    s_add_u32 s50, s48, s45
    s_cmp_lt_u32 s48, 5120
    s_cselect_b32 s49, s50, s49
    buffer_load_dwordx4 v15, s[40:43], s49 offen lds
attn1_kernel_d_end:
    ds_read_b128 v[176:179], v13 offset:0
    ds_read_b64 v[180:181], v14 offset:12288
    ds_read_b128 v[184:187], v13 offset:1024
    ds_read_b64 v[188:189], v14 offset:12544
    ds_read_b128 v[192:195], v13 offset:2048
    ds_read_b64 v[196:197], v14 offset:12800
    ds_read_b128 v[200:203], v13 offset:3072
    ds_read_b64 v[204:205], v14 offset:13056
    ds_read_b128 v[208:211], v13 offset:4096
    ds_read_b64 v[212:213], v14 offset:13312
    ds_read_b128 v[216:219], v13 offset:5120
    ds_read_b64 v[220:221], v14 offset:13568
    ds_read_b128 v[224:227], v13 offset:6144
    ds_read_b64 v[228:229], v14 offset:13824
    v_cmp_eq_u32 vcc, 0, v4
    s_nop 1
    v_cndmask_b32_e64 v252, 0, v252, vcc
    v_cndmask_b32_e64 v253, 0, v253, vcc
    s_waitcnt lgkmcnt(12)
    v_mfma_f32_32x32x16_bf16 v[16:31], v[176:179], v[248:251], v[16:31]
    v_mfma_f32_32x32x8_bf16 v[16:31], v[180:181], v[252:253], v[16:31]
    ds_read_b128 v[232:235], v13 offset:7168
    ds_read_b64 v[236:237], v14 offset:14080
    s_waitcnt lgkmcnt(12)
    v_mfma_f32_32x32x16_bf16 v[32:47], v[184:187], v[248:251], 0
    v_mfma_f32_32x32x8_bf16 v[32:47], v[188:189], v[252:253], v[32:47]
    ds_read_b128 v[240:243], v13 offset:8192
    ds_read_b64 v[244:245], v14 offset:14336
    s_waitcnt lgkmcnt(12)
    v_mfma_f32_32x32x16_bf16 v[48:63], v[192:195], v[248:251], 0
    v_mfma_f32_32x32x8_bf16 v[48:63], v[196:197], v[252:253], v[48:63]
    s_waitcnt lgkmcnt(10)
    v_mfma_f32_32x32x16_bf16 v[64:79], v[200:203], v[248:251], 0
    v_mfma_f32_32x32x8_bf16 v[64:79], v[204:205], v[252:253], v[64:79]
    s_waitcnt lgkmcnt(8)
    v_mfma_f32_32x32x16_bf16 v[80:95], v[208:211], v[248:251], 0
    v_mfma_f32_32x32x8_bf16 v[80:95], v[212:213], v[252:253], v[80:95]
    s_waitcnt lgkmcnt(6)
    v_mfma_f32_32x32x16_bf16 v[96:111], v[216:219], v[248:251], 0
    v_mfma_f32_32x32x8_bf16 v[96:111], v[220:221], v[252:253], v[96:111]
    s_waitcnt lgkmcnt(4)
    v_mfma_f32_32x32x16_bf16 v[112:127], v[224:227], v[248:251], 0
    v_mfma_f32_32x32x8_bf16 v[112:127], v[228:229], v[252:253], v[112:127]
    s_waitcnt lgkmcnt(2)
    v_mfma_f32_32x32x16_bf16 v[128:143], v[232:235], v[248:251], 0
    v_mfma_f32_32x32x8_bf16 v[128:143], v[236:237], v[252:253], v[128:143]
    s_waitcnt lgkmcnt(0)
    v_mfma_f32_32x32x16_bf16 v[144:159], v[240:243], v[248:251], v[144:159]
    v_mfma_f32_32x32x8_bf16 v[144:159], v[244:245], v[252:253], v[144:159]
    s_cmp_ge_i32 s15, 256
    s_nop 10
    s_cbranch_scc1 skip_2
    v_mov_b32 v16, v10
    v_mov_b32 v17, v10
    v_mov_b32 v18, v10
    v_mov_b32 v19, v10
    v_mov_b32 v20, v10
    v_mov_b32 v21, v10
    v_mov_b32 v22, v10
    v_mov_b32 v23, v10
    v_mov_b32 v24, v10
    v_mov_b32 v25, v10
    v_mov_b32 v26, v10
    v_mov_b32 v27, v10
    v_mov_b32 v28, v10
    v_mov_b32 v29, v10
    v_mov_b32 v30, v10
    v_mov_b32 v31, v10
    s_nop 4
skip_2:
    s_cmp_ge_i32 s15, 224
    s_cbranch_scc1 skip_3
    v_mov_b32 v32, v10
    v_mov_b32 v33, v10
    v_mov_b32 v34, v10
    v_mov_b32 v35, v10
    v_mov_b32 v36, v10
    v_mov_b32 v37, v10
    v_mov_b32 v38, v10
    v_mov_b32 v39, v10
    v_mov_b32 v40, v10
    v_mov_b32 v41, v10
    v_mov_b32 v42, v10
    v_mov_b32 v43, v10
    v_mov_b32 v44, v10
    v_mov_b32 v45, v10
    v_mov_b32 v46, v10
    v_mov_b32 v47, v10
    s_nop 4
skip_3:
    s_cmp_ge_i32 s15, 192
    s_cbranch_scc1 skip_4
    v_mov_b32 v48, v10
    v_mov_b32 v49, v10
    v_mov_b32 v50, v10
    v_mov_b32 v51, v10
    v_mov_b32 v52, v10
    v_mov_b32 v53, v10
    v_mov_b32 v54, v10
    v_mov_b32 v55, v10
    v_mov_b32 v56, v10
    v_mov_b32 v57, v10
    v_mov_b32 v58, v10
    v_mov_b32 v59, v10
    v_mov_b32 v60, v10
    v_mov_b32 v61, v10
    v_mov_b32 v62, v10
    v_mov_b32 v63, v10
    s_nop 4
skip_4:
    s_cmp_ge_i32 s15, 160
    s_cbranch_scc1 skip_5
    v_mov_b32 v64, v10
    v_mov_b32 v65, v10
    v_mov_b32 v66, v10
    v_mov_b32 v67, v10
    v_mov_b32 v68, v10
    v_mov_b32 v69, v10
    v_mov_b32 v70, v10
    v_mov_b32 v71, v10
    v_mov_b32 v72, v10
    v_mov_b32 v73, v10
    v_mov_b32 v74, v10
    v_mov_b32 v75, v10
    v_mov_b32 v76, v10
    v_mov_b32 v77, v10
    v_mov_b32 v78, v10
    v_mov_b32 v79, v10
    s_nop 4
skip_5:
    s_cmp_ge_i32 s15, 128
    s_cbranch_scc1 skip_6
    v_mov_b32 v80, v10
    v_mov_b32 v81, v10
    v_mov_b32 v82, v10
    v_mov_b32 v83, v10
    v_mov_b32 v84, v10
    v_mov_b32 v85, v10
    v_mov_b32 v86, v10
    v_mov_b32 v87, v10
    v_mov_b32 v88, v10
    v_mov_b32 v89, v10
    v_mov_b32 v90, v10
    v_mov_b32 v91, v10
    v_mov_b32 v92, v10
    v_mov_b32 v93, v10
    v_mov_b32 v94, v10
    v_mov_b32 v95, v10
    s_nop 4
skip_6:
    s_cmp_ge_i32 s15, 96
    s_cbranch_scc1 skip_7
    v_mov_b32 v96, v10
    v_mov_b32 v97, v10
    v_mov_b32 v98, v10
    v_mov_b32 v99, v10
    v_mov_b32 v100, v10
    v_mov_b32 v101, v10
    v_mov_b32 v102, v10
    v_mov_b32 v103, v10
    v_mov_b32 v104, v10
    v_mov_b32 v105, v10
    v_mov_b32 v106, v10
    v_mov_b32 v107, v10
    v_mov_b32 v108, v10
    v_mov_b32 v109, v10
    v_mov_b32 v110, v10
    v_mov_b32 v111, v10
    s_nop 4
skip_7:
    s_cmp_ge_i32 s15, 64
    s_cbranch_scc1 skip_8
    v_mov_b32 v112, v10
    v_mov_b32 v113, v10
    v_mov_b32 v114, v10
    v_mov_b32 v115, v10
    v_mov_b32 v116, v10
    v_mov_b32 v117, v10
    v_mov_b32 v118, v10
    v_mov_b32 v119, v10
    v_mov_b32 v120, v10
    v_mov_b32 v121, v10
    v_mov_b32 v122, v10
    v_mov_b32 v123, v10
    v_mov_b32 v124, v10
    v_mov_b32 v125, v10
    v_mov_b32 v126, v10
    v_mov_b32 v127, v10
    s_nop 4
skip_8:
    s_cmp_ge_i32 s15, 32
    s_cbranch_scc1 skip_9
    v_mov_b32 v128, v10
    v_mov_b32 v129, v10
    v_mov_b32 v130, v10
    v_mov_b32 v131, v10
    v_mov_b32 v132, v10
    v_mov_b32 v133, v10
    v_mov_b32 v134, v10
    v_mov_b32 v135, v10
    v_mov_b32 v136, v10
    v_mov_b32 v137, v10
    v_mov_b32 v138, v10
    v_mov_b32 v139, v10
    v_mov_b32 v140, v10
    v_mov_b32 v141, v10
    v_mov_b32 v142, v10
    v_mov_b32 v143, v10
    s_nop 4
skip_9:
    v_max3_f32 v11, v16, v17, v18
    v_max3_f32 v12, v19, v20, v21
    v_max3_f32 v11, v11, v22, v23
    v_max3_f32 v12, v12, v24, v25
    v_max3_f32 v11, v11, v26, v27
    v_max3_f32 v12, v12, v28, v29
    v_max3_f32 v11, v11, v30, v31
    v_max3_f32 v12, v12, v32, v33
    v_max3_f32 v11, v11, v34, v35
    v_max3_f32 v12, v12, v36, v37
    v_max3_f32 v11, v11, v38, v39
    v_max3_f32 v12, v12, v40, v41
    v_max3_f32 v11, v11, v42, v43
    v_max3_f32 v12, v12, v44, v45
    v_max3_f32 v11, v11, v46, v47
    v_max3_f32 v12, v12, v48, v49
    v_max3_f32 v11, v11, v50, v51
    v_max3_f32 v12, v12, v52, v53
    v_max3_f32 v11, v11, v54, v55
    v_max3_f32 v12, v12, v56, v57
    v_max3_f32 v11, v11, v58, v59
    v_max3_f32 v12, v12, v60, v61
    v_max3_f32 v11, v11, v62, v63
    v_max3_f32 v12, v12, v64, v65
    v_max3_f32 v11, v11, v66, v67
    v_max3_f32 v12, v12, v68, v69
    v_max3_f32 v11, v11, v70, v71
    v_max3_f32 v12, v12, v72, v73
    v_max3_f32 v11, v11, v74, v75
    v_max3_f32 v12, v12, v76, v77
    v_max3_f32 v11, v11, v78, v79
    v_max3_f32 v12, v12, v80, v81
    v_max3_f32 v11, v11, v82, v83
    v_max3_f32 v12, v12, v84, v85
    v_max3_f32 v11, v11, v86, v87
    v_max3_f32 v12, v12, v88, v89
    v_max3_f32 v11, v11, v90, v91
    v_max3_f32 v12, v12, v92, v93
    v_max3_f32 v11, v11, v94, v95
    v_max3_f32 v12, v12, v96, v97
    v_max3_f32 v11, v11, v98, v99
    v_max3_f32 v12, v12, v100, v101
    v_max3_f32 v11, v11, v102, v103
    v_max3_f32 v12, v12, v104, v105
    v_max3_f32 v11, v11, v106, v107
    v_max3_f32 v12, v12, v108, v109
    v_max3_f32 v11, v11, v110, v111
    v_max3_f32 v12, v12, v112, v113
    v_max3_f32 v11, v11, v114, v115
    v_max3_f32 v12, v12, v116, v117
    v_max3_f32 v11, v11, v118, v119
    v_max3_f32 v12, v12, v120, v121
    v_max3_f32 v11, v11, v122, v123
    v_max3_f32 v12, v12, v124, v125
    v_max3_f32 v11, v11, v126, v127
    v_max3_f32 v12, v12, v128, v129
    v_max3_f32 v11, v11, v130, v131
    v_max3_f32 v12, v12, v132, v133
    v_max3_f32 v11, v11, v134, v135
    v_max3_f32 v12, v12, v136, v137
    v_max3_f32 v11, v11, v138, v139
    v_max3_f32 v12, v12, v140, v141
    v_max3_f32 v11, v11, v142, v143
    v_max3_f32 v12, v12, v144, v145
    v_max3_f32 v11, v11, v146, v147
    v_max3_f32 v12, v12, v148, v149
    v_max3_f32 v11, v11, v150, v151
    v_max3_f32 v12, v12, v152, v153
    v_max3_f32 v11, v11, v154, v155
    v_max3_f32 v12, v12, v156, v157
    v_max3_f32 v11, v11, v158, v159
    v_max_f32 v11, v11, v12
    v_mov_b32 v12, v11
    s_nop 1
    v_permlane32_swap_b32 v11, v12
    v_max_f32 v11, v11, v12
    s_mov_b32 s22, 0x3ea52b5c
    v_mul_f32 v12, s22, v11
    v_mov_b32 v13, s22
    s_waitcnt vmcnt(0)
    s_barrier
    ds_read_b128 v[176:179], v2 offset:15360
    ds_read_b128 v[180:183], v2 offset:16384
    v_pk_fma_f32 v[16:17], v[16:17], v[12:13], v[12:13] op_sel:[0,1,0] op_sel_hi:[1,1,0] neg_lo:[0,0,1] neg_hi:[0,0,1]
    v_pk_fma_f32 v[18:19], v[18:19], v[12:13], v[12:13] op_sel:[0,1,0] op_sel_hi:[1,1,0] neg_lo:[0,0,1] neg_hi:[0,0,1]
    v_pk_fma_f32 v[20:21], v[20:21], v[12:13], v[12:13] op_sel:[0,1,0] op_sel_hi:[1,1,0] neg_lo:[0,0,1] neg_hi:[0,0,1]
    v_pk_fma_f32 v[22:23], v[22:23], v[12:13], v[12:13] op_sel:[0,1,0] op_sel_hi:[1,1,0] neg_lo:[0,0,1] neg_hi:[0,0,1]
    v_pk_fma_f32 v[24:25], v[24:25], v[12:13], v[12:13] op_sel:[0,1,0] op_sel_hi:[1,1,0] neg_lo:[0,0,1] neg_hi:[0,0,1]
    v_pk_fma_f32 v[26:27], v[26:27], v[12:13], v[12:13] op_sel:[0,1,0] op_sel_hi:[1,1,0] neg_lo:[0,0,1] neg_hi:[0,0,1]
    v_pk_fma_f32 v[28:29], v[28:29], v[12:13], v[12:13] op_sel:[0,1,0] op_sel_hi:[1,1,0] neg_lo:[0,0,1] neg_hi:[0,0,1]
    v_pk_fma_f32 v[30:31], v[30:31], v[12:13], v[12:13] op_sel:[0,1,0] op_sel_hi:[1,1,0] neg_lo:[0,0,1] neg_hi:[0,0,1]
    v_exp_f32 v16, v16
    v_exp_f32 v17, v17
    v_exp_f32 v18, v18
    v_exp_f32 v19, v19
    v_exp_f32 v20, v20
    v_exp_f32 v21, v21
    v_exp_f32 v22, v22
    v_exp_f32 v23, v23
    v_exp_f32 v24, v24
    v_exp_f32 v25, v25
    v_exp_f32 v26, v26
    v_exp_f32 v27, v27
    v_exp_f32 v28, v28
    v_exp_f32 v29, v29
    v_exp_f32 v30, v30
    v_exp_f32 v31, v31
    v_cvt_pk_bf16_f32 v16, v16, v17
    v_cvt_pk_bf16_f32 v17, v18, v19
    v_cvt_pk_bf16_f32 v18, v20, v21
    v_cvt_pk_bf16_f32 v19, v22, v23
    v_cvt_pk_bf16_f32 v20, v24, v25
    v_cvt_pk_bf16_f32 v21, v26, v27
    v_cvt_pk_bf16_f32 v22, v28, v29
    v_cvt_pk_bf16_f32 v23, v30, v31
    s_waitcnt lgkmcnt(0)
    v_mfma_f32_32x32x16_bf16 v[160:175], v[176:179], v[16:19], 0
    v_mfma_f32_32x32x16_bf16 v[160:175], v[180:183], v[20:23], v[160:175]
    ds_read_b128 v[184:187], v2 offset:17408
    ds_read_b128 v[188:191], v2 offset:18432
    v_pk_fma_f32 v[32:33], v[32:33], v[12:13], v[12:13] op_sel:[0,1,0] op_sel_hi:[1,1,0] neg_lo:[0,0,1] neg_hi:[0,0,1]
    v_pk_fma_f32 v[34:35], v[34:35], v[12:13], v[12:13] op_sel:[0,1,0] op_sel_hi:[1,1,0] neg_lo:[0,0,1] neg_hi:[0,0,1]
    v_pk_fma_f32 v[36:37], v[36:37], v[12:13], v[12:13] op_sel:[0,1,0] op_sel_hi:[1,1,0] neg_lo:[0,0,1] neg_hi:[0,0,1]
    v_pk_fma_f32 v[38:39], v[38:39], v[12:13], v[12:13] op_sel:[0,1,0] op_sel_hi:[1,1,0] neg_lo:[0,0,1] neg_hi:[0,0,1]
    v_pk_fma_f32 v[40:41], v[40:41], v[12:13], v[12:13] op_sel:[0,1,0] op_sel_hi:[1,1,0] neg_lo:[0,0,1] neg_hi:[0,0,1]
    v_pk_fma_f32 v[42:43], v[42:43], v[12:13], v[12:13] op_sel:[0,1,0] op_sel_hi:[1,1,0] neg_lo:[0,0,1] neg_hi:[0,0,1]
    v_pk_fma_f32 v[44:45], v[44:45], v[12:13], v[12:13] op_sel:[0,1,0] op_sel_hi:[1,1,0] neg_lo:[0,0,1] neg_hi:[0,0,1]
    v_pk_fma_f32 v[46:47], v[46:47], v[12:13], v[12:13] op_sel:[0,1,0] op_sel_hi:[1,1,0] neg_lo:[0,0,1] neg_hi:[0,0,1]
    v_exp_f32 v32, v32
    v_exp_f32 v33, v33
    v_exp_f32 v34, v34
    v_exp_f32 v35, v35
    v_exp_f32 v36, v36
    v_exp_f32 v37, v37
    v_exp_f32 v38, v38
    v_exp_f32 v39, v39
    v_exp_f32 v40, v40
    v_exp_f32 v41, v41
    v_exp_f32 v42, v42
    v_exp_f32 v43, v43
    v_exp_f32 v44, v44
    v_exp_f32 v45, v45
    v_exp_f32 v46, v46
    v_exp_f32 v47, v47
    v_cvt_pk_bf16_f32 v32, v32, v33
    v_cvt_pk_bf16_f32 v33, v34, v35
    v_cvt_pk_bf16_f32 v34, v36, v37
    v_cvt_pk_bf16_f32 v35, v38, v39
    v_cvt_pk_bf16_f32 v36, v40, v41
    v_cvt_pk_bf16_f32 v37, v42, v43
    v_cvt_pk_bf16_f32 v38, v44, v45
    v_cvt_pk_bf16_f32 v39, v46, v47
    s_waitcnt lgkmcnt(0)
    v_mfma_f32_32x32x16_bf16 v[160:175], v[184:187], v[32:35], v[160:175]
    v_mfma_f32_32x32x16_bf16 v[160:175], v[188:191], v[36:39], v[160:175]
    ds_read_b128 v[192:195], v2 offset:19456
    ds_read_b128 v[196:199], v2 offset:20480
    v_pk_fma_f32 v[48:49], v[48:49], v[12:13], v[12:13] op_sel:[0,1,0] op_sel_hi:[1,1,0] neg_lo:[0,0,1] neg_hi:[0,0,1]
    v_pk_fma_f32 v[50:51], v[50:51], v[12:13], v[12:13] op_sel:[0,1,0] op_sel_hi:[1,1,0] neg_lo:[0,0,1] neg_hi:[0,0,1]
    v_pk_fma_f32 v[52:53], v[52:53], v[12:13], v[12:13] op_sel:[0,1,0] op_sel_hi:[1,1,0] neg_lo:[0,0,1] neg_hi:[0,0,1]
    v_pk_fma_f32 v[54:55], v[54:55], v[12:13], v[12:13] op_sel:[0,1,0] op_sel_hi:[1,1,0] neg_lo:[0,0,1] neg_hi:[0,0,1]
    v_pk_fma_f32 v[56:57], v[56:57], v[12:13], v[12:13] op_sel:[0,1,0] op_sel_hi:[1,1,0] neg_lo:[0,0,1] neg_hi:[0,0,1]
    v_pk_fma_f32 v[58:59], v[58:59], v[12:13], v[12:13] op_sel:[0,1,0] op_sel_hi:[1,1,0] neg_lo:[0,0,1] neg_hi:[0,0,1]
    v_pk_fma_f32 v[60:61], v[60:61], v[12:13], v[12:13] op_sel:[0,1,0] op_sel_hi:[1,1,0] neg_lo:[0,0,1] neg_hi:[0,0,1]
    v_pk_fma_f32 v[62:63], v[62:63], v[12:13], v[12:13] op_sel:[0,1,0] op_sel_hi:[1,1,0] neg_lo:[0,0,1] neg_hi:[0,0,1]
    v_exp_f32 v48, v48
    v_exp_f32 v49, v49
    v_exp_f32 v50, v50
    v_exp_f32 v51, v51
    v_exp_f32 v52, v52
    v_exp_f32 v53, v53
    v_exp_f32 v54, v54
    v_exp_f32 v55, v55
    v_exp_f32 v56, v56
    v_exp_f32 v57, v57
    v_exp_f32 v58, v58
    v_exp_f32 v59, v59
    v_exp_f32 v60, v60
    v_exp_f32 v61, v61
    v_exp_f32 v62, v62
    v_exp_f32 v63, v63
    v_cvt_pk_bf16_f32 v48, v48, v49
    v_cvt_pk_bf16_f32 v49, v50, v51
    v_cvt_pk_bf16_f32 v50, v52, v53
    v_cvt_pk_bf16_f32 v51, v54, v55
    v_cvt_pk_bf16_f32 v52, v56, v57
    v_cvt_pk_bf16_f32 v53, v58, v59
    v_cvt_pk_bf16_f32 v54, v60, v61
    v_cvt_pk_bf16_f32 v55, v62, v63
    s_waitcnt lgkmcnt(0)
    v_mfma_f32_32x32x16_bf16 v[160:175], v[192:195], v[48:51], v[160:175]
    v_mfma_f32_32x32x16_bf16 v[160:175], v[196:199], v[52:55], v[160:175]
    ds_read_b128 v[200:203], v2 offset:21504
    ds_read_b128 v[204:207], v2 offset:22528
    v_pk_fma_f32 v[64:65], v[64:65], v[12:13], v[12:13] op_sel:[0,1,0] op_sel_hi:[1,1,0] neg_lo:[0,0,1] neg_hi:[0,0,1]
    v_pk_fma_f32 v[66:67], v[66:67], v[12:13], v[12:13] op_sel:[0,1,0] op_sel_hi:[1,1,0] neg_lo:[0,0,1] neg_hi:[0,0,1]
    v_pk_fma_f32 v[68:69], v[68:69], v[12:13], v[12:13] op_sel:[0,1,0] op_sel_hi:[1,1,0] neg_lo:[0,0,1] neg_hi:[0,0,1]
    v_pk_fma_f32 v[70:71], v[70:71], v[12:13], v[12:13] op_sel:[0,1,0] op_sel_hi:[1,1,0] neg_lo:[0,0,1] neg_hi:[0,0,1]
    v_pk_fma_f32 v[72:73], v[72:73], v[12:13], v[12:13] op_sel:[0,1,0] op_sel_hi:[1,1,0] neg_lo:[0,0,1] neg_hi:[0,0,1]
    v_pk_fma_f32 v[74:75], v[74:75], v[12:13], v[12:13] op_sel:[0,1,0] op_sel_hi:[1,1,0] neg_lo:[0,0,1] neg_hi:[0,0,1]
    v_pk_fma_f32 v[76:77], v[76:77], v[12:13], v[12:13] op_sel:[0,1,0] op_sel_hi:[1,1,0] neg_lo:[0,0,1] neg_hi:[0,0,1]
    v_pk_fma_f32 v[78:79], v[78:79], v[12:13], v[12:13] op_sel:[0,1,0] op_sel_hi:[1,1,0] neg_lo:[0,0,1] neg_hi:[0,0,1]
    v_exp_f32 v64, v64
    v_exp_f32 v65, v65
    v_exp_f32 v66, v66
    v_exp_f32 v67, v67
    v_exp_f32 v68, v68
    v_exp_f32 v69, v69
    v_exp_f32 v70, v70
    v_exp_f32 v71, v71
    v_exp_f32 v72, v72
    v_exp_f32 v73, v73
    v_exp_f32 v74, v74
    v_exp_f32 v75, v75
    v_exp_f32 v76, v76
    v_exp_f32 v77, v77
    v_exp_f32 v78, v78
    v_exp_f32 v79, v79
    v_cvt_pk_bf16_f32 v64, v64, v65
    v_cvt_pk_bf16_f32 v65, v66, v67
    v_cvt_pk_bf16_f32 v66, v68, v69
    v_cvt_pk_bf16_f32 v67, v70, v71
    v_cvt_pk_bf16_f32 v68, v72, v73
    v_cvt_pk_bf16_f32 v69, v74, v75
    v_cvt_pk_bf16_f32 v70, v76, v77
    v_cvt_pk_bf16_f32 v71, v78, v79
    s_waitcnt lgkmcnt(0)
    v_mfma_f32_32x32x16_bf16 v[160:175], v[200:203], v[64:67], v[160:175]
    v_mfma_f32_32x32x16_bf16 v[160:175], v[204:207], v[68:71], v[160:175]
    ds_read_b128 v[208:211], v2 offset:23552
    ds_read_b128 v[212:215], v2 offset:24576
    v_pk_fma_f32 v[80:81], v[80:81], v[12:13], v[12:13] op_sel:[0,1,0] op_sel_hi:[1,1,0] neg_lo:[0,0,1] neg_hi:[0,0,1]
    v_pk_fma_f32 v[82:83], v[82:83], v[12:13], v[12:13] op_sel:[0,1,0] op_sel_hi:[1,1,0] neg_lo:[0,0,1] neg_hi:[0,0,1]
    v_pk_fma_f32 v[84:85], v[84:85], v[12:13], v[12:13] op_sel:[0,1,0] op_sel_hi:[1,1,0] neg_lo:[0,0,1] neg_hi:[0,0,1]
    v_pk_fma_f32 v[86:87], v[86:87], v[12:13], v[12:13] op_sel:[0,1,0] op_sel_hi:[1,1,0] neg_lo:[0,0,1] neg_hi:[0,0,1]
    v_pk_fma_f32 v[88:89], v[88:89], v[12:13], v[12:13] op_sel:[0,1,0] op_sel_hi:[1,1,0] neg_lo:[0,0,1] neg_hi:[0,0,1]
    v_pk_fma_f32 v[90:91], v[90:91], v[12:13], v[12:13] op_sel:[0,1,0] op_sel_hi:[1,1,0] neg_lo:[0,0,1] neg_hi:[0,0,1]
    v_pk_fma_f32 v[92:93], v[92:93], v[12:13], v[12:13] op_sel:[0,1,0] op_sel_hi:[1,1,0] neg_lo:[0,0,1] neg_hi:[0,0,1]
    v_pk_fma_f32 v[94:95], v[94:95], v[12:13], v[12:13] op_sel:[0,1,0] op_sel_hi:[1,1,0] neg_lo:[0,0,1] neg_hi:[0,0,1]
    v_exp_f32 v80, v80
    v_exp_f32 v81, v81
    v_exp_f32 v82, v82
    v_exp_f32 v83, v83
    v_exp_f32 v84, v84
    v_exp_f32 v85, v85
    v_exp_f32 v86, v86
    v_exp_f32 v87, v87
    v_exp_f32 v88, v88
    v_exp_f32 v89, v89
    v_exp_f32 v90, v90
    v_exp_f32 v91, v91
    v_exp_f32 v92, v92
    v_exp_f32 v93, v93
    v_exp_f32 v94, v94
    v_exp_f32 v95, v95
    v_cvt_pk_bf16_f32 v80, v80, v81
    v_cvt_pk_bf16_f32 v81, v82, v83
    v_cvt_pk_bf16_f32 v82, v84, v85
    v_cvt_pk_bf16_f32 v83, v86, v87
    v_cvt_pk_bf16_f32 v84, v88, v89
    v_cvt_pk_bf16_f32 v85, v90, v91
    v_cvt_pk_bf16_f32 v86, v92, v93
    v_cvt_pk_bf16_f32 v87, v94, v95
    s_waitcnt lgkmcnt(0)
    v_mfma_f32_32x32x16_bf16 v[160:175], v[208:211], v[80:83], v[160:175]
    v_mfma_f32_32x32x16_bf16 v[160:175], v[212:215], v[84:87], v[160:175]
    ds_read_b128 v[216:219], v2 offset:25600
    ds_read_b128 v[220:223], v2 offset:26624
    v_pk_fma_f32 v[96:97], v[96:97], v[12:13], v[12:13] op_sel:[0,1,0] op_sel_hi:[1,1,0] neg_lo:[0,0,1] neg_hi:[0,0,1]
    v_pk_fma_f32 v[98:99], v[98:99], v[12:13], v[12:13] op_sel:[0,1,0] op_sel_hi:[1,1,0] neg_lo:[0,0,1] neg_hi:[0,0,1]
    v_pk_fma_f32 v[100:101], v[100:101], v[12:13], v[12:13] op_sel:[0,1,0] op_sel_hi:[1,1,0] neg_lo:[0,0,1] neg_hi:[0,0,1]
    v_pk_fma_f32 v[102:103], v[102:103], v[12:13], v[12:13] op_sel:[0,1,0] op_sel_hi:[1,1,0] neg_lo:[0,0,1] neg_hi:[0,0,1]
    v_pk_fma_f32 v[104:105], v[104:105], v[12:13], v[12:13] op_sel:[0,1,0] op_sel_hi:[1,1,0] neg_lo:[0,0,1] neg_hi:[0,0,1]
    v_pk_fma_f32 v[106:107], v[106:107], v[12:13], v[12:13] op_sel:[0,1,0] op_sel_hi:[1,1,0] neg_lo:[0,0,1] neg_hi:[0,0,1]
    v_pk_fma_f32 v[108:109], v[108:109], v[12:13], v[12:13] op_sel:[0,1,0] op_sel_hi:[1,1,0] neg_lo:[0,0,1] neg_hi:[0,0,1]
    v_pk_fma_f32 v[110:111], v[110:111], v[12:13], v[12:13] op_sel:[0,1,0] op_sel_hi:[1,1,0] neg_lo:[0,0,1] neg_hi:[0,0,1]
    v_exp_f32 v96, v96
    v_exp_f32 v97, v97
    v_exp_f32 v98, v98
    v_exp_f32 v99, v99
    v_exp_f32 v100, v100
    v_exp_f32 v101, v101
    v_exp_f32 v102, v102
    v_exp_f32 v103, v103
    v_exp_f32 v104, v104
    v_exp_f32 v105, v105
    v_exp_f32 v106, v106
    v_exp_f32 v107, v107
    v_exp_f32 v108, v108
    v_exp_f32 v109, v109
    v_exp_f32 v110, v110
    v_exp_f32 v111, v111
    v_cvt_pk_bf16_f32 v96, v96, v97
    v_cvt_pk_bf16_f32 v97, v98, v99
    v_cvt_pk_bf16_f32 v98, v100, v101
    v_cvt_pk_bf16_f32 v99, v102, v103
    v_cvt_pk_bf16_f32 v100, v104, v105
    v_cvt_pk_bf16_f32 v101, v106, v107
    v_cvt_pk_bf16_f32 v102, v108, v109
    v_cvt_pk_bf16_f32 v103, v110, v111
    s_waitcnt lgkmcnt(0)
    v_mfma_f32_32x32x16_bf16 v[160:175], v[216:219], v[96:99], v[160:175]
    v_mfma_f32_32x32x16_bf16 v[160:175], v[220:223], v[100:103], v[160:175]
    ds_read_b128 v[224:227], v2 offset:27648
    ds_read_b128 v[228:231], v2 offset:28672
    v_pk_fma_f32 v[112:113], v[112:113], v[12:13], v[12:13] op_sel:[0,1,0] op_sel_hi:[1,1,0] neg_lo:[0,0,1] neg_hi:[0,0,1]
    v_pk_fma_f32 v[114:115], v[114:115], v[12:13], v[12:13] op_sel:[0,1,0] op_sel_hi:[1,1,0] neg_lo:[0,0,1] neg_hi:[0,0,1]
    v_pk_fma_f32 v[116:117], v[116:117], v[12:13], v[12:13] op_sel:[0,1,0] op_sel_hi:[1,1,0] neg_lo:[0,0,1] neg_hi:[0,0,1]
    v_pk_fma_f32 v[118:119], v[118:119], v[12:13], v[12:13] op_sel:[0,1,0] op_sel_hi:[1,1,0] neg_lo:[0,0,1] neg_hi:[0,0,1]
    v_pk_fma_f32 v[120:121], v[120:121], v[12:13], v[12:13] op_sel:[0,1,0] op_sel_hi:[1,1,0] neg_lo:[0,0,1] neg_hi:[0,0,1]
    v_pk_fma_f32 v[122:123], v[122:123], v[12:13], v[12:13] op_sel:[0,1,0] op_sel_hi:[1,1,0] neg_lo:[0,0,1] neg_hi:[0,0,1]
    v_pk_fma_f32 v[124:125], v[124:125], v[12:13], v[12:13] op_sel:[0,1,0] op_sel_hi:[1,1,0] neg_lo:[0,0,1] neg_hi:[0,0,1]
    v_pk_fma_f32 v[126:127], v[126:127], v[12:13], v[12:13] op_sel:[0,1,0] op_sel_hi:[1,1,0] neg_lo:[0,0,1] neg_hi:[0,0,1]
    v_exp_f32 v112, v112
    v_exp_f32 v113, v113
    v_exp_f32 v114, v114
    v_exp_f32 v115, v115
    v_exp_f32 v116, v116
    v_exp_f32 v117, v117
    v_exp_f32 v118, v118
    v_exp_f32 v119, v119
    v_exp_f32 v120, v120
    v_exp_f32 v121, v121
    v_exp_f32 v122, v122
    v_exp_f32 v123, v123
    v_exp_f32 v124, v124
    v_exp_f32 v125, v125
    v_exp_f32 v126, v126
    v_exp_f32 v127, v127
    v_cvt_pk_bf16_f32 v112, v112, v113
    v_cvt_pk_bf16_f32 v113, v114, v115
    v_cvt_pk_bf16_f32 v114, v116, v117
    v_cvt_pk_bf16_f32 v115, v118, v119
    v_cvt_pk_bf16_f32 v116, v120, v121
    v_cvt_pk_bf16_f32 v117, v122, v123
    v_cvt_pk_bf16_f32 v118, v124, v125
    v_cvt_pk_bf16_f32 v119, v126, v127
    s_waitcnt lgkmcnt(0)
    v_mfma_f32_32x32x16_bf16 v[160:175], v[224:227], v[112:115], v[160:175]
    v_mfma_f32_32x32x16_bf16 v[160:175], v[228:231], v[116:119], v[160:175]
    ds_read_b128 v[232:235], v2 offset:29696
    ds_read_b128 v[236:239], v2 offset:30720
    v_pk_fma_f32 v[128:129], v[128:129], v[12:13], v[12:13] op_sel:[0,1,0] op_sel_hi:[1,1,0] neg_lo:[0,0,1] neg_hi:[0,0,1]
    v_pk_fma_f32 v[130:131], v[130:131], v[12:13], v[12:13] op_sel:[0,1,0] op_sel_hi:[1,1,0] neg_lo:[0,0,1] neg_hi:[0,0,1]
    v_pk_fma_f32 v[132:133], v[132:133], v[12:13], v[12:13] op_sel:[0,1,0] op_sel_hi:[1,1,0] neg_lo:[0,0,1] neg_hi:[0,0,1]
    v_pk_fma_f32 v[134:135], v[134:135], v[12:13], v[12:13] op_sel:[0,1,0] op_sel_hi:[1,1,0] neg_lo:[0,0,1] neg_hi:[0,0,1]
    v_pk_fma_f32 v[136:137], v[136:137], v[12:13], v[12:13] op_sel:[0,1,0] op_sel_hi:[1,1,0] neg_lo:[0,0,1] neg_hi:[0,0,1]
    v_pk_fma_f32 v[138:139], v[138:139], v[12:13], v[12:13] op_sel:[0,1,0] op_sel_hi:[1,1,0] neg_lo:[0,0,1] neg_hi:[0,0,1]
    v_pk_fma_f32 v[140:141], v[140:141], v[12:13], v[12:13] op_sel:[0,1,0] op_sel_hi:[1,1,0] neg_lo:[0,0,1] neg_hi:[0,0,1]
    v_pk_fma_f32 v[142:143], v[142:143], v[12:13], v[12:13] op_sel:[0,1,0] op_sel_hi:[1,1,0] neg_lo:[0,0,1] neg_hi:[0,0,1]
    v_exp_f32 v128, v128
    v_exp_f32 v129, v129
    v_exp_f32 v130, v130
    v_exp_f32 v131, v131
    v_exp_f32 v132, v132
    v_exp_f32 v133, v133
    v_exp_f32 v134, v134
    v_exp_f32 v135, v135
    v_exp_f32 v136, v136
    v_exp_f32 v137, v137
    v_exp_f32 v138, v138
    v_exp_f32 v139, v139
    v_exp_f32 v140, v140
    v_exp_f32 v141, v141
    v_exp_f32 v142, v142
    v_exp_f32 v143, v143
    v_cvt_pk_bf16_f32 v128, v128, v129
    v_cvt_pk_bf16_f32 v129, v130, v131
    v_cvt_pk_bf16_f32 v130, v132, v133
    v_cvt_pk_bf16_f32 v131, v134, v135
    v_cvt_pk_bf16_f32 v132, v136, v137
    v_cvt_pk_bf16_f32 v133, v138, v139
    v_cvt_pk_bf16_f32 v134, v140, v141
    v_cvt_pk_bf16_f32 v135, v142, v143
    s_waitcnt lgkmcnt(0)
    v_mfma_f32_32x32x16_bf16 v[160:175], v[232:235], v[128:131], v[160:175]
    v_mfma_f32_32x32x16_bf16 v[160:175], v[236:239], v[132:135], v[160:175]
    ds_read_b128 v[240:243], v2 offset:31744
    ds_read_b128 v[244:247], v2 offset:32768
    v_pk_fma_f32 v[144:145], v[144:145], v[12:13], v[12:13] op_sel:[0,1,0] op_sel_hi:[1,1,0] neg_lo:[0,0,1] neg_hi:[0,0,1]
    v_pk_fma_f32 v[146:147], v[146:147], v[12:13], v[12:13] op_sel:[0,1,0] op_sel_hi:[1,1,0] neg_lo:[0,0,1] neg_hi:[0,0,1]
    v_pk_fma_f32 v[148:149], v[148:149], v[12:13], v[12:13] op_sel:[0,1,0] op_sel_hi:[1,1,0] neg_lo:[0,0,1] neg_hi:[0,0,1]
    v_pk_fma_f32 v[150:151], v[150:151], v[12:13], v[12:13] op_sel:[0,1,0] op_sel_hi:[1,1,0] neg_lo:[0,0,1] neg_hi:[0,0,1]
    v_pk_fma_f32 v[152:153], v[152:153], v[12:13], v[12:13] op_sel:[0,1,0] op_sel_hi:[1,1,0] neg_lo:[0,0,1] neg_hi:[0,0,1]
    v_pk_fma_f32 v[154:155], v[154:155], v[12:13], v[12:13] op_sel:[0,1,0] op_sel_hi:[1,1,0] neg_lo:[0,0,1] neg_hi:[0,0,1]
    v_pk_fma_f32 v[156:157], v[156:157], v[12:13], v[12:13] op_sel:[0,1,0] op_sel_hi:[1,1,0] neg_lo:[0,0,1] neg_hi:[0,0,1]
    v_pk_fma_f32 v[158:159], v[158:159], v[12:13], v[12:13] op_sel:[0,1,0] op_sel_hi:[1,1,0] neg_lo:[0,0,1] neg_hi:[0,0,1]
    v_exp_f32 v144, v144
    v_exp_f32 v145, v145
    v_exp_f32 v146, v146
    v_exp_f32 v147, v147
    v_exp_f32 v148, v148
    v_exp_f32 v149, v149
    v_exp_f32 v150, v150
    v_exp_f32 v151, v151
    v_exp_f32 v152, v152
    v_exp_f32 v153, v153
    v_exp_f32 v154, v154
    v_exp_f32 v155, v155
    v_exp_f32 v156, v156
    v_exp_f32 v157, v157
    v_exp_f32 v158, v158
    v_exp_f32 v159, v159
    v_cvt_pk_bf16_f32 v144, v144, v145
    v_cvt_pk_bf16_f32 v145, v146, v147
    v_cvt_pk_bf16_f32 v146, v148, v149
    v_cvt_pk_bf16_f32 v147, v150, v151
    v_cvt_pk_bf16_f32 v148, v152, v153
    v_cvt_pk_bf16_f32 v149, v154, v155
    v_cvt_pk_bf16_f32 v150, v156, v157
    v_cvt_pk_bf16_f32 v151, v158, v159
    s_waitcnt lgkmcnt(0)
    v_mfma_f32_32x32x16_bf16 v[160:175], v[240:243], v[144:147], v[160:175]
    v_mfma_f32_32x32x16_bf16 v[160:175], v[244:247], v[148:151], v[160:175]
    s_nop 11
    v_mov_b32 v11, v168
    v_mov_b32 v12, v168
    s_nop 1
    v_permlane32_swap_b32 v11, v12
    v_rcp_f32 v12, v12
    s_nop 0
    v_mul_f32 v160, v160, v12
    v_mul_f32 v161, v161, v12
    v_mul_f32 v162, v162, v12
    v_mul_f32 v163, v163, v12
    v_mul_f32 v164, v164, v12
    v_mul_f32 v165, v165, v12
    v_mul_f32 v166, v166, v12
    v_mul_f32 v167, v167, v12
    v_mul_f32 v168, v168, v12
    v_mul_f32 v169, v169, v12
    v_mul_f32 v170, v170, v12
    v_mul_f32 v171, v171, v12
    v_cvt_pk_bf16_f32 v160, v160, v161
    v_cvt_pk_bf16_f32 v161, v162, v163
    v_cvt_pk_bf16_f32 v162, v164, v165
    v_cvt_pk_bf16_f32 v163, v166, v167
    v_cvt_pk_bf16_f32 v164, v168, v169
    v_cvt_pk_bf16_f32 v165, v170, v171
    v_lshrrev_b32 v13, 4, v3
    v_mul_u32_u24 v13, 20480, v13
    v_and_b32 v14, 15, v3
    v_lshlrev_b32 v14, 4, v14
    v_add_u32 v13, v13, v14
    v_lshlrev_b32 v14, 8, v4
    v_add_u32 v14, v14, v13
    s_lshr_b32 s17, s15, 4
    s_mul_i32 s17, s17, 20480
    s_add_u32 s17, s17, 32505856
    s_lshr_b32 s18, s13, 1
    s_lshl_b32 s18, s18, 10
    s_and_b32 s19, s13, 1
    s_lshl_b32 s20, s19, 9
    s_add_u32 s18, s18, s20
    s_add_u32 s18, s18, s17
    buffer_store_dwordx4 v[160:163], v14, s[4:7], s18 offen
    s_lshr_b32 s18, s13, 3
    s_add_u32 s18, s18, 16
    s_lshl_b32 s18, s18, 10
    s_lshr_b32 s20, s13, 1
    s_and_b32 s20, s20, 3
    s_lshl_b32 s20, s20, 8
    s_add_u32 s18, s18, s20
    s_lshl_b32 s19, s19, 3
    s_add_u32 s18, s18, s19
    s_add_u32 s18, s18, s17
    s_mov_b32 exec_hi, 0
    buffer_store_dwordx2 v[164:165], v13, s[4:7], s18 offen
    s_mov_b64 exec, -1
    s_cmp_ge_u32 s2, 432
    s_cbranch_scc1 attn1_kernel_o_end
    s_cmp_ge_u32 s2, 240
    s_cbranch_scc1 attn1_kernel_o_wd
    s_cmp_ge_u32 s2, 160
    s_cbranch_scc1 attn1_kernel_o_wu
    s_cmp_ge_u32 s2, 80
    s_cbranch_scc1 attn1_kernel_o_wg
attn1_kernel_o_wo:
    v_lshrrev_b32 v16, 4, v1
    v_bfe_u32 v17, v1, 2, 2
    v_and_b32 v18, 3, v1
    v_mul_u32_u24 v17, 1280, v17
    v_add_u32 v17, 39936, v17
    v_and_b32 v19, 15, v1
    v_lshlrev_b32 v19, 4, v19
    s_lshr_b32 s45, s44, 2
    s_lshl_b32 s45, s45, 10
    s_and_b32 s46, s44, 3
    s_lshl_b32 s46, s46, 8
    s_add_u32 s45, s45, s46
    s_add_u32 s45, s45, 2490368
    s_lshl_b32 s46, s12, 2
    v_add_u32 v16, s46, v16
    v_add_u32 v20, 0, v16
    v_lshrrev_b32 v22, 1, v20
    v_and_b32 v23, 1, v20
    v_lshlrev_b32 v21, 5, v22
    v_lshl_add_u32 v21, v18, 3, v21
    v_lshl_add_u32 v21, v23, 2, v21
    v_lshl_add_u32 v21, v21, 1, v17
    ds_read_b64_tr_b16 v[28:29], v21
    ds_read_b64_tr_b16 v[30:31], v21 offset:5120
    v_mul_u32_u24 v20, 20480, v20
    v_add_u32 v20, v20, v19
    s_waitcnt lgkmcnt(0)
    buffer_store_dwordx4 v[28:31], v20, s[4:7], s45 offen
    v_add_u32 v32, 16, v16
    v_lshrrev_b32 v34, 1, v32
    v_and_b32 v35, 1, v32
    v_lshlrev_b32 v33, 5, v34
    v_lshl_add_u32 v33, v18, 3, v33
    v_lshl_add_u32 v33, v35, 2, v33
    v_lshl_add_u32 v33, v33, 1, v17
    ds_read_b64_tr_b16 v[40:41], v33
    ds_read_b64_tr_b16 v[42:43], v33 offset:5120
    v_mul_u32_u24 v32, 20480, v32
    v_add_u32 v32, v32, v19
    s_waitcnt lgkmcnt(0)
    buffer_store_dwordx4 v[40:43], v32, s[4:7], s45 offen
    v_add_u32 v44, 32, v16
    v_min_u32 v44, 39, v44
    v_lshrrev_b32 v46, 1, v44
    v_and_b32 v47, 1, v44
    v_lshlrev_b32 v45, 5, v46
    v_lshl_add_u32 v45, v18, 3, v45
    v_lshl_add_u32 v45, v47, 2, v45
    v_lshl_add_u32 v45, v45, 1, v17
    ds_read_b64_tr_b16 v[52:53], v45
    ds_read_b64_tr_b16 v[54:55], v45 offset:5120
    v_mul_u32_u24 v44, 20480, v44
    v_add_u32 v44, v44, v19
    s_waitcnt lgkmcnt(0)
    buffer_store_dwordx4 v[52:55], v44, s[4:7], s45 offen
    s_nop 2
    s_branch attn1_kernel_o_end
attn1_kernel_o_wg:
    v_lshrrev_b32 v16, 4, v1
    v_bfe_u32 v17, v1, 2, 2
    v_and_b32 v18, 3, v1
    v_mul_u32_u24 v17, 3072, v17
    v_add_u32 v17, 39936, v17
    v_and_b32 v19, 15, v1
    v_lshlrev_b32 v19, 4, v19
    s_lshr_b32 s45, s44, 2
    s_lshl_b32 s45, s45, 10
    s_and_b32 s46, s44, 3
    s_lshl_b32 s46, s46, 8
    s_add_u32 s45, s45, s46
    s_add_u32 s45, s45, 3342336
    s_lshl_b32 s46, s12, 2
    v_add_u32 v16, s46, v16
    v_add_u32 v20, 0, v16
    v_lshrrev_b32 v22, 1, v20
    v_and_b32 v23, 1, v20
    v_lshlrev_b32 v21, 5, v22
    v_lshl_add_u32 v21, v18, 3, v21
    v_lshl_add_u32 v21, v23, 2, v21
    v_lshlrev_b32 v20, 2, v22
    v_add_u32 v20, v20, v23
    v_lshl_add_u32 v21, v21, 1, v17
    ds_read_b64_tr_b16 v[28:29], v21
    ds_read_b64_tr_b16 v[30:31], v21 offset:12288
    v_mul_u32_u24 v20, 20480, v20
    v_add_u32 v20, v20, v19
    s_waitcnt lgkmcnt(0)
    buffer_store_dwordx4 v[28:31], v20, s[4:7], s45 offen
    v_add_u32 v32, 16, v16
    v_lshrrev_b32 v34, 1, v32
    v_and_b32 v35, 1, v32
    v_lshlrev_b32 v33, 5, v34
    v_lshl_add_u32 v33, v18, 3, v33
    v_lshl_add_u32 v33, v35, 2, v33
    v_lshlrev_b32 v32, 2, v34
    v_add_u32 v32, v32, v35
    v_lshl_add_u32 v33, v33, 1, v17
    ds_read_b64_tr_b16 v[40:41], v33
    ds_read_b64_tr_b16 v[42:43], v33 offset:12288
    v_mul_u32_u24 v32, 20480, v32
    v_add_u32 v32, v32, v19
    s_waitcnt lgkmcnt(0)
    buffer_store_dwordx4 v[40:43], v32, s[4:7], s45 offen
    v_add_u32 v44, 32, v16
    v_lshrrev_b32 v46, 1, v44
    v_and_b32 v47, 1, v44
    v_lshlrev_b32 v45, 5, v46
    v_lshl_add_u32 v45, v18, 3, v45
    v_lshl_add_u32 v45, v47, 2, v45
    v_lshlrev_b32 v44, 2, v46
    v_add_u32 v44, v44, v47
    v_lshl_add_u32 v45, v45, 1, v17
    ds_read_b64_tr_b16 v[52:53], v45
    ds_read_b64_tr_b16 v[54:55], v45 offset:12288
    v_mul_u32_u24 v44, 20480, v44
    v_add_u32 v44, v44, v19
    s_waitcnt lgkmcnt(0)
    buffer_store_dwordx4 v[52:55], v44, s[4:7], s45 offen
    v_add_u32 v20, 48, v16
    v_lshrrev_b32 v22, 1, v20
    v_and_b32 v23, 1, v20
    v_lshlrev_b32 v21, 5, v22
    v_lshl_add_u32 v21, v18, 3, v21
    v_lshl_add_u32 v21, v23, 2, v21
    v_lshlrev_b32 v20, 2, v22
    v_add_u32 v20, v20, v23
    v_lshl_add_u32 v21, v21, 1, v17
    ds_read_b64_tr_b16 v[28:29], v21
    ds_read_b64_tr_b16 v[30:31], v21 offset:12288
    v_mul_u32_u24 v20, 20480, v20
    v_add_u32 v20, v20, v19
    s_waitcnt lgkmcnt(0)
    buffer_store_dwordx4 v[28:31], v20, s[4:7], s45 offen
    v_add_u32 v32, 64, v16
    v_lshrrev_b32 v34, 1, v32
    v_and_b32 v35, 1, v32
    v_lshlrev_b32 v33, 5, v34
    v_lshl_add_u32 v33, v18, 3, v33
    v_lshl_add_u32 v33, v35, 2, v33
    v_lshlrev_b32 v32, 2, v34
    v_add_u32 v32, v32, v35
    v_lshl_add_u32 v33, v33, 1, v17
    ds_read_b64_tr_b16 v[40:41], v33
    ds_read_b64_tr_b16 v[42:43], v33 offset:12288
    v_mul_u32_u24 v32, 20480, v32
    v_add_u32 v32, v32, v19
    s_waitcnt lgkmcnt(0)
    buffer_store_dwordx4 v[40:43], v32, s[4:7], s45 offen
    v_add_u32 v44, 80, v16
    v_lshrrev_b32 v46, 1, v44
    v_and_b32 v47, 1, v44
    v_lshlrev_b32 v45, 5, v46
    v_lshl_add_u32 v45, v18, 3, v45
    v_lshl_add_u32 v45, v47, 2, v45
    v_lshlrev_b32 v44, 2, v46
    v_add_u32 v44, v44, v47
    v_lshl_add_u32 v45, v45, 1, v17
    ds_read_b64_tr_b16 v[52:53], v45
    ds_read_b64_tr_b16 v[54:55], v45 offset:12288
    v_mul_u32_u24 v44, 20480, v44
    v_add_u32 v44, v44, v19
    s_waitcnt lgkmcnt(0)
    buffer_store_dwordx4 v[52:55], v44, s[4:7], s45 offen
    s_nop 2
    s_branch attn1_kernel_o_end
attn1_kernel_o_wu:
    v_lshrrev_b32 v16, 4, v1
    v_bfe_u32 v17, v1, 2, 2
    v_and_b32 v18, 3, v1
    v_mul_u32_u24 v17, 3072, v17
    v_add_u32 v17, 39936, v17
    v_and_b32 v19, 15, v1
    v_lshlrev_b32 v19, 4, v19
    s_lshr_b32 s45, s44, 2
    s_lshl_b32 s45, s45, 10
    s_and_b32 s46, s44, 3
    s_lshl_b32 s46, s46, 8
    s_add_u32 s45, s45, s46
    s_add_u32 s45, s45, 3342336
    s_lshl_b32 s46, s12, 2
    v_add_u32 v16, s46, v16
    v_add_u32 v20, 0, v16
    v_lshrrev_b32 v22, 1, v20
    v_and_b32 v23, 1, v20
    v_lshlrev_b32 v21, 5, v22
    v_lshl_add_u32 v21, v18, 3, v21
    v_lshl_add_u32 v21, v23, 2, v21
    v_lshlrev_b32 v20, 2, v22
    v_add_u32 v20, v20, v23
    v_add_u32 v20, 2, v20
    v_lshl_add_u32 v21, v21, 1, v17
    ds_read_b64_tr_b16 v[28:29], v21
    ds_read_b64_tr_b16 v[30:31], v21 offset:12288
    v_mul_u32_u24 v20, 20480, v20
    v_add_u32 v20, v20, v19
    s_waitcnt lgkmcnt(0)
    buffer_store_dwordx4 v[28:31], v20, s[4:7], s45 offen
    v_add_u32 v32, 16, v16
    v_lshrrev_b32 v34, 1, v32
    v_and_b32 v35, 1, v32
    v_lshlrev_b32 v33, 5, v34
    v_lshl_add_u32 v33, v18, 3, v33
    v_lshl_add_u32 v33, v35, 2, v33
    v_lshlrev_b32 v32, 2, v34
    v_add_u32 v32, v32, v35
    v_add_u32 v32, 2, v32
    v_lshl_add_u32 v33, v33, 1, v17
    ds_read_b64_tr_b16 v[40:41], v33
    ds_read_b64_tr_b16 v[42:43], v33 offset:12288
    v_mul_u32_u24 v32, 20480, v32
    v_add_u32 v32, v32, v19
    s_waitcnt lgkmcnt(0)
    buffer_store_dwordx4 v[40:43], v32, s[4:7], s45 offen
    v_add_u32 v44, 32, v16
    v_lshrrev_b32 v46, 1, v44
    v_and_b32 v47, 1, v44
    v_lshlrev_b32 v45, 5, v46
    v_lshl_add_u32 v45, v18, 3, v45
    v_lshl_add_u32 v45, v47, 2, v45
    v_lshlrev_b32 v44, 2, v46
    v_add_u32 v44, v44, v47
    v_add_u32 v44, 2, v44
    v_lshl_add_u32 v45, v45, 1, v17
    ds_read_b64_tr_b16 v[52:53], v45
    ds_read_b64_tr_b16 v[54:55], v45 offset:12288
    v_mul_u32_u24 v44, 20480, v44
    v_add_u32 v44, v44, v19
    s_waitcnt lgkmcnt(0)
    buffer_store_dwordx4 v[52:55], v44, s[4:7], s45 offen
    v_add_u32 v20, 48, v16
    v_lshrrev_b32 v22, 1, v20
    v_and_b32 v23, 1, v20
    v_lshlrev_b32 v21, 5, v22
    v_lshl_add_u32 v21, v18, 3, v21
    v_lshl_add_u32 v21, v23, 2, v21
    v_lshlrev_b32 v20, 2, v22
    v_add_u32 v20, v20, v23
    v_add_u32 v20, 2, v20
    v_lshl_add_u32 v21, v21, 1, v17
    ds_read_b64_tr_b16 v[28:29], v21
    ds_read_b64_tr_b16 v[30:31], v21 offset:12288
    v_mul_u32_u24 v20, 20480, v20
    v_add_u32 v20, v20, v19
    s_waitcnt lgkmcnt(0)
    buffer_store_dwordx4 v[28:31], v20, s[4:7], s45 offen
    v_add_u32 v32, 64, v16
    v_lshrrev_b32 v34, 1, v32
    v_and_b32 v35, 1, v32
    v_lshlrev_b32 v33, 5, v34
    v_lshl_add_u32 v33, v18, 3, v33
    v_lshl_add_u32 v33, v35, 2, v33
    v_lshlrev_b32 v32, 2, v34
    v_add_u32 v32, v32, v35
    v_add_u32 v32, 2, v32
    v_lshl_add_u32 v33, v33, 1, v17
    ds_read_b64_tr_b16 v[40:41], v33
    ds_read_b64_tr_b16 v[42:43], v33 offset:12288
    v_mul_u32_u24 v32, 20480, v32
    v_add_u32 v32, v32, v19
    s_waitcnt lgkmcnt(0)
    buffer_store_dwordx4 v[40:43], v32, s[4:7], s45 offen
    v_add_u32 v44, 80, v16
    v_lshrrev_b32 v46, 1, v44
    v_and_b32 v47, 1, v44
    v_lshlrev_b32 v45, 5, v46
    v_lshl_add_u32 v45, v18, 3, v45
    v_lshl_add_u32 v45, v47, 2, v45
    v_lshlrev_b32 v44, 2, v46
    v_add_u32 v44, v44, v47
    v_add_u32 v44, 2, v44
    v_lshl_add_u32 v45, v45, 1, v17
    ds_read_b64_tr_b16 v[52:53], v45
    ds_read_b64_tr_b16 v[54:55], v45 offset:12288
    v_mul_u32_u24 v44, 20480, v44
    v_add_u32 v44, v44, v19
    s_waitcnt lgkmcnt(0)
    buffer_store_dwordx4 v[52:55], v44, s[4:7], s45 offen
    s_nop 2
    s_branch attn1_kernel_o_end
attn1_kernel_o_wd:
    v_lshrrev_b32 v16, 4, v1
    v_bfe_u32 v17, v1, 2, 2
    v_and_b32 v18, 3, v1
    v_mul_u32_u24 v17, 1280, v17
    v_add_u32 v17, 39936, v17
    v_and_b32 v19, 15, v1
    v_lshlrev_b32 v19, 4, v19
    s_lshr_b32 s45, s44, 2
    s_lshl_b32 s45, s45, 10
    s_and_b32 s46, s44, 3
    s_lshl_b32 s46, s46, 8
    s_add_u32 s45, s45, s46
    s_add_u32 s45, s45, 7274496
    s_lshl_b32 s46, s12, 2
    v_add_u32 v16, s46, v16
    v_add_u32 v20, 0, v16
    v_lshrrev_b32 v22, 1, v20
    v_and_b32 v23, 1, v20
    v_lshlrev_b32 v21, 5, v22
    v_lshl_add_u32 v21, v18, 3, v21
    v_lshl_add_u32 v21, v23, 2, v21
    v_lshl_add_u32 v21, v21, 1, v17
    ds_read_b64_tr_b16 v[28:29], v21
    ds_read_b64_tr_b16 v[30:31], v21 offset:5120
    v_mul_u32_u24 v20, 49152, v20
    v_add_u32 v20, v20, v19
    s_waitcnt lgkmcnt(0)
    buffer_store_dwordx4 v[28:31], v20, s[4:7], s45 offen
    v_add_u32 v32, 16, v16
    v_lshrrev_b32 v34, 1, v32
    v_and_b32 v35, 1, v32
    v_lshlrev_b32 v33, 5, v34
    v_lshl_add_u32 v33, v18, 3, v33
    v_lshl_add_u32 v33, v35, 2, v33
    v_lshl_add_u32 v33, v33, 1, v17
    ds_read_b64_tr_b16 v[40:41], v33
    ds_read_b64_tr_b16 v[42:43], v33 offset:5120
    v_mul_u32_u24 v32, 49152, v32
    v_add_u32 v32, v32, v19
    s_waitcnt lgkmcnt(0)
    buffer_store_dwordx4 v[40:43], v32, s[4:7], s45 offen
    v_add_u32 v44, 32, v16
    v_min_u32 v44, 39, v44
    v_lshrrev_b32 v46, 1, v44
    v_and_b32 v47, 1, v44
    v_lshlrev_b32 v45, 5, v46
    v_lshl_add_u32 v45, v18, 3, v45
    v_lshl_add_u32 v45, v47, 2, v45
    v_lshl_add_u32 v45, v45, 1, v17
    ds_read_b64_tr_b16 v[52:53], v45
    ds_read_b64_tr_b16 v[54:55], v45 offset:5120
    v_mul_u32_u24 v44, 49152, v44
    v_add_u32 v44, v44, v19
    s_waitcnt lgkmcnt(0)
    buffer_store_dwordx4 v[52:55], v44, s[4:7], s45 offen
    s_nop 2
attn1_kernel_o_end:
attn1_kernel_end:
    s_endpgm

.text
.globl attn_kernel
.p2align 8
.type attn_kernel,@function
attn_kernel:
    s_cmp_ge_u32 s2, 512
    s_cbranch_scc1 attn_kernel_end
    s_load_dwordx2 s[4:5], s[0:1], 72
    v_lshrrev_b32 v2, 6, v0
    s_nop 0
    v_readfirstlane_b32 s12, v2
    v_and_b32 v1, 63, v0
    v_and_b32 v3, 31, v1
    v_lshrrev_b32 v4, 5, v1
    v_lshlrev_b32 v5, 5, v3
    v_lshlrev_b32 v6, 4, v4
    v_add_u32 v5, v5, v6
    v_lshlrev_b32 v7, 3, v3
    v_min_u32 v8, 20, v3
    v_lshlrev_b32 v8, 5, v8
    v_add_u32 v8, v8, v6
    v_lshlrev_b32 v15, 4, v1
    s_and_b32 s13, s2, 7
    s_lshl_b32 s13, s13, 2
    s_lshr_b32 s14, s2, 7
    s_add_u32 s13, s13, s14
    s_lshr_b32 s14, s2, 3
    s_and_b32 s14, s14, 15
    s_lshl_b32 s23, s14, 7
    s_lshl_b32 s15, s12, 5
    s_add_u32 s15, s15, s23
    s_lshl_b32 s16, s13, 11
    s_waitcnt lgkmcnt(0)
    s_and_b32 s5, s5, 0xffff
    s_mov_b32 s6, 268435456
    s_mov_b32 s7, 0x00020000
    s_add_i32 s19, s15, -256
    s_max_i32 s19, s19, 0
    s_add_u32 s19, s19, s16
    s_lshl_b32 s20, s19, 5
    s_add_u32 s20, s20, 25165824
    s_lshl_b32 s21, s12, 10
    s_add_u32 m0, s21, 0
    s_nop 0
    buffer_load_dwordx4 v5, s[4:7], s20 offen lds
    s_add_i32 s19, s15, -128
    s_max_i32 s19, s19, 0
    s_add_u32 s19, s19, s16
    s_lshl_b32 s20, s19, 5
    s_add_u32 s20, s20, 25165824
    s_lshl_b32 s21, s12, 10
    s_add_u32 m0, s21, 4096
    s_nop 0
    buffer_load_dwordx4 v5, s[4:7], s20 offen lds
    s_add_i32 s19, s15, 0
    s_max_i32 s19, s19, 0
    s_add_u32 s19, s19, s16
    s_lshl_b32 s20, s19, 5
    s_add_u32 s20, s20, 25165824
    s_lshl_b32 s21, s12, 10
    s_add_u32 m0, s21, 8192
    s_nop 0
    buffer_load_dwordx4 v5, s[4:7], s20 offen lds
    s_min_u32 s21, s12, 2
    s_lshl_b32 s19, s21, 7
    s_add_u32 s19, s19, s23
    s_add_i32 s19, s19, -256
    s_max_i32 s19, s19, 0
    s_add_u32 s19, s19, s16
    s_lshl_b32 s20, s19, 3
    s_add_u32 s20, s20, 27787264
    s_lshl_b32 s21, s21, 10
    s_add_u32 m0, s21, 12288
    s_nop 0
    buffer_load_dwordx4 v15, s[4:7], s20 offen lds
    s_add_u32 s17, s16, s15
    s_lshl_b32 s18, s17, 5
    s_add_u32 s18, s18, 23068672
    buffer_load_dwordx4 v[248:251], v5, s[4:7], s18 offen
    s_lshl_b32 s18, s17, 3
    s_add_u32 s18, s18, 27262976
    buffer_load_dwordx2 v[252:253], v7, s[4:7], s18 offen
    s_lshl_b32 s24, s13, 17
    s_add_u32 s24, s24, 28311552
    s_lshl_b32 s25, s12, 4
    s_add_u32 s25, s25, s23
    s_add_i32 s19, s25, -256
    s_max_i32 s19, s19, 0
    s_lshl_b32 s19, s19, 6
    s_add_u32 s19, s19, s24
    s_lshl_b32 s21, s12, 10
    s_add_u32 m0, s21, 15360
    s_nop 0
    buffer_load_dwordx4 v8, s[4:7], s19 offen lds
    s_add_i32 s19, s25, -192
    s_max_i32 s19, s19, 0
    s_lshl_b32 s19, s19, 6
    s_add_u32 s19, s19, s24
    s_lshl_b32 s21, s12, 10
    s_add_u32 m0, s21, 19456
    s_nop 0
    buffer_load_dwordx4 v8, s[4:7], s19 offen lds
    s_add_i32 s19, s25, -128
    s_max_i32 s19, s19, 0
    s_lshl_b32 s19, s19, 6
    s_add_u32 s19, s19, s24
    s_lshl_b32 s21, s12, 10
    s_add_u32 m0, s21, 23552
    s_nop 0
    buffer_load_dwordx4 v8, s[4:7], s19 offen lds
    s_add_i32 s19, s25, -64
    s_max_i32 s19, s19, 0
    s_lshl_b32 s19, s19, 6
    s_add_u32 s19, s19, s24
    s_lshl_b32 s21, s12, 10
    s_add_u32 m0, s21, 27648
    s_nop 0
    buffer_load_dwordx4 v8, s[4:7], s19 offen lds
    s_add_i32 s19, s25, 0
    s_max_i32 s19, s19, 0
    s_lshl_b32 s19, s19, 6
    s_add_u32 s19, s19, s24
    s_lshl_b32 s21, s12, 10
    s_add_u32 m0, s21, 31744
    s_nop 0
    buffer_load_dwordx4 v8, s[4:7], s19 offen lds
    s_add_i32 s19, s25, 64
    s_max_i32 s19, s19, 0
    s_lshl_b32 s19, s19, 6
    s_add_u32 s19, s19, s24
    s_lshl_b32 s21, s12, 10
    s_add_u32 m0, s21, 35840
    s_nop 0
    buffer_load_dwordx4 v8, s[4:7], s19 offen lds
    v_lshlrev_b32 v9, 2, v4
    v_sub_u32 v9, v3, v9
    v_mov_b32 v10, 0xff7fffff
    v_cmp_le_i32 vcc, 0, v9
    s_nop 1
    v_cndmask_b32_e64 v144, v10, 0, vcc
    v_cndmask_b32_e64 v16, 0, v10, vcc
    v_cmp_le_i32 vcc, 1, v9
    s_nop 1
    v_cndmask_b32_e64 v145, v10, 0, vcc
    v_cndmask_b32_e64 v17, 0, v10, vcc
    v_cmp_le_i32 vcc, 2, v9
    s_nop 1
    v_cndmask_b32_e64 v146, v10, 0, vcc
    v_cndmask_b32_e64 v18, 0, v10, vcc
    v_cmp_le_i32 vcc, 3, v9
    s_nop 1
    v_cndmask_b32_e64 v147, v10, 0, vcc
    v_cndmask_b32_e64 v19, 0, v10, vcc
    v_cmp_le_i32 vcc, 8, v9
    s_nop 1
    v_cndmask_b32_e64 v148, v10, 0, vcc
    v_cndmask_b32_e64 v20, 0, v10, vcc
    v_cmp_le_i32 vcc, 9, v9
    s_nop 1
    v_cndmask_b32_e64 v149, v10, 0, vcc
    v_cndmask_b32_e64 v21, 0, v10, vcc
    v_cmp_le_i32 vcc, 10, v9
    s_nop 1
    v_cndmask_b32_e64 v150, v10, 0, vcc
    v_cndmask_b32_e64 v22, 0, v10, vcc
    v_cmp_le_i32 vcc, 11, v9
    s_nop 1
    v_cndmask_b32_e64 v151, v10, 0, vcc
    v_cndmask_b32_e64 v23, 0, v10, vcc
    v_cmp_le_i32 vcc, 16, v9
    s_nop 1
    v_cndmask_b32_e64 v152, v10, 0, vcc
    v_cndmask_b32_e64 v24, 0, v10, vcc
    v_cmp_le_i32 vcc, 17, v9
    s_nop 1
    v_cndmask_b32_e64 v153, v10, 0, vcc
    v_cndmask_b32_e64 v25, 0, v10, vcc
    v_cmp_le_i32 vcc, 18, v9
    s_nop 1
    v_cndmask_b32_e64 v154, v10, 0, vcc
    v_cndmask_b32_e64 v26, 0, v10, vcc
    v_cmp_le_i32 vcc, 19, v9
    s_nop 1
    v_cndmask_b32_e64 v155, v10, 0, vcc
    v_cndmask_b32_e64 v27, 0, v10, vcc
    v_cmp_le_i32 vcc, 24, v9
    s_nop 1
    v_cndmask_b32_e64 v156, v10, 0, vcc
    v_cndmask_b32_e64 v28, 0, v10, vcc
    v_cmp_le_i32 vcc, 25, v9
    s_nop 1
    v_cndmask_b32_e64 v157, v10, 0, vcc
    v_cndmask_b32_e64 v29, 0, v10, vcc
    v_cmp_le_i32 vcc, 26, v9
    s_nop 1
    v_cndmask_b32_e64 v158, v10, 0, vcc
    v_cndmask_b32_e64 v30, 0, v10, vcc
    v_cmp_le_i32 vcc, 27, v9
    s_nop 1
    v_cndmask_b32_e64 v159, v10, 0, vcc
    v_cndmask_b32_e64 v31, 0, v10, vcc
    s_lshl_b32 s21, s12, 10
    v_add_u32 v13, s21, v15
    s_lshl_b32 s21, s12, 8
    v_add_u32 v14, s21, v7
    s_lshl_b32 s21, s12, 11
    v_add_u32 v2, s21, v15
    s_waitcnt vmcnt(6)
    s_barrier
    ds_read_b128 v[176:179], v13 offset:0
    ds_read_b64 v[180:181], v14 offset:12288
    ds_read_b128 v[184:187], v13 offset:1024
    ds_read_b64 v[188:189], v14 offset:12544
    ds_read_b128 v[192:195], v13 offset:2048
    ds_read_b64 v[196:197], v14 offset:12800
    ds_read_b128 v[200:203], v13 offset:3072
    ds_read_b64 v[204:205], v14 offset:13056
    ds_read_b128 v[208:211], v13 offset:4096
    ds_read_b64 v[212:213], v14 offset:13312
    ds_read_b128 v[216:219], v13 offset:5120
    ds_read_b64 v[220:221], v14 offset:13568
    ds_read_b128 v[224:227], v13 offset:6144
    ds_read_b64 v[228:229], v14 offset:13824
    v_cmp_eq_u32 vcc, 0, v4
    s_nop 1
    v_cndmask_b32_e64 v252, 0, v252, vcc
    v_cndmask_b32_e64 v253, 0, v253, vcc
    s_waitcnt lgkmcnt(12)
    v_mfma_f32_32x32x16_bf16 v[16:31], v[176:179], v[248:251], v[16:31]
    v_mfma_f32_32x32x8_bf16 v[16:31], v[180:181], v[252:253], v[16:31]
    ds_read_b128 v[232:235], v13 offset:7168
    ds_read_b64 v[236:237], v14 offset:14080
    s_waitcnt lgkmcnt(12)
    v_mfma_f32_32x32x16_bf16 v[32:47], v[184:187], v[248:251], 0
    v_mfma_f32_32x32x8_bf16 v[32:47], v[188:189], v[252:253], v[32:47]
    ds_read_b128 v[240:243], v13 offset:8192
    ds_read_b64 v[244:245], v14 offset:14336
    s_waitcnt lgkmcnt(12)
    v_mfma_f32_32x32x16_bf16 v[48:63], v[192:195], v[248:251], 0
    v_mfma_f32_32x32x8_bf16 v[48:63], v[196:197], v[252:253], v[48:63]
    s_waitcnt lgkmcnt(10)
    v_mfma_f32_32x32x16_bf16 v[64:79], v[200:203], v[248:251], 0
    v_mfma_f32_32x32x8_bf16 v[64:79], v[204:205], v[252:253], v[64:79]
    s_waitcnt lgkmcnt(8)
    v_mfma_f32_32x32x16_bf16 v[80:95], v[208:211], v[248:251], 0
    v_mfma_f32_32x32x8_bf16 v[80:95], v[212:213], v[252:253], v[80:95]
    s_waitcnt lgkmcnt(6)
    v_mfma_f32_32x32x16_bf16 v[96:111], v[216:219], v[248:251], 0
    v_mfma_f32_32x32x8_bf16 v[96:111], v[220:221], v[252:253], v[96:111]
    s_waitcnt lgkmcnt(4)
    v_mfma_f32_32x32x16_bf16 v[112:127], v[224:227], v[248:251], 0
    v_mfma_f32_32x32x8_bf16 v[112:127], v[228:229], v[252:253], v[112:127]
    s_waitcnt lgkmcnt(2)
    v_mfma_f32_32x32x16_bf16 v[128:143], v[232:235], v[248:251], 0
    v_mfma_f32_32x32x8_bf16 v[128:143], v[236:237], v[252:253], v[128:143]
    s_waitcnt lgkmcnt(0)
    v_mfma_f32_32x32x16_bf16 v[144:159], v[240:243], v[248:251], v[144:159]
    v_mfma_f32_32x32x8_bf16 v[144:159], v[244:245], v[252:253], v[144:159]
    s_cmp_ge_i32 s15, 256
    s_nop 10
    s_cbranch_scc1 skip_10
    v_mov_b32 v16, v10
    v_mov_b32 v17, v10
    v_mov_b32 v18, v10
    v_mov_b32 v19, v10
    v_mov_b32 v20, v10
    v_mov_b32 v21, v10
    v_mov_b32 v22, v10
    v_mov_b32 v23, v10
    v_mov_b32 v24, v10
    v_mov_b32 v25, v10
    v_mov_b32 v26, v10
    v_mov_b32 v27, v10
    v_mov_b32 v28, v10
    v_mov_b32 v29, v10
    v_mov_b32 v30, v10
    v_mov_b32 v31, v10
    s_nop 4
skip_10:
    s_cmp_ge_i32 s15, 224
    s_cbranch_scc1 skip_11
    v_mov_b32 v32, v10
    v_mov_b32 v33, v10
    v_mov_b32 v34, v10
    v_mov_b32 v35, v10
    v_mov_b32 v36, v10
    v_mov_b32 v37, v10
    v_mov_b32 v38, v10
    v_mov_b32 v39, v10
    v_mov_b32 v40, v10
    v_mov_b32 v41, v10
    v_mov_b32 v42, v10
    v_mov_b32 v43, v10
    v_mov_b32 v44, v10
    v_mov_b32 v45, v10
    v_mov_b32 v46, v10
    v_mov_b32 v47, v10
    s_nop 4
skip_11:
    s_cmp_ge_i32 s15, 192
    s_cbranch_scc1 skip_12
    v_mov_b32 v48, v10
    v_mov_b32 v49, v10
    v_mov_b32 v50, v10
    v_mov_b32 v51, v10
    v_mov_b32 v52, v10
    v_mov_b32 v53, v10
    v_mov_b32 v54, v10
    v_mov_b32 v55, v10
    v_mov_b32 v56, v10
    v_mov_b32 v57, v10
    v_mov_b32 v58, v10
    v_mov_b32 v59, v10
    v_mov_b32 v60, v10
    v_mov_b32 v61, v10
    v_mov_b32 v62, v10
    v_mov_b32 v63, v10
    s_nop 4
skip_12:
    s_cmp_ge_i32 s15, 160
    s_cbranch_scc1 skip_13
    v_mov_b32 v64, v10
    v_mov_b32 v65, v10
    v_mov_b32 v66, v10
    v_mov_b32 v67, v10
    v_mov_b32 v68, v10
    v_mov_b32 v69, v10
    v_mov_b32 v70, v10
    v_mov_b32 v71, v10
    v_mov_b32 v72, v10
    v_mov_b32 v73, v10
    v_mov_b32 v74, v10
    v_mov_b32 v75, v10
    v_mov_b32 v76, v10
    v_mov_b32 v77, v10
    v_mov_b32 v78, v10
    v_mov_b32 v79, v10
    s_nop 4
skip_13:
    s_cmp_ge_i32 s15, 128
    s_cbranch_scc1 skip_14
    v_mov_b32 v80, v10
    v_mov_b32 v81, v10
    v_mov_b32 v82, v10
    v_mov_b32 v83, v10
    v_mov_b32 v84, v10
    v_mov_b32 v85, v10
    v_mov_b32 v86, v10
    v_mov_b32 v87, v10
    v_mov_b32 v88, v10
    v_mov_b32 v89, v10
    v_mov_b32 v90, v10
    v_mov_b32 v91, v10
    v_mov_b32 v92, v10
    v_mov_b32 v93, v10
    v_mov_b32 v94, v10
    v_mov_b32 v95, v10
    s_nop 4
skip_14:
    s_cmp_ge_i32 s15, 96
    s_cbranch_scc1 skip_15
    v_mov_b32 v96, v10
    v_mov_b32 v97, v10
    v_mov_b32 v98, v10
    v_mov_b32 v99, v10
    v_mov_b32 v100, v10
    v_mov_b32 v101, v10
    v_mov_b32 v102, v10
    v_mov_b32 v103, v10
    v_mov_b32 v104, v10
    v_mov_b32 v105, v10
    v_mov_b32 v106, v10
    v_mov_b32 v107, v10
    v_mov_b32 v108, v10
    v_mov_b32 v109, v10
    v_mov_b32 v110, v10
    v_mov_b32 v111, v10
    s_nop 4
skip_15:
    s_cmp_ge_i32 s15, 64
    s_cbranch_scc1 skip_16
    v_mov_b32 v112, v10
    v_mov_b32 v113, v10
    v_mov_b32 v114, v10
    v_mov_b32 v115, v10
    v_mov_b32 v116, v10
    v_mov_b32 v117, v10
    v_mov_b32 v118, v10
    v_mov_b32 v119, v10
    v_mov_b32 v120, v10
    v_mov_b32 v121, v10
    v_mov_b32 v122, v10
    v_mov_b32 v123, v10
    v_mov_b32 v124, v10
    v_mov_b32 v125, v10
    v_mov_b32 v126, v10
    v_mov_b32 v127, v10
    s_nop 4
skip_16:
    s_cmp_ge_i32 s15, 32
    s_cbranch_scc1 skip_17
    v_mov_b32 v128, v10
    v_mov_b32 v129, v10
    v_mov_b32 v130, v10
    v_mov_b32 v131, v10
    v_mov_b32 v132, v10
    v_mov_b32 v133, v10
    v_mov_b32 v134, v10
    v_mov_b32 v135, v10
    v_mov_b32 v136, v10
    v_mov_b32 v137, v10
    v_mov_b32 v138, v10
    v_mov_b32 v139, v10
    v_mov_b32 v140, v10
    v_mov_b32 v141, v10
    v_mov_b32 v142, v10
    v_mov_b32 v143, v10
    s_nop 4
skip_17:
    v_max3_f32 v11, v16, v17, v18
    v_max3_f32 v12, v19, v20, v21
    v_max3_f32 v11, v11, v22, v23
    v_max3_f32 v12, v12, v24, v25
    v_max3_f32 v11, v11, v26, v27
    v_max3_f32 v12, v12, v28, v29
    v_max3_f32 v11, v11, v30, v31
    v_max3_f32 v12, v12, v32, v33
    v_max3_f32 v11, v11, v34, v35
    v_max3_f32 v12, v12, v36, v37
    v_max3_f32 v11, v11, v38, v39
    v_max3_f32 v12, v12, v40, v41
    v_max3_f32 v11, v11, v42, v43
    v_max3_f32 v12, v12, v44, v45
    v_max3_f32 v11, v11, v46, v47
    v_max3_f32 v12, v12, v48, v49
    v_max3_f32 v11, v11, v50, v51
    v_max3_f32 v12, v12, v52, v53
    v_max3_f32 v11, v11, v54, v55
    v_max3_f32 v12, v12, v56, v57
    v_max3_f32 v11, v11, v58, v59
    v_max3_f32 v12, v12, v60, v61
    v_max3_f32 v11, v11, v62, v63
    v_max3_f32 v12, v12, v64, v65
    v_max3_f32 v11, v11, v66, v67
    v_max3_f32 v12, v12, v68, v69
    v_max3_f32 v11, v11, v70, v71
    v_max3_f32 v12, v12, v72, v73
    v_max3_f32 v11, v11, v74, v75
    v_max3_f32 v12, v12, v76, v77
    v_max3_f32 v11, v11, v78, v79
    v_max3_f32 v12, v12, v80, v81
    v_max3_f32 v11, v11, v82, v83
    v_max3_f32 v12, v12, v84, v85
    v_max3_f32 v11, v11, v86, v87
    v_max3_f32 v12, v12, v88, v89
    v_max3_f32 v11, v11, v90, v91
    v_max3_f32 v12, v12, v92, v93
    v_max3_f32 v11, v11, v94, v95
    v_max3_f32 v12, v12, v96, v97
    v_max3_f32 v11, v11, v98, v99
    v_max3_f32 v12, v12, v100, v101
    v_max3_f32 v11, v11, v102, v103
    v_max3_f32 v12, v12, v104, v105
    v_max3_f32 v11, v11, v106, v107
    v_max3_f32 v12, v12, v108, v109
    v_max3_f32 v11, v11, v110, v111
    v_max3_f32 v12, v12, v112, v113
    v_max3_f32 v11, v11, v114, v115
    v_max3_f32 v12, v12, v116, v117
    v_max3_f32 v11, v11, v118, v119
    v_max3_f32 v12, v12, v120, v121
    v_max3_f32 v11, v11, v122, v123
    v_max3_f32 v12, v12, v124, v125
    v_max3_f32 v11, v11, v126, v127
    v_max3_f32 v12, v12, v128, v129
    v_max3_f32 v11, v11, v130, v131
    v_max3_f32 v12, v12, v132, v133
    v_max3_f32 v11, v11, v134, v135
    v_max3_f32 v12, v12, v136, v137
    v_max3_f32 v11, v11, v138, v139
    v_max3_f32 v12, v12, v140, v141
    v_max3_f32 v11, v11, v142, v143
    v_max3_f32 v12, v12, v144, v145
    v_max3_f32 v11, v11, v146, v147
    v_max3_f32 v12, v12, v148, v149
    v_max3_f32 v11, v11, v150, v151
    v_max3_f32 v12, v12, v152, v153
    v_max3_f32 v11, v11, v154, v155
    v_max3_f32 v12, v12, v156, v157
    v_max3_f32 v11, v11, v158, v159
    v_max_f32 v11, v11, v12
    v_mov_b32 v12, v11
    s_nop 1
    v_permlane32_swap_b32 v11, v12
    v_max_f32 v11, v11, v12
    s_mov_b32 s22, 0x3ea52b5c
    v_mul_f32 v12, s22, v11
    v_mov_b32 v13, s22
    s_waitcnt vmcnt(0)
    s_barrier
    ds_read_b128 v[176:179], v2 offset:15360
    ds_read_b128 v[180:183], v2 offset:16384
    v_pk_fma_f32 v[16:17], v[16:17], v[12:13], v[12:13] op_sel:[0,1,0] op_sel_hi:[1,1,0] neg_lo:[0,0,1] neg_hi:[0,0,1]
    v_pk_fma_f32 v[18:19], v[18:19], v[12:13], v[12:13] op_sel:[0,1,0] op_sel_hi:[1,1,0] neg_lo:[0,0,1] neg_hi:[0,0,1]
    v_pk_fma_f32 v[20:21], v[20:21], v[12:13], v[12:13] op_sel:[0,1,0] op_sel_hi:[1,1,0] neg_lo:[0,0,1] neg_hi:[0,0,1]
    v_pk_fma_f32 v[22:23], v[22:23], v[12:13], v[12:13] op_sel:[0,1,0] op_sel_hi:[1,1,0] neg_lo:[0,0,1] neg_hi:[0,0,1]
    v_pk_fma_f32 v[24:25], v[24:25], v[12:13], v[12:13] op_sel:[0,1,0] op_sel_hi:[1,1,0] neg_lo:[0,0,1] neg_hi:[0,0,1]
    v_pk_fma_f32 v[26:27], v[26:27], v[12:13], v[12:13] op_sel:[0,1,0] op_sel_hi:[1,1,0] neg_lo:[0,0,1] neg_hi:[0,0,1]
    v_pk_fma_f32 v[28:29], v[28:29], v[12:13], v[12:13] op_sel:[0,1,0] op_sel_hi:[1,1,0] neg_lo:[0,0,1] neg_hi:[0,0,1]
    v_pk_fma_f32 v[30:31], v[30:31], v[12:13], v[12:13] op_sel:[0,1,0] op_sel_hi:[1,1,0] neg_lo:[0,0,1] neg_hi:[0,0,1]
    v_exp_f32 v16, v16
    v_exp_f32 v17, v17
    v_exp_f32 v18, v18
    v_exp_f32 v19, v19
    v_exp_f32 v20, v20
    v_exp_f32 v21, v21
    v_exp_f32 v22, v22
    v_exp_f32 v23, v23
    v_exp_f32 v24, v24
    v_exp_f32 v25, v25
    v_exp_f32 v26, v26
    v_exp_f32 v27, v27
    v_exp_f32 v28, v28
    v_exp_f32 v29, v29
    v_exp_f32 v30, v30
    v_exp_f32 v31, v31
    v_cvt_pk_bf16_f32 v16, v16, v17
    v_cvt_pk_bf16_f32 v17, v18, v19
    v_cvt_pk_bf16_f32 v18, v20, v21
    v_cvt_pk_bf16_f32 v19, v22, v23
    v_cvt_pk_bf16_f32 v20, v24, v25
    v_cvt_pk_bf16_f32 v21, v26, v27
    v_cvt_pk_bf16_f32 v22, v28, v29
    v_cvt_pk_bf16_f32 v23, v30, v31
    s_waitcnt lgkmcnt(0)
    v_mfma_f32_32x32x16_bf16 v[160:175], v[176:179], v[16:19], 0
    v_mfma_f32_32x32x16_bf16 v[160:175], v[180:183], v[20:23], v[160:175]
    ds_read_b128 v[184:187], v2 offset:17408
    ds_read_b128 v[188:191], v2 offset:18432
    v_pk_fma_f32 v[32:33], v[32:33], v[12:13], v[12:13] op_sel:[0,1,0] op_sel_hi:[1,1,0] neg_lo:[0,0,1] neg_hi:[0,0,1]
    v_pk_fma_f32 v[34:35], v[34:35], v[12:13], v[12:13] op_sel:[0,1,0] op_sel_hi:[1,1,0] neg_lo:[0,0,1] neg_hi:[0,0,1]
    v_pk_fma_f32 v[36:37], v[36:37], v[12:13], v[12:13] op_sel:[0,1,0] op_sel_hi:[1,1,0] neg_lo:[0,0,1] neg_hi:[0,0,1]
    v_pk_fma_f32 v[38:39], v[38:39], v[12:13], v[12:13] op_sel:[0,1,0] op_sel_hi:[1,1,0] neg_lo:[0,0,1] neg_hi:[0,0,1]
    v_pk_fma_f32 v[40:41], v[40:41], v[12:13], v[12:13] op_sel:[0,1,0] op_sel_hi:[1,1,0] neg_lo:[0,0,1] neg_hi:[0,0,1]
    v_pk_fma_f32 v[42:43], v[42:43], v[12:13], v[12:13] op_sel:[0,1,0] op_sel_hi:[1,1,0] neg_lo:[0,0,1] neg_hi:[0,0,1]
    v_pk_fma_f32 v[44:45], v[44:45], v[12:13], v[12:13] op_sel:[0,1,0] op_sel_hi:[1,1,0] neg_lo:[0,0,1] neg_hi:[0,0,1]
    v_pk_fma_f32 v[46:47], v[46:47], v[12:13], v[12:13] op_sel:[0,1,0] op_sel_hi:[1,1,0] neg_lo:[0,0,1] neg_hi:[0,0,1]
    v_exp_f32 v32, v32
    v_exp_f32 v33, v33
    v_exp_f32 v34, v34
    v_exp_f32 v35, v35
    v_exp_f32 v36, v36
    v_exp_f32 v37, v37
    v_exp_f32 v38, v38
    v_exp_f32 v39, v39
    v_exp_f32 v40, v40
    v_exp_f32 v41, v41
    v_exp_f32 v42, v42
    v_exp_f32 v43, v43
    v_exp_f32 v44, v44
    v_exp_f32 v45, v45
    v_exp_f32 v46, v46
    v_exp_f32 v47, v47
    v_cvt_pk_bf16_f32 v32, v32, v33
    v_cvt_pk_bf16_f32 v33, v34, v35
    v_cvt_pk_bf16_f32 v34, v36, v37
    v_cvt_pk_bf16_f32 v35, v38, v39
    v_cvt_pk_bf16_f32 v36, v40, v41
    v_cvt_pk_bf16_f32 v37, v42, v43
    v_cvt_pk_bf16_f32 v38, v44, v45
    v_cvt_pk_bf16_f32 v39, v46, v47
    s_waitcnt lgkmcnt(0)
    v_mfma_f32_32x32x16_bf16 v[160:175], v[184:187], v[32:35], v[160:175]
    v_mfma_f32_32x32x16_bf16 v[160:175], v[188:191], v[36:39], v[160:175]
    ds_read_b128 v[192:195], v2 offset:19456
    ds_read_b128 v[196:199], v2 offset:20480
    v_pk_fma_f32 v[48:49], v[48:49], v[12:13], v[12:13] op_sel:[0,1,0] op_sel_hi:[1,1,0] neg_lo:[0,0,1] neg_hi:[0,0,1]
    v_pk_fma_f32 v[50:51], v[50:51], v[12:13], v[12:13] op_sel:[0,1,0] op_sel_hi:[1,1,0] neg_lo:[0,0,1] neg_hi:[0,0,1]
    v_pk_fma_f32 v[52:53], v[52:53], v[12:13], v[12:13] op_sel:[0,1,0] op_sel_hi:[1,1,0] neg_lo:[0,0,1] neg_hi:[0,0,1]
    v_pk_fma_f32 v[54:55], v[54:55], v[12:13], v[12:13] op_sel:[0,1,0] op_sel_hi:[1,1,0] neg_lo:[0,0,1] neg_hi:[0,0,1]
    v_pk_fma_f32 v[56:57], v[56:57], v[12:13], v[12:13] op_sel:[0,1,0] op_sel_hi:[1,1,0] neg_lo:[0,0,1] neg_hi:[0,0,1]
    v_pk_fma_f32 v[58:59], v[58:59], v[12:13], v[12:13] op_sel:[0,1,0] op_sel_hi:[1,1,0] neg_lo:[0,0,1] neg_hi:[0,0,1]
    v_pk_fma_f32 v[60:61], v[60:61], v[12:13], v[12:13] op_sel:[0,1,0] op_sel_hi:[1,1,0] neg_lo:[0,0,1] neg_hi:[0,0,1]
    v_pk_fma_f32 v[62:63], v[62:63], v[12:13], v[12:13] op_sel:[0,1,0] op_sel_hi:[1,1,0] neg_lo:[0,0,1] neg_hi:[0,0,1]
    v_exp_f32 v48, v48
    v_exp_f32 v49, v49
    v_exp_f32 v50, v50
    v_exp_f32 v51, v51
    v_exp_f32 v52, v52
    v_exp_f32 v53, v53
    v_exp_f32 v54, v54
    v_exp_f32 v55, v55
    v_exp_f32 v56, v56
    v_exp_f32 v57, v57
    v_exp_f32 v58, v58
    v_exp_f32 v59, v59
    v_exp_f32 v60, v60
    v_exp_f32 v61, v61
    v_exp_f32 v62, v62
    v_exp_f32 v63, v63
    v_cvt_pk_bf16_f32 v48, v48, v49
    v_cvt_pk_bf16_f32 v49, v50, v51
    v_cvt_pk_bf16_f32 v50, v52, v53
    v_cvt_pk_bf16_f32 v51, v54, v55
    v_cvt_pk_bf16_f32 v52, v56, v57
    v_cvt_pk_bf16_f32 v53, v58, v59
    v_cvt_pk_bf16_f32 v54, v60, v61
    v_cvt_pk_bf16_f32 v55, v62, v63
    s_waitcnt lgkmcnt(0)
    v_mfma_f32_32x32x16_bf16 v[160:175], v[192:195], v[48:51], v[160:175]
    v_mfma_f32_32x32x16_bf16 v[160:175], v[196:199], v[52:55], v[160:175]
    ds_read_b128 v[200:203], v2 offset:21504
    ds_read_b128 v[204:207], v2 offset:22528
    v_pk_fma_f32 v[64:65], v[64:65], v[12:13], v[12:13] op_sel:[0,1,0] op_sel_hi:[1,1,0] neg_lo:[0,0,1] neg_hi:[0,0,1]
    v_pk_fma_f32 v[66:67], v[66:67], v[12:13], v[12:13] op_sel:[0,1,0] op_sel_hi:[1,1,0] neg_lo:[0,0,1] neg_hi:[0,0,1]
    v_pk_fma_f32 v[68:69], v[68:69], v[12:13], v[12:13] op_sel:[0,1,0] op_sel_hi:[1,1,0] neg_lo:[0,0,1] neg_hi:[0,0,1]
    v_pk_fma_f32 v[70:71], v[70:71], v[12:13], v[12:13] op_sel:[0,1,0] op_sel_hi:[1,1,0] neg_lo:[0,0,1] neg_hi:[0,0,1]
    v_pk_fma_f32 v[72:73], v[72:73], v[12:13], v[12:13] op_sel:[0,1,0] op_sel_hi:[1,1,0] neg_lo:[0,0,1] neg_hi:[0,0,1]
    v_pk_fma_f32 v[74:75], v[74:75], v[12:13], v[12:13] op_sel:[0,1,0] op_sel_hi:[1,1,0] neg_lo:[0,0,1] neg_hi:[0,0,1]
    v_pk_fma_f32 v[76:77], v[76:77], v[12:13], v[12:13] op_sel:[0,1,0] op_sel_hi:[1,1,0] neg_lo:[0,0,1] neg_hi:[0,0,1]
    v_pk_fma_f32 v[78:79], v[78:79], v[12:13], v[12:13] op_sel:[0,1,0] op_sel_hi:[1,1,0] neg_lo:[0,0,1] neg_hi:[0,0,1]
    v_exp_f32 v64, v64
    v_exp_f32 v65, v65
    v_exp_f32 v66, v66
    v_exp_f32 v67, v67
    v_exp_f32 v68, v68
    v_exp_f32 v69, v69
    v_exp_f32 v70, v70
    v_exp_f32 v71, v71
    v_exp_f32 v72, v72
    v_exp_f32 v73, v73
    v_exp_f32 v74, v74
    v_exp_f32 v75, v75
    v_exp_f32 v76, v76
    v_exp_f32 v77, v77
    v_exp_f32 v78, v78
    v_exp_f32 v79, v79
    v_cvt_pk_bf16_f32 v64, v64, v65
    v_cvt_pk_bf16_f32 v65, v66, v67
    v_cvt_pk_bf16_f32 v66, v68, v69
    v_cvt_pk_bf16_f32 v67, v70, v71
    v_cvt_pk_bf16_f32 v68, v72, v73
    v_cvt_pk_bf16_f32 v69, v74, v75
    v_cvt_pk_bf16_f32 v70, v76, v77
    v_cvt_pk_bf16_f32 v71, v78, v79
    s_waitcnt lgkmcnt(0)
    v_mfma_f32_32x32x16_bf16 v[160:175], v[200:203], v[64:67], v[160:175]
    v_mfma_f32_32x32x16_bf16 v[160:175], v[204:207], v[68:71], v[160:175]
    ds_read_b128 v[208:211], v2 offset:23552
    ds_read_b128 v[212:215], v2 offset:24576
    v_pk_fma_f32 v[80:81], v[80:81], v[12:13], v[12:13] op_sel:[0,1,0] op_sel_hi:[1,1,0] neg_lo:[0,0,1] neg_hi:[0,0,1]
    v_pk_fma_f32 v[82:83], v[82:83], v[12:13], v[12:13] op_sel:[0,1,0] op_sel_hi:[1,1,0] neg_lo:[0,0,1] neg_hi:[0,0,1]
    v_pk_fma_f32 v[84:85], v[84:85], v[12:13], v[12:13] op_sel:[0,1,0] op_sel_hi:[1,1,0] neg_lo:[0,0,1] neg_hi:[0,0,1]
    v_pk_fma_f32 v[86:87], v[86:87], v[12:13], v[12:13] op_sel:[0,1,0] op_sel_hi:[1,1,0] neg_lo:[0,0,1] neg_hi:[0,0,1]
    v_pk_fma_f32 v[88:89], v[88:89], v[12:13], v[12:13] op_sel:[0,1,0] op_sel_hi:[1,1,0] neg_lo:[0,0,1] neg_hi:[0,0,1]
    v_pk_fma_f32 v[90:91], v[90:91], v[12:13], v[12:13] op_sel:[0,1,0] op_sel_hi:[1,1,0] neg_lo:[0,0,1] neg_hi:[0,0,1]
    v_pk_fma_f32 v[92:93], v[92:93], v[12:13], v[12:13] op_sel:[0,1,0] op_sel_hi:[1,1,0] neg_lo:[0,0,1] neg_hi:[0,0,1]
    v_pk_fma_f32 v[94:95], v[94:95], v[12:13], v[12:13] op_sel:[0,1,0] op_sel_hi:[1,1,0] neg_lo:[0,0,1] neg_hi:[0,0,1]
    v_exp_f32 v80, v80
    v_exp_f32 v81, v81
    v_exp_f32 v82, v82
    v_exp_f32 v83, v83
    v_exp_f32 v84, v84
    v_exp_f32 v85, v85
    v_exp_f32 v86, v86
    v_exp_f32 v87, v87
    v_exp_f32 v88, v88
    v_exp_f32 v89, v89
    v_exp_f32 v90, v90
    v_exp_f32 v91, v91
    v_exp_f32 v92, v92
    v_exp_f32 v93, v93
    v_exp_f32 v94, v94
    v_exp_f32 v95, v95
    v_cvt_pk_bf16_f32 v80, v80, v81
    v_cvt_pk_bf16_f32 v81, v82, v83
    v_cvt_pk_bf16_f32 v82, v84, v85
    v_cvt_pk_bf16_f32 v83, v86, v87
    v_cvt_pk_bf16_f32 v84, v88, v89
    v_cvt_pk_bf16_f32 v85, v90, v91
    v_cvt_pk_bf16_f32 v86, v92, v93
    v_cvt_pk_bf16_f32 v87, v94, v95
    s_waitcnt lgkmcnt(0)
    v_mfma_f32_32x32x16_bf16 v[160:175], v[208:211], v[80:83], v[160:175]
    v_mfma_f32_32x32x16_bf16 v[160:175], v[212:215], v[84:87], v[160:175]
    ds_read_b128 v[216:219], v2 offset:25600
    ds_read_b128 v[220:223], v2 offset:26624
    v_pk_fma_f32 v[96:97], v[96:97], v[12:13], v[12:13] op_sel:[0,1,0] op_sel_hi:[1,1,0] neg_lo:[0,0,1] neg_hi:[0,0,1]
    v_pk_fma_f32 v[98:99], v[98:99], v[12:13], v[12:13] op_sel:[0,1,0] op_sel_hi:[1,1,0] neg_lo:[0,0,1] neg_hi:[0,0,1]
    v_pk_fma_f32 v[100:101], v[100:101], v[12:13], v[12:13] op_sel:[0,1,0] op_sel_hi:[1,1,0] neg_lo:[0,0,1] neg_hi:[0,0,1]
    v_pk_fma_f32 v[102:103], v[102:103], v[12:13], v[12:13] op_sel:[0,1,0] op_sel_hi:[1,1,0] neg_lo:[0,0,1] neg_hi:[0,0,1]
    v_pk_fma_f32 v[104:105], v[104:105], v[12:13], v[12:13] op_sel:[0,1,0] op_sel_hi:[1,1,0] neg_lo:[0,0,1] neg_hi:[0,0,1]
    v_pk_fma_f32 v[106:107], v[106:107], v[12:13], v[12:13] op_sel:[0,1,0] op_sel_hi:[1,1,0] neg_lo:[0,0,1] neg_hi:[0,0,1]
    v_pk_fma_f32 v[108:109], v[108:109], v[12:13], v[12:13] op_sel:[0,1,0] op_sel_hi:[1,1,0] neg_lo:[0,0,1] neg_hi:[0,0,1]
    v_pk_fma_f32 v[110:111], v[110:111], v[12:13], v[12:13] op_sel:[0,1,0] op_sel_hi:[1,1,0] neg_lo:[0,0,1] neg_hi:[0,0,1]
    v_exp_f32 v96, v96
    v_exp_f32 v97, v97
    v_exp_f32 v98, v98
    v_exp_f32 v99, v99
    v_exp_f32 v100, v100
    v_exp_f32 v101, v101
    v_exp_f32 v102, v102
    v_exp_f32 v103, v103
    v_exp_f32 v104, v104
    v_exp_f32 v105, v105
    v_exp_f32 v106, v106
    v_exp_f32 v107, v107
    v_exp_f32 v108, v108
    v_exp_f32 v109, v109
    v_exp_f32 v110, v110
    v_exp_f32 v111, v111
    v_cvt_pk_bf16_f32 v96, v96, v97
    v_cvt_pk_bf16_f32 v97, v98, v99
    v_cvt_pk_bf16_f32 v98, v100, v101
    v_cvt_pk_bf16_f32 v99, v102, v103
    v_cvt_pk_bf16_f32 v100, v104, v105
    v_cvt_pk_bf16_f32 v101, v106, v107
    v_cvt_pk_bf16_f32 v102, v108, v109
    v_cvt_pk_bf16_f32 v103, v110, v111
    s_waitcnt lgkmcnt(0)
    v_mfma_f32_32x32x16_bf16 v[160:175], v[216:219], v[96:99], v[160:175]
    v_mfma_f32_32x32x16_bf16 v[160:175], v[220:223], v[100:103], v[160:175]
    ds_read_b128 v[224:227], v2 offset:27648
    ds_read_b128 v[228:231], v2 offset:28672
    v_pk_fma_f32 v[112:113], v[112:113], v[12:13], v[12:13] op_sel:[0,1,0] op_sel_hi:[1,1,0] neg_lo:[0,0,1] neg_hi:[0,0,1]
    v_pk_fma_f32 v[114:115], v[114:115], v[12:13], v[12:13] op_sel:[0,1,0] op_sel_hi:[1,1,0] neg_lo:[0,0,1] neg_hi:[0,0,1]
    v_pk_fma_f32 v[116:117], v[116:117], v[12:13], v[12:13] op_sel:[0,1,0] op_sel_hi:[1,1,0] neg_lo:[0,0,1] neg_hi:[0,0,1]
    v_pk_fma_f32 v[118:119], v[118:119], v[12:13], v[12:13] op_sel:[0,1,0] op_sel_hi:[1,1,0] neg_lo:[0,0,1] neg_hi:[0,0,1]
    v_pk_fma_f32 v[120:121], v[120:121], v[12:13], v[12:13] op_sel:[0,1,0] op_sel_hi:[1,1,0] neg_lo:[0,0,1] neg_hi:[0,0,1]
    v_pk_fma_f32 v[122:123], v[122:123], v[12:13], v[12:13] op_sel:[0,1,0] op_sel_hi:[1,1,0] neg_lo:[0,0,1] neg_hi:[0,0,1]
    v_pk_fma_f32 v[124:125], v[124:125], v[12:13], v[12:13] op_sel:[0,1,0] op_sel_hi:[1,1,0] neg_lo:[0,0,1] neg_hi:[0,0,1]
    v_pk_fma_f32 v[126:127], v[126:127], v[12:13], v[12:13] op_sel:[0,1,0] op_sel_hi:[1,1,0] neg_lo:[0,0,1] neg_hi:[0,0,1]
    v_exp_f32 v112, v112
    v_exp_f32 v113, v113
    v_exp_f32 v114, v114
    v_exp_f32 v115, v115
    v_exp_f32 v116, v116
    v_exp_f32 v117, v117
    v_exp_f32 v118, v118
    v_exp_f32 v119, v119
    v_exp_f32 v120, v120
    v_exp_f32 v121, v121
    v_exp_f32 v122, v122
    v_exp_f32 v123, v123
    v_exp_f32 v124, v124
    v_exp_f32 v125, v125
    v_exp_f32 v126, v126
    v_exp_f32 v127, v127
    v_cvt_pk_bf16_f32 v112, v112, v113
    v_cvt_pk_bf16_f32 v113, v114, v115
    v_cvt_pk_bf16_f32 v114, v116, v117
    v_cvt_pk_bf16_f32 v115, v118, v119
    v_cvt_pk_bf16_f32 v116, v120, v121
    v_cvt_pk_bf16_f32 v117, v122, v123
    v_cvt_pk_bf16_f32 v118, v124, v125
    v_cvt_pk_bf16_f32 v119, v126, v127
    s_waitcnt lgkmcnt(0)
    v_mfma_f32_32x32x16_bf16 v[160:175], v[224:227], v[112:115], v[160:175]
    v_mfma_f32_32x32x16_bf16 v[160:175], v[228:231], v[116:119], v[160:175]
    ds_read_b128 v[232:235], v2 offset:29696
    ds_read_b128 v[236:239], v2 offset:30720
    v_pk_fma_f32 v[128:129], v[128:129], v[12:13], v[12:13] op_sel:[0,1,0] op_sel_hi:[1,1,0] neg_lo:[0,0,1] neg_hi:[0,0,1]
    v_pk_fma_f32 v[130:131], v[130:131], v[12:13], v[12:13] op_sel:[0,1,0] op_sel_hi:[1,1,0] neg_lo:[0,0,1] neg_hi:[0,0,1]
    v_pk_fma_f32 v[132:133], v[132:133], v[12:13], v[12:13] op_sel:[0,1,0] op_sel_hi:[1,1,0] neg_lo:[0,0,1] neg_hi:[0,0,1]
    v_pk_fma_f32 v[134:135], v[134:135], v[12:13], v[12:13] op_sel:[0,1,0] op_sel_hi:[1,1,0] neg_lo:[0,0,1] neg_hi:[0,0,1]
    v_pk_fma_f32 v[136:137], v[136:137], v[12:13], v[12:13] op_sel:[0,1,0] op_sel_hi:[1,1,0] neg_lo:[0,0,1] neg_hi:[0,0,1]
    v_pk_fma_f32 v[138:139], v[138:139], v[12:13], v[12:13] op_sel:[0,1,0] op_sel_hi:[1,1,0] neg_lo:[0,0,1] neg_hi:[0,0,1]
    v_pk_fma_f32 v[140:141], v[140:141], v[12:13], v[12:13] op_sel:[0,1,0] op_sel_hi:[1,1,0] neg_lo:[0,0,1] neg_hi:[0,0,1]
    v_pk_fma_f32 v[142:143], v[142:143], v[12:13], v[12:13] op_sel:[0,1,0] op_sel_hi:[1,1,0] neg_lo:[0,0,1] neg_hi:[0,0,1]
    v_exp_f32 v128, v128
    v_exp_f32 v129, v129
    v_exp_f32 v130, v130
    v_exp_f32 v131, v131
    v_exp_f32 v132, v132
    v_exp_f32 v133, v133
    v_exp_f32 v134, v134
    v_exp_f32 v135, v135
    v_exp_f32 v136, v136
    v_exp_f32 v137, v137
    v_exp_f32 v138, v138
    v_exp_f32 v139, v139
    v_exp_f32 v140, v140
    v_exp_f32 v141, v141
    v_exp_f32 v142, v142
    v_exp_f32 v143, v143
    v_cvt_pk_bf16_f32 v128, v128, v129
    v_cvt_pk_bf16_f32 v129, v130, v131
    v_cvt_pk_bf16_f32 v130, v132, v133
    v_cvt_pk_bf16_f32 v131, v134, v135
    v_cvt_pk_bf16_f32 v132, v136, v137
    v_cvt_pk_bf16_f32 v133, v138, v139
    v_cvt_pk_bf16_f32 v134, v140, v141
    v_cvt_pk_bf16_f32 v135, v142, v143
    s_waitcnt lgkmcnt(0)
    v_mfma_f32_32x32x16_bf16 v[160:175], v[232:235], v[128:131], v[160:175]
    v_mfma_f32_32x32x16_bf16 v[160:175], v[236:239], v[132:135], v[160:175]
    ds_read_b128 v[240:243], v2 offset:31744
    ds_read_b128 v[244:247], v2 offset:32768
    v_pk_fma_f32 v[144:145], v[144:145], v[12:13], v[12:13] op_sel:[0,1,0] op_sel_hi:[1,1,0] neg_lo:[0,0,1] neg_hi:[0,0,1]
    v_pk_fma_f32 v[146:147], v[146:147], v[12:13], v[12:13] op_sel:[0,1,0] op_sel_hi:[1,1,0] neg_lo:[0,0,1] neg_hi:[0,0,1]
    v_pk_fma_f32 v[148:149], v[148:149], v[12:13], v[12:13] op_sel:[0,1,0] op_sel_hi:[1,1,0] neg_lo:[0,0,1] neg_hi:[0,0,1]
    v_pk_fma_f32 v[150:151], v[150:151], v[12:13], v[12:13] op_sel:[0,1,0] op_sel_hi:[1,1,0] neg_lo:[0,0,1] neg_hi:[0,0,1]
    v_pk_fma_f32 v[152:153], v[152:153], v[12:13], v[12:13] op_sel:[0,1,0] op_sel_hi:[1,1,0] neg_lo:[0,0,1] neg_hi:[0,0,1]
    v_pk_fma_f32 v[154:155], v[154:155], v[12:13], v[12:13] op_sel:[0,1,0] op_sel_hi:[1,1,0] neg_lo:[0,0,1] neg_hi:[0,0,1]
    v_pk_fma_f32 v[156:157], v[156:157], v[12:13], v[12:13] op_sel:[0,1,0] op_sel_hi:[1,1,0] neg_lo:[0,0,1] neg_hi:[0,0,1]
    v_pk_fma_f32 v[158:159], v[158:159], v[12:13], v[12:13] op_sel:[0,1,0] op_sel_hi:[1,1,0] neg_lo:[0,0,1] neg_hi:[0,0,1]
    v_exp_f32 v144, v144
    v_exp_f32 v145, v145
    v_exp_f32 v146, v146
    v_exp_f32 v147, v147
    v_exp_f32 v148, v148
    v_exp_f32 v149, v149
    v_exp_f32 v150, v150
    v_exp_f32 v151, v151
    v_exp_f32 v152, v152
    v_exp_f32 v153, v153
    v_exp_f32 v154, v154
    v_exp_f32 v155, v155
    v_exp_f32 v156, v156
    v_exp_f32 v157, v157
    v_exp_f32 v158, v158
    v_exp_f32 v159, v159
    v_cvt_pk_bf16_f32 v144, v144, v145
    v_cvt_pk_bf16_f32 v145, v146, v147
    v_cvt_pk_bf16_f32 v146, v148, v149
    v_cvt_pk_bf16_f32 v147, v150, v151
    v_cvt_pk_bf16_f32 v148, v152, v153
    v_cvt_pk_bf16_f32 v149, v154, v155
    v_cvt_pk_bf16_f32 v150, v156, v157
    v_cvt_pk_bf16_f32 v151, v158, v159
    s_waitcnt lgkmcnt(0)
    v_mfma_f32_32x32x16_bf16 v[160:175], v[240:243], v[144:147], v[160:175]
    v_mfma_f32_32x32x16_bf16 v[160:175], v[244:247], v[148:151], v[160:175]
    s_nop 11
    v_mov_b32 v11, v168
    v_mov_b32 v12, v168
    s_nop 1
    v_permlane32_swap_b32 v11, v12
    v_rcp_f32 v12, v12
    s_nop 0
    v_mul_f32 v160, v160, v12
    v_mul_f32 v161, v161, v12
    v_mul_f32 v162, v162, v12
    v_mul_f32 v163, v163, v12
    v_mul_f32 v164, v164, v12
    v_mul_f32 v165, v165, v12
    v_mul_f32 v166, v166, v12
    v_mul_f32 v167, v167, v12
    v_mul_f32 v168, v168, v12
    v_mul_f32 v169, v169, v12
    v_mul_f32 v170, v170, v12
    v_mul_f32 v171, v171, v12
    v_cvt_pk_bf16_f32 v160, v160, v161
    v_cvt_pk_bf16_f32 v161, v162, v163
    v_cvt_pk_bf16_f32 v162, v164, v165
    v_cvt_pk_bf16_f32 v163, v166, v167
    v_cvt_pk_bf16_f32 v164, v168, v169
    v_cvt_pk_bf16_f32 v165, v170, v171
    v_lshrrev_b32 v13, 4, v3
    v_mul_u32_u24 v13, 20480, v13
    v_and_b32 v14, 15, v3
    v_lshlrev_b32 v14, 4, v14
    v_add_u32 v13, v13, v14
    v_lshlrev_b32 v14, 8, v4
    v_add_u32 v14, v14, v13
    s_lshr_b32 s17, s15, 4
    s_mul_i32 s17, s17, 20480
    s_add_u32 s17, s17, 32505856
    s_lshr_b32 s18, s13, 1
    s_lshl_b32 s18, s18, 10
    s_and_b32 s19, s13, 1
    s_lshl_b32 s20, s19, 9
    s_add_u32 s18, s18, s20
    s_add_u32 s18, s18, s17
    buffer_store_dwordx4 v[160:163], v14, s[4:7], s18 offen
    s_lshr_b32 s18, s13, 3
    s_add_u32 s18, s18, 16
    s_lshl_b32 s18, s18, 10
    s_lshr_b32 s20, s13, 1
    s_and_b32 s20, s20, 3
    s_lshl_b32 s20, s20, 8
    s_add_u32 s18, s18, s20
    s_lshl_b32 s19, s19, 3
    s_add_u32 s18, s18, s19
    s_add_u32 s18, s18, s17
    s_mov_b32 exec_hi, 0
    buffer_store_dwordx2 v[164:165], v13, s[4:7], s18 offen
attn_kernel_end:
    s_endpgm

.text
.globl wo1_kernel
.p2align 8
.type wo1_kernel,@function
wo1_kernel:
    s_cmp_ge_u32 s2, 256
    s_cbranch_scc1 wo1_kernel_end
    s_load_dwordx2 s[4:5], s[0:1], 72
    v_lshrrev_b32 v2, 6, v0
    s_nop 0
    v_readfirstlane_b32 s12, v2
    v_and_b32 v1, 63, v0
    v_lshlrev_b32 v3, 4, v1
    s_and_b32 s17, s2, 7
    s_lshr_b32 s18, s2, 3
    s_and_b32 s19, s17, 1
    s_lshr_b32 s17, s17, 1
    s_mul_i32 s19, s19, 32
    s_add_u32 s18, s18, s19
    s_and_b32 s13, s18, 7
    s_lshl_b32 s17, s17, 3
    s_add_u32 s13, s13, s17
    s_lshr_b32 s14, s18, 3
    s_cmp_lt_u32 s12, 4
    s_cbranch_scc1 wo1_kernel_comp
    s_sub_u32 s12, s12, 4
    s_add_u32 s18, s12, 0
    s_mul_i32 s56, s18, 2048
    s_mul_i32 s20, s13, 4
    s_add_u32 s20, s20, s18
    s_mul_i32 s20, s20, 20480
    s_add_u32 s20, s20, 32505856
    s_mul_i32 s21, s14, 5
    s_add_u32 s21, s21, s18
    s_sub_u32 s21, s21, 4
    s_mul_i32 s21, s21, 20480
    s_add_u32 s21, s21, 2490368
    s_cmp_lt_u32 s18, 4
    s_cselect_b32 s24, s20, s21
    s_add_u32 s18, s12, 2
    s_mul_i32 s57, s18, 2048
    s_mul_i32 s20, s13, 4
    s_add_u32 s20, s20, s18
    s_mul_i32 s20, s20, 20480
    s_add_u32 s20, s20, 32505856
    s_mul_i32 s21, s14, 5
    s_add_u32 s21, s21, s18
    s_sub_u32 s21, s21, 4
    s_mul_i32 s21, s21, 20480
    s_add_u32 s21, s21, 2490368
    s_cmp_lt_u32 s18, 4
    s_cselect_b32 s25, s20, s21
    s_add_u32 s18, s12, 4
    s_mul_i32 s58, s18, 2048
    s_mul_i32 s20, s13, 4
    s_add_u32 s20, s20, s18
    s_mul_i32 s20, s20, 20480
    s_add_u32 s20, s20, 32505856
    s_mul_i32 s21, s14, 5
    s_add_u32 s21, s21, s18
    s_sub_u32 s21, s21, 4
    s_mul_i32 s21, s21, 20480
    s_add_u32 s21, s21, 2490368
    s_cmp_lt_u32 s18, 4
    s_cselect_b32 s26, s20, s21
    s_add_u32 s18, s12, 6
    s_mul_i32 s59, s18, 2048
    s_mul_i32 s20, s13, 4
    s_add_u32 s20, s20, s18
    s_mul_i32 s20, s20, 20480
    s_add_u32 s20, s20, 32505856
    s_mul_i32 s21, s14, 5
    s_add_u32 s21, s21, s18
    s_sub_u32 s21, s21, 4
    s_mul_i32 s21, s21, 20480
    s_add_u32 s21, s21, 2490368
    s_cmp_lt_u32 s18, 4
    s_cselect_b32 s27, s20, s21
    s_mov_b32 s18, 8
    s_mul_i32 s60, s18, 2048
    s_mul_i32 s20, s13, 4
    s_add_u32 s20, s20, s18
    s_mul_i32 s20, s20, 20480
    s_add_u32 s20, s20, 32505856
    s_mul_i32 s21, s14, 5
    s_add_u32 s21, s21, s18
    s_sub_u32 s21, s21, 4
    s_mul_i32 s21, s21, 20480
    s_add_u32 s21, s21, 2490368
    s_cmp_lt_u32 s18, 4
    s_cselect_b32 s28, s20, s21
    s_lshl_b32 s18, s12, 10
    s_add_u32 s28, s28, s18
    s_add_u32 s60, s60, s18
    s_waitcnt lgkmcnt(0)
    s_and_b32 s5, s5, 0xffff
    s_mov_b32 s6, 268435456
    s_mov_b32 s7, 0x00020000
    s_add_u32 m0, s56, 0
    s_add_u32 s22, s24, 0
    buffer_load_dwordx4 v3, s[4:7], s22 offen offset:0 lds
    buffer_load_dwordx4 v3, s[4:7], s22 offen offset:1024 lds
    s_add_u32 m0, s57, 0
    s_add_u32 s23, s25, 0
    buffer_load_dwordx4 v3, s[4:7], s23 offen offset:0 lds
    buffer_load_dwordx4 v3, s[4:7], s23 offen offset:1024 lds
    s_add_u32 m0, s58, 0
    s_add_u32 s22, s26, 0
    buffer_load_dwordx4 v3, s[4:7], s22 offen offset:0 lds
    buffer_load_dwordx4 v3, s[4:7], s22 offen offset:1024 lds
    s_add_u32 m0, s59, 0
    s_add_u32 s23, s27, 0
    buffer_load_dwordx4 v3, s[4:7], s23 offen offset:0 lds
    buffer_load_dwordx4 v3, s[4:7], s23 offen offset:1024 lds
    s_add_u32 m0, s60, 0
    s_add_u32 s22, s28, 0
    buffer_load_dwordx4 v3, s[4:7], s22 offen offset:0 lds
    s_add_u32 m0, s56, 18432
    s_add_u32 s22, s24, 2048
    buffer_load_dwordx4 v3, s[4:7], s22 offen offset:0 lds
    buffer_load_dwordx4 v3, s[4:7], s22 offen offset:1024 lds
    s_add_u32 m0, s57, 18432
    s_add_u32 s23, s25, 2048
    buffer_load_dwordx4 v3, s[4:7], s23 offen offset:0 lds
    buffer_load_dwordx4 v3, s[4:7], s23 offen offset:1024 lds
    s_add_u32 m0, s58, 18432
    s_add_u32 s22, s26, 2048
    buffer_load_dwordx4 v3, s[4:7], s22 offen offset:0 lds
    buffer_load_dwordx4 v3, s[4:7], s22 offen offset:1024 lds
    s_add_u32 m0, s59, 18432
    s_add_u32 s23, s27, 2048
    buffer_load_dwordx4 v3, s[4:7], s23 offen offset:0 lds
    buffer_load_dwordx4 v3, s[4:7], s23 offen offset:1024 lds
    s_add_u32 m0, s60, 18432
    s_add_u32 s22, s28, 2048
    buffer_load_dwordx4 v3, s[4:7], s22 offen offset:0 lds
    s_waitcnt vmcnt(9)
    s_barrier
    s_add_u32 m0, s56, 36864
    s_add_u32 s22, s24, 4096
    buffer_load_dwordx4 v3, s[4:7], s22 offen offset:0 lds
    buffer_load_dwordx4 v3, s[4:7], s22 offen offset:1024 lds
    s_add_u32 m0, s57, 36864
    s_add_u32 s23, s25, 4096
    buffer_load_dwordx4 v3, s[4:7], s23 offen offset:0 lds
    buffer_load_dwordx4 v3, s[4:7], s23 offen offset:1024 lds
    s_add_u32 m0, s58, 36864
    s_add_u32 s22, s26, 4096
    buffer_load_dwordx4 v3, s[4:7], s22 offen offset:0 lds
    buffer_load_dwordx4 v3, s[4:7], s22 offen offset:1024 lds
    s_add_u32 m0, s59, 36864
    s_add_u32 s23, s27, 4096
    buffer_load_dwordx4 v3, s[4:7], s23 offen offset:0 lds
    buffer_load_dwordx4 v3, s[4:7], s23 offen offset:1024 lds
    s_add_u32 m0, s60, 36864
    s_add_u32 s22, s28, 4096
    buffer_load_dwordx4 v3, s[4:7], s22 offen offset:0 lds
    s_add_u32 m0, s56, 55296
    s_add_u32 s22, s24, 6144
    buffer_load_dwordx4 v3, s[4:7], s22 offen offset:0 lds
    buffer_load_dwordx4 v3, s[4:7], s22 offen offset:1024 lds
    s_add_u32 m0, s57, 55296
    s_add_u32 s23, s25, 6144
    buffer_load_dwordx4 v3, s[4:7], s23 offen offset:0 lds
    buffer_load_dwordx4 v3, s[4:7], s23 offen offset:1024 lds
    s_add_u32 m0, s58, 55296
    s_add_u32 s22, s26, 6144
    buffer_load_dwordx4 v3, s[4:7], s22 offen offset:0 lds
    buffer_load_dwordx4 v3, s[4:7], s22 offen offset:1024 lds
    s_add_u32 m0, s59, 55296
    s_add_u32 s23, s27, 6144
    buffer_load_dwordx4 v3, s[4:7], s23 offen offset:0 lds
    buffer_load_dwordx4 v3, s[4:7], s23 offen offset:1024 lds
    s_add_u32 m0, s60, 55296
    s_add_u32 s22, s28, 6144
    buffer_load_dwordx4 v3, s[4:7], s22 offen offset:0 lds
    s_waitcnt vmcnt(18)
    s_barrier
    s_add_u32 m0, s56, 73728
    s_add_u32 s22, s24, 8192
    buffer_load_dwordx4 v3, s[4:7], s22 offen offset:0 lds
    buffer_load_dwordx4 v3, s[4:7], s22 offen offset:1024 lds
    s_add_u32 m0, s57, 73728
    s_add_u32 s23, s25, 8192
    buffer_load_dwordx4 v3, s[4:7], s23 offen offset:0 lds
    buffer_load_dwordx4 v3, s[4:7], s23 offen offset:1024 lds
    s_add_u32 m0, s58, 73728
    s_add_u32 s22, s26, 8192
    buffer_load_dwordx4 v3, s[4:7], s22 offen offset:0 lds
    buffer_load_dwordx4 v3, s[4:7], s22 offen offset:1024 lds
    s_add_u32 m0, s59, 73728
    s_add_u32 s23, s27, 8192
    buffer_load_dwordx4 v3, s[4:7], s23 offen offset:0 lds
    buffer_load_dwordx4 v3, s[4:7], s23 offen offset:1024 lds
    s_add_u32 m0, s60, 73728
    s_add_u32 s22, s28, 8192
    buffer_load_dwordx4 v3, s[4:7], s22 offen offset:0 lds
    s_add_u32 m0, s56, 92160
    s_add_u32 s22, s24, 10240
    buffer_load_dwordx4 v3, s[4:7], s22 offen offset:0 lds
    buffer_load_dwordx4 v3, s[4:7], s22 offen offset:1024 lds
    s_add_u32 m0, s57, 92160
    s_add_u32 s23, s25, 10240
    buffer_load_dwordx4 v3, s[4:7], s23 offen offset:0 lds
    buffer_load_dwordx4 v3, s[4:7], s23 offen offset:1024 lds
    s_add_u32 m0, s58, 92160
    s_add_u32 s22, s26, 10240
    buffer_load_dwordx4 v3, s[4:7], s22 offen offset:0 lds
    buffer_load_dwordx4 v3, s[4:7], s22 offen offset:1024 lds
    s_add_u32 m0, s59, 92160
    s_add_u32 s23, s27, 10240
    buffer_load_dwordx4 v3, s[4:7], s23 offen offset:0 lds
    buffer_load_dwordx4 v3, s[4:7], s23 offen offset:1024 lds
    s_add_u32 m0, s60, 92160
    s_add_u32 s22, s28, 10240
    buffer_load_dwordx4 v3, s[4:7], s22 offen offset:0 lds
    s_waitcnt vmcnt(27)
    s_barrier
    s_add_u32 m0, s56, 110592
    s_add_u32 s22, s24, 12288
    buffer_load_dwordx4 v3, s[4:7], s22 offen offset:0 lds
    buffer_load_dwordx4 v3, s[4:7], s22 offen offset:1024 lds
    s_add_u32 m0, s57, 110592
    s_add_u32 s23, s25, 12288
    buffer_load_dwordx4 v3, s[4:7], s23 offen offset:0 lds
    buffer_load_dwordx4 v3, s[4:7], s23 offen offset:1024 lds
    s_add_u32 m0, s58, 110592
    s_add_u32 s22, s26, 12288
    buffer_load_dwordx4 v3, s[4:7], s22 offen offset:0 lds
    buffer_load_dwordx4 v3, s[4:7], s22 offen offset:1024 lds
    s_add_u32 m0, s59, 110592
    s_add_u32 s23, s27, 12288
    buffer_load_dwordx4 v3, s[4:7], s23 offen offset:0 lds
    buffer_load_dwordx4 v3, s[4:7], s23 offen offset:1024 lds
    s_add_u32 m0, s60, 110592
    s_add_u32 s22, s28, 12288
    buffer_load_dwordx4 v3, s[4:7], s22 offen offset:0 lds
    s_add_u32 m0, s56, 129024
    s_add_u32 s22, s24, 14336
    buffer_load_dwordx4 v3, s[4:7], s22 offen offset:0 lds
    buffer_load_dwordx4 v3, s[4:7], s22 offen offset:1024 lds
    s_add_u32 m0, s57, 129024
    s_add_u32 s23, s25, 14336
    buffer_load_dwordx4 v3, s[4:7], s23 offen offset:0 lds
    buffer_load_dwordx4 v3, s[4:7], s23 offen offset:1024 lds
    s_add_u32 m0, s58, 129024
    s_add_u32 s22, s26, 14336
    buffer_load_dwordx4 v3, s[4:7], s22 offen offset:0 lds
    buffer_load_dwordx4 v3, s[4:7], s22 offen offset:1024 lds
    s_add_u32 m0, s59, 129024
    s_add_u32 s23, s27, 14336
    buffer_load_dwordx4 v3, s[4:7], s23 offen offset:0 lds
    buffer_load_dwordx4 v3, s[4:7], s23 offen offset:1024 lds
    s_add_u32 m0, s60, 129024
    s_add_u32 s22, s28, 14336
    buffer_load_dwordx4 v3, s[4:7], s22 offen offset:0 lds
    s_waitcnt vmcnt(36)
    s_barrier
    s_add_u32 m0, s56, 0
    s_add_u32 s22, s24, 16384
    buffer_load_dwordx4 v3, s[4:7], s22 offen offset:0 lds
    buffer_load_dwordx4 v3, s[4:7], s22 offen offset:1024 lds
    s_add_u32 m0, s57, 0
    s_add_u32 s23, s25, 16384
    buffer_load_dwordx4 v3, s[4:7], s23 offen offset:0 lds
    buffer_load_dwordx4 v3, s[4:7], s23 offen offset:1024 lds
    s_add_u32 m0, s58, 0
    s_add_u32 s22, s26, 16384
    buffer_load_dwordx4 v3, s[4:7], s22 offen offset:0 lds
    buffer_load_dwordx4 v3, s[4:7], s22 offen offset:1024 lds
    s_add_u32 m0, s59, 0
    s_add_u32 s23, s27, 16384
    buffer_load_dwordx4 v3, s[4:7], s23 offen offset:0 lds
    buffer_load_dwordx4 v3, s[4:7], s23 offen offset:1024 lds
    s_add_u32 m0, s60, 0
    s_add_u32 s22, s28, 16384
    buffer_load_dwordx4 v3, s[4:7], s22 offen offset:0 lds
    s_add_u32 m0, s56, 18432
    s_add_u32 s22, s24, 18432
    buffer_load_dwordx4 v3, s[4:7], s22 offen offset:0 lds
    buffer_load_dwordx4 v3, s[4:7], s22 offen offset:1024 lds
    s_add_u32 m0, s57, 18432
    s_add_u32 s23, s25, 18432
    buffer_load_dwordx4 v3, s[4:7], s23 offen offset:0 lds
    buffer_load_dwordx4 v3, s[4:7], s23 offen offset:1024 lds
    s_add_u32 m0, s58, 18432
    s_add_u32 s22, s26, 18432
    buffer_load_dwordx4 v3, s[4:7], s22 offen offset:0 lds
    buffer_load_dwordx4 v3, s[4:7], s22 offen offset:1024 lds
    s_add_u32 m0, s59, 18432
    s_add_u32 s23, s27, 18432
    buffer_load_dwordx4 v3, s[4:7], s23 offen offset:0 lds
    buffer_load_dwordx4 v3, s[4:7], s23 offen offset:1024 lds
    s_add_u32 m0, s60, 18432
    s_add_u32 s22, s28, 18432
    buffer_load_dwordx4 v3, s[4:7], s22 offen offset:0 lds
    s_waitcnt vmcnt(45)
    s_barrier
    s_waitcnt vmcnt(36)
    s_barrier
    s_waitcnt vmcnt(27)
    s_barrier
    s_waitcnt vmcnt(18)
    s_barrier
    s_waitcnt vmcnt(9)
    s_barrier
    s_waitcnt vmcnt(0)
    s_barrier
    s_endpgm
wo1_kernel_comp:
    s_mov_b32 s15, s12
    s_mov_b32 s16, 0
    s_mul_i32 s17, s15, 2048
    s_mul_i32 s18, s16, 10240
    v_add_u32 v4, s17, v3
    v_add_u32 v7, s18, v3
    v_add_u32 v5, s17, v3
    v_add_u32 v8, s18, v3
    v_add_u32 v5, 65536, v5
    v_add_u32 v8, 65536, v8
    v_add_u32 v6, s17, v3
    v_add_u32 v9, s18, v3
    v_add_u32 v6, 131072, v6
    v_add_u32 v9, 131072, v9
    s_waitcnt lgkmcnt(0)
    s_and_b32 s5, s5, 0xffff
    s_mov_b32 s6, 268435456
    s_mov_b32 s7, 0x00020000
    s_lshl_b32 s17, s13, 2
    s_add_u32 s17, s17, s15
    s_mul_i32 s18, s14, 5
    s_add_u32 s19, s18, 0
    s_lshr_b32 s20, s19, 1
    s_and_b32 s21, s19, 1
    s_lshl_b32 s21, s21, 3
    s_mul_i32 s22, s17, 20
    s_add_u32 s22, s22, s20
    s_lshl_b32 s22, s22, 10
    s_add_u32 s40, s22, s21
    s_add_u32 s22, s40, 9437184
    buffer_load_dwordx2 v[10:11], v3, s[4:7], s22 offen
    s_add_u32 s19, s18, 1
    s_lshr_b32 s20, s19, 1
    s_and_b32 s21, s19, 1
    s_lshl_b32 s21, s21, 3
    s_mul_i32 s22, s17, 20
    s_add_u32 s22, s22, s20
    s_lshl_b32 s22, s22, 10
    s_add_u32 s41, s22, s21
    s_add_u32 s22, s41, 9437184
    buffer_load_dwordx2 v[12:13], v3, s[4:7], s22 offen
    s_add_u32 s19, s18, 2
    s_lshr_b32 s20, s19, 1
    s_and_b32 s21, s19, 1
    s_lshl_b32 s21, s21, 3
    s_mul_i32 s22, s17, 20
    s_add_u32 s22, s22, s20
    s_lshl_b32 s22, s22, 10
    s_add_u32 s42, s22, s21
    s_add_u32 s22, s42, 9437184
    buffer_load_dwordx2 v[14:15], v3, s[4:7], s22 offen
    s_add_u32 s19, s18, 3
    s_lshr_b32 s20, s19, 1
    s_and_b32 s21, s19, 1
    s_lshl_b32 s21, s21, 3
    s_mul_i32 s22, s17, 20
    s_add_u32 s22, s22, s20
    s_lshl_b32 s22, s22, 10
    s_add_u32 s43, s22, s21
    s_add_u32 s22, s43, 9437184
    buffer_load_dwordx2 v[16:17], v3, s[4:7], s22 offen
    s_add_u32 s19, s18, 4
    s_lshr_b32 s20, s19, 1
    s_and_b32 s21, s19, 1
    s_lshl_b32 s21, s21, 3
    s_mul_i32 s22, s17, 20
    s_add_u32 s22, s22, s20
    s_lshl_b32 s22, s22, 10
    s_add_u32 s44, s22, s21
    s_add_u32 s22, s44, 9437184
    buffer_load_dwordx2 v[18:19], v3, s[4:7], s22 offen
    s_waitcnt lgkmcnt(0)
    s_barrier
    ds_read_b128 v[52:55], v4 offset:0
    ds_read_b128 v[56:59], v7 offset:8192
    ds_read_b128 v[60:63], v7 offset:10240
    ds_read_b128 v[64:67], v7 offset:12288
    ds_read_b128 v[68:71], v7 offset:14336
    ds_read_b128 v[72:75], v7 offset:16384
    s_waitcnt lgkmcnt(0)
    v_mfma_f32_16x16x32_bf16 v[32:35], v[56:59], v[52:55], 0
    ds_read_b128 v[76:79], v4 offset:1024
    ds_read_b128 v[80:83], v7 offset:9216
    v_mfma_f32_16x16x32_bf16 v[36:39], v[60:63], v[52:55], 0
    ds_read_b128 v[84:87], v7 offset:11264
    ds_read_b128 v[88:91], v7 offset:13312
    v_mfma_f32_16x16x32_bf16 v[40:43], v[64:67], v[52:55], 0
    ds_read_b128 v[92:95], v7 offset:15360
    ds_read_b128 v[96:99], v7 offset:17408
    v_mfma_f32_16x16x32_bf16 v[44:47], v[68:71], v[52:55], 0
    v_mfma_f32_16x16x32_bf16 v[48:51], v[72:75], v[52:55], 0
    s_waitcnt lgkmcnt(0)
    s_barrier
    v_mfma_f32_16x16x32_bf16 v[32:35], v[80:83], v[76:79], v[32:35]
    ds_read_b128 v[52:55], v4 offset:18432
    ds_read_b128 v[56:59], v7 offset:26624
    v_mfma_f32_16x16x32_bf16 v[36:39], v[84:87], v[76:79], v[36:39]
    ds_read_b128 v[60:63], v7 offset:28672
    ds_read_b128 v[64:67], v7 offset:30720
    v_mfma_f32_16x16x32_bf16 v[40:43], v[88:91], v[76:79], v[40:43]
    ds_read_b128 v[68:71], v7 offset:32768
    ds_read_b128 v[72:75], v7 offset:34816
    v_mfma_f32_16x16x32_bf16 v[44:47], v[92:95], v[76:79], v[44:47]
    v_mfma_f32_16x16x32_bf16 v[48:51], v[96:99], v[76:79], v[48:51]
    s_waitcnt lgkmcnt(0)
    v_mfma_f32_16x16x32_bf16 v[32:35], v[56:59], v[52:55], v[32:35]
    ds_read_b128 v[76:79], v4 offset:19456
    ds_read_b128 v[80:83], v7 offset:27648
    v_mfma_f32_16x16x32_bf16 v[36:39], v[60:63], v[52:55], v[36:39]
    ds_read_b128 v[84:87], v7 offset:29696
    ds_read_b128 v[88:91], v7 offset:31744
    v_mfma_f32_16x16x32_bf16 v[40:43], v[64:67], v[52:55], v[40:43]
    ds_read_b128 v[92:95], v7 offset:33792
    ds_read_b128 v[96:99], v7 offset:35840
    v_mfma_f32_16x16x32_bf16 v[44:47], v[68:71], v[52:55], v[44:47]
    v_mfma_f32_16x16x32_bf16 v[48:51], v[72:75], v[52:55], v[48:51]
    s_waitcnt lgkmcnt(0)
    s_barrier
    v_mfma_f32_16x16x32_bf16 v[32:35], v[80:83], v[76:79], v[32:35]
    ds_read_b128 v[52:55], v4 offset:36864
    ds_read_b128 v[56:59], v7 offset:45056
    v_mfma_f32_16x16x32_bf16 v[36:39], v[84:87], v[76:79], v[36:39]
    ds_read_b128 v[60:63], v7 offset:47104
    ds_read_b128 v[64:67], v7 offset:49152
    v_mfma_f32_16x16x32_bf16 v[40:43], v[88:91], v[76:79], v[40:43]
    ds_read_b128 v[68:71], v7 offset:51200
    ds_read_b128 v[72:75], v7 offset:53248
    v_mfma_f32_16x16x32_bf16 v[44:47], v[92:95], v[76:79], v[44:47]
    v_mfma_f32_16x16x32_bf16 v[48:51], v[96:99], v[76:79], v[48:51]
    s_waitcnt lgkmcnt(0)
    v_mfma_f32_16x16x32_bf16 v[32:35], v[56:59], v[52:55], v[32:35]
    ds_read_b128 v[76:79], v4 offset:37888
    ds_read_b128 v[80:83], v7 offset:46080
    v_mfma_f32_16x16x32_bf16 v[36:39], v[60:63], v[52:55], v[36:39]
    ds_read_b128 v[84:87], v7 offset:48128
    ds_read_b128 v[88:91], v7 offset:50176
    v_mfma_f32_16x16x32_bf16 v[40:43], v[64:67], v[52:55], v[40:43]
    ds_read_b128 v[92:95], v7 offset:52224
    ds_read_b128 v[96:99], v7 offset:54272
    v_mfma_f32_16x16x32_bf16 v[44:47], v[68:71], v[52:55], v[44:47]
    v_mfma_f32_16x16x32_bf16 v[48:51], v[72:75], v[52:55], v[48:51]
    s_waitcnt lgkmcnt(0)
    s_barrier
    v_mfma_f32_16x16x32_bf16 v[32:35], v[80:83], v[76:79], v[32:35]
    ds_read_b128 v[52:55], v4 offset:55296
    ds_read_b128 v[56:59], v7 offset:63488
    v_mfma_f32_16x16x32_bf16 v[36:39], v[84:87], v[76:79], v[36:39]
    ds_read_b128 v[60:63], v8 offset:0
    ds_read_b128 v[64:67], v8 offset:2048
    v_mfma_f32_16x16x32_bf16 v[40:43], v[88:91], v[76:79], v[40:43]
    ds_read_b128 v[68:71], v8 offset:4096
    ds_read_b128 v[72:75], v8 offset:6144
    v_mfma_f32_16x16x32_bf16 v[44:47], v[92:95], v[76:79], v[44:47]
    v_mfma_f32_16x16x32_bf16 v[48:51], v[96:99], v[76:79], v[48:51]
    s_waitcnt lgkmcnt(0)
    v_mfma_f32_16x16x32_bf16 v[32:35], v[56:59], v[52:55], v[32:35]
    ds_read_b128 v[76:79], v4 offset:56320
    ds_read_b128 v[80:83], v7 offset:64512
    v_mfma_f32_16x16x32_bf16 v[36:39], v[60:63], v[52:55], v[36:39]
    ds_read_b128 v[84:87], v8 offset:1024
    ds_read_b128 v[88:91], v8 offset:3072
    v_mfma_f32_16x16x32_bf16 v[40:43], v[64:67], v[52:55], v[40:43]
    ds_read_b128 v[92:95], v8 offset:5120
    ds_read_b128 v[96:99], v8 offset:7168
    v_mfma_f32_16x16x32_bf16 v[44:47], v[68:71], v[52:55], v[44:47]
    v_mfma_f32_16x16x32_bf16 v[48:51], v[72:75], v[52:55], v[48:51]
    s_waitcnt lgkmcnt(0)
    s_barrier
    v_mfma_f32_16x16x32_bf16 v[32:35], v[80:83], v[76:79], v[32:35]
    ds_read_b128 v[52:55], v5 offset:8192
    ds_read_b128 v[56:59], v8 offset:16384
    v_mfma_f32_16x16x32_bf16 v[36:39], v[84:87], v[76:79], v[36:39]
    ds_read_b128 v[60:63], v8 offset:18432
    ds_read_b128 v[64:67], v8 offset:20480
    v_mfma_f32_16x16x32_bf16 v[40:43], v[88:91], v[76:79], v[40:43]
    ds_read_b128 v[68:71], v8 offset:22528
    ds_read_b128 v[72:75], v8 offset:24576
    v_mfma_f32_16x16x32_bf16 v[44:47], v[92:95], v[76:79], v[44:47]
    v_mfma_f32_16x16x32_bf16 v[48:51], v[96:99], v[76:79], v[48:51]
    s_waitcnt lgkmcnt(0)
    v_mfma_f32_16x16x32_bf16 v[32:35], v[56:59], v[52:55], v[32:35]
    ds_read_b128 v[76:79], v5 offset:9216
    ds_read_b128 v[80:83], v8 offset:17408
    v_mfma_f32_16x16x32_bf16 v[36:39], v[60:63], v[52:55], v[36:39]
    ds_read_b128 v[84:87], v8 offset:19456
    ds_read_b128 v[88:91], v8 offset:21504
    v_mfma_f32_16x16x32_bf16 v[40:43], v[64:67], v[52:55], v[40:43]
    ds_read_b128 v[92:95], v8 offset:23552
    ds_read_b128 v[96:99], v8 offset:25600
    v_mfma_f32_16x16x32_bf16 v[44:47], v[68:71], v[52:55], v[44:47]
    v_mfma_f32_16x16x32_bf16 v[48:51], v[72:75], v[52:55], v[48:51]
    s_waitcnt lgkmcnt(0)
    s_barrier
    v_mfma_f32_16x16x32_bf16 v[32:35], v[80:83], v[76:79], v[32:35]
    ds_read_b128 v[52:55], v5 offset:26624
    ds_read_b128 v[56:59], v8 offset:34816
    v_mfma_f32_16x16x32_bf16 v[36:39], v[84:87], v[76:79], v[36:39]
    ds_read_b128 v[60:63], v8 offset:36864
    ds_read_b128 v[64:67], v8 offset:38912
    v_mfma_f32_16x16x32_bf16 v[40:43], v[88:91], v[76:79], v[40:43]
    ds_read_b128 v[68:71], v8 offset:40960
    ds_read_b128 v[72:75], v8 offset:43008
    v_mfma_f32_16x16x32_bf16 v[44:47], v[92:95], v[76:79], v[44:47]
    v_mfma_f32_16x16x32_bf16 v[48:51], v[96:99], v[76:79], v[48:51]
    s_waitcnt lgkmcnt(0)
    v_mfma_f32_16x16x32_bf16 v[32:35], v[56:59], v[52:55], v[32:35]
    ds_read_b128 v[76:79], v5 offset:27648
    ds_read_b128 v[80:83], v8 offset:35840
    v_mfma_f32_16x16x32_bf16 v[36:39], v[60:63], v[52:55], v[36:39]
    ds_read_b128 v[84:87], v8 offset:37888
    ds_read_b128 v[88:91], v8 offset:39936
    v_mfma_f32_16x16x32_bf16 v[40:43], v[64:67], v[52:55], v[40:43]
    ds_read_b128 v[92:95], v8 offset:41984
    ds_read_b128 v[96:99], v8 offset:44032
    v_mfma_f32_16x16x32_bf16 v[44:47], v[68:71], v[52:55], v[44:47]
    v_mfma_f32_16x16x32_bf16 v[48:51], v[72:75], v[52:55], v[48:51]
    s_waitcnt lgkmcnt(0)
    s_barrier
    v_mfma_f32_16x16x32_bf16 v[32:35], v[80:83], v[76:79], v[32:35]
    ds_read_b128 v[52:55], v5 offset:45056
    ds_read_b128 v[56:59], v8 offset:53248
    v_mfma_f32_16x16x32_bf16 v[36:39], v[84:87], v[76:79], v[36:39]
    ds_read_b128 v[60:63], v8 offset:55296
    ds_read_b128 v[64:67], v8 offset:57344
    v_mfma_f32_16x16x32_bf16 v[40:43], v[88:91], v[76:79], v[40:43]
    ds_read_b128 v[68:71], v8 offset:59392
    ds_read_b128 v[72:75], v8 offset:61440
    v_mfma_f32_16x16x32_bf16 v[44:47], v[92:95], v[76:79], v[44:47]
    v_mfma_f32_16x16x32_bf16 v[48:51], v[96:99], v[76:79], v[48:51]
    s_waitcnt lgkmcnt(0)
    v_mfma_f32_16x16x32_bf16 v[32:35], v[56:59], v[52:55], v[32:35]
    ds_read_b128 v[76:79], v5 offset:46080
    ds_read_b128 v[80:83], v8 offset:54272
    v_mfma_f32_16x16x32_bf16 v[36:39], v[60:63], v[52:55], v[36:39]
    ds_read_b128 v[84:87], v8 offset:56320
    ds_read_b128 v[88:91], v8 offset:58368
    v_mfma_f32_16x16x32_bf16 v[40:43], v[64:67], v[52:55], v[40:43]
    ds_read_b128 v[92:95], v8 offset:60416
    ds_read_b128 v[96:99], v8 offset:62464
    v_mfma_f32_16x16x32_bf16 v[44:47], v[68:71], v[52:55], v[44:47]
    v_mfma_f32_16x16x32_bf16 v[48:51], v[72:75], v[52:55], v[48:51]
    s_waitcnt lgkmcnt(0)
    s_barrier
    v_mfma_f32_16x16x32_bf16 v[32:35], v[80:83], v[76:79], v[32:35]
    ds_read_b128 v[52:55], v5 offset:63488
    ds_read_b128 v[56:59], v9 offset:6144
    v_mfma_f32_16x16x32_bf16 v[36:39], v[84:87], v[76:79], v[36:39]
    ds_read_b128 v[60:63], v9 offset:8192
    ds_read_b128 v[64:67], v9 offset:10240
    v_mfma_f32_16x16x32_bf16 v[40:43], v[88:91], v[76:79], v[40:43]
    ds_read_b128 v[68:71], v9 offset:12288
    ds_read_b128 v[72:75], v9 offset:14336
    v_mfma_f32_16x16x32_bf16 v[44:47], v[92:95], v[76:79], v[44:47]
    v_mfma_f32_16x16x32_bf16 v[48:51], v[96:99], v[76:79], v[48:51]
    s_waitcnt lgkmcnt(0)
    v_mfma_f32_16x16x32_bf16 v[32:35], v[56:59], v[52:55], v[32:35]
    ds_read_b128 v[76:79], v5 offset:64512
    ds_read_b128 v[80:83], v9 offset:7168
    v_mfma_f32_16x16x32_bf16 v[36:39], v[60:63], v[52:55], v[36:39]
    ds_read_b128 v[84:87], v9 offset:9216
    ds_read_b128 v[88:91], v9 offset:11264
    v_mfma_f32_16x16x32_bf16 v[40:43], v[64:67], v[52:55], v[40:43]
    ds_read_b128 v[92:95], v9 offset:13312
    ds_read_b128 v[96:99], v9 offset:15360
    v_mfma_f32_16x16x32_bf16 v[44:47], v[68:71], v[52:55], v[44:47]
    v_mfma_f32_16x16x32_bf16 v[48:51], v[72:75], v[52:55], v[48:51]
    s_waitcnt lgkmcnt(0)
    s_barrier
    v_mfma_f32_16x16x32_bf16 v[32:35], v[80:83], v[76:79], v[32:35]
    ds_read_b128 v[52:55], v4 offset:0
    ds_read_b128 v[56:59], v7 offset:8192
    v_mfma_f32_16x16x32_bf16 v[36:39], v[84:87], v[76:79], v[36:39]
    ds_read_b128 v[60:63], v7 offset:10240
    ds_read_b128 v[64:67], v7 offset:12288
    v_mfma_f32_16x16x32_bf16 v[40:43], v[88:91], v[76:79], v[40:43]
    ds_read_b128 v[68:71], v7 offset:14336
    ds_read_b128 v[72:75], v7 offset:16384
    v_mfma_f32_16x16x32_bf16 v[44:47], v[92:95], v[76:79], v[44:47]
    v_mfma_f32_16x16x32_bf16 v[48:51], v[96:99], v[76:79], v[48:51]
    s_waitcnt lgkmcnt(0)
    v_mfma_f32_16x16x32_bf16 v[32:35], v[56:59], v[52:55], v[32:35]
    ds_read_b128 v[76:79], v4 offset:1024
    ds_read_b128 v[80:83], v7 offset:9216
    v_mfma_f32_16x16x32_bf16 v[36:39], v[60:63], v[52:55], v[36:39]
    ds_read_b128 v[84:87], v7 offset:11264
    ds_read_b128 v[88:91], v7 offset:13312
    v_mfma_f32_16x16x32_bf16 v[40:43], v[64:67], v[52:55], v[40:43]
    ds_read_b128 v[92:95], v7 offset:15360
    ds_read_b128 v[96:99], v7 offset:17408
    v_mfma_f32_16x16x32_bf16 v[44:47], v[68:71], v[52:55], v[44:47]
    v_mfma_f32_16x16x32_bf16 v[48:51], v[72:75], v[52:55], v[48:51]
    s_waitcnt lgkmcnt(0)
    s_barrier
    v_mfma_f32_16x16x32_bf16 v[32:35], v[80:83], v[76:79], v[32:35]
    ds_read_b128 v[52:55], v4 offset:18432
    ds_read_b128 v[56:59], v7 offset:26624
    v_mfma_f32_16x16x32_bf16 v[36:39], v[84:87], v[76:79], v[36:39]
    ds_read_b128 v[60:63], v7 offset:28672
    ds_read_b128 v[64:67], v7 offset:30720
    v_mfma_f32_16x16x32_bf16 v[40:43], v[88:91], v[76:79], v[40:43]
    ds_read_b128 v[68:71], v7 offset:32768
    ds_read_b128 v[72:75], v7 offset:34816
    v_mfma_f32_16x16x32_bf16 v[44:47], v[92:95], v[76:79], v[44:47]
    v_mfma_f32_16x16x32_bf16 v[48:51], v[96:99], v[76:79], v[48:51]
    s_waitcnt lgkmcnt(0)
    v_mfma_f32_16x16x32_bf16 v[32:35], v[56:59], v[52:55], v[32:35]
    ds_read_b128 v[76:79], v4 offset:19456
    ds_read_b128 v[80:83], v7 offset:27648
    v_mfma_f32_16x16x32_bf16 v[36:39], v[60:63], v[52:55], v[36:39]
    ds_read_b128 v[84:87], v7 offset:29696
    ds_read_b128 v[88:91], v7 offset:31744
    v_mfma_f32_16x16x32_bf16 v[40:43], v[64:67], v[52:55], v[40:43]
    ds_read_b128 v[92:95], v7 offset:33792
    ds_read_b128 v[96:99], v7 offset:35840
    v_mfma_f32_16x16x32_bf16 v[44:47], v[68:71], v[52:55], v[44:47]
    v_mfma_f32_16x16x32_bf16 v[48:51], v[72:75], v[52:55], v[48:51]
    s_waitcnt lgkmcnt(0)
    v_mfma_f32_16x16x32_bf16 v[32:35], v[80:83], v[76:79], v[32:35]
    v_mfma_f32_16x16x32_bf16 v[36:39], v[84:87], v[76:79], v[36:39]
    v_mfma_f32_16x16x32_bf16 v[40:43], v[88:91], v[76:79], v[40:43]
    v_mfma_f32_16x16x32_bf16 v[44:47], v[92:95], v[76:79], v[44:47]
    v_mfma_f32_16x16x32_bf16 v[48:51], v[96:99], v[76:79], v[48:51]
    s_waitcnt vmcnt(0)
    v_mov_b32 v20, 0
    v_mov_b32 v21, 0
    s_nop 0
    v_cvt_pk_bf16_f32 v32, v32, v33
    v_cvt_pk_bf16_f32 v34, v34, v35
    v_and_b32 v33, 0xffff0000, v32
    v_lshlrev_b32 v32, 16, v32
    v_and_b32 v35, 0xffff0000, v34
    v_lshlrev_b32 v34, 16, v34
    v_lshlrev_b32 v22, 16, v10
    v_and_b32 v23, 0xffff0000, v10
    v_add_f32 v32, v32, v22
    v_add_f32 v33, v33, v23
    v_lshlrev_b32 v22, 16, v11
    v_and_b32 v23, 0xffff0000, v11
    v_add_f32 v34, v34, v22
    v_add_f32 v35, v35, v23
    v_cvt_pk_bf16_f32 v10, v32, v33
    v_cvt_pk_bf16_f32 v11, v34, v35
    s_add_u32 s22, s40, 12582912
    buffer_store_dwordx2 v[10:11], v3, s[4:7], s22 offen
    v_lshlrev_b32 v22, 16, v10
    v_and_b32 v23, 0xffff0000, v10
    v_add_f32 v20, v20, v22
    v_fma_f32 v21, v22, v22, v21
    v_add_f32 v20, v20, v23
    v_fma_f32 v21, v23, v23, v21
    v_lshlrev_b32 v22, 16, v11
    v_and_b32 v23, 0xffff0000, v11
    v_add_f32 v20, v20, v22
    v_fma_f32 v21, v22, v22, v21
    v_add_f32 v20, v20, v23
    v_fma_f32 v21, v23, v23, v21
    v_cvt_pk_bf16_f32 v36, v36, v37
    v_cvt_pk_bf16_f32 v38, v38, v39
    v_and_b32 v37, 0xffff0000, v36
    v_lshlrev_b32 v36, 16, v36
    v_and_b32 v39, 0xffff0000, v38
    v_lshlrev_b32 v38, 16, v38
    v_lshlrev_b32 v22, 16, v12
    v_and_b32 v23, 0xffff0000, v12
    v_add_f32 v36, v36, v22
    v_add_f32 v37, v37, v23
    v_lshlrev_b32 v22, 16, v13
    v_and_b32 v23, 0xffff0000, v13
    v_add_f32 v38, v38, v22
    v_add_f32 v39, v39, v23
    v_cvt_pk_bf16_f32 v12, v36, v37
    v_cvt_pk_bf16_f32 v13, v38, v39
    s_add_u32 s22, s41, 12582912
    buffer_store_dwordx2 v[12:13], v3, s[4:7], s22 offen
    v_lshlrev_b32 v22, 16, v12
    v_and_b32 v23, 0xffff0000, v12
    v_add_f32 v20, v20, v22
    v_fma_f32 v21, v22, v22, v21
    v_add_f32 v20, v20, v23
    v_fma_f32 v21, v23, v23, v21
    v_lshlrev_b32 v22, 16, v13
    v_and_b32 v23, 0xffff0000, v13
    v_add_f32 v20, v20, v22
    v_fma_f32 v21, v22, v22, v21
    v_add_f32 v20, v20, v23
    v_fma_f32 v21, v23, v23, v21
    v_cvt_pk_bf16_f32 v40, v40, v41
    v_cvt_pk_bf16_f32 v42, v42, v43
    v_and_b32 v41, 0xffff0000, v40
    v_lshlrev_b32 v40, 16, v40
    v_and_b32 v43, 0xffff0000, v42
    v_lshlrev_b32 v42, 16, v42
    v_lshlrev_b32 v22, 16, v14
    v_and_b32 v23, 0xffff0000, v14
    v_add_f32 v40, v40, v22
    v_add_f32 v41, v41, v23
    v_lshlrev_b32 v22, 16, v15
    v_and_b32 v23, 0xffff0000, v15
    v_add_f32 v42, v42, v22
    v_add_f32 v43, v43, v23
    v_cvt_pk_bf16_f32 v14, v40, v41
    v_cvt_pk_bf16_f32 v15, v42, v43
    s_add_u32 s22, s42, 12582912
    buffer_store_dwordx2 v[14:15], v3, s[4:7], s22 offen
    v_lshlrev_b32 v22, 16, v14
    v_and_b32 v23, 0xffff0000, v14
    v_add_f32 v20, v20, v22
    v_fma_f32 v21, v22, v22, v21
    v_add_f32 v20, v20, v23
    v_fma_f32 v21, v23, v23, v21
    v_lshlrev_b32 v22, 16, v15
    v_and_b32 v23, 0xffff0000, v15
    v_add_f32 v20, v20, v22
    v_fma_f32 v21, v22, v22, v21
    v_add_f32 v20, v20, v23
    v_fma_f32 v21, v23, v23, v21
    v_cvt_pk_bf16_f32 v44, v44, v45
    v_cvt_pk_bf16_f32 v46, v46, v47
    v_and_b32 v45, 0xffff0000, v44
    v_lshlrev_b32 v44, 16, v44
    v_and_b32 v47, 0xffff0000, v46
    v_lshlrev_b32 v46, 16, v46
    v_lshlrev_b32 v22, 16, v16
    v_and_b32 v23, 0xffff0000, v16
    v_add_f32 v44, v44, v22
    v_add_f32 v45, v45, v23
    v_lshlrev_b32 v22, 16, v17
    v_and_b32 v23, 0xffff0000, v17
    v_add_f32 v46, v46, v22
    v_add_f32 v47, v47, v23
    v_cvt_pk_bf16_f32 v16, v44, v45
    v_cvt_pk_bf16_f32 v17, v46, v47
    s_add_u32 s22, s43, 12582912
    buffer_store_dwordx2 v[16:17], v3, s[4:7], s22 offen
    v_lshlrev_b32 v22, 16, v16
    v_and_b32 v23, 0xffff0000, v16
    v_add_f32 v20, v20, v22
    v_fma_f32 v21, v22, v22, v21
    v_add_f32 v20, v20, v23
    v_fma_f32 v21, v23, v23, v21
    v_lshlrev_b32 v22, 16, v17
    v_and_b32 v23, 0xffff0000, v17
    v_add_f32 v20, v20, v22
    v_fma_f32 v21, v22, v22, v21
    v_add_f32 v20, v20, v23
    v_fma_f32 v21, v23, v23, v21
    v_cvt_pk_bf16_f32 v48, v48, v49
    v_cvt_pk_bf16_f32 v50, v50, v51
    v_and_b32 v49, 0xffff0000, v48
    v_lshlrev_b32 v48, 16, v48
    v_and_b32 v51, 0xffff0000, v50
    v_lshlrev_b32 v50, 16, v50
    v_lshlrev_b32 v22, 16, v18
    v_and_b32 v23, 0xffff0000, v18
    v_add_f32 v48, v48, v22
    v_add_f32 v49, v49, v23
    v_lshlrev_b32 v22, 16, v19
    v_and_b32 v23, 0xffff0000, v19
    v_add_f32 v50, v50, v22
    v_add_f32 v51, v51, v23
    v_cvt_pk_bf16_f32 v18, v48, v49
    v_cvt_pk_bf16_f32 v19, v50, v51
    s_add_u32 s22, s44, 12582912
    buffer_store_dwordx2 v[18:19], v3, s[4:7], s22 offen
    v_lshlrev_b32 v22, 16, v18
    v_and_b32 v23, 0xffff0000, v18
    v_add_f32 v20, v20, v22
    v_fma_f32 v21, v22, v22, v21
    v_add_f32 v20, v20, v23
    v_fma_f32 v21, v23, v23, v21
    v_lshlrev_b32 v22, 16, v19
    v_and_b32 v23, 0xffff0000, v19
    v_add_f32 v20, v20, v22
    v_fma_f32 v21, v22, v22, v21
    v_add_f32 v20, v20, v23
    v_fma_f32 v21, v23, v23, v21
    v_mov_b32 v22, v20
    s_nop 1
    v_permlane16_swap_b32 v22, v20
    v_add_f32 v20, v20, v22
    v_mov_b32 v22, v21
    s_nop 1
    v_permlane16_swap_b32 v22, v21
    v_add_f32 v21, v21, v22
    v_mov_b32 v22, v20
    s_nop 1
    v_permlane32_swap_b32 v22, v20
    v_add_f32 v20, v20, v22
    v_mov_b32 v22, v21
    s_nop 1
    v_permlane32_swap_b32 v22, v21
    v_add_f32 v21, v21, v22
    v_lshlrev_b32 v22, 6, v1
    s_lshl_b32 s22, s17, 10
    s_lshl_b32 s23, s14, 3
    s_add_u32 s22, s22, s23
    s_add_u32 s22, s22, 22151168
    s_mov_b64 exec, 0xffff
    buffer_store_dwordx2 v[20:21], v22, s[4:7], s22 offen
wo1_kernel_end:
    s_endpgm

.text
.globl gu1_kernel
.p2align 8
.type gu1_kernel,@function
gu1_kernel:
    s_cmp_ge_u32 s2, 256
    s_cbranch_scc1 gu1_kernel_end
    s_load_dwordx2 s[4:5], s[0:1], 72
    v_lshrrev_b32 v2, 6, v0
    s_nop 0
    v_readfirstlane_b32 s12, v2
    v_and_b32 v1, 63, v0
    v_lshlrev_b32 v3, 4, v1
    s_and_b32 s17, s2, 7
    s_lshr_b32 s18, s2, 3
    s_and_b32 s19, s17, 3
    s_lshr_b32 s17, s17, 2
    s_mul_i32 s19, s19, 32
    s_add_u32 s18, s18, s19
    s_and_b32 s13, s18, 7
    s_lshl_b32 s17, s17, 3
    s_add_u32 s13, s13, s17
    s_lshr_b32 s14, s18, 3
    s_cmp_lt_u32 s12, 4
    s_cbranch_scc1 gu1_kernel_comp
    s_sub_u32 s12, s12, 4
    s_add_u32 s18, s12, 0
    s_mul_i32 s56, s18, 2048
    s_mul_i32 s20, s13, 8
    s_add_u32 s20, s20, s18
    s_mul_i32 s20, s20, 20480
    s_add_u32 s20, s20, 12582912
    s_mul_i32 s21, s14, 12
    s_add_u32 s21, s21, s18
    s_sub_u32 s21, s21, 8
    s_mul_i32 s21, s21, 20480
    s_add_u32 s21, s21, 3342336
    s_cmp_lt_u32 s18, 8
    s_cselect_b32 s24, s20, s21
    s_add_u32 s18, s12, 2
    s_mul_i32 s57, s18, 2048
    s_mul_i32 s20, s13, 8
    s_add_u32 s20, s20, s18
    s_mul_i32 s20, s20, 20480
    s_add_u32 s20, s20, 12582912
    s_mul_i32 s21, s14, 12
    s_add_u32 s21, s21, s18
    s_sub_u32 s21, s21, 8
    s_mul_i32 s21, s21, 20480
    s_add_u32 s21, s21, 3342336
    s_cmp_lt_u32 s18, 8
    s_cselect_b32 s25, s20, s21
    s_add_u32 s18, s12, 4
    s_mul_i32 s58, s18, 2048
    s_mul_i32 s20, s13, 8
    s_add_u32 s20, s20, s18
    s_mul_i32 s20, s20, 20480
    s_add_u32 s20, s20, 12582912
    s_mul_i32 s21, s14, 12
    s_add_u32 s21, s21, s18
    s_sub_u32 s21, s21, 8
    s_mul_i32 s21, s21, 20480
    s_add_u32 s21, s21, 3342336
    s_cmp_lt_u32 s18, 8
    s_cselect_b32 s26, s20, s21
    s_add_u32 s18, s12, 6
    s_mul_i32 s59, s18, 2048
    s_mul_i32 s20, s13, 8
    s_add_u32 s20, s20, s18
    s_mul_i32 s20, s20, 20480
    s_add_u32 s20, s20, 12582912
    s_mul_i32 s21, s14, 12
    s_add_u32 s21, s21, s18
    s_sub_u32 s21, s21, 8
    s_mul_i32 s21, s21, 20480
    s_add_u32 s21, s21, 3342336
    s_cmp_lt_u32 s18, 8
    s_cselect_b32 s27, s20, s21
    s_add_u32 s18, s12, 8
    s_mul_i32 s60, s18, 2048
    s_mul_i32 s20, s13, 8
    s_add_u32 s20, s20, s18
    s_mul_i32 s20, s20, 20480
    s_add_u32 s20, s20, 12582912
    s_mul_i32 s21, s14, 12
    s_add_u32 s21, s21, s18
    s_sub_u32 s21, s21, 8
    s_mul_i32 s21, s21, 20480
    s_add_u32 s21, s21, 3342336
    s_cmp_lt_u32 s18, 8
    s_cselect_b32 s28, s20, s21
    s_add_u32 s18, s12, 10
    s_mul_i32 s61, s18, 2048
    s_mul_i32 s20, s13, 8
    s_add_u32 s20, s20, s18
    s_mul_i32 s20, s20, 20480
    s_add_u32 s20, s20, 12582912
    s_mul_i32 s21, s14, 12
    s_add_u32 s21, s21, s18
    s_sub_u32 s21, s21, 8
    s_mul_i32 s21, s21, 20480
    s_add_u32 s21, s21, 3342336
    s_cmp_lt_u32 s18, 8
    s_cselect_b32 s29, s20, s21
    s_add_u32 s18, s12, 12
    s_mul_i32 s62, s18, 2048
    s_mul_i32 s20, s13, 8
    s_add_u32 s20, s20, s18
    s_mul_i32 s20, s20, 20480
    s_add_u32 s20, s20, 12582912
    s_mul_i32 s21, s14, 12
    s_add_u32 s21, s21, s18
    s_sub_u32 s21, s21, 8
    s_mul_i32 s21, s21, 20480
    s_add_u32 s21, s21, 3342336
    s_cmp_lt_u32 s18, 8
    s_cselect_b32 s30, s20, s21
    s_add_u32 s18, s12, 14
    s_mul_i32 s63, s18, 2048
    s_mul_i32 s20, s13, 8
    s_add_u32 s20, s20, s18
    s_mul_i32 s20, s20, 20480
    s_add_u32 s20, s20, 12582912
    s_mul_i32 s21, s14, 12
    s_add_u32 s21, s21, s18
    s_sub_u32 s21, s21, 8
    s_mul_i32 s21, s21, 20480
    s_add_u32 s21, s21, 3342336
    s_cmp_lt_u32 s18, 8
    s_cselect_b32 s31, s20, s21
    s_add_u32 s18, s12, 16
    s_mul_i32 s64, s18, 2048
    s_mul_i32 s20, s13, 8
    s_add_u32 s20, s20, s18
    s_mul_i32 s20, s20, 20480
    s_add_u32 s20, s20, 12582912
    s_mul_i32 s21, s14, 12
    s_add_u32 s21, s21, s18
    s_sub_u32 s21, s21, 8
    s_mul_i32 s21, s21, 20480
    s_add_u32 s21, s21, 3342336
    s_cmp_lt_u32 s18, 8
    s_cselect_b32 s32, s20, s21
    s_add_u32 s18, s12, 18
    s_mul_i32 s65, s18, 2048
    s_mul_i32 s20, s13, 8
    s_add_u32 s20, s20, s18
    s_mul_i32 s20, s20, 20480
    s_add_u32 s20, s20, 12582912
    s_mul_i32 s21, s14, 12
    s_add_u32 s21, s21, s18
    s_sub_u32 s21, s21, 8
    s_mul_i32 s21, s21, 20480
    s_add_u32 s21, s21, 3342336
    s_cmp_lt_u32 s18, 8
    s_cselect_b32 s33, s20, s21
    s_waitcnt lgkmcnt(0)
    s_and_b32 s5, s5, 0xffff
    s_mov_b32 s6, 268435456
    s_mov_b32 s7, 0x00020000
    s_add_u32 m0, s56, 0
    s_add_u32 s22, s24, 0
    buffer_load_dwordx4 v3, s[4:7], s22 offen offset:0 lds
    buffer_load_dwordx4 v3, s[4:7], s22 offen offset:1024 lds
    s_add_u32 m0, s57, 0
    s_add_u32 s23, s25, 0
    buffer_load_dwordx4 v3, s[4:7], s23 offen offset:0 lds
    buffer_load_dwordx4 v3, s[4:7], s23 offen offset:1024 lds
    s_add_u32 m0, s58, 0
    s_add_u32 s22, s26, 0
    buffer_load_dwordx4 v3, s[4:7], s22 offen offset:0 lds
    buffer_load_dwordx4 v3, s[4:7], s22 offen offset:1024 lds
    s_add_u32 m0, s59, 0
    s_add_u32 s23, s27, 0
    buffer_load_dwordx4 v3, s[4:7], s23 offen offset:0 lds
    buffer_load_dwordx4 v3, s[4:7], s23 offen offset:1024 lds
    s_add_u32 m0, s60, 0
    s_add_u32 s22, s28, 0
    buffer_load_dwordx4 v3, s[4:7], s22 offen offset:0 lds
    buffer_load_dwordx4 v3, s[4:7], s22 offen offset:1024 lds
    s_add_u32 m0, s61, 0
    s_add_u32 s23, s29, 0
    buffer_load_dwordx4 v3, s[4:7], s23 offen offset:0 lds
    buffer_load_dwordx4 v3, s[4:7], s23 offen offset:1024 lds
    s_add_u32 m0, s62, 0
    s_add_u32 s22, s30, 0
    buffer_load_dwordx4 v3, s[4:7], s22 offen offset:0 lds
    buffer_load_dwordx4 v3, s[4:7], s22 offen offset:1024 lds
    s_add_u32 m0, s63, 0
    s_add_u32 s23, s31, 0
    buffer_load_dwordx4 v3, s[4:7], s23 offen offset:0 lds
    buffer_load_dwordx4 v3, s[4:7], s23 offen offset:1024 lds
    s_add_u32 m0, s64, 0
    s_add_u32 s22, s32, 0
    buffer_load_dwordx4 v3, s[4:7], s22 offen offset:0 lds
    buffer_load_dwordx4 v3, s[4:7], s22 offen offset:1024 lds
    s_add_u32 m0, s65, 0
    s_add_u32 s23, s33, 0
    buffer_load_dwordx4 v3, s[4:7], s23 offen offset:0 lds
    buffer_load_dwordx4 v3, s[4:7], s23 offen offset:1024 lds
    s_add_u32 m0, s56, 40960
    s_add_u32 s22, s24, 2048
    buffer_load_dwordx4 v3, s[4:7], s22 offen offset:0 lds
    buffer_load_dwordx4 v3, s[4:7], s22 offen offset:1024 lds
    s_add_u32 m0, s57, 40960
    s_add_u32 s23, s25, 2048
    buffer_load_dwordx4 v3, s[4:7], s23 offen offset:0 lds
    buffer_load_dwordx4 v3, s[4:7], s23 offen offset:1024 lds
    s_add_u32 m0, s58, 40960
    s_add_u32 s22, s26, 2048
    buffer_load_dwordx4 v3, s[4:7], s22 offen offset:0 lds
    buffer_load_dwordx4 v3, s[4:7], s22 offen offset:1024 lds
    s_add_u32 m0, s59, 40960
    s_add_u32 s23, s27, 2048
    buffer_load_dwordx4 v3, s[4:7], s23 offen offset:0 lds
    buffer_load_dwordx4 v3, s[4:7], s23 offen offset:1024 lds
    s_add_u32 m0, s60, 40960
    s_add_u32 s22, s28, 2048
    buffer_load_dwordx4 v3, s[4:7], s22 offen offset:0 lds
    buffer_load_dwordx4 v3, s[4:7], s22 offen offset:1024 lds
    s_add_u32 m0, s61, 40960
    s_add_u32 s23, s29, 2048
    buffer_load_dwordx4 v3, s[4:7], s23 offen offset:0 lds
    buffer_load_dwordx4 v3, s[4:7], s23 offen offset:1024 lds
    s_add_u32 m0, s62, 40960
    s_add_u32 s22, s30, 2048
    buffer_load_dwordx4 v3, s[4:7], s22 offen offset:0 lds
    buffer_load_dwordx4 v3, s[4:7], s22 offen offset:1024 lds
    s_add_u32 m0, s63, 40960
    s_add_u32 s23, s31, 2048
    buffer_load_dwordx4 v3, s[4:7], s23 offen offset:0 lds
    buffer_load_dwordx4 v3, s[4:7], s23 offen offset:1024 lds
    s_add_u32 m0, s64, 40960
    s_add_u32 s22, s32, 2048
    buffer_load_dwordx4 v3, s[4:7], s22 offen offset:0 lds
    buffer_load_dwordx4 v3, s[4:7], s22 offen offset:1024 lds
    s_add_u32 m0, s65, 40960
    s_add_u32 s23, s33, 2048
    buffer_load_dwordx4 v3, s[4:7], s23 offen offset:0 lds
    buffer_load_dwordx4 v3, s[4:7], s23 offen offset:1024 lds
    s_waitcnt vmcnt(20)
    s_barrier
    s_add_u32 m0, s56, 81920
    s_add_u32 s22, s24, 4096
    buffer_load_dwordx4 v3, s[4:7], s22 offen offset:0 lds
    buffer_load_dwordx4 v3, s[4:7], s22 offen offset:1024 lds
    s_add_u32 m0, s57, 81920
    s_add_u32 s23, s25, 4096
    buffer_load_dwordx4 v3, s[4:7], s23 offen offset:0 lds
    buffer_load_dwordx4 v3, s[4:7], s23 offen offset:1024 lds
    s_add_u32 m0, s58, 81920
    s_add_u32 s22, s26, 4096
    buffer_load_dwordx4 v3, s[4:7], s22 offen offset:0 lds
    buffer_load_dwordx4 v3, s[4:7], s22 offen offset:1024 lds
    s_add_u32 m0, s59, 81920
    s_add_u32 s23, s27, 4096
    buffer_load_dwordx4 v3, s[4:7], s23 offen offset:0 lds
    buffer_load_dwordx4 v3, s[4:7], s23 offen offset:1024 lds
    s_add_u32 m0, s60, 81920
    s_add_u32 s22, s28, 4096
    buffer_load_dwordx4 v3, s[4:7], s22 offen offset:0 lds
    buffer_load_dwordx4 v3, s[4:7], s22 offen offset:1024 lds
    s_add_u32 m0, s61, 81920
    s_add_u32 s23, s29, 4096
    buffer_load_dwordx4 v3, s[4:7], s23 offen offset:0 lds
    buffer_load_dwordx4 v3, s[4:7], s23 offen offset:1024 lds
    s_add_u32 m0, s62, 81920
    s_add_u32 s22, s30, 4096
    buffer_load_dwordx4 v3, s[4:7], s22 offen offset:0 lds
    buffer_load_dwordx4 v3, s[4:7], s22 offen offset:1024 lds
    s_add_u32 m0, s63, 81920
    s_add_u32 s23, s31, 4096
    buffer_load_dwordx4 v3, s[4:7], s23 offen offset:0 lds
    buffer_load_dwordx4 v3, s[4:7], s23 offen offset:1024 lds
    s_add_u32 m0, s64, 81920
    s_add_u32 s22, s32, 4096
    buffer_load_dwordx4 v3, s[4:7], s22 offen offset:0 lds
    buffer_load_dwordx4 v3, s[4:7], s22 offen offset:1024 lds
    s_add_u32 m0, s65, 81920
    s_add_u32 s23, s33, 4096
    buffer_load_dwordx4 v3, s[4:7], s23 offen offset:0 lds
    buffer_load_dwordx4 v3, s[4:7], s23 offen offset:1024 lds
    s_waitcnt vmcnt(20)
    s_barrier
    s_add_u32 m0, s56, 0
    s_add_u32 s22, s24, 6144
    buffer_load_dwordx4 v3, s[4:7], s22 offen offset:0 lds
    buffer_load_dwordx4 v3, s[4:7], s22 offen offset:1024 lds
    s_add_u32 m0, s57, 0
    s_add_u32 s23, s25, 6144
    buffer_load_dwordx4 v3, s[4:7], s23 offen offset:0 lds
    buffer_load_dwordx4 v3, s[4:7], s23 offen offset:1024 lds
    s_add_u32 m0, s58, 0
    s_add_u32 s22, s26, 6144
    buffer_load_dwordx4 v3, s[4:7], s22 offen offset:0 lds
    buffer_load_dwordx4 v3, s[4:7], s22 offen offset:1024 lds
    s_add_u32 m0, s59, 0
    s_add_u32 s23, s27, 6144
    buffer_load_dwordx4 v3, s[4:7], s23 offen offset:0 lds
    buffer_load_dwordx4 v3, s[4:7], s23 offen offset:1024 lds
    s_add_u32 m0, s60, 0
    s_add_u32 s22, s28, 6144
    buffer_load_dwordx4 v3, s[4:7], s22 offen offset:0 lds
    buffer_load_dwordx4 v3, s[4:7], s22 offen offset:1024 lds
    s_add_u32 m0, s61, 0
    s_add_u32 s23, s29, 6144
    buffer_load_dwordx4 v3, s[4:7], s23 offen offset:0 lds
    buffer_load_dwordx4 v3, s[4:7], s23 offen offset:1024 lds
    s_add_u32 m0, s62, 0
    s_add_u32 s22, s30, 6144
    buffer_load_dwordx4 v3, s[4:7], s22 offen offset:0 lds
    buffer_load_dwordx4 v3, s[4:7], s22 offen offset:1024 lds
    s_add_u32 m0, s63, 0
    s_add_u32 s23, s31, 6144
    buffer_load_dwordx4 v3, s[4:7], s23 offen offset:0 lds
    buffer_load_dwordx4 v3, s[4:7], s23 offen offset:1024 lds
    s_add_u32 m0, s64, 0
    s_add_u32 s22, s32, 6144
    buffer_load_dwordx4 v3, s[4:7], s22 offen offset:0 lds
    buffer_load_dwordx4 v3, s[4:7], s22 offen offset:1024 lds
    s_add_u32 m0, s65, 0
    s_add_u32 s23, s33, 6144
    buffer_load_dwordx4 v3, s[4:7], s23 offen offset:0 lds
    buffer_load_dwordx4 v3, s[4:7], s23 offen offset:1024 lds
    s_waitcnt vmcnt(20)
    s_barrier
    s_add_u32 m0, s56, 40960
    s_add_u32 s22, s24, 8192
    buffer_load_dwordx4 v3, s[4:7], s22 offen offset:0 lds
    buffer_load_dwordx4 v3, s[4:7], s22 offen offset:1024 lds
    s_add_u32 m0, s57, 40960
    s_add_u32 s23, s25, 8192
    buffer_load_dwordx4 v3, s[4:7], s23 offen offset:0 lds
    buffer_load_dwordx4 v3, s[4:7], s23 offen offset:1024 lds
    s_add_u32 m0, s58, 40960
    s_add_u32 s22, s26, 8192
    buffer_load_dwordx4 v3, s[4:7], s22 offen offset:0 lds
    buffer_load_dwordx4 v3, s[4:7], s22 offen offset:1024 lds
    s_add_u32 m0, s59, 40960
    s_add_u32 s23, s27, 8192
    buffer_load_dwordx4 v3, s[4:7], s23 offen offset:0 lds
    buffer_load_dwordx4 v3, s[4:7], s23 offen offset:1024 lds
    s_add_u32 m0, s60, 40960
    s_add_u32 s22, s28, 8192
    buffer_load_dwordx4 v3, s[4:7], s22 offen offset:0 lds
    buffer_load_dwordx4 v3, s[4:7], s22 offen offset:1024 lds
    s_add_u32 m0, s61, 40960
    s_add_u32 s23, s29, 8192
    buffer_load_dwordx4 v3, s[4:7], s23 offen offset:0 lds
    buffer_load_dwordx4 v3, s[4:7], s23 offen offset:1024 lds
    s_add_u32 m0, s62, 40960
    s_add_u32 s22, s30, 8192
    buffer_load_dwordx4 v3, s[4:7], s22 offen offset:0 lds
    buffer_load_dwordx4 v3, s[4:7], s22 offen offset:1024 lds
    s_add_u32 m0, s63, 40960
    s_add_u32 s23, s31, 8192
    buffer_load_dwordx4 v3, s[4:7], s23 offen offset:0 lds
    buffer_load_dwordx4 v3, s[4:7], s23 offen offset:1024 lds
    s_add_u32 m0, s64, 40960
    s_add_u32 s22, s32, 8192
    buffer_load_dwordx4 v3, s[4:7], s22 offen offset:0 lds
    buffer_load_dwordx4 v3, s[4:7], s22 offen offset:1024 lds
    s_add_u32 m0, s65, 40960
    s_add_u32 s23, s33, 8192
    buffer_load_dwordx4 v3, s[4:7], s23 offen offset:0 lds
    buffer_load_dwordx4 v3, s[4:7], s23 offen offset:1024 lds
    s_waitcnt vmcnt(20)
    s_barrier
    s_add_u32 m0, s56, 81920
    s_add_u32 s22, s24, 10240
    buffer_load_dwordx4 v3, s[4:7], s22 offen offset:0 lds
    buffer_load_dwordx4 v3, s[4:7], s22 offen offset:1024 lds
    s_add_u32 m0, s57, 81920
    s_add_u32 s23, s25, 10240
    buffer_load_dwordx4 v3, s[4:7], s23 offen offset:0 lds
    buffer_load_dwordx4 v3, s[4:7], s23 offen offset:1024 lds
    s_add_u32 m0, s58, 81920
    s_add_u32 s22, s26, 10240
    buffer_load_dwordx4 v3, s[4:7], s22 offen offset:0 lds
    buffer_load_dwordx4 v3, s[4:7], s22 offen offset:1024 lds
    s_add_u32 m0, s59, 81920
    s_add_u32 s23, s27, 10240
    buffer_load_dwordx4 v3, s[4:7], s23 offen offset:0 lds
    buffer_load_dwordx4 v3, s[4:7], s23 offen offset:1024 lds
    s_add_u32 m0, s60, 81920
    s_add_u32 s22, s28, 10240
    buffer_load_dwordx4 v3, s[4:7], s22 offen offset:0 lds
    buffer_load_dwordx4 v3, s[4:7], s22 offen offset:1024 lds
    s_add_u32 m0, s61, 81920
    s_add_u32 s23, s29, 10240
    buffer_load_dwordx4 v3, s[4:7], s23 offen offset:0 lds
    buffer_load_dwordx4 v3, s[4:7], s23 offen offset:1024 lds
    s_add_u32 m0, s62, 81920
    s_add_u32 s22, s30, 10240
    buffer_load_dwordx4 v3, s[4:7], s22 offen offset:0 lds
    buffer_load_dwordx4 v3, s[4:7], s22 offen offset:1024 lds
    s_add_u32 m0, s63, 81920
    s_add_u32 s23, s31, 10240
    buffer_load_dwordx4 v3, s[4:7], s23 offen offset:0 lds
    buffer_load_dwordx4 v3, s[4:7], s23 offen offset:1024 lds
    s_add_u32 m0, s64, 81920
    s_add_u32 s22, s32, 10240
    buffer_load_dwordx4 v3, s[4:7], s22 offen offset:0 lds
    buffer_load_dwordx4 v3, s[4:7], s22 offen offset:1024 lds
    s_add_u32 m0, s65, 81920
    s_add_u32 s23, s33, 10240
    buffer_load_dwordx4 v3, s[4:7], s23 offen offset:0 lds
    buffer_load_dwordx4 v3, s[4:7], s23 offen offset:1024 lds
    s_waitcnt vmcnt(20)
    s_barrier
    s_add_u32 m0, s56, 0
    s_add_u32 s22, s24, 12288
    buffer_load_dwordx4 v3, s[4:7], s22 offen offset:0 lds
    buffer_load_dwordx4 v3, s[4:7], s22 offen offset:1024 lds
    s_add_u32 m0, s57, 0
    s_add_u32 s23, s25, 12288
    buffer_load_dwordx4 v3, s[4:7], s23 offen offset:0 lds
    buffer_load_dwordx4 v3, s[4:7], s23 offen offset:1024 lds
    s_add_u32 m0, s58, 0
    s_add_u32 s22, s26, 12288
    buffer_load_dwordx4 v3, s[4:7], s22 offen offset:0 lds
    buffer_load_dwordx4 v3, s[4:7], s22 offen offset:1024 lds
    s_add_u32 m0, s59, 0
    s_add_u32 s23, s27, 12288
    buffer_load_dwordx4 v3, s[4:7], s23 offen offset:0 lds
    buffer_load_dwordx4 v3, s[4:7], s23 offen offset:1024 lds
    s_add_u32 m0, s60, 0
    s_add_u32 s22, s28, 12288
    buffer_load_dwordx4 v3, s[4:7], s22 offen offset:0 lds
    buffer_load_dwordx4 v3, s[4:7], s22 offen offset:1024 lds
    s_add_u32 m0, s61, 0
    s_add_u32 s23, s29, 12288
    buffer_load_dwordx4 v3, s[4:7], s23 offen offset:0 lds
    buffer_load_dwordx4 v3, s[4:7], s23 offen offset:1024 lds
    s_add_u32 m0, s62, 0
    s_add_u32 s22, s30, 12288
    buffer_load_dwordx4 v3, s[4:7], s22 offen offset:0 lds
    buffer_load_dwordx4 v3, s[4:7], s22 offen offset:1024 lds
    s_add_u32 m0, s63, 0
    s_add_u32 s23, s31, 12288
    buffer_load_dwordx4 v3, s[4:7], s23 offen offset:0 lds
    buffer_load_dwordx4 v3, s[4:7], s23 offen offset:1024 lds
    s_add_u32 m0, s64, 0
    s_add_u32 s22, s32, 12288
    buffer_load_dwordx4 v3, s[4:7], s22 offen offset:0 lds
    buffer_load_dwordx4 v3, s[4:7], s22 offen offset:1024 lds
    s_add_u32 m0, s65, 0
    s_add_u32 s23, s33, 12288
    buffer_load_dwordx4 v3, s[4:7], s23 offen offset:0 lds
    buffer_load_dwordx4 v3, s[4:7], s23 offen offset:1024 lds
    s_waitcnt vmcnt(20)
    s_barrier
    s_add_u32 m0, s56, 40960
    s_add_u32 s22, s24, 14336
    buffer_load_dwordx4 v3, s[4:7], s22 offen offset:0 lds
    buffer_load_dwordx4 v3, s[4:7], s22 offen offset:1024 lds
    s_add_u32 m0, s57, 40960
    s_add_u32 s23, s25, 14336
    buffer_load_dwordx4 v3, s[4:7], s23 offen offset:0 lds
    buffer_load_dwordx4 v3, s[4:7], s23 offen offset:1024 lds
    s_add_u32 m0, s58, 40960
    s_add_u32 s22, s26, 14336
    buffer_load_dwordx4 v3, s[4:7], s22 offen offset:0 lds
    buffer_load_dwordx4 v3, s[4:7], s22 offen offset:1024 lds
    s_add_u32 m0, s59, 40960
    s_add_u32 s23, s27, 14336
    buffer_load_dwordx4 v3, s[4:7], s23 offen offset:0 lds
    buffer_load_dwordx4 v3, s[4:7], s23 offen offset:1024 lds
    s_add_u32 m0, s60, 40960
    s_add_u32 s22, s28, 14336
    buffer_load_dwordx4 v3, s[4:7], s22 offen offset:0 lds
    buffer_load_dwordx4 v3, s[4:7], s22 offen offset:1024 lds
    s_add_u32 m0, s61, 40960
    s_add_u32 s23, s29, 14336
    buffer_load_dwordx4 v3, s[4:7], s23 offen offset:0 lds
    buffer_load_dwordx4 v3, s[4:7], s23 offen offset:1024 lds
    s_add_u32 m0, s62, 40960
    s_add_u32 s22, s30, 14336
    buffer_load_dwordx4 v3, s[4:7], s22 offen offset:0 lds
    buffer_load_dwordx4 v3, s[4:7], s22 offen offset:1024 lds
    s_add_u32 m0, s63, 40960
    s_add_u32 s23, s31, 14336
    buffer_load_dwordx4 v3, s[4:7], s23 offen offset:0 lds
    buffer_load_dwordx4 v3, s[4:7], s23 offen offset:1024 lds
    s_add_u32 m0, s64, 40960
    s_add_u32 s22, s32, 14336
    buffer_load_dwordx4 v3, s[4:7], s22 offen offset:0 lds
    buffer_load_dwordx4 v3, s[4:7], s22 offen offset:1024 lds
    s_add_u32 m0, s65, 40960
    s_add_u32 s23, s33, 14336
    buffer_load_dwordx4 v3, s[4:7], s23 offen offset:0 lds
    buffer_load_dwordx4 v3, s[4:7], s23 offen offset:1024 lds
    s_waitcnt vmcnt(20)
    s_barrier
    s_add_u32 m0, s56, 81920
    s_add_u32 s22, s24, 16384
    buffer_load_dwordx4 v3, s[4:7], s22 offen offset:0 lds
    buffer_load_dwordx4 v3, s[4:7], s22 offen offset:1024 lds
    s_add_u32 m0, s57, 81920
    s_add_u32 s23, s25, 16384
    buffer_load_dwordx4 v3, s[4:7], s23 offen offset:0 lds
    buffer_load_dwordx4 v3, s[4:7], s23 offen offset:1024 lds
    s_add_u32 m0, s58, 81920
    s_add_u32 s22, s26, 16384
    buffer_load_dwordx4 v3, s[4:7], s22 offen offset:0 lds
    buffer_load_dwordx4 v3, s[4:7], s22 offen offset:1024 lds
    s_add_u32 m0, s59, 81920
    s_add_u32 s23, s27, 16384
    buffer_load_dwordx4 v3, s[4:7], s23 offen offset:0 lds
    buffer_load_dwordx4 v3, s[4:7], s23 offen offset:1024 lds
    s_add_u32 m0, s60, 81920
    s_add_u32 s22, s28, 16384
    buffer_load_dwordx4 v3, s[4:7], s22 offen offset:0 lds
    buffer_load_dwordx4 v3, s[4:7], s22 offen offset:1024 lds
    s_add_u32 m0, s61, 81920
    s_add_u32 s23, s29, 16384
    buffer_load_dwordx4 v3, s[4:7], s23 offen offset:0 lds
    buffer_load_dwordx4 v3, s[4:7], s23 offen offset:1024 lds
    s_add_u32 m0, s62, 81920
    s_add_u32 s22, s30, 16384
    buffer_load_dwordx4 v3, s[4:7], s22 offen offset:0 lds
    buffer_load_dwordx4 v3, s[4:7], s22 offen offset:1024 lds
    s_add_u32 m0, s63, 81920
    s_add_u32 s23, s31, 16384
    buffer_load_dwordx4 v3, s[4:7], s23 offen offset:0 lds
    buffer_load_dwordx4 v3, s[4:7], s23 offen offset:1024 lds
    s_add_u32 m0, s64, 81920
    s_add_u32 s22, s32, 16384
    buffer_load_dwordx4 v3, s[4:7], s22 offen offset:0 lds
    buffer_load_dwordx4 v3, s[4:7], s22 offen offset:1024 lds
    s_add_u32 m0, s65, 81920
    s_add_u32 s23, s33, 16384
    buffer_load_dwordx4 v3, s[4:7], s23 offen offset:0 lds
    buffer_load_dwordx4 v3, s[4:7], s23 offen offset:1024 lds
    s_waitcnt vmcnt(20)
    s_barrier
    s_add_u32 m0, s56, 0
    s_add_u32 s22, s24, 18432
    buffer_load_dwordx4 v3, s[4:7], s22 offen offset:0 lds
    buffer_load_dwordx4 v3, s[4:7], s22 offen offset:1024 lds
    s_add_u32 m0, s57, 0
    s_add_u32 s23, s25, 18432
    buffer_load_dwordx4 v3, s[4:7], s23 offen offset:0 lds
    buffer_load_dwordx4 v3, s[4:7], s23 offen offset:1024 lds
    s_add_u32 m0, s58, 0
    s_add_u32 s22, s26, 18432
    buffer_load_dwordx4 v3, s[4:7], s22 offen offset:0 lds
    buffer_load_dwordx4 v3, s[4:7], s22 offen offset:1024 lds
    s_add_u32 m0, s59, 0
    s_add_u32 s23, s27, 18432
    buffer_load_dwordx4 v3, s[4:7], s23 offen offset:0 lds
    buffer_load_dwordx4 v3, s[4:7], s23 offen offset:1024 lds
    s_add_u32 m0, s60, 0
    s_add_u32 s22, s28, 18432
    buffer_load_dwordx4 v3, s[4:7], s22 offen offset:0 lds
    buffer_load_dwordx4 v3, s[4:7], s22 offen offset:1024 lds
    s_add_u32 m0, s61, 0
    s_add_u32 s23, s29, 18432
    buffer_load_dwordx4 v3, s[4:7], s23 offen offset:0 lds
    buffer_load_dwordx4 v3, s[4:7], s23 offen offset:1024 lds
    s_add_u32 m0, s62, 0
    s_add_u32 s22, s30, 18432
    buffer_load_dwordx4 v3, s[4:7], s22 offen offset:0 lds
    buffer_load_dwordx4 v3, s[4:7], s22 offen offset:1024 lds
    s_add_u32 m0, s63, 0
    s_add_u32 s23, s31, 18432
    buffer_load_dwordx4 v3, s[4:7], s23 offen offset:0 lds
    buffer_load_dwordx4 v3, s[4:7], s23 offen offset:1024 lds
    s_add_u32 m0, s64, 0
    s_add_u32 s22, s32, 18432
    buffer_load_dwordx4 v3, s[4:7], s22 offen offset:0 lds
    buffer_load_dwordx4 v3, s[4:7], s22 offen offset:1024 lds
    s_add_u32 m0, s65, 0
    s_add_u32 s23, s33, 18432
    buffer_load_dwordx4 v3, s[4:7], s23 offen offset:0 lds
    buffer_load_dwordx4 v3, s[4:7], s23 offen offset:1024 lds
    s_waitcnt vmcnt(20)
    s_barrier
    s_waitcnt vmcnt(0)
    s_barrier
    s_endpgm
gu1_kernel_comp:
    s_mov_b32 s15, s12
    s_mov_b32 s16, 0
    s_mul_i32 s17, s15, 4096
    s_mul_i32 s18, s16, 24576
    v_add_u32 v4, s17, v3
    v_add_u32 v7, s18, v3
    v_add_u32 v5, s17, v3
    v_add_u32 v8, s18, v3
    v_add_u32 v5, 65536, v5
    v_add_u32 v8, 65536, v8
    v_add_u32 v6, s17, v3
    v_add_u32 v9, s18, v3
    v_add_u32 v6, 131072, v6
    v_add_u32 v9, 131072, v9
    s_waitcnt lgkmcnt(0)
    s_and_b32 s5, s5, 0xffff
    s_mov_b32 s6, 268435456
    s_mov_b32 s7, 0x00020000
    v_and_b32 v2, 127, v0
    v_lshlrev_b32 v2, 6, v2
    s_lshl_b32 s17, s13, 13
    s_add_u32 s17, s17, 22151168
    buffer_load_dwordx4 v[10:13], v2, s[4:7], s17 offen offset:0
    buffer_load_dwordx4 v[14:17], v2, s[4:7], s17 offen offset:16
    buffer_load_dwordx4 v[18:21], v2, s[4:7], s17 offen offset:32
    buffer_load_dwordx4 v[22:25], v2, s[4:7], s17 offen offset:48
    v_lshlrev_b32 v26, 2, v0
    s_mul_i32 s17, s14, 768
    s_add_u32 s17, s17, 9248768
    buffer_load_dword v27, v26, s[4:7], s17 offen
    s_waitcnt vmcnt(1)
    v_add_f32 v10, v10, v12
    v_add_f32 v11, v11, v13
    v_add_f32 v10, v10, v14
    v_add_f32 v11, v11, v15
    v_add_f32 v10, v10, v16
    v_add_f32 v11, v11, v17
    v_add_f32 v10, v10, v18
    v_add_f32 v11, v11, v19
    v_add_f32 v10, v10, v20
    v_add_f32 v11, v11, v21
    v_add_f32 v10, v10, v22
    v_add_f32 v11, v11, v23
    v_add_f32 v10, v10, v24
    v_add_f32 v11, v11, v25
    v_mul_f32 v10, 0x3acccccd, v10
    v_mul_f32 v11, 0x3acccccd, v11
    v_fma_f32 v11, -v10, v10, v11
    v_max_f32 v11, 0, v11
    v_cvt_pk_bf16_f32 v10, v10, v10
    v_lshlrev_b32 v10, 16, v10
    v_cvt_pk_bf16_f32 v11, v11, v11
    v_lshlrev_b32 v11, 16, v11
    v_add_f32 v11, 0x3727c5ac, v11
    v_cvt_pk_bf16_f32 v11, v11, v11
    v_lshlrev_b32 v11, 16, v11
    v_sqrt_f32 v11, v11
    s_nop 0
    v_cvt_pk_bf16_f32 v11, v11, v11
    v_lshlrev_b32 v11, 16, v11
    v_rcp_f32 v11, v11
    v_and_b32 v12, 127, v0
    v_lshlrev_b32 v12, 3, v12
    v_add_u32 v12, 122880, v12
    ds_write_b64 v12, v[10:11]
    s_waitcnt vmcnt(0)
    v_add_u32 v26, 123904, v26
    ds_write_b32 v26, v27
    s_waitcnt lgkmcnt(0)
    s_barrier
    ds_read_b128 v[128:131], v4 offset:0
    ds_read_b128 v[132:135], v4 offset:2048
    ds_read_b128 v[136:139], v7 offset:16384
    ds_read_b128 v[140:143], v7 offset:18432
    ds_read_b128 v[144:147], v7 offset:20480
    ds_read_b128 v[148:151], v7 offset:22528
    ds_read_b128 v[152:155], v7 offset:24576
    ds_read_b128 v[156:159], v7 offset:26624
    ds_read_b128 v[160:163], v7 offset:28672
    ds_read_b128 v[164:167], v7 offset:30720
    ds_read_b128 v[168:171], v7 offset:32768
    ds_read_b128 v[172:175], v7 offset:34816
    ds_read_b128 v[176:179], v7 offset:36864
    ds_read_b128 v[180:183], v7 offset:38912
    s_waitcnt lgkmcnt(0)
    v_mfma_f32_16x16x32_bf16 v[32:35], v[136:139], v[128:131], 0
    ds_read_b128 v[184:187], v4 offset:1024
    v_mfma_f32_16x16x32_bf16 v[36:39], v[140:143], v[128:131], 0
    ds_read_b128 v[188:191], v4 offset:3072
    v_mfma_f32_16x16x32_bf16 v[40:43], v[144:147], v[128:131], 0
    ds_read_b128 v[192:195], v7 offset:17408
    v_mfma_f32_16x16x32_bf16 v[44:47], v[148:151], v[128:131], 0
    ds_read_b128 v[196:199], v7 offset:19456
    v_mfma_f32_16x16x32_bf16 v[48:51], v[152:155], v[128:131], 0
    ds_read_b128 v[200:203], v7 offset:21504
    v_mfma_f32_16x16x32_bf16 v[52:55], v[156:159], v[128:131], 0
    ds_read_b128 v[204:207], v7 offset:23552
    v_mfma_f32_16x16x32_bf16 v[56:59], v[160:163], v[128:131], 0
    ds_read_b128 v[208:211], v7 offset:25600
    v_mfma_f32_16x16x32_bf16 v[60:63], v[164:167], v[128:131], 0
    ds_read_b128 v[212:215], v7 offset:27648
    v_mfma_f32_16x16x32_bf16 v[64:67], v[168:171], v[128:131], 0
    ds_read_b128 v[216:219], v7 offset:29696
    v_mfma_f32_16x16x32_bf16 v[68:71], v[172:175], v[128:131], 0
    ds_read_b128 v[220:223], v7 offset:31744
    v_mfma_f32_16x16x32_bf16 v[72:75], v[176:179], v[128:131], 0
    ds_read_b128 v[224:227], v7 offset:33792
    v_mfma_f32_16x16x32_bf16 v[76:79], v[180:183], v[128:131], 0
    ds_read_b128 v[228:231], v7 offset:35840
    v_mfma_f32_16x16x32_bf16 v[80:83], v[136:139], v[132:135], 0
    ds_read_b128 v[232:235], v7 offset:37888
    v_mfma_f32_16x16x32_bf16 v[84:87], v[140:143], v[132:135], 0
    ds_read_b128 v[236:239], v7 offset:39936
    v_mfma_f32_16x16x32_bf16 v[88:91], v[144:147], v[132:135], 0
    v_mfma_f32_16x16x32_bf16 v[92:95], v[148:151], v[132:135], 0
    v_mfma_f32_16x16x32_bf16 v[96:99], v[152:155], v[132:135], 0
    v_mfma_f32_16x16x32_bf16 v[100:103], v[156:159], v[132:135], 0
    v_mfma_f32_16x16x32_bf16 v[104:107], v[160:163], v[132:135], 0
    v_mfma_f32_16x16x32_bf16 v[108:111], v[164:167], v[132:135], 0
    v_mfma_f32_16x16x32_bf16 v[112:115], v[168:171], v[132:135], 0
    v_mfma_f32_16x16x32_bf16 v[116:119], v[172:175], v[132:135], 0
    v_mfma_f32_16x16x32_bf16 v[120:123], v[176:179], v[132:135], 0
    v_mfma_f32_16x16x32_bf16 v[124:127], v[180:183], v[132:135], 0
    s_waitcnt lgkmcnt(0)
    s_barrier
    v_mfma_f32_16x16x32_bf16 v[32:35], v[192:195], v[184:187], v[32:35]
    ds_read_b128 v[128:131], v4 offset:40960
    v_mfma_f32_16x16x32_bf16 v[36:39], v[196:199], v[184:187], v[36:39]
    ds_read_b128 v[132:135], v4 offset:43008
    v_mfma_f32_16x16x32_bf16 v[40:43], v[200:203], v[184:187], v[40:43]
    ds_read_b128 v[136:139], v7 offset:57344
    v_mfma_f32_16x16x32_bf16 v[44:47], v[204:207], v[184:187], v[44:47]
    ds_read_b128 v[140:143], v7 offset:59392
    v_mfma_f32_16x16x32_bf16 v[48:51], v[208:211], v[184:187], v[48:51]
    ds_read_b128 v[144:147], v7 offset:61440
    v_mfma_f32_16x16x32_bf16 v[52:55], v[212:215], v[184:187], v[52:55]
    ds_read_b128 v[148:151], v7 offset:63488
    v_mfma_f32_16x16x32_bf16 v[56:59], v[216:219], v[184:187], v[56:59]
    ds_read_b128 v[152:155], v8 offset:0
    v_mfma_f32_16x16x32_bf16 v[60:63], v[220:223], v[184:187], v[60:63]
    ds_read_b128 v[156:159], v8 offset:2048
    v_mfma_f32_16x16x32_bf16 v[64:67], v[224:227], v[184:187], v[64:67]
    ds_read_b128 v[160:163], v8 offset:4096
    v_mfma_f32_16x16x32_bf16 v[68:71], v[228:231], v[184:187], v[68:71]
    ds_read_b128 v[164:167], v8 offset:6144
    v_mfma_f32_16x16x32_bf16 v[72:75], v[232:235], v[184:187], v[72:75]
    ds_read_b128 v[168:171], v8 offset:8192
    v_mfma_f32_16x16x32_bf16 v[76:79], v[236:239], v[184:187], v[76:79]
    ds_read_b128 v[172:175], v8 offset:10240
    v_mfma_f32_16x16x32_bf16 v[80:83], v[192:195], v[188:191], v[80:83]
    ds_read_b128 v[176:179], v8 offset:12288
    v_mfma_f32_16x16x32_bf16 v[84:87], v[196:199], v[188:191], v[84:87]
    ds_read_b128 v[180:183], v8 offset:14336
    v_mfma_f32_16x16x32_bf16 v[88:91], v[200:203], v[188:191], v[88:91]
    v_mfma_f32_16x16x32_bf16 v[92:95], v[204:207], v[188:191], v[92:95]
    v_mfma_f32_16x16x32_bf16 v[96:99], v[208:211], v[188:191], v[96:99]
    v_mfma_f32_16x16x32_bf16 v[100:103], v[212:215], v[188:191], v[100:103]
    v_mfma_f32_16x16x32_bf16 v[104:107], v[216:219], v[188:191], v[104:107]
    v_mfma_f32_16x16x32_bf16 v[108:111], v[220:223], v[188:191], v[108:111]
    v_mfma_f32_16x16x32_bf16 v[112:115], v[224:227], v[188:191], v[112:115]
    v_mfma_f32_16x16x32_bf16 v[116:119], v[228:231], v[188:191], v[116:119]
    v_mfma_f32_16x16x32_bf16 v[120:123], v[232:235], v[188:191], v[120:123]
    v_mfma_f32_16x16x32_bf16 v[124:127], v[236:239], v[188:191], v[124:127]
    s_waitcnt lgkmcnt(0)
    v_mfma_f32_16x16x32_bf16 v[32:35], v[136:139], v[128:131], v[32:35]
    ds_read_b128 v[184:187], v4 offset:41984
    v_mfma_f32_16x16x32_bf16 v[36:39], v[140:143], v[128:131], v[36:39]
    ds_read_b128 v[188:191], v4 offset:44032
    v_mfma_f32_16x16x32_bf16 v[40:43], v[144:147], v[128:131], v[40:43]
    ds_read_b128 v[192:195], v7 offset:58368
    v_mfma_f32_16x16x32_bf16 v[44:47], v[148:151], v[128:131], v[44:47]
    ds_read_b128 v[196:199], v7 offset:60416
    v_mfma_f32_16x16x32_bf16 v[48:51], v[152:155], v[128:131], v[48:51]
    ds_read_b128 v[200:203], v7 offset:62464
    v_mfma_f32_16x16x32_bf16 v[52:55], v[156:159], v[128:131], v[52:55]
    ds_read_b128 v[204:207], v7 offset:64512
    v_mfma_f32_16x16x32_bf16 v[56:59], v[160:163], v[128:131], v[56:59]
    ds_read_b128 v[208:211], v8 offset:1024
    v_mfma_f32_16x16x32_bf16 v[60:63], v[164:167], v[128:131], v[60:63]
    ds_read_b128 v[212:215], v8 offset:3072
    v_mfma_f32_16x16x32_bf16 v[64:67], v[168:171], v[128:131], v[64:67]
    ds_read_b128 v[216:219], v8 offset:5120
    v_mfma_f32_16x16x32_bf16 v[68:71], v[172:175], v[128:131], v[68:71]
    ds_read_b128 v[220:223], v8 offset:7168
    v_mfma_f32_16x16x32_bf16 v[72:75], v[176:179], v[128:131], v[72:75]
    ds_read_b128 v[224:227], v8 offset:9216
    v_mfma_f32_16x16x32_bf16 v[76:79], v[180:183], v[128:131], v[76:79]
    ds_read_b128 v[228:231], v8 offset:11264
    v_mfma_f32_16x16x32_bf16 v[80:83], v[136:139], v[132:135], v[80:83]
    ds_read_b128 v[232:235], v8 offset:13312
    v_mfma_f32_16x16x32_bf16 v[84:87], v[140:143], v[132:135], v[84:87]
    ds_read_b128 v[236:239], v8 offset:15360
    v_mfma_f32_16x16x32_bf16 v[88:91], v[144:147], v[132:135], v[88:91]
    v_mfma_f32_16x16x32_bf16 v[92:95], v[148:151], v[132:135], v[92:95]
    v_mfma_f32_16x16x32_bf16 v[96:99], v[152:155], v[132:135], v[96:99]
    v_mfma_f32_16x16x32_bf16 v[100:103], v[156:159], v[132:135], v[100:103]
    v_mfma_f32_16x16x32_bf16 v[104:107], v[160:163], v[132:135], v[104:107]
    v_mfma_f32_16x16x32_bf16 v[108:111], v[164:167], v[132:135], v[108:111]
    v_mfma_f32_16x16x32_bf16 v[112:115], v[168:171], v[132:135], v[112:115]
    v_mfma_f32_16x16x32_bf16 v[116:119], v[172:175], v[132:135], v[116:119]
    v_mfma_f32_16x16x32_bf16 v[120:123], v[176:179], v[132:135], v[120:123]
    v_mfma_f32_16x16x32_bf16 v[124:127], v[180:183], v[132:135], v[124:127]
    s_waitcnt lgkmcnt(0)
    s_barrier
    v_mfma_f32_16x16x32_bf16 v[32:35], v[192:195], v[184:187], v[32:35]
    ds_read_b128 v[128:131], v5 offset:16384
    v_mfma_f32_16x16x32_bf16 v[36:39], v[196:199], v[184:187], v[36:39]
    ds_read_b128 v[132:135], v5 offset:18432
    v_mfma_f32_16x16x32_bf16 v[40:43], v[200:203], v[184:187], v[40:43]
    ds_read_b128 v[136:139], v8 offset:32768
    v_mfma_f32_16x16x32_bf16 v[44:47], v[204:207], v[184:187], v[44:47]
    ds_read_b128 v[140:143], v8 offset:34816
    v_mfma_f32_16x16x32_bf16 v[48:51], v[208:211], v[184:187], v[48:51]
    ds_read_b128 v[144:147], v8 offset:36864
    v_mfma_f32_16x16x32_bf16 v[52:55], v[212:215], v[184:187], v[52:55]
    ds_read_b128 v[148:151], v8 offset:38912
    v_mfma_f32_16x16x32_bf16 v[56:59], v[216:219], v[184:187], v[56:59]
    ds_read_b128 v[152:155], v8 offset:40960
    v_mfma_f32_16x16x32_bf16 v[60:63], v[220:223], v[184:187], v[60:63]
    ds_read_b128 v[156:159], v8 offset:43008
    v_mfma_f32_16x16x32_bf16 v[64:67], v[224:227], v[184:187], v[64:67]
    ds_read_b128 v[160:163], v8 offset:45056
    v_mfma_f32_16x16x32_bf16 v[68:71], v[228:231], v[184:187], v[68:71]
    ds_read_b128 v[164:167], v8 offset:47104
    v_mfma_f32_16x16x32_bf16 v[72:75], v[232:235], v[184:187], v[72:75]
    ds_read_b128 v[168:171], v8 offset:49152
    v_mfma_f32_16x16x32_bf16 v[76:79], v[236:239], v[184:187], v[76:79]
    ds_read_b128 v[172:175], v8 offset:51200
    v_mfma_f32_16x16x32_bf16 v[80:83], v[192:195], v[188:191], v[80:83]
    ds_read_b128 v[176:179], v8 offset:53248
    v_mfma_f32_16x16x32_bf16 v[84:87], v[196:199], v[188:191], v[84:87]
    ds_read_b128 v[180:183], v8 offset:55296
    v_mfma_f32_16x16x32_bf16 v[88:91], v[200:203], v[188:191], v[88:91]
    v_mfma_f32_16x16x32_bf16 v[92:95], v[204:207], v[188:191], v[92:95]
    v_mfma_f32_16x16x32_bf16 v[96:99], v[208:211], v[188:191], v[96:99]
    v_mfma_f32_16x16x32_bf16 v[100:103], v[212:215], v[188:191], v[100:103]
    v_mfma_f32_16x16x32_bf16 v[104:107], v[216:219], v[188:191], v[104:107]
    v_mfma_f32_16x16x32_bf16 v[108:111], v[220:223], v[188:191], v[108:111]
    v_mfma_f32_16x16x32_bf16 v[112:115], v[224:227], v[188:191], v[112:115]
    v_mfma_f32_16x16x32_bf16 v[116:119], v[228:231], v[188:191], v[116:119]
    v_mfma_f32_16x16x32_bf16 v[120:123], v[232:235], v[188:191], v[120:123]
    v_mfma_f32_16x16x32_bf16 v[124:127], v[236:239], v[188:191], v[124:127]
    s_waitcnt lgkmcnt(0)
    v_mfma_f32_16x16x32_bf16 v[32:35], v[136:139], v[128:131], v[32:35]
    ds_read_b128 v[184:187], v5 offset:17408
    v_mfma_f32_16x16x32_bf16 v[36:39], v[140:143], v[128:131], v[36:39]
    ds_read_b128 v[188:191], v5 offset:19456
    v_mfma_f32_16x16x32_bf16 v[40:43], v[144:147], v[128:131], v[40:43]
    ds_read_b128 v[192:195], v8 offset:33792
    v_mfma_f32_16x16x32_bf16 v[44:47], v[148:151], v[128:131], v[44:47]
    ds_read_b128 v[196:199], v8 offset:35840
    v_mfma_f32_16x16x32_bf16 v[48:51], v[152:155], v[128:131], v[48:51]
    ds_read_b128 v[200:203], v8 offset:37888
    v_mfma_f32_16x16x32_bf16 v[52:55], v[156:159], v[128:131], v[52:55]
    ds_read_b128 v[204:207], v8 offset:39936
    v_mfma_f32_16x16x32_bf16 v[56:59], v[160:163], v[128:131], v[56:59]
    ds_read_b128 v[208:211], v8 offset:41984
    v_mfma_f32_16x16x32_bf16 v[60:63], v[164:167], v[128:131], v[60:63]
    ds_read_b128 v[212:215], v8 offset:44032
    v_mfma_f32_16x16x32_bf16 v[64:67], v[168:171], v[128:131], v[64:67]
    ds_read_b128 v[216:219], v8 offset:46080
    v_mfma_f32_16x16x32_bf16 v[68:71], v[172:175], v[128:131], v[68:71]
    ds_read_b128 v[220:223], v8 offset:48128
    v_mfma_f32_16x16x32_bf16 v[72:75], v[176:179], v[128:131], v[72:75]
    ds_read_b128 v[224:227], v8 offset:50176
    v_mfma_f32_16x16x32_bf16 v[76:79], v[180:183], v[128:131], v[76:79]
    ds_read_b128 v[228:231], v8 offset:52224
    v_mfma_f32_16x16x32_bf16 v[80:83], v[136:139], v[132:135], v[80:83]
    ds_read_b128 v[232:235], v8 offset:54272
    v_mfma_f32_16x16x32_bf16 v[84:87], v[140:143], v[132:135], v[84:87]
    ds_read_b128 v[236:239], v8 offset:56320
    v_mfma_f32_16x16x32_bf16 v[88:91], v[144:147], v[132:135], v[88:91]
    v_mfma_f32_16x16x32_bf16 v[92:95], v[148:151], v[132:135], v[92:95]
    v_mfma_f32_16x16x32_bf16 v[96:99], v[152:155], v[132:135], v[96:99]
    v_mfma_f32_16x16x32_bf16 v[100:103], v[156:159], v[132:135], v[100:103]
    v_mfma_f32_16x16x32_bf16 v[104:107], v[160:163], v[132:135], v[104:107]
    v_mfma_f32_16x16x32_bf16 v[108:111], v[164:167], v[132:135], v[108:111]
    v_mfma_f32_16x16x32_bf16 v[112:115], v[168:171], v[132:135], v[112:115]
    v_mfma_f32_16x16x32_bf16 v[116:119], v[172:175], v[132:135], v[116:119]
    v_mfma_f32_16x16x32_bf16 v[120:123], v[176:179], v[132:135], v[120:123]
    v_mfma_f32_16x16x32_bf16 v[124:127], v[180:183], v[132:135], v[124:127]
    s_waitcnt lgkmcnt(0)
    s_barrier
    v_mfma_f32_16x16x32_bf16 v[32:35], v[192:195], v[184:187], v[32:35]
    ds_read_b128 v[128:131], v4 offset:0
    v_mfma_f32_16x16x32_bf16 v[36:39], v[196:199], v[184:187], v[36:39]
    ds_read_b128 v[132:135], v4 offset:2048
    v_mfma_f32_16x16x32_bf16 v[40:43], v[200:203], v[184:187], v[40:43]
    ds_read_b128 v[136:139], v7 offset:16384
    v_mfma_f32_16x16x32_bf16 v[44:47], v[204:207], v[184:187], v[44:47]
    ds_read_b128 v[140:143], v7 offset:18432
    v_mfma_f32_16x16x32_bf16 v[48:51], v[208:211], v[184:187], v[48:51]
    ds_read_b128 v[144:147], v7 offset:20480
    v_mfma_f32_16x16x32_bf16 v[52:55], v[212:215], v[184:187], v[52:55]
    ds_read_b128 v[148:151], v7 offset:22528
    v_mfma_f32_16x16x32_bf16 v[56:59], v[216:219], v[184:187], v[56:59]
    ds_read_b128 v[152:155], v7 offset:24576
    v_mfma_f32_16x16x32_bf16 v[60:63], v[220:223], v[184:187], v[60:63]
    ds_read_b128 v[156:159], v7 offset:26624
    v_mfma_f32_16x16x32_bf16 v[64:67], v[224:227], v[184:187], v[64:67]
    ds_read_b128 v[160:163], v7 offset:28672
    v_mfma_f32_16x16x32_bf16 v[68:71], v[228:231], v[184:187], v[68:71]
    ds_read_b128 v[164:167], v7 offset:30720
    v_mfma_f32_16x16x32_bf16 v[72:75], v[232:235], v[184:187], v[72:75]
    ds_read_b128 v[168:171], v7 offset:32768
    v_mfma_f32_16x16x32_bf16 v[76:79], v[236:239], v[184:187], v[76:79]
    ds_read_b128 v[172:175], v7 offset:34816
    v_mfma_f32_16x16x32_bf16 v[80:83], v[192:195], v[188:191], v[80:83]
    ds_read_b128 v[176:179], v7 offset:36864
    v_mfma_f32_16x16x32_bf16 v[84:87], v[196:199], v[188:191], v[84:87]
    ds_read_b128 v[180:183], v7 offset:38912
    v_mfma_f32_16x16x32_bf16 v[88:91], v[200:203], v[188:191], v[88:91]
    v_mfma_f32_16x16x32_bf16 v[92:95], v[204:207], v[188:191], v[92:95]
    v_mfma_f32_16x16x32_bf16 v[96:99], v[208:211], v[188:191], v[96:99]
    v_mfma_f32_16x16x32_bf16 v[100:103], v[212:215], v[188:191], v[100:103]
    v_mfma_f32_16x16x32_bf16 v[104:107], v[216:219], v[188:191], v[104:107]
    v_mfma_f32_16x16x32_bf16 v[108:111], v[220:223], v[188:191], v[108:111]
    v_mfma_f32_16x16x32_bf16 v[112:115], v[224:227], v[188:191], v[112:115]
    v_mfma_f32_16x16x32_bf16 v[116:119], v[228:231], v[188:191], v[116:119]
    v_mfma_f32_16x16x32_bf16 v[120:123], v[232:235], v[188:191], v[120:123]
    v_mfma_f32_16x16x32_bf16 v[124:127], v[236:239], v[188:191], v[124:127]
    s_waitcnt lgkmcnt(0)
    v_mfma_f32_16x16x32_bf16 v[32:35], v[136:139], v[128:131], v[32:35]
    ds_read_b128 v[184:187], v4 offset:1024
    v_mfma_f32_16x16x32_bf16 v[36:39], v[140:143], v[128:131], v[36:39]
    ds_read_b128 v[188:191], v4 offset:3072
    v_mfma_f32_16x16x32_bf16 v[40:43], v[144:147], v[128:131], v[40:43]
    ds_read_b128 v[192:195], v7 offset:17408
    v_mfma_f32_16x16x32_bf16 v[44:47], v[148:151], v[128:131], v[44:47]
    ds_read_b128 v[196:199], v7 offset:19456
    v_mfma_f32_16x16x32_bf16 v[48:51], v[152:155], v[128:131], v[48:51]
    ds_read_b128 v[200:203], v7 offset:21504
    v_mfma_f32_16x16x32_bf16 v[52:55], v[156:159], v[128:131], v[52:55]
    ds_read_b128 v[204:207], v7 offset:23552
    v_mfma_f32_16x16x32_bf16 v[56:59], v[160:163], v[128:131], v[56:59]
    ds_read_b128 v[208:211], v7 offset:25600
    v_mfma_f32_16x16x32_bf16 v[60:63], v[164:167], v[128:131], v[60:63]
    ds_read_b128 v[212:215], v7 offset:27648
    v_mfma_f32_16x16x32_bf16 v[64:67], v[168:171], v[128:131], v[64:67]
    ds_read_b128 v[216:219], v7 offset:29696
    v_mfma_f32_16x16x32_bf16 v[68:71], v[172:175], v[128:131], v[68:71]
    ds_read_b128 v[220:223], v7 offset:31744
    v_mfma_f32_16x16x32_bf16 v[72:75], v[176:179], v[128:131], v[72:75]
    ds_read_b128 v[224:227], v7 offset:33792
    v_mfma_f32_16x16x32_bf16 v[76:79], v[180:183], v[128:131], v[76:79]
    ds_read_b128 v[228:231], v7 offset:35840
    v_mfma_f32_16x16x32_bf16 v[80:83], v[136:139], v[132:135], v[80:83]
    ds_read_b128 v[232:235], v7 offset:37888
    v_mfma_f32_16x16x32_bf16 v[84:87], v[140:143], v[132:135], v[84:87]
    ds_read_b128 v[236:239], v7 offset:39936
    v_mfma_f32_16x16x32_bf16 v[88:91], v[144:147], v[132:135], v[88:91]
    v_mfma_f32_16x16x32_bf16 v[92:95], v[148:151], v[132:135], v[92:95]
    v_mfma_f32_16x16x32_bf16 v[96:99], v[152:155], v[132:135], v[96:99]
    v_mfma_f32_16x16x32_bf16 v[100:103], v[156:159], v[132:135], v[100:103]
    v_mfma_f32_16x16x32_bf16 v[104:107], v[160:163], v[132:135], v[104:107]
    v_mfma_f32_16x16x32_bf16 v[108:111], v[164:167], v[132:135], v[108:111]
    v_mfma_f32_16x16x32_bf16 v[112:115], v[168:171], v[132:135], v[112:115]
    v_mfma_f32_16x16x32_bf16 v[116:119], v[172:175], v[132:135], v[116:119]
    v_mfma_f32_16x16x32_bf16 v[120:123], v[176:179], v[132:135], v[120:123]
    v_mfma_f32_16x16x32_bf16 v[124:127], v[180:183], v[132:135], v[124:127]
    s_waitcnt lgkmcnt(0)
    s_barrier
    v_mfma_f32_16x16x32_bf16 v[32:35], v[192:195], v[184:187], v[32:35]
    ds_read_b128 v[128:131], v4 offset:40960
    v_mfma_f32_16x16x32_bf16 v[36:39], v[196:199], v[184:187], v[36:39]
    ds_read_b128 v[132:135], v4 offset:43008
    v_mfma_f32_16x16x32_bf16 v[40:43], v[200:203], v[184:187], v[40:43]
    ds_read_b128 v[136:139], v7 offset:57344
    v_mfma_f32_16x16x32_bf16 v[44:47], v[204:207], v[184:187], v[44:47]
    ds_read_b128 v[140:143], v7 offset:59392
    v_mfma_f32_16x16x32_bf16 v[48:51], v[208:211], v[184:187], v[48:51]
    ds_read_b128 v[144:147], v7 offset:61440
    v_mfma_f32_16x16x32_bf16 v[52:55], v[212:215], v[184:187], v[52:55]
    ds_read_b128 v[148:151], v7 offset:63488
    v_mfma_f32_16x16x32_bf16 v[56:59], v[216:219], v[184:187], v[56:59]
    ds_read_b128 v[152:155], v8 offset:0
    v_mfma_f32_16x16x32_bf16 v[60:63], v[220:223], v[184:187], v[60:63]
    ds_read_b128 v[156:159], v8 offset:2048
    v_mfma_f32_16x16x32_bf16 v[64:67], v[224:227], v[184:187], v[64:67]
    ds_read_b128 v[160:163], v8 offset:4096
    v_mfma_f32_16x16x32_bf16 v[68:71], v[228:231], v[184:187], v[68:71]
    ds_read_b128 v[164:167], v8 offset:6144
    v_mfma_f32_16x16x32_bf16 v[72:75], v[232:235], v[184:187], v[72:75]
    ds_read_b128 v[168:171], v8 offset:8192
    v_mfma_f32_16x16x32_bf16 v[76:79], v[236:239], v[184:187], v[76:79]
    ds_read_b128 v[172:175], v8 offset:10240
    v_mfma_f32_16x16x32_bf16 v[80:83], v[192:195], v[188:191], v[80:83]
    ds_read_b128 v[176:179], v8 offset:12288
    v_mfma_f32_16x16x32_bf16 v[84:87], v[196:199], v[188:191], v[84:87]
    ds_read_b128 v[180:183], v8 offset:14336
    v_mfma_f32_16x16x32_bf16 v[88:91], v[200:203], v[188:191], v[88:91]
    v_mfma_f32_16x16x32_bf16 v[92:95], v[204:207], v[188:191], v[92:95]
    v_mfma_f32_16x16x32_bf16 v[96:99], v[208:211], v[188:191], v[96:99]
    v_mfma_f32_16x16x32_bf16 v[100:103], v[212:215], v[188:191], v[100:103]
    v_mfma_f32_16x16x32_bf16 v[104:107], v[216:219], v[188:191], v[104:107]
    v_mfma_f32_16x16x32_bf16 v[108:111], v[220:223], v[188:191], v[108:111]
    v_mfma_f32_16x16x32_bf16 v[112:115], v[224:227], v[188:191], v[112:115]
    v_mfma_f32_16x16x32_bf16 v[116:119], v[228:231], v[188:191], v[116:119]
    v_mfma_f32_16x16x32_bf16 v[120:123], v[232:235], v[188:191], v[120:123]
    v_mfma_f32_16x16x32_bf16 v[124:127], v[236:239], v[188:191], v[124:127]
    s_waitcnt lgkmcnt(0)
    v_mfma_f32_16x16x32_bf16 v[32:35], v[136:139], v[128:131], v[32:35]
    ds_read_b128 v[184:187], v4 offset:41984
    v_mfma_f32_16x16x32_bf16 v[36:39], v[140:143], v[128:131], v[36:39]
    ds_read_b128 v[188:191], v4 offset:44032
    v_mfma_f32_16x16x32_bf16 v[40:43], v[144:147], v[128:131], v[40:43]
    ds_read_b128 v[192:195], v7 offset:58368
    v_mfma_f32_16x16x32_bf16 v[44:47], v[148:151], v[128:131], v[44:47]
    ds_read_b128 v[196:199], v7 offset:60416
    v_mfma_f32_16x16x32_bf16 v[48:51], v[152:155], v[128:131], v[48:51]
    ds_read_b128 v[200:203], v7 offset:62464
    v_mfma_f32_16x16x32_bf16 v[52:55], v[156:159], v[128:131], v[52:55]
    ds_read_b128 v[204:207], v7 offset:64512
    v_mfma_f32_16x16x32_bf16 v[56:59], v[160:163], v[128:131], v[56:59]
    ds_read_b128 v[208:211], v8 offset:1024
    v_mfma_f32_16x16x32_bf16 v[60:63], v[164:167], v[128:131], v[60:63]
    ds_read_b128 v[212:215], v8 offset:3072
    v_mfma_f32_16x16x32_bf16 v[64:67], v[168:171], v[128:131], v[64:67]
    ds_read_b128 v[216:219], v8 offset:5120
    v_mfma_f32_16x16x32_bf16 v[68:71], v[172:175], v[128:131], v[68:71]
    ds_read_b128 v[220:223], v8 offset:7168
    v_mfma_f32_16x16x32_bf16 v[72:75], v[176:179], v[128:131], v[72:75]
    ds_read_b128 v[224:227], v8 offset:9216
    v_mfma_f32_16x16x32_bf16 v[76:79], v[180:183], v[128:131], v[76:79]
    ds_read_b128 v[228:231], v8 offset:11264
    v_mfma_f32_16x16x32_bf16 v[80:83], v[136:139], v[132:135], v[80:83]
    ds_read_b128 v[232:235], v8 offset:13312
    v_mfma_f32_16x16x32_bf16 v[84:87], v[140:143], v[132:135], v[84:87]
    ds_read_b128 v[236:239], v8 offset:15360
    v_mfma_f32_16x16x32_bf16 v[88:91], v[144:147], v[132:135], v[88:91]
    v_mfma_f32_16x16x32_bf16 v[92:95], v[148:151], v[132:135], v[92:95]
    v_mfma_f32_16x16x32_bf16 v[96:99], v[152:155], v[132:135], v[96:99]
    v_mfma_f32_16x16x32_bf16 v[100:103], v[156:159], v[132:135], v[100:103]
    v_mfma_f32_16x16x32_bf16 v[104:107], v[160:163], v[132:135], v[104:107]
    v_mfma_f32_16x16x32_bf16 v[108:111], v[164:167], v[132:135], v[108:111]
    v_mfma_f32_16x16x32_bf16 v[112:115], v[168:171], v[132:135], v[112:115]
    v_mfma_f32_16x16x32_bf16 v[116:119], v[172:175], v[132:135], v[116:119]
    v_mfma_f32_16x16x32_bf16 v[120:123], v[176:179], v[132:135], v[120:123]
    v_mfma_f32_16x16x32_bf16 v[124:127], v[180:183], v[132:135], v[124:127]
    s_waitcnt lgkmcnt(0)
    s_barrier
    v_mfma_f32_16x16x32_bf16 v[32:35], v[192:195], v[184:187], v[32:35]
    ds_read_b128 v[128:131], v5 offset:16384
    v_mfma_f32_16x16x32_bf16 v[36:39], v[196:199], v[184:187], v[36:39]
    ds_read_b128 v[132:135], v5 offset:18432
    v_mfma_f32_16x16x32_bf16 v[40:43], v[200:203], v[184:187], v[40:43]
    ds_read_b128 v[136:139], v8 offset:32768
    v_mfma_f32_16x16x32_bf16 v[44:47], v[204:207], v[184:187], v[44:47]
    ds_read_b128 v[140:143], v8 offset:34816
    v_mfma_f32_16x16x32_bf16 v[48:51], v[208:211], v[184:187], v[48:51]
    ds_read_b128 v[144:147], v8 offset:36864
    v_mfma_f32_16x16x32_bf16 v[52:55], v[212:215], v[184:187], v[52:55]
    ds_read_b128 v[148:151], v8 offset:38912
    v_mfma_f32_16x16x32_bf16 v[56:59], v[216:219], v[184:187], v[56:59]
    ds_read_b128 v[152:155], v8 offset:40960
    v_mfma_f32_16x16x32_bf16 v[60:63], v[220:223], v[184:187], v[60:63]
    ds_read_b128 v[156:159], v8 offset:43008
    v_mfma_f32_16x16x32_bf16 v[64:67], v[224:227], v[184:187], v[64:67]
    ds_read_b128 v[160:163], v8 offset:45056
    v_mfma_f32_16x16x32_bf16 v[68:71], v[228:231], v[184:187], v[68:71]
    ds_read_b128 v[164:167], v8 offset:47104
    v_mfma_f32_16x16x32_bf16 v[72:75], v[232:235], v[184:187], v[72:75]
    ds_read_b128 v[168:171], v8 offset:49152
    v_mfma_f32_16x16x32_bf16 v[76:79], v[236:239], v[184:187], v[76:79]
    ds_read_b128 v[172:175], v8 offset:51200
    v_mfma_f32_16x16x32_bf16 v[80:83], v[192:195], v[188:191], v[80:83]
    ds_read_b128 v[176:179], v8 offset:53248
    v_mfma_f32_16x16x32_bf16 v[84:87], v[196:199], v[188:191], v[84:87]
    ds_read_b128 v[180:183], v8 offset:55296
    v_mfma_f32_16x16x32_bf16 v[88:91], v[200:203], v[188:191], v[88:91]
    v_mfma_f32_16x16x32_bf16 v[92:95], v[204:207], v[188:191], v[92:95]
    v_mfma_f32_16x16x32_bf16 v[96:99], v[208:211], v[188:191], v[96:99]
    v_mfma_f32_16x16x32_bf16 v[100:103], v[212:215], v[188:191], v[100:103]
    v_mfma_f32_16x16x32_bf16 v[104:107], v[216:219], v[188:191], v[104:107]
    v_mfma_f32_16x16x32_bf16 v[108:111], v[220:223], v[188:191], v[108:111]
    v_mfma_f32_16x16x32_bf16 v[112:115], v[224:227], v[188:191], v[112:115]
    v_mfma_f32_16x16x32_bf16 v[116:119], v[228:231], v[188:191], v[116:119]
    v_mfma_f32_16x16x32_bf16 v[120:123], v[232:235], v[188:191], v[120:123]
    v_mfma_f32_16x16x32_bf16 v[124:127], v[236:239], v[188:191], v[124:127]
    s_waitcnt lgkmcnt(0)
    v_mfma_f32_16x16x32_bf16 v[32:35], v[136:139], v[128:131], v[32:35]
    ds_read_b128 v[184:187], v5 offset:17408
    v_mfma_f32_16x16x32_bf16 v[36:39], v[140:143], v[128:131], v[36:39]
    ds_read_b128 v[188:191], v5 offset:19456
    v_mfma_f32_16x16x32_bf16 v[40:43], v[144:147], v[128:131], v[40:43]
    ds_read_b128 v[192:195], v8 offset:33792
    v_mfma_f32_16x16x32_bf16 v[44:47], v[148:151], v[128:131], v[44:47]
    ds_read_b128 v[196:199], v8 offset:35840
    v_mfma_f32_16x16x32_bf16 v[48:51], v[152:155], v[128:131], v[48:51]
    ds_read_b128 v[200:203], v8 offset:37888
    v_mfma_f32_16x16x32_bf16 v[52:55], v[156:159], v[128:131], v[52:55]
    ds_read_b128 v[204:207], v8 offset:39936
    v_mfma_f32_16x16x32_bf16 v[56:59], v[160:163], v[128:131], v[56:59]
    ds_read_b128 v[208:211], v8 offset:41984
    v_mfma_f32_16x16x32_bf16 v[60:63], v[164:167], v[128:131], v[60:63]
    ds_read_b128 v[212:215], v8 offset:44032
    v_mfma_f32_16x16x32_bf16 v[64:67], v[168:171], v[128:131], v[64:67]
    ds_read_b128 v[216:219], v8 offset:46080
    v_mfma_f32_16x16x32_bf16 v[68:71], v[172:175], v[128:131], v[68:71]
    ds_read_b128 v[220:223], v8 offset:48128
    v_mfma_f32_16x16x32_bf16 v[72:75], v[176:179], v[128:131], v[72:75]
    ds_read_b128 v[224:227], v8 offset:50176
    v_mfma_f32_16x16x32_bf16 v[76:79], v[180:183], v[128:131], v[76:79]
    ds_read_b128 v[228:231], v8 offset:52224
    v_mfma_f32_16x16x32_bf16 v[80:83], v[136:139], v[132:135], v[80:83]
    ds_read_b128 v[232:235], v8 offset:54272
    v_mfma_f32_16x16x32_bf16 v[84:87], v[140:143], v[132:135], v[84:87]
    ds_read_b128 v[236:239], v8 offset:56320
    v_mfma_f32_16x16x32_bf16 v[88:91], v[144:147], v[132:135], v[88:91]
    v_mfma_f32_16x16x32_bf16 v[92:95], v[148:151], v[132:135], v[92:95]
    v_mfma_f32_16x16x32_bf16 v[96:99], v[152:155], v[132:135], v[96:99]
    v_mfma_f32_16x16x32_bf16 v[100:103], v[156:159], v[132:135], v[100:103]
    v_mfma_f32_16x16x32_bf16 v[104:107], v[160:163], v[132:135], v[104:107]
    v_mfma_f32_16x16x32_bf16 v[108:111], v[164:167], v[132:135], v[108:111]
    v_mfma_f32_16x16x32_bf16 v[112:115], v[168:171], v[132:135], v[112:115]
    v_mfma_f32_16x16x32_bf16 v[116:119], v[172:175], v[132:135], v[116:119]
    v_mfma_f32_16x16x32_bf16 v[120:123], v[176:179], v[132:135], v[120:123]
    v_mfma_f32_16x16x32_bf16 v[124:127], v[180:183], v[132:135], v[124:127]
    s_waitcnt lgkmcnt(0)
    s_barrier
    v_mfma_f32_16x16x32_bf16 v[32:35], v[192:195], v[184:187], v[32:35]
    ds_read_b128 v[128:131], v4 offset:0
    v_mfma_f32_16x16x32_bf16 v[36:39], v[196:199], v[184:187], v[36:39]
    ds_read_b128 v[132:135], v4 offset:2048
    v_mfma_f32_16x16x32_bf16 v[40:43], v[200:203], v[184:187], v[40:43]
    ds_read_b128 v[136:139], v7 offset:16384
    v_mfma_f32_16x16x32_bf16 v[44:47], v[204:207], v[184:187], v[44:47]
    ds_read_b128 v[140:143], v7 offset:18432
    v_mfma_f32_16x16x32_bf16 v[48:51], v[208:211], v[184:187], v[48:51]
    ds_read_b128 v[144:147], v7 offset:20480
    v_mfma_f32_16x16x32_bf16 v[52:55], v[212:215], v[184:187], v[52:55]
    ds_read_b128 v[148:151], v7 offset:22528
    v_mfma_f32_16x16x32_bf16 v[56:59], v[216:219], v[184:187], v[56:59]
    ds_read_b128 v[152:155], v7 offset:24576
    v_mfma_f32_16x16x32_bf16 v[60:63], v[220:223], v[184:187], v[60:63]
    ds_read_b128 v[156:159], v7 offset:26624
    v_mfma_f32_16x16x32_bf16 v[64:67], v[224:227], v[184:187], v[64:67]
    ds_read_b128 v[160:163], v7 offset:28672
    v_mfma_f32_16x16x32_bf16 v[68:71], v[228:231], v[184:187], v[68:71]
    ds_read_b128 v[164:167], v7 offset:30720
    v_mfma_f32_16x16x32_bf16 v[72:75], v[232:235], v[184:187], v[72:75]
    ds_read_b128 v[168:171], v7 offset:32768
    v_mfma_f32_16x16x32_bf16 v[76:79], v[236:239], v[184:187], v[76:79]
    ds_read_b128 v[172:175], v7 offset:34816
    v_mfma_f32_16x16x32_bf16 v[80:83], v[192:195], v[188:191], v[80:83]
    ds_read_b128 v[176:179], v7 offset:36864
    v_mfma_f32_16x16x32_bf16 v[84:87], v[196:199], v[188:191], v[84:87]
    ds_read_b128 v[180:183], v7 offset:38912
    v_mfma_f32_16x16x32_bf16 v[88:91], v[200:203], v[188:191], v[88:91]
    v_mfma_f32_16x16x32_bf16 v[92:95], v[204:207], v[188:191], v[92:95]
    v_mfma_f32_16x16x32_bf16 v[96:99], v[208:211], v[188:191], v[96:99]
    v_mfma_f32_16x16x32_bf16 v[100:103], v[212:215], v[188:191], v[100:103]
    v_mfma_f32_16x16x32_bf16 v[104:107], v[216:219], v[188:191], v[104:107]
    v_mfma_f32_16x16x32_bf16 v[108:111], v[220:223], v[188:191], v[108:111]
    v_mfma_f32_16x16x32_bf16 v[112:115], v[224:227], v[188:191], v[112:115]
    v_mfma_f32_16x16x32_bf16 v[116:119], v[228:231], v[188:191], v[116:119]
    v_mfma_f32_16x16x32_bf16 v[120:123], v[232:235], v[188:191], v[120:123]
    v_mfma_f32_16x16x32_bf16 v[124:127], v[236:239], v[188:191], v[124:127]
    s_waitcnt lgkmcnt(0)
    v_mfma_f32_16x16x32_bf16 v[32:35], v[136:139], v[128:131], v[32:35]
    ds_read_b128 v[184:187], v4 offset:1024
    v_mfma_f32_16x16x32_bf16 v[36:39], v[140:143], v[128:131], v[36:39]
    ds_read_b128 v[188:191], v4 offset:3072
    v_mfma_f32_16x16x32_bf16 v[40:43], v[144:147], v[128:131], v[40:43]
    ds_read_b128 v[192:195], v7 offset:17408
    v_mfma_f32_16x16x32_bf16 v[44:47], v[148:151], v[128:131], v[44:47]
    ds_read_b128 v[196:199], v7 offset:19456
    v_mfma_f32_16x16x32_bf16 v[48:51], v[152:155], v[128:131], v[48:51]
    ds_read_b128 v[200:203], v7 offset:21504
    v_mfma_f32_16x16x32_bf16 v[52:55], v[156:159], v[128:131], v[52:55]
    ds_read_b128 v[204:207], v7 offset:23552
    v_mfma_f32_16x16x32_bf16 v[56:59], v[160:163], v[128:131], v[56:59]
    ds_read_b128 v[208:211], v7 offset:25600
    v_mfma_f32_16x16x32_bf16 v[60:63], v[164:167], v[128:131], v[60:63]
    ds_read_b128 v[212:215], v7 offset:27648
    v_mfma_f32_16x16x32_bf16 v[64:67], v[168:171], v[128:131], v[64:67]
    ds_read_b128 v[216:219], v7 offset:29696
    v_mfma_f32_16x16x32_bf16 v[68:71], v[172:175], v[128:131], v[68:71]
    ds_read_b128 v[220:223], v7 offset:31744
    v_mfma_f32_16x16x32_bf16 v[72:75], v[176:179], v[128:131], v[72:75]
    ds_read_b128 v[224:227], v7 offset:33792
    v_mfma_f32_16x16x32_bf16 v[76:79], v[180:183], v[128:131], v[76:79]
    ds_read_b128 v[228:231], v7 offset:35840
    v_mfma_f32_16x16x32_bf16 v[80:83], v[136:139], v[132:135], v[80:83]
    ds_read_b128 v[232:235], v7 offset:37888
    v_mfma_f32_16x16x32_bf16 v[84:87], v[140:143], v[132:135], v[84:87]
    ds_read_b128 v[236:239], v7 offset:39936
    v_mfma_f32_16x16x32_bf16 v[88:91], v[144:147], v[132:135], v[88:91]
    v_mfma_f32_16x16x32_bf16 v[92:95], v[148:151], v[132:135], v[92:95]
    v_mfma_f32_16x16x32_bf16 v[96:99], v[152:155], v[132:135], v[96:99]
    v_mfma_f32_16x16x32_bf16 v[100:103], v[156:159], v[132:135], v[100:103]
    v_mfma_f32_16x16x32_bf16 v[104:107], v[160:163], v[132:135], v[104:107]
    v_mfma_f32_16x16x32_bf16 v[108:111], v[164:167], v[132:135], v[108:111]
    v_mfma_f32_16x16x32_bf16 v[112:115], v[168:171], v[132:135], v[112:115]
    v_mfma_f32_16x16x32_bf16 v[116:119], v[172:175], v[132:135], v[116:119]
    v_mfma_f32_16x16x32_bf16 v[120:123], v[176:179], v[132:135], v[120:123]
    v_mfma_f32_16x16x32_bf16 v[124:127], v[180:183], v[132:135], v[124:127]
    s_waitcnt lgkmcnt(0)
    s_barrier
    v_mfma_f32_16x16x32_bf16 v[32:35], v[192:195], v[184:187], v[32:35]
    ds_read_b128 v[128:131], v4 offset:40960
    v_mfma_f32_16x16x32_bf16 v[36:39], v[196:199], v[184:187], v[36:39]
    ds_read_b128 v[132:135], v4 offset:43008
    v_mfma_f32_16x16x32_bf16 v[40:43], v[200:203], v[184:187], v[40:43]
    ds_read_b128 v[136:139], v7 offset:57344
    v_mfma_f32_16x16x32_bf16 v[44:47], v[204:207], v[184:187], v[44:47]
    ds_read_b128 v[140:143], v7 offset:59392
    v_mfma_f32_16x16x32_bf16 v[48:51], v[208:211], v[184:187], v[48:51]
    ds_read_b128 v[144:147], v7 offset:61440
    v_mfma_f32_16x16x32_bf16 v[52:55], v[212:215], v[184:187], v[52:55]
    ds_read_b128 v[148:151], v7 offset:63488
    v_mfma_f32_16x16x32_bf16 v[56:59], v[216:219], v[184:187], v[56:59]
    ds_read_b128 v[152:155], v8 offset:0
    v_mfma_f32_16x16x32_bf16 v[60:63], v[220:223], v[184:187], v[60:63]
    ds_read_b128 v[156:159], v8 offset:2048
    v_mfma_f32_16x16x32_bf16 v[64:67], v[224:227], v[184:187], v[64:67]
    ds_read_b128 v[160:163], v8 offset:4096
    v_mfma_f32_16x16x32_bf16 v[68:71], v[228:231], v[184:187], v[68:71]
    ds_read_b128 v[164:167], v8 offset:6144
    v_mfma_f32_16x16x32_bf16 v[72:75], v[232:235], v[184:187], v[72:75]
    ds_read_b128 v[168:171], v8 offset:8192
    v_mfma_f32_16x16x32_bf16 v[76:79], v[236:239], v[184:187], v[76:79]
    ds_read_b128 v[172:175], v8 offset:10240
    v_mfma_f32_16x16x32_bf16 v[80:83], v[192:195], v[188:191], v[80:83]
    ds_read_b128 v[176:179], v8 offset:12288
    v_mfma_f32_16x16x32_bf16 v[84:87], v[196:199], v[188:191], v[84:87]
    ds_read_b128 v[180:183], v8 offset:14336
    v_mfma_f32_16x16x32_bf16 v[88:91], v[200:203], v[188:191], v[88:91]
    v_mfma_f32_16x16x32_bf16 v[92:95], v[204:207], v[188:191], v[92:95]
    v_mfma_f32_16x16x32_bf16 v[96:99], v[208:211], v[188:191], v[96:99]
    v_mfma_f32_16x16x32_bf16 v[100:103], v[212:215], v[188:191], v[100:103]
    v_mfma_f32_16x16x32_bf16 v[104:107], v[216:219], v[188:191], v[104:107]
    v_mfma_f32_16x16x32_bf16 v[108:111], v[220:223], v[188:191], v[108:111]
    v_mfma_f32_16x16x32_bf16 v[112:115], v[224:227], v[188:191], v[112:115]
    v_mfma_f32_16x16x32_bf16 v[116:119], v[228:231], v[188:191], v[116:119]
    v_mfma_f32_16x16x32_bf16 v[120:123], v[232:235], v[188:191], v[120:123]
    v_mfma_f32_16x16x32_bf16 v[124:127], v[236:239], v[188:191], v[124:127]
    s_waitcnt lgkmcnt(0)
    v_mfma_f32_16x16x32_bf16 v[32:35], v[136:139], v[128:131], v[32:35]
    ds_read_b128 v[184:187], v4 offset:41984
    v_mfma_f32_16x16x32_bf16 v[36:39], v[140:143], v[128:131], v[36:39]
    ds_read_b128 v[188:191], v4 offset:44032
    v_mfma_f32_16x16x32_bf16 v[40:43], v[144:147], v[128:131], v[40:43]
    ds_read_b128 v[192:195], v7 offset:58368
    v_mfma_f32_16x16x32_bf16 v[44:47], v[148:151], v[128:131], v[44:47]
    ds_read_b128 v[196:199], v7 offset:60416
    v_mfma_f32_16x16x32_bf16 v[48:51], v[152:155], v[128:131], v[48:51]
    ds_read_b128 v[200:203], v7 offset:62464
    v_mfma_f32_16x16x32_bf16 v[52:55], v[156:159], v[128:131], v[52:55]
    ds_read_b128 v[204:207], v7 offset:64512
    v_mfma_f32_16x16x32_bf16 v[56:59], v[160:163], v[128:131], v[56:59]
    ds_read_b128 v[208:211], v8 offset:1024
    v_mfma_f32_16x16x32_bf16 v[60:63], v[164:167], v[128:131], v[60:63]
    ds_read_b128 v[212:215], v8 offset:3072
    v_mfma_f32_16x16x32_bf16 v[64:67], v[168:171], v[128:131], v[64:67]
    ds_read_b128 v[216:219], v8 offset:5120
    v_mfma_f32_16x16x32_bf16 v[68:71], v[172:175], v[128:131], v[68:71]
    ds_read_b128 v[220:223], v8 offset:7168
    v_mfma_f32_16x16x32_bf16 v[72:75], v[176:179], v[128:131], v[72:75]
    ds_read_b128 v[224:227], v8 offset:9216
    v_mfma_f32_16x16x32_bf16 v[76:79], v[180:183], v[128:131], v[76:79]
    ds_read_b128 v[228:231], v8 offset:11264
    v_mfma_f32_16x16x32_bf16 v[80:83], v[136:139], v[132:135], v[80:83]
    ds_read_b128 v[232:235], v8 offset:13312
    v_mfma_f32_16x16x32_bf16 v[84:87], v[140:143], v[132:135], v[84:87]
    ds_read_b128 v[236:239], v8 offset:15360
    v_mfma_f32_16x16x32_bf16 v[88:91], v[144:147], v[132:135], v[88:91]
    v_mfma_f32_16x16x32_bf16 v[92:95], v[148:151], v[132:135], v[92:95]
    v_mfma_f32_16x16x32_bf16 v[96:99], v[152:155], v[132:135], v[96:99]
    v_mfma_f32_16x16x32_bf16 v[100:103], v[156:159], v[132:135], v[100:103]
    v_mfma_f32_16x16x32_bf16 v[104:107], v[160:163], v[132:135], v[104:107]
    v_mfma_f32_16x16x32_bf16 v[108:111], v[164:167], v[132:135], v[108:111]
    v_mfma_f32_16x16x32_bf16 v[112:115], v[168:171], v[132:135], v[112:115]
    v_mfma_f32_16x16x32_bf16 v[116:119], v[172:175], v[132:135], v[116:119]
    v_mfma_f32_16x16x32_bf16 v[120:123], v[176:179], v[132:135], v[120:123]
    v_mfma_f32_16x16x32_bf16 v[124:127], v[180:183], v[132:135], v[124:127]
    s_waitcnt lgkmcnt(0)
    s_barrier
    v_mfma_f32_16x16x32_bf16 v[32:35], v[192:195], v[184:187], v[32:35]
    ds_read_b128 v[128:131], v5 offset:16384
    v_mfma_f32_16x16x32_bf16 v[36:39], v[196:199], v[184:187], v[36:39]
    ds_read_b128 v[132:135], v5 offset:18432
    v_mfma_f32_16x16x32_bf16 v[40:43], v[200:203], v[184:187], v[40:43]
    ds_read_b128 v[136:139], v8 offset:32768
    v_mfma_f32_16x16x32_bf16 v[44:47], v[204:207], v[184:187], v[44:47]
    ds_read_b128 v[140:143], v8 offset:34816
    v_mfma_f32_16x16x32_bf16 v[48:51], v[208:211], v[184:187], v[48:51]
    ds_read_b128 v[144:147], v8 offset:36864
    v_mfma_f32_16x16x32_bf16 v[52:55], v[212:215], v[184:187], v[52:55]
    ds_read_b128 v[148:151], v8 offset:38912
    v_mfma_f32_16x16x32_bf16 v[56:59], v[216:219], v[184:187], v[56:59]
    ds_read_b128 v[152:155], v8 offset:40960
    v_mfma_f32_16x16x32_bf16 v[60:63], v[220:223], v[184:187], v[60:63]
    ds_read_b128 v[156:159], v8 offset:43008
    v_mfma_f32_16x16x32_bf16 v[64:67], v[224:227], v[184:187], v[64:67]
    ds_read_b128 v[160:163], v8 offset:45056
    v_mfma_f32_16x16x32_bf16 v[68:71], v[228:231], v[184:187], v[68:71]
    ds_read_b128 v[164:167], v8 offset:47104
    v_mfma_f32_16x16x32_bf16 v[72:75], v[232:235], v[184:187], v[72:75]
    ds_read_b128 v[168:171], v8 offset:49152
    v_mfma_f32_16x16x32_bf16 v[76:79], v[236:239], v[184:187], v[76:79]
    ds_read_b128 v[172:175], v8 offset:51200
    v_mfma_f32_16x16x32_bf16 v[80:83], v[192:195], v[188:191], v[80:83]
    ds_read_b128 v[176:179], v8 offset:53248
    v_mfma_f32_16x16x32_bf16 v[84:87], v[196:199], v[188:191], v[84:87]
    ds_read_b128 v[180:183], v8 offset:55296
    v_mfma_f32_16x16x32_bf16 v[88:91], v[200:203], v[188:191], v[88:91]
    v_mfma_f32_16x16x32_bf16 v[92:95], v[204:207], v[188:191], v[92:95]
    v_mfma_f32_16x16x32_bf16 v[96:99], v[208:211], v[188:191], v[96:99]
    v_mfma_f32_16x16x32_bf16 v[100:103], v[212:215], v[188:191], v[100:103]
    v_mfma_f32_16x16x32_bf16 v[104:107], v[216:219], v[188:191], v[104:107]
    v_mfma_f32_16x16x32_bf16 v[108:111], v[220:223], v[188:191], v[108:111]
    v_mfma_f32_16x16x32_bf16 v[112:115], v[224:227], v[188:191], v[112:115]
    v_mfma_f32_16x16x32_bf16 v[116:119], v[228:231], v[188:191], v[116:119]
    v_mfma_f32_16x16x32_bf16 v[120:123], v[232:235], v[188:191], v[120:123]
    v_mfma_f32_16x16x32_bf16 v[124:127], v[236:239], v[188:191], v[124:127]
    s_waitcnt lgkmcnt(0)
    v_mfma_f32_16x16x32_bf16 v[32:35], v[136:139], v[128:131], v[32:35]
    ds_read_b128 v[184:187], v5 offset:17408
    v_mfma_f32_16x16x32_bf16 v[36:39], v[140:143], v[128:131], v[36:39]
    ds_read_b128 v[188:191], v5 offset:19456
    v_mfma_f32_16x16x32_bf16 v[40:43], v[144:147], v[128:131], v[40:43]
    ds_read_b128 v[192:195], v8 offset:33792
    v_mfma_f32_16x16x32_bf16 v[44:47], v[148:151], v[128:131], v[44:47]
    ds_read_b128 v[196:199], v8 offset:35840
    v_mfma_f32_16x16x32_bf16 v[48:51], v[152:155], v[128:131], v[48:51]
    ds_read_b128 v[200:203], v8 offset:37888
    v_mfma_f32_16x16x32_bf16 v[52:55], v[156:159], v[128:131], v[52:55]
    ds_read_b128 v[204:207], v8 offset:39936
    v_mfma_f32_16x16x32_bf16 v[56:59], v[160:163], v[128:131], v[56:59]
    ds_read_b128 v[208:211], v8 offset:41984
    v_mfma_f32_16x16x32_bf16 v[60:63], v[164:167], v[128:131], v[60:63]
    ds_read_b128 v[212:215], v8 offset:44032
    v_mfma_f32_16x16x32_bf16 v[64:67], v[168:171], v[128:131], v[64:67]
    ds_read_b128 v[216:219], v8 offset:46080
    v_mfma_f32_16x16x32_bf16 v[68:71], v[172:175], v[128:131], v[68:71]
    ds_read_b128 v[220:223], v8 offset:48128
    v_mfma_f32_16x16x32_bf16 v[72:75], v[176:179], v[128:131], v[72:75]
    ds_read_b128 v[224:227], v8 offset:50176
    v_mfma_f32_16x16x32_bf16 v[76:79], v[180:183], v[128:131], v[76:79]
    ds_read_b128 v[228:231], v8 offset:52224
    v_mfma_f32_16x16x32_bf16 v[80:83], v[136:139], v[132:135], v[80:83]
    ds_read_b128 v[232:235], v8 offset:54272
    v_mfma_f32_16x16x32_bf16 v[84:87], v[140:143], v[132:135], v[84:87]
    ds_read_b128 v[236:239], v8 offset:56320
    v_mfma_f32_16x16x32_bf16 v[88:91], v[144:147], v[132:135], v[88:91]
    v_mfma_f32_16x16x32_bf16 v[92:95], v[148:151], v[132:135], v[92:95]
    v_mfma_f32_16x16x32_bf16 v[96:99], v[152:155], v[132:135], v[96:99]
    v_mfma_f32_16x16x32_bf16 v[100:103], v[156:159], v[132:135], v[100:103]
    v_mfma_f32_16x16x32_bf16 v[104:107], v[160:163], v[132:135], v[104:107]
    v_mfma_f32_16x16x32_bf16 v[108:111], v[164:167], v[132:135], v[108:111]
    v_mfma_f32_16x16x32_bf16 v[112:115], v[168:171], v[132:135], v[112:115]
    v_mfma_f32_16x16x32_bf16 v[116:119], v[172:175], v[132:135], v[116:119]
    v_mfma_f32_16x16x32_bf16 v[120:123], v[176:179], v[132:135], v[120:123]
    v_mfma_f32_16x16x32_bf16 v[124:127], v[180:183], v[132:135], v[124:127]
    s_waitcnt lgkmcnt(0)
    s_barrier
    v_mfma_f32_16x16x32_bf16 v[32:35], v[192:195], v[184:187], v[32:35]
    ds_read_b128 v[128:131], v4 offset:0
    v_mfma_f32_16x16x32_bf16 v[36:39], v[196:199], v[184:187], v[36:39]
    ds_read_b128 v[132:135], v4 offset:2048
    v_mfma_f32_16x16x32_bf16 v[40:43], v[200:203], v[184:187], v[40:43]
    ds_read_b128 v[136:139], v7 offset:16384
    v_mfma_f32_16x16x32_bf16 v[44:47], v[204:207], v[184:187], v[44:47]
    ds_read_b128 v[140:143], v7 offset:18432
    v_mfma_f32_16x16x32_bf16 v[48:51], v[208:211], v[184:187], v[48:51]
    ds_read_b128 v[144:147], v7 offset:20480
    v_mfma_f32_16x16x32_bf16 v[52:55], v[212:215], v[184:187], v[52:55]
    ds_read_b128 v[148:151], v7 offset:22528
    v_mfma_f32_16x16x32_bf16 v[56:59], v[216:219], v[184:187], v[56:59]
    ds_read_b128 v[152:155], v7 offset:24576
    v_mfma_f32_16x16x32_bf16 v[60:63], v[220:223], v[184:187], v[60:63]
    ds_read_b128 v[156:159], v7 offset:26624
    v_mfma_f32_16x16x32_bf16 v[64:67], v[224:227], v[184:187], v[64:67]
    ds_read_b128 v[160:163], v7 offset:28672
    v_mfma_f32_16x16x32_bf16 v[68:71], v[228:231], v[184:187], v[68:71]
    ds_read_b128 v[164:167], v7 offset:30720
    v_mfma_f32_16x16x32_bf16 v[72:75], v[232:235], v[184:187], v[72:75]
    ds_read_b128 v[168:171], v7 offset:32768
    v_mfma_f32_16x16x32_bf16 v[76:79], v[236:239], v[184:187], v[76:79]
    ds_read_b128 v[172:175], v7 offset:34816
    v_mfma_f32_16x16x32_bf16 v[80:83], v[192:195], v[188:191], v[80:83]
    ds_read_b128 v[176:179], v7 offset:36864
    v_mfma_f32_16x16x32_bf16 v[84:87], v[196:199], v[188:191], v[84:87]
    ds_read_b128 v[180:183], v7 offset:38912
    v_mfma_f32_16x16x32_bf16 v[88:91], v[200:203], v[188:191], v[88:91]
    v_mfma_f32_16x16x32_bf16 v[92:95], v[204:207], v[188:191], v[92:95]
    v_mfma_f32_16x16x32_bf16 v[96:99], v[208:211], v[188:191], v[96:99]
    v_mfma_f32_16x16x32_bf16 v[100:103], v[212:215], v[188:191], v[100:103]
    v_mfma_f32_16x16x32_bf16 v[104:107], v[216:219], v[188:191], v[104:107]
    v_mfma_f32_16x16x32_bf16 v[108:111], v[220:223], v[188:191], v[108:111]
    v_mfma_f32_16x16x32_bf16 v[112:115], v[224:227], v[188:191], v[112:115]
    v_mfma_f32_16x16x32_bf16 v[116:119], v[228:231], v[188:191], v[116:119]
    v_mfma_f32_16x16x32_bf16 v[120:123], v[232:235], v[188:191], v[120:123]
    v_mfma_f32_16x16x32_bf16 v[124:127], v[236:239], v[188:191], v[124:127]
    s_waitcnt lgkmcnt(0)
    v_mfma_f32_16x16x32_bf16 v[32:35], v[136:139], v[128:131], v[32:35]
    ds_read_b128 v[184:187], v4 offset:1024
    v_mfma_f32_16x16x32_bf16 v[36:39], v[140:143], v[128:131], v[36:39]
    ds_read_b128 v[188:191], v4 offset:3072
    v_mfma_f32_16x16x32_bf16 v[40:43], v[144:147], v[128:131], v[40:43]
    ds_read_b128 v[192:195], v7 offset:17408
    v_mfma_f32_16x16x32_bf16 v[44:47], v[148:151], v[128:131], v[44:47]
    ds_read_b128 v[196:199], v7 offset:19456
    v_mfma_f32_16x16x32_bf16 v[48:51], v[152:155], v[128:131], v[48:51]
    ds_read_b128 v[200:203], v7 offset:21504
    v_mfma_f32_16x16x32_bf16 v[52:55], v[156:159], v[128:131], v[52:55]
    ds_read_b128 v[204:207], v7 offset:23552
    v_mfma_f32_16x16x32_bf16 v[56:59], v[160:163], v[128:131], v[56:59]
    ds_read_b128 v[208:211], v7 offset:25600
    v_mfma_f32_16x16x32_bf16 v[60:63], v[164:167], v[128:131], v[60:63]
    ds_read_b128 v[212:215], v7 offset:27648
    v_mfma_f32_16x16x32_bf16 v[64:67], v[168:171], v[128:131], v[64:67]
    ds_read_b128 v[216:219], v7 offset:29696
    v_mfma_f32_16x16x32_bf16 v[68:71], v[172:175], v[128:131], v[68:71]
    ds_read_b128 v[220:223], v7 offset:31744
    v_mfma_f32_16x16x32_bf16 v[72:75], v[176:179], v[128:131], v[72:75]
    ds_read_b128 v[224:227], v7 offset:33792
    v_mfma_f32_16x16x32_bf16 v[76:79], v[180:183], v[128:131], v[76:79]
    ds_read_b128 v[228:231], v7 offset:35840
    v_mfma_f32_16x16x32_bf16 v[80:83], v[136:139], v[132:135], v[80:83]
    ds_read_b128 v[232:235], v7 offset:37888
    v_mfma_f32_16x16x32_bf16 v[84:87], v[140:143], v[132:135], v[84:87]
    ds_read_b128 v[236:239], v7 offset:39936
    v_mfma_f32_16x16x32_bf16 v[88:91], v[144:147], v[132:135], v[88:91]
    v_mfma_f32_16x16x32_bf16 v[92:95], v[148:151], v[132:135], v[92:95]
    v_mfma_f32_16x16x32_bf16 v[96:99], v[152:155], v[132:135], v[96:99]
    v_mfma_f32_16x16x32_bf16 v[100:103], v[156:159], v[132:135], v[100:103]
    v_mfma_f32_16x16x32_bf16 v[104:107], v[160:163], v[132:135], v[104:107]
    v_mfma_f32_16x16x32_bf16 v[108:111], v[164:167], v[132:135], v[108:111]
    v_mfma_f32_16x16x32_bf16 v[112:115], v[168:171], v[132:135], v[112:115]
    v_mfma_f32_16x16x32_bf16 v[116:119], v[172:175], v[132:135], v[116:119]
    v_mfma_f32_16x16x32_bf16 v[120:123], v[176:179], v[132:135], v[120:123]
    v_mfma_f32_16x16x32_bf16 v[124:127], v[180:183], v[132:135], v[124:127]
    s_waitcnt lgkmcnt(0)
    v_mfma_f32_16x16x32_bf16 v[32:35], v[192:195], v[184:187], v[32:35]
    v_mfma_f32_16x16x32_bf16 v[36:39], v[196:199], v[184:187], v[36:39]
    v_mfma_f32_16x16x32_bf16 v[40:43], v[200:203], v[184:187], v[40:43]
    v_mfma_f32_16x16x32_bf16 v[44:47], v[204:207], v[184:187], v[44:47]
    v_mfma_f32_16x16x32_bf16 v[48:51], v[208:211], v[184:187], v[48:51]
    v_mfma_f32_16x16x32_bf16 v[52:55], v[212:215], v[184:187], v[52:55]
    v_mfma_f32_16x16x32_bf16 v[56:59], v[216:219], v[184:187], v[56:59]
    v_mfma_f32_16x16x32_bf16 v[60:63], v[220:223], v[184:187], v[60:63]
    v_mfma_f32_16x16x32_bf16 v[64:67], v[224:227], v[184:187], v[64:67]
    v_mfma_f32_16x16x32_bf16 v[68:71], v[228:231], v[184:187], v[68:71]
    v_mfma_f32_16x16x32_bf16 v[72:75], v[232:235], v[184:187], v[72:75]
    v_mfma_f32_16x16x32_bf16 v[76:79], v[236:239], v[184:187], v[76:79]
    v_mfma_f32_16x16x32_bf16 v[80:83], v[192:195], v[188:191], v[80:83]
    v_mfma_f32_16x16x32_bf16 v[84:87], v[196:199], v[188:191], v[84:87]
    v_mfma_f32_16x16x32_bf16 v[88:91], v[200:203], v[188:191], v[88:91]
    v_mfma_f32_16x16x32_bf16 v[92:95], v[204:207], v[188:191], v[92:95]
    v_mfma_f32_16x16x32_bf16 v[96:99], v[208:211], v[188:191], v[96:99]
    v_mfma_f32_16x16x32_bf16 v[100:103], v[212:215], v[188:191], v[100:103]
    v_mfma_f32_16x16x32_bf16 v[104:107], v[216:219], v[188:191], v[104:107]
    v_mfma_f32_16x16x32_bf16 v[108:111], v[220:223], v[188:191], v[108:111]
    v_mfma_f32_16x16x32_bf16 v[112:115], v[224:227], v[188:191], v[112:115]
    v_mfma_f32_16x16x32_bf16 v[116:119], v[228:231], v[188:191], v[116:119]
    v_mfma_f32_16x16x32_bf16 v[120:123], v[232:235], v[188:191], v[120:123]
    v_mfma_f32_16x16x32_bf16 v[124:127], v[236:239], v[188:191], v[124:127]
    v_lshrrev_b32 v2, 4, v1
    v_lshlrev_b32 v26, 4, v2
    v_add_u32 v26, 123904, v26
    ds_read_b128 v[128:131], v26 offset:0
    ds_read_b128 v[132:135], v26 offset:64
    ds_read_b128 v[136:139], v26 offset:128
    ds_read_b128 v[140:143], v26 offset:192
    ds_read_b128 v[144:147], v26 offset:256
    ds_read_b128 v[148:151], v26 offset:320
    ds_read_b128 v[152:155], v26 offset:384
    ds_read_b128 v[156:159], v26 offset:448
    ds_read_b128 v[160:163], v26 offset:512
    ds_read_b128 v[164:167], v26 offset:576
    ds_read_b128 v[168:171], v26 offset:640
    ds_read_b128 v[172:175], v26 offset:704
    v_and_b32 v27, 15, v1
    v_lshlrev_b32 v27, 3, v27
    s_lshl_b32 s17, s15, 8
    s_add_u32 s17, s17, 122880
    v_add_u32 v27, s17, v27
    ds_read_b64 v[10:11], v27 offset:0
    ds_read_b64 v[14:15], v27 offset:128
    s_lshl_b32 s17, s13, 3
    s_lshl_b32 s18, s15, 1
    s_add_u32 s17, s17, s18
    s_mul_i32 s17, s17, 48
    s_mul_i32 s18, s14, 3
    s_add_u32 s17, s17, s18
    s_lshl_b32 s17, s17, 10
    s_add_u32 s17, s17, 35651584
    s_add_u32 s18, s17, 49152
    s_waitcnt lgkmcnt(0)
    v_mul_f32 v12, 0xbfb8aa3b, v11
    v_mov_b32 v13, 1.0
    v_mul_f32 v16, 0xbfb8aa3b, v15
    v_mov_b32 v17, 1.0
    v_pk_fma_f32 v[32:33], v[10:11], v[128:129], v[32:33] op_sel_hi:[0,1,1] neg_lo:[1,0,0] neg_hi:[1,0,0]
    v_pk_mul_f32 v[32:33], v[12:13], v[32:33] op_sel_hi:[0,1]
    v_exp_f32 v32, v32
    v_exp_f32 v33, v33
    v_pk_fma_f32 v[40:41], v[10:11], v[136:137], v[40:41] op_sel_hi:[0,1,1] neg_lo:[1,0,0] neg_hi:[1,0,0]
    v_pk_mul_f32 v[40:41], v[10:11], v[40:41] op_sel:[1,0] op_sel_hi:[1,1]
    v_pk_add_f32 v[32:33], v[12:13], v[32:33] op_sel:[1,0] op_sel_hi:[1,1]
    v_rcp_f32 v32, v32
    v_rcp_f32 v33, v33
    v_pk_fma_f32 v[34:35], v[10:11], v[130:131], v[34:35] op_sel_hi:[0,1,1] neg_lo:[1,0,0] neg_hi:[1,0,0]
    v_pk_mul_f32 v[34:35], v[12:13], v[34:35] op_sel_hi:[0,1]
    v_exp_f32 v34, v34
    v_exp_f32 v35, v35
    v_pk_fma_f32 v[42:43], v[10:11], v[138:139], v[42:43] op_sel_hi:[0,1,1] neg_lo:[1,0,0] neg_hi:[1,0,0]
    v_pk_mul_f32 v[42:43], v[10:11], v[42:43] op_sel:[1,0] op_sel_hi:[1,1]
    v_pk_add_f32 v[34:35], v[12:13], v[34:35] op_sel:[1,0] op_sel_hi:[1,1]
    v_rcp_f32 v34, v34
    v_rcp_f32 v35, v35
    v_pk_mul_f32 v[40:41], v[40:41], v[32:33]
    v_pk_mul_f32 v[42:43], v[42:43], v[34:35]
    v_pk_fma_f32 v[36:37], v[10:11], v[132:133], v[36:37] op_sel_hi:[0,1,1] neg_lo:[1,0,0] neg_hi:[1,0,0]
    v_pk_mul_f32 v[36:37], v[12:13], v[36:37] op_sel_hi:[0,1]
    v_exp_f32 v36, v36
    v_exp_f32 v37, v37
    v_pk_fma_f32 v[44:45], v[10:11], v[140:141], v[44:45] op_sel_hi:[0,1,1] neg_lo:[1,0,0] neg_hi:[1,0,0]
    v_pk_mul_f32 v[44:45], v[10:11], v[44:45] op_sel:[1,0] op_sel_hi:[1,1]
    v_pk_add_f32 v[36:37], v[12:13], v[36:37] op_sel:[1,0] op_sel_hi:[1,1]
    v_rcp_f32 v36, v36
    v_rcp_f32 v37, v37
    v_pk_fma_f32 v[38:39], v[10:11], v[134:135], v[38:39] op_sel_hi:[0,1,1] neg_lo:[1,0,0] neg_hi:[1,0,0]
    v_pk_mul_f32 v[38:39], v[12:13], v[38:39] op_sel_hi:[0,1]
    v_exp_f32 v38, v38
    v_exp_f32 v39, v39
    v_pk_fma_f32 v[46:47], v[10:11], v[142:143], v[46:47] op_sel_hi:[0,1,1] neg_lo:[1,0,0] neg_hi:[1,0,0]
    v_pk_mul_f32 v[46:47], v[10:11], v[46:47] op_sel:[1,0] op_sel_hi:[1,1]
    v_pk_add_f32 v[38:39], v[12:13], v[38:39] op_sel:[1,0] op_sel_hi:[1,1]
    v_rcp_f32 v38, v38
    v_rcp_f32 v39, v39
    v_pk_mul_f32 v[44:45], v[44:45], v[36:37]
    v_pk_mul_f32 v[46:47], v[46:47], v[38:39]
    v_cvt_pk_bf16_f32 v32, v40, v41
    v_cvt_pk_bf16_f32 v33, v42, v43
    v_cvt_pk_bf16_f32 v34, v44, v45
    v_cvt_pk_bf16_f32 v35, v46, v47
    buffer_store_dwordx4 v[32:35], v3, s[4:7], s17 offen offset:0
    v_pk_fma_f32 v[48:49], v[10:11], v[144:145], v[48:49] op_sel_hi:[0,1,1] neg_lo:[1,0,0] neg_hi:[1,0,0]
    v_pk_mul_f32 v[48:49], v[12:13], v[48:49] op_sel_hi:[0,1]
    v_exp_f32 v48, v48
    v_exp_f32 v49, v49
    v_pk_fma_f32 v[56:57], v[10:11], v[152:153], v[56:57] op_sel_hi:[0,1,1] neg_lo:[1,0,0] neg_hi:[1,0,0]
    v_pk_mul_f32 v[56:57], v[10:11], v[56:57] op_sel:[1,0] op_sel_hi:[1,1]
    v_pk_add_f32 v[48:49], v[12:13], v[48:49] op_sel:[1,0] op_sel_hi:[1,1]
    v_rcp_f32 v48, v48
    v_rcp_f32 v49, v49
    v_pk_fma_f32 v[50:51], v[10:11], v[146:147], v[50:51] op_sel_hi:[0,1,1] neg_lo:[1,0,0] neg_hi:[1,0,0]
    v_pk_mul_f32 v[50:51], v[12:13], v[50:51] op_sel_hi:[0,1]
    v_exp_f32 v50, v50
    v_exp_f32 v51, v51
    v_pk_fma_f32 v[58:59], v[10:11], v[154:155], v[58:59] op_sel_hi:[0,1,1] neg_lo:[1,0,0] neg_hi:[1,0,0]
    v_pk_mul_f32 v[58:59], v[10:11], v[58:59] op_sel:[1,0] op_sel_hi:[1,1]
    v_pk_add_f32 v[50:51], v[12:13], v[50:51] op_sel:[1,0] op_sel_hi:[1,1]
    v_rcp_f32 v50, v50
    v_rcp_f32 v51, v51
    v_pk_mul_f32 v[56:57], v[56:57], v[48:49]
    v_pk_mul_f32 v[58:59], v[58:59], v[50:51]
    v_pk_fma_f32 v[52:53], v[10:11], v[148:149], v[52:53] op_sel_hi:[0,1,1] neg_lo:[1,0,0] neg_hi:[1,0,0]
    v_pk_mul_f32 v[52:53], v[12:13], v[52:53] op_sel_hi:[0,1]
    v_exp_f32 v52, v52
    v_exp_f32 v53, v53
    v_pk_fma_f32 v[60:61], v[10:11], v[156:157], v[60:61] op_sel_hi:[0,1,1] neg_lo:[1,0,0] neg_hi:[1,0,0]
    v_pk_mul_f32 v[60:61], v[10:11], v[60:61] op_sel:[1,0] op_sel_hi:[1,1]
    v_pk_add_f32 v[52:53], v[12:13], v[52:53] op_sel:[1,0] op_sel_hi:[1,1]
    v_rcp_f32 v52, v52
    v_rcp_f32 v53, v53
    v_pk_fma_f32 v[54:55], v[10:11], v[150:151], v[54:55] op_sel_hi:[0,1,1] neg_lo:[1,0,0] neg_hi:[1,0,0]
    v_pk_mul_f32 v[54:55], v[12:13], v[54:55] op_sel_hi:[0,1]
    v_exp_f32 v54, v54
    v_exp_f32 v55, v55
    v_pk_fma_f32 v[62:63], v[10:11], v[158:159], v[62:63] op_sel_hi:[0,1,1] neg_lo:[1,0,0] neg_hi:[1,0,0]
    v_pk_mul_f32 v[62:63], v[10:11], v[62:63] op_sel:[1,0] op_sel_hi:[1,1]
    v_pk_add_f32 v[54:55], v[12:13], v[54:55] op_sel:[1,0] op_sel_hi:[1,1]
    v_rcp_f32 v54, v54
    v_rcp_f32 v55, v55
    v_pk_mul_f32 v[60:61], v[60:61], v[52:53]
    v_pk_mul_f32 v[62:63], v[62:63], v[54:55]
    v_cvt_pk_bf16_f32 v48, v56, v57
    v_cvt_pk_bf16_f32 v49, v58, v59
    v_cvt_pk_bf16_f32 v50, v60, v61
    v_cvt_pk_bf16_f32 v51, v62, v63
    buffer_store_dwordx4 v[48:51], v3, s[4:7], s17 offen offset:1024
    v_pk_fma_f32 v[64:65], v[10:11], v[160:161], v[64:65] op_sel_hi:[0,1,1] neg_lo:[1,0,0] neg_hi:[1,0,0]
    v_pk_mul_f32 v[64:65], v[12:13], v[64:65] op_sel_hi:[0,1]
    v_exp_f32 v64, v64
    v_exp_f32 v65, v65
    v_pk_fma_f32 v[72:73], v[10:11], v[168:169], v[72:73] op_sel_hi:[0,1,1] neg_lo:[1,0,0] neg_hi:[1,0,0]
    v_pk_mul_f32 v[72:73], v[10:11], v[72:73] op_sel:[1,0] op_sel_hi:[1,1]
    v_pk_add_f32 v[64:65], v[12:13], v[64:65] op_sel:[1,0] op_sel_hi:[1,1]
    v_rcp_f32 v64, v64
    v_rcp_f32 v65, v65
    v_pk_fma_f32 v[66:67], v[10:11], v[162:163], v[66:67] op_sel_hi:[0,1,1] neg_lo:[1,0,0] neg_hi:[1,0,0]
    v_pk_mul_f32 v[66:67], v[12:13], v[66:67] op_sel_hi:[0,1]
    v_exp_f32 v66, v66
    v_exp_f32 v67, v67
    v_pk_fma_f32 v[74:75], v[10:11], v[170:171], v[74:75] op_sel_hi:[0,1,1] neg_lo:[1,0,0] neg_hi:[1,0,0]
    v_pk_mul_f32 v[74:75], v[10:11], v[74:75] op_sel:[1,0] op_sel_hi:[1,1]
    v_pk_add_f32 v[66:67], v[12:13], v[66:67] op_sel:[1,0] op_sel_hi:[1,1]
    v_rcp_f32 v66, v66
    v_rcp_f32 v67, v67
    v_pk_mul_f32 v[72:73], v[72:73], v[64:65]
    v_pk_mul_f32 v[74:75], v[74:75], v[66:67]
    v_pk_fma_f32 v[68:69], v[10:11], v[164:165], v[68:69] op_sel_hi:[0,1,1] neg_lo:[1,0,0] neg_hi:[1,0,0]
    v_pk_mul_f32 v[68:69], v[12:13], v[68:69] op_sel_hi:[0,1]
    v_exp_f32 v68, v68
    v_exp_f32 v69, v69
    v_pk_fma_f32 v[76:77], v[10:11], v[172:173], v[76:77] op_sel_hi:[0,1,1] neg_lo:[1,0,0] neg_hi:[1,0,0]
    v_pk_mul_f32 v[76:77], v[10:11], v[76:77] op_sel:[1,0] op_sel_hi:[1,1]
    v_pk_add_f32 v[68:69], v[12:13], v[68:69] op_sel:[1,0] op_sel_hi:[1,1]
    v_rcp_f32 v68, v68
    v_rcp_f32 v69, v69
    v_pk_fma_f32 v[70:71], v[10:11], v[166:167], v[70:71] op_sel_hi:[0,1,1] neg_lo:[1,0,0] neg_hi:[1,0,0]
    v_pk_mul_f32 v[70:71], v[12:13], v[70:71] op_sel_hi:[0,1]
    v_exp_f32 v70, v70
    v_exp_f32 v71, v71
    v_pk_fma_f32 v[78:79], v[10:11], v[174:175], v[78:79] op_sel_hi:[0,1,1] neg_lo:[1,0,0] neg_hi:[1,0,0]
    v_pk_mul_f32 v[78:79], v[10:11], v[78:79] op_sel:[1,0] op_sel_hi:[1,1]
    v_pk_add_f32 v[70:71], v[12:13], v[70:71] op_sel:[1,0] op_sel_hi:[1,1]
    v_rcp_f32 v70, v70
    v_rcp_f32 v71, v71
    v_pk_mul_f32 v[76:77], v[76:77], v[68:69]
    v_pk_mul_f32 v[78:79], v[78:79], v[70:71]
    v_cvt_pk_bf16_f32 v64, v72, v73
    v_cvt_pk_bf16_f32 v65, v74, v75
    v_cvt_pk_bf16_f32 v66, v76, v77
    v_cvt_pk_bf16_f32 v67, v78, v79
    buffer_store_dwordx4 v[64:67], v3, s[4:7], s17 offen offset:2048
    v_pk_fma_f32 v[80:81], v[14:15], v[128:129], v[80:81] op_sel_hi:[0,1,1] neg_lo:[1,0,0] neg_hi:[1,0,0]
    v_pk_mul_f32 v[80:81], v[16:17], v[80:81] op_sel_hi:[0,1]
    v_exp_f32 v80, v80
    v_exp_f32 v81, v81
    v_pk_fma_f32 v[88:89], v[14:15], v[136:137], v[88:89] op_sel_hi:[0,1,1] neg_lo:[1,0,0] neg_hi:[1,0,0]
    v_pk_mul_f32 v[88:89], v[14:15], v[88:89] op_sel:[1,0] op_sel_hi:[1,1]
    v_pk_add_f32 v[80:81], v[16:17], v[80:81] op_sel:[1,0] op_sel_hi:[1,1]
    v_rcp_f32 v80, v80
    v_rcp_f32 v81, v81
    v_pk_fma_f32 v[82:83], v[14:15], v[130:131], v[82:83] op_sel_hi:[0,1,1] neg_lo:[1,0,0] neg_hi:[1,0,0]
    v_pk_mul_f32 v[82:83], v[16:17], v[82:83] op_sel_hi:[0,1]
    v_exp_f32 v82, v82
    v_exp_f32 v83, v83
    v_pk_fma_f32 v[90:91], v[14:15], v[138:139], v[90:91] op_sel_hi:[0,1,1] neg_lo:[1,0,0] neg_hi:[1,0,0]
    v_pk_mul_f32 v[90:91], v[14:15], v[90:91] op_sel:[1,0] op_sel_hi:[1,1]
    v_pk_add_f32 v[82:83], v[16:17], v[82:83] op_sel:[1,0] op_sel_hi:[1,1]
    v_rcp_f32 v82, v82
    v_rcp_f32 v83, v83
    v_pk_mul_f32 v[88:89], v[88:89], v[80:81]
    v_pk_mul_f32 v[90:91], v[90:91], v[82:83]
    v_pk_fma_f32 v[84:85], v[14:15], v[132:133], v[84:85] op_sel_hi:[0,1,1] neg_lo:[1,0,0] neg_hi:[1,0,0]
    v_pk_mul_f32 v[84:85], v[16:17], v[84:85] op_sel_hi:[0,1]
    v_exp_f32 v84, v84
    v_exp_f32 v85, v85
    v_pk_fma_f32 v[92:93], v[14:15], v[140:141], v[92:93] op_sel_hi:[0,1,1] neg_lo:[1,0,0] neg_hi:[1,0,0]
    v_pk_mul_f32 v[92:93], v[14:15], v[92:93] op_sel:[1,0] op_sel_hi:[1,1]
    v_pk_add_f32 v[84:85], v[16:17], v[84:85] op_sel:[1,0] op_sel_hi:[1,1]
    v_rcp_f32 v84, v84
    v_rcp_f32 v85, v85
    v_pk_fma_f32 v[86:87], v[14:15], v[134:135], v[86:87] op_sel_hi:[0,1,1] neg_lo:[1,0,0] neg_hi:[1,0,0]
    v_pk_mul_f32 v[86:87], v[16:17], v[86:87] op_sel_hi:[0,1]
    v_exp_f32 v86, v86
    v_exp_f32 v87, v87
    v_pk_fma_f32 v[94:95], v[14:15], v[142:143], v[94:95] op_sel_hi:[0,1,1] neg_lo:[1,0,0] neg_hi:[1,0,0]
    v_pk_mul_f32 v[94:95], v[14:15], v[94:95] op_sel:[1,0] op_sel_hi:[1,1]
    v_pk_add_f32 v[86:87], v[16:17], v[86:87] op_sel:[1,0] op_sel_hi:[1,1]
    v_rcp_f32 v86, v86
    v_rcp_f32 v87, v87
    v_pk_mul_f32 v[92:93], v[92:93], v[84:85]
    v_pk_mul_f32 v[94:95], v[94:95], v[86:87]
    v_cvt_pk_bf16_f32 v80, v88, v89
    v_cvt_pk_bf16_f32 v81, v90, v91
    v_cvt_pk_bf16_f32 v82, v92, v93
    v_cvt_pk_bf16_f32 v83, v94, v95
    buffer_store_dwordx4 v[80:83], v3, s[4:7], s18 offen offset:0
    v_pk_fma_f32 v[96:97], v[14:15], v[144:145], v[96:97] op_sel_hi:[0,1,1] neg_lo:[1,0,0] neg_hi:[1,0,0]
    v_pk_mul_f32 v[96:97], v[16:17], v[96:97] op_sel_hi:[0,1]
    v_exp_f32 v96, v96
    v_exp_f32 v97, v97
    v_pk_fma_f32 v[104:105], v[14:15], v[152:153], v[104:105] op_sel_hi:[0,1,1] neg_lo:[1,0,0] neg_hi:[1,0,0]
    v_pk_mul_f32 v[104:105], v[14:15], v[104:105] op_sel:[1,0] op_sel_hi:[1,1]
    v_pk_add_f32 v[96:97], v[16:17], v[96:97] op_sel:[1,0] op_sel_hi:[1,1]
    v_rcp_f32 v96, v96
    v_rcp_f32 v97, v97
    v_pk_fma_f32 v[98:99], v[14:15], v[146:147], v[98:99] op_sel_hi:[0,1,1] neg_lo:[1,0,0] neg_hi:[1,0,0]
    v_pk_mul_f32 v[98:99], v[16:17], v[98:99] op_sel_hi:[0,1]
    v_exp_f32 v98, v98
    v_exp_f32 v99, v99
    v_pk_fma_f32 v[106:107], v[14:15], v[154:155], v[106:107] op_sel_hi:[0,1,1] neg_lo:[1,0,0] neg_hi:[1,0,0]
    v_pk_mul_f32 v[106:107], v[14:15], v[106:107] op_sel:[1,0] op_sel_hi:[1,1]
    v_pk_add_f32 v[98:99], v[16:17], v[98:99] op_sel:[1,0] op_sel_hi:[1,1]
    v_rcp_f32 v98, v98
    v_rcp_f32 v99, v99
    v_pk_mul_f32 v[104:105], v[104:105], v[96:97]
    v_pk_mul_f32 v[106:107], v[106:107], v[98:99]
    v_pk_fma_f32 v[100:101], v[14:15], v[148:149], v[100:101] op_sel_hi:[0,1,1] neg_lo:[1,0,0] neg_hi:[1,0,0]
    v_pk_mul_f32 v[100:101], v[16:17], v[100:101] op_sel_hi:[0,1]
    v_exp_f32 v100, v100
    v_exp_f32 v101, v101
    v_pk_fma_f32 v[108:109], v[14:15], v[156:157], v[108:109] op_sel_hi:[0,1,1] neg_lo:[1,0,0] neg_hi:[1,0,0]
    v_pk_mul_f32 v[108:109], v[14:15], v[108:109] op_sel:[1,0] op_sel_hi:[1,1]
    v_pk_add_f32 v[100:101], v[16:17], v[100:101] op_sel:[1,0] op_sel_hi:[1,1]
    v_rcp_f32 v100, v100
    v_rcp_f32 v101, v101
    v_pk_fma_f32 v[102:103], v[14:15], v[150:151], v[102:103] op_sel_hi:[0,1,1] neg_lo:[1,0,0] neg_hi:[1,0,0]
    v_pk_mul_f32 v[102:103], v[16:17], v[102:103] op_sel_hi:[0,1]
    v_exp_f32 v102, v102
    v_exp_f32 v103, v103
    v_pk_fma_f32 v[110:111], v[14:15], v[158:159], v[110:111] op_sel_hi:[0,1,1] neg_lo:[1,0,0] neg_hi:[1,0,0]
    v_pk_mul_f32 v[110:111], v[14:15], v[110:111] op_sel:[1,0] op_sel_hi:[1,1]
    v_pk_add_f32 v[102:103], v[16:17], v[102:103] op_sel:[1,0] op_sel_hi:[1,1]
    v_rcp_f32 v102, v102
    v_rcp_f32 v103, v103
    v_pk_mul_f32 v[108:109], v[108:109], v[100:101]
    v_pk_mul_f32 v[110:111], v[110:111], v[102:103]
    v_cvt_pk_bf16_f32 v96, v104, v105
    v_cvt_pk_bf16_f32 v97, v106, v107
    v_cvt_pk_bf16_f32 v98, v108, v109
    v_cvt_pk_bf16_f32 v99, v110, v111
    buffer_store_dwordx4 v[96:99], v3, s[4:7], s18 offen offset:1024
    v_pk_fma_f32 v[112:113], v[14:15], v[160:161], v[112:113] op_sel_hi:[0,1,1] neg_lo:[1,0,0] neg_hi:[1,0,0]
    v_pk_mul_f32 v[112:113], v[16:17], v[112:113] op_sel_hi:[0,1]
    v_exp_f32 v112, v112
    v_exp_f32 v113, v113
    v_pk_fma_f32 v[120:121], v[14:15], v[168:169], v[120:121] op_sel_hi:[0,1,1] neg_lo:[1,0,0] neg_hi:[1,0,0]
    v_pk_mul_f32 v[120:121], v[14:15], v[120:121] op_sel:[1,0] op_sel_hi:[1,1]
    v_pk_add_f32 v[112:113], v[16:17], v[112:113] op_sel:[1,0] op_sel_hi:[1,1]
    v_rcp_f32 v112, v112
    v_rcp_f32 v113, v113
    v_pk_fma_f32 v[114:115], v[14:15], v[162:163], v[114:115] op_sel_hi:[0,1,1] neg_lo:[1,0,0] neg_hi:[1,0,0]
    v_pk_mul_f32 v[114:115], v[16:17], v[114:115] op_sel_hi:[0,1]
    v_exp_f32 v114, v114
    v_exp_f32 v115, v115
    v_pk_fma_f32 v[122:123], v[14:15], v[170:171], v[122:123] op_sel_hi:[0,1,1] neg_lo:[1,0,0] neg_hi:[1,0,0]
    v_pk_mul_f32 v[122:123], v[14:15], v[122:123] op_sel:[1,0] op_sel_hi:[1,1]
    v_pk_add_f32 v[114:115], v[16:17], v[114:115] op_sel:[1,0] op_sel_hi:[1,1]
    v_rcp_f32 v114, v114
    v_rcp_f32 v115, v115
    v_pk_mul_f32 v[120:121], v[120:121], v[112:113]
    v_pk_mul_f32 v[122:123], v[122:123], v[114:115]
    v_pk_fma_f32 v[116:117], v[14:15], v[164:165], v[116:117] op_sel_hi:[0,1,1] neg_lo:[1,0,0] neg_hi:[1,0,0]
    v_pk_mul_f32 v[116:117], v[16:17], v[116:117] op_sel_hi:[0,1]
    v_exp_f32 v116, v116
    v_exp_f32 v117, v117
    v_pk_fma_f32 v[124:125], v[14:15], v[172:173], v[124:125] op_sel_hi:[0,1,1] neg_lo:[1,0,0] neg_hi:[1,0,0]
    v_pk_mul_f32 v[124:125], v[14:15], v[124:125] op_sel:[1,0] op_sel_hi:[1,1]
    v_pk_add_f32 v[116:117], v[16:17], v[116:117] op_sel:[1,0] op_sel_hi:[1,1]
    v_rcp_f32 v116, v116
    v_rcp_f32 v117, v117
    v_pk_fma_f32 v[118:119], v[14:15], v[166:167], v[118:119] op_sel_hi:[0,1,1] neg_lo:[1,0,0] neg_hi:[1,0,0]
    v_pk_mul_f32 v[118:119], v[16:17], v[118:119] op_sel_hi:[0,1]
    v_exp_f32 v118, v118
    v_exp_f32 v119, v119
    v_pk_fma_f32 v[126:127], v[14:15], v[174:175], v[126:127] op_sel_hi:[0,1,1] neg_lo:[1,0,0] neg_hi:[1,0,0]
    v_pk_mul_f32 v[126:127], v[14:15], v[126:127] op_sel:[1,0] op_sel_hi:[1,1]
    v_pk_add_f32 v[118:119], v[16:17], v[118:119] op_sel:[1,0] op_sel_hi:[1,1]
    v_rcp_f32 v118, v118
    v_rcp_f32 v119, v119
    v_pk_mul_f32 v[124:125], v[124:125], v[116:117]
    v_pk_mul_f32 v[126:127], v[126:127], v[118:119]
    v_cvt_pk_bf16_f32 v112, v120, v121
    v_cvt_pk_bf16_f32 v113, v122, v123
    v_cvt_pk_bf16_f32 v114, v124, v125
    v_cvt_pk_bf16_f32 v115, v126, v127
    buffer_store_dwordx4 v[112:115], v3, s[4:7], s18 offen offset:2048
    s_nop 3
gu1_kernel_end:
    s_endpgm

.text
.globl dn1_kernel
.p2align 8
.type dn1_kernel,@function
dn1_kernel:
    s_cmp_ge_u32 s2, 256
    s_cbranch_scc1 dn1_kernel_end
    s_load_dwordx2 s[4:5], s[0:1], 72
    v_lshrrev_b32 v2, 6, v0
    s_nop 0
    v_readfirstlane_b32 s12, v2
    v_and_b32 v1, 63, v0
    v_lshlrev_b32 v3, 4, v1
    s_and_b32 s17, s2, 7
    s_lshr_b32 s18, s2, 3
    s_and_b32 s19, s17, 1
    s_lshr_b32 s17, s17, 1
    s_mul_i32 s19, s19, 32
    s_add_u32 s18, s18, s19
    s_and_b32 s13, s18, 7
    s_lshl_b32 s17, s17, 3
    s_add_u32 s13, s13, s17
    s_lshr_b32 s14, s18, 3
    s_cmp_lt_u32 s12, 4
    s_cbranch_scc1 dn1_kernel_comp
    s_sub_u32 s12, s12, 4
    s_add_u32 s18, s12, 0
    s_mul_i32 s56, s18, 2048
    s_mul_i32 s20, s13, 4
    s_add_u32 s20, s20, s18
    s_mul_i32 s20, s20, 49152
    s_add_u32 s20, s20, 35651584
    s_mul_i32 s21, s14, 5
    s_add_u32 s21, s21, s18
    s_sub_u32 s21, s21, 4
    s_mul_i32 s21, s21, 49152
    s_add_u32 s21, s21, 7274496
    s_cmp_lt_u32 s18, 4
    s_cselect_b32 s24, s20, s21
    s_add_u32 s18, s12, 2
    s_mul_i32 s57, s18, 2048
    s_mul_i32 s20, s13, 4
    s_add_u32 s20, s20, s18
    s_mul_i32 s20, s20, 49152
    s_add_u32 s20, s20, 35651584
    s_mul_i32 s21, s14, 5
    s_add_u32 s21, s21, s18
    s_sub_u32 s21, s21, 4
    s_mul_i32 s21, s21, 49152
    s_add_u32 s21, s21, 7274496
    s_cmp_lt_u32 s18, 4
    s_cselect_b32 s25, s20, s21
    s_add_u32 s18, s12, 4
    s_mul_i32 s58, s18, 2048
    s_mul_i32 s20, s13, 4
    s_add_u32 s20, s20, s18
    s_mul_i32 s20, s20, 49152
    s_add_u32 s20, s20, 35651584
    s_mul_i32 s21, s14, 5
    s_add_u32 s21, s21, s18
    s_sub_u32 s21, s21, 4
    s_mul_i32 s21, s21, 49152
    s_add_u32 s21, s21, 7274496
    s_cmp_lt_u32 s18, 4
    s_cselect_b32 s26, s20, s21
    s_add_u32 s18, s12, 6
    s_mul_i32 s59, s18, 2048
    s_mul_i32 s20, s13, 4
    s_add_u32 s20, s20, s18
    s_mul_i32 s20, s20, 49152
    s_add_u32 s20, s20, 35651584
    s_mul_i32 s21, s14, 5
    s_add_u32 s21, s21, s18
    s_sub_u32 s21, s21, 4
    s_mul_i32 s21, s21, 49152
    s_add_u32 s21, s21, 7274496
    s_cmp_lt_u32 s18, 4
    s_cselect_b32 s27, s20, s21
    s_mov_b32 s18, 8
    s_mul_i32 s60, s18, 2048
    s_mul_i32 s20, s13, 4
    s_add_u32 s20, s20, s18
    s_mul_i32 s20, s20, 49152
    s_add_u32 s20, s20, 35651584
    s_mul_i32 s21, s14, 5
    s_add_u32 s21, s21, s18
    s_sub_u32 s21, s21, 4
    s_mul_i32 s21, s21, 49152
    s_add_u32 s21, s21, 7274496
    s_cmp_lt_u32 s18, 4
    s_cselect_b32 s28, s20, s21
    s_lshl_b32 s18, s12, 10
    s_add_u32 s28, s28, s18
    s_add_u32 s60, s60, s18
    s_waitcnt lgkmcnt(0)
    s_and_b32 s5, s5, 0xffff
    s_mov_b32 s6, 268435456
    s_mov_b32 s7, 0x00020000
    s_add_u32 m0, s56, 0
    s_add_u32 s22, s24, 0
    buffer_load_dwordx4 v3, s[4:7], s22 offen offset:0 lds
    buffer_load_dwordx4 v3, s[4:7], s22 offen offset:1024 lds
    s_add_u32 m0, s57, 0
    s_add_u32 s23, s25, 0
    buffer_load_dwordx4 v3, s[4:7], s23 offen offset:0 lds
    buffer_load_dwordx4 v3, s[4:7], s23 offen offset:1024 lds
    s_add_u32 m0, s58, 0
    s_add_u32 s22, s26, 0
    buffer_load_dwordx4 v3, s[4:7], s22 offen offset:0 lds
    buffer_load_dwordx4 v3, s[4:7], s22 offen offset:1024 lds
    s_add_u32 m0, s59, 0
    s_add_u32 s23, s27, 0
    buffer_load_dwordx4 v3, s[4:7], s23 offen offset:0 lds
    buffer_load_dwordx4 v3, s[4:7], s23 offen offset:1024 lds
    s_add_u32 m0, s60, 0
    s_add_u32 s22, s28, 0
    buffer_load_dwordx4 v3, s[4:7], s22 offen offset:0 lds
    s_add_u32 m0, s56, 18432
    s_add_u32 s22, s24, 2048
    buffer_load_dwordx4 v3, s[4:7], s22 offen offset:0 lds
    buffer_load_dwordx4 v3, s[4:7], s22 offen offset:1024 lds
    s_add_u32 m0, s57, 18432
    s_add_u32 s23, s25, 2048
    buffer_load_dwordx4 v3, s[4:7], s23 offen offset:0 lds
    buffer_load_dwordx4 v3, s[4:7], s23 offen offset:1024 lds
    s_add_u32 m0, s58, 18432
    s_add_u32 s22, s26, 2048
    buffer_load_dwordx4 v3, s[4:7], s22 offen offset:0 lds
    buffer_load_dwordx4 v3, s[4:7], s22 offen offset:1024 lds
    s_add_u32 m0, s59, 18432
    s_add_u32 s23, s27, 2048
    buffer_load_dwordx4 v3, s[4:7], s23 offen offset:0 lds
    buffer_load_dwordx4 v3, s[4:7], s23 offen offset:1024 lds
    s_add_u32 m0, s60, 18432
    s_add_u32 s22, s28, 2048
    buffer_load_dwordx4 v3, s[4:7], s22 offen offset:0 lds
    s_add_u32 m0, s56, 36864
    s_add_u32 s22, s24, 4096
    buffer_load_dwordx4 v3, s[4:7], s22 offen offset:0 lds
    buffer_load_dwordx4 v3, s[4:7], s22 offen offset:1024 lds
    s_add_u32 m0, s57, 36864
    s_add_u32 s23, s25, 4096
    buffer_load_dwordx4 v3, s[4:7], s23 offen offset:0 lds
    buffer_load_dwordx4 v3, s[4:7], s23 offen offset:1024 lds
    s_add_u32 m0, s58, 36864
    s_add_u32 s22, s26, 4096
    buffer_load_dwordx4 v3, s[4:7], s22 offen offset:0 lds
    buffer_load_dwordx4 v3, s[4:7], s22 offen offset:1024 lds
    s_add_u32 m0, s59, 36864
    s_add_u32 s23, s27, 4096
    buffer_load_dwordx4 v3, s[4:7], s23 offen offset:0 lds
    buffer_load_dwordx4 v3, s[4:7], s23 offen offset:1024 lds
    s_add_u32 m0, s60, 36864
    s_add_u32 s22, s28, 4096
    buffer_load_dwordx4 v3, s[4:7], s22 offen offset:0 lds
    s_waitcnt vmcnt(18)
    s_barrier
    s_add_u32 m0, s56, 55296
    s_add_u32 s22, s24, 6144
    buffer_load_dwordx4 v3, s[4:7], s22 offen offset:0 lds
    buffer_load_dwordx4 v3, s[4:7], s22 offen offset:1024 lds
    s_add_u32 m0, s57, 55296
    s_add_u32 s23, s25, 6144
    buffer_load_dwordx4 v3, s[4:7], s23 offen offset:0 lds
    buffer_load_dwordx4 v3, s[4:7], s23 offen offset:1024 lds
    s_add_u32 m0, s58, 55296
    s_add_u32 s22, s26, 6144
    buffer_load_dwordx4 v3, s[4:7], s22 offen offset:0 lds
    buffer_load_dwordx4 v3, s[4:7], s22 offen offset:1024 lds
    s_add_u32 m0, s59, 55296
    s_add_u32 s23, s27, 6144
    buffer_load_dwordx4 v3, s[4:7], s23 offen offset:0 lds
    buffer_load_dwordx4 v3, s[4:7], s23 offen offset:1024 lds
    s_add_u32 m0, s60, 55296
    s_add_u32 s22, s28, 6144
    buffer_load_dwordx4 v3, s[4:7], s22 offen offset:0 lds
    s_add_u32 m0, s56, 73728
    s_add_u32 s22, s24, 8192
    buffer_load_dwordx4 v3, s[4:7], s22 offen offset:0 lds
    buffer_load_dwordx4 v3, s[4:7], s22 offen offset:1024 lds
    s_add_u32 m0, s57, 73728
    s_add_u32 s23, s25, 8192
    buffer_load_dwordx4 v3, s[4:7], s23 offen offset:0 lds
    buffer_load_dwordx4 v3, s[4:7], s23 offen offset:1024 lds
    s_add_u32 m0, s58, 73728
    s_add_u32 s22, s26, 8192
    buffer_load_dwordx4 v3, s[4:7], s22 offen offset:0 lds
    buffer_load_dwordx4 v3, s[4:7], s22 offen offset:1024 lds
    s_add_u32 m0, s59, 73728
    s_add_u32 s23, s27, 8192
    buffer_load_dwordx4 v3, s[4:7], s23 offen offset:0 lds
    buffer_load_dwordx4 v3, s[4:7], s23 offen offset:1024 lds
    s_add_u32 m0, s60, 73728
    s_add_u32 s22, s28, 8192
    buffer_load_dwordx4 v3, s[4:7], s22 offen offset:0 lds
    s_add_u32 m0, s56, 92160
    s_add_u32 s22, s24, 10240
    buffer_load_dwordx4 v3, s[4:7], s22 offen offset:0 lds
    buffer_load_dwordx4 v3, s[4:7], s22 offen offset:1024 lds
    s_add_u32 m0, s57, 92160
    s_add_u32 s23, s25, 10240
    buffer_load_dwordx4 v3, s[4:7], s23 offen offset:0 lds
    buffer_load_dwordx4 v3, s[4:7], s23 offen offset:1024 lds
    s_add_u32 m0, s58, 92160
    s_add_u32 s22, s26, 10240
    buffer_load_dwordx4 v3, s[4:7], s22 offen offset:0 lds
    buffer_load_dwordx4 v3, s[4:7], s22 offen offset:1024 lds
    s_add_u32 m0, s59, 92160
    s_add_u32 s23, s27, 10240
    buffer_load_dwordx4 v3, s[4:7], s23 offen offset:0 lds
    buffer_load_dwordx4 v3, s[4:7], s23 offen offset:1024 lds
    s_add_u32 m0, s60, 92160
    s_add_u32 s22, s28, 10240
    buffer_load_dwordx4 v3, s[4:7], s22 offen offset:0 lds
    s_waitcnt vmcnt(36)
    s_barrier
    s_add_u32 m0, s56, 110592
    s_add_u32 s22, s24, 12288
    buffer_load_dwordx4 v3, s[4:7], s22 offen offset:0 lds
    buffer_load_dwordx4 v3, s[4:7], s22 offen offset:1024 lds
    s_add_u32 m0, s57, 110592
    s_add_u32 s23, s25, 12288
    buffer_load_dwordx4 v3, s[4:7], s23 offen offset:0 lds
    buffer_load_dwordx4 v3, s[4:7], s23 offen offset:1024 lds
    s_add_u32 m0, s58, 110592
    s_add_u32 s22, s26, 12288
    buffer_load_dwordx4 v3, s[4:7], s22 offen offset:0 lds
    buffer_load_dwordx4 v3, s[4:7], s22 offen offset:1024 lds
    s_add_u32 m0, s59, 110592
    s_add_u32 s23, s27, 12288
    buffer_load_dwordx4 v3, s[4:7], s23 offen offset:0 lds
    buffer_load_dwordx4 v3, s[4:7], s23 offen offset:1024 lds
    s_add_u32 m0, s60, 110592
    s_add_u32 s22, s28, 12288
    buffer_load_dwordx4 v3, s[4:7], s22 offen offset:0 lds
    s_add_u32 m0, s56, 129024
    s_add_u32 s22, s24, 14336
    buffer_load_dwordx4 v3, s[4:7], s22 offen offset:0 lds
    buffer_load_dwordx4 v3, s[4:7], s22 offen offset:1024 lds
    s_add_u32 m0, s57, 129024
    s_add_u32 s23, s25, 14336
    buffer_load_dwordx4 v3, s[4:7], s23 offen offset:0 lds
    buffer_load_dwordx4 v3, s[4:7], s23 offen offset:1024 lds
    s_add_u32 m0, s58, 129024
    s_add_u32 s22, s26, 14336
    buffer_load_dwordx4 v3, s[4:7], s22 offen offset:0 lds
    buffer_load_dwordx4 v3, s[4:7], s22 offen offset:1024 lds
    s_add_u32 m0, s59, 129024
    s_add_u32 s23, s27, 14336
    buffer_load_dwordx4 v3, s[4:7], s23 offen offset:0 lds
    buffer_load_dwordx4 v3, s[4:7], s23 offen offset:1024 lds
    s_add_u32 m0, s60, 129024
    s_add_u32 s22, s28, 14336
    buffer_load_dwordx4 v3, s[4:7], s22 offen offset:0 lds
    s_add_u32 m0, s56, 0
    s_add_u32 s22, s24, 16384
    buffer_load_dwordx4 v3, s[4:7], s22 offen offset:0 lds
    buffer_load_dwordx4 v3, s[4:7], s22 offen offset:1024 lds
    s_add_u32 m0, s57, 0
    s_add_u32 s23, s25, 16384
    buffer_load_dwordx4 v3, s[4:7], s23 offen offset:0 lds
    buffer_load_dwordx4 v3, s[4:7], s23 offen offset:1024 lds
    s_add_u32 m0, s58, 0
    s_add_u32 s22, s26, 16384
    buffer_load_dwordx4 v3, s[4:7], s22 offen offset:0 lds
    buffer_load_dwordx4 v3, s[4:7], s22 offen offset:1024 lds
    s_add_u32 m0, s59, 0
    s_add_u32 s23, s27, 16384
    buffer_load_dwordx4 v3, s[4:7], s23 offen offset:0 lds
    buffer_load_dwordx4 v3, s[4:7], s23 offen offset:1024 lds
    s_add_u32 m0, s60, 0
    s_add_u32 s22, s28, 16384
    buffer_load_dwordx4 v3, s[4:7], s22 offen offset:0 lds
    s_waitcnt vmcnt(54)
    s_barrier
    s_add_u32 m0, s56, 18432
    s_add_u32 s22, s24, 18432
    buffer_load_dwordx4 v3, s[4:7], s22 offen offset:0 lds
    buffer_load_dwordx4 v3, s[4:7], s22 offen offset:1024 lds
    s_add_u32 m0, s57, 18432
    s_add_u32 s23, s25, 18432
    buffer_load_dwordx4 v3, s[4:7], s23 offen offset:0 lds
    buffer_load_dwordx4 v3, s[4:7], s23 offen offset:1024 lds
    s_add_u32 m0, s58, 18432
    s_add_u32 s22, s26, 18432
    buffer_load_dwordx4 v3, s[4:7], s22 offen offset:0 lds
    buffer_load_dwordx4 v3, s[4:7], s22 offen offset:1024 lds
    s_add_u32 m0, s59, 18432
    s_add_u32 s23, s27, 18432
    buffer_load_dwordx4 v3, s[4:7], s23 offen offset:0 lds
    buffer_load_dwordx4 v3, s[4:7], s23 offen offset:1024 lds
    s_add_u32 m0, s60, 18432
    s_add_u32 s22, s28, 18432
    buffer_load_dwordx4 v3, s[4:7], s22 offen offset:0 lds
    s_waitcnt vmcnt(54)
    s_barrier
    s_add_u32 m0, s56, 36864
    s_add_u32 s22, s24, 20480
    buffer_load_dwordx4 v3, s[4:7], s22 offen offset:0 lds
    buffer_load_dwordx4 v3, s[4:7], s22 offen offset:1024 lds
    s_add_u32 m0, s57, 36864
    s_add_u32 s23, s25, 20480
    buffer_load_dwordx4 v3, s[4:7], s23 offen offset:0 lds
    buffer_load_dwordx4 v3, s[4:7], s23 offen offset:1024 lds
    s_add_u32 m0, s58, 36864
    s_add_u32 s22, s26, 20480
    buffer_load_dwordx4 v3, s[4:7], s22 offen offset:0 lds
    buffer_load_dwordx4 v3, s[4:7], s22 offen offset:1024 lds
    s_add_u32 m0, s59, 36864
    s_add_u32 s23, s27, 20480
    buffer_load_dwordx4 v3, s[4:7], s23 offen offset:0 lds
    buffer_load_dwordx4 v3, s[4:7], s23 offen offset:1024 lds
    s_add_u32 m0, s60, 36864
    s_add_u32 s22, s28, 20480
    buffer_load_dwordx4 v3, s[4:7], s22 offen offset:0 lds
    s_waitcnt vmcnt(54)
    s_barrier
    s_add_u32 m0, s56, 55296
    s_add_u32 s22, s24, 22528
    buffer_load_dwordx4 v3, s[4:7], s22 offen offset:0 lds
    buffer_load_dwordx4 v3, s[4:7], s22 offen offset:1024 lds
    s_add_u32 m0, s57, 55296
    s_add_u32 s23, s25, 22528
    buffer_load_dwordx4 v3, s[4:7], s23 offen offset:0 lds
    buffer_load_dwordx4 v3, s[4:7], s23 offen offset:1024 lds
    s_add_u32 m0, s58, 55296
    s_add_u32 s22, s26, 22528
    buffer_load_dwordx4 v3, s[4:7], s22 offen offset:0 lds
    buffer_load_dwordx4 v3, s[4:7], s22 offen offset:1024 lds
    s_add_u32 m0, s59, 55296
    s_add_u32 s23, s27, 22528
    buffer_load_dwordx4 v3, s[4:7], s23 offen offset:0 lds
    buffer_load_dwordx4 v3, s[4:7], s23 offen offset:1024 lds
    s_add_u32 m0, s60, 55296
    s_add_u32 s22, s28, 22528
    buffer_load_dwordx4 v3, s[4:7], s22 offen offset:0 lds
    s_waitcnt vmcnt(54)
    s_barrier
    s_add_u32 m0, s56, 73728
    s_add_u32 s22, s24, 24576
    buffer_load_dwordx4 v3, s[4:7], s22 offen offset:0 lds
    buffer_load_dwordx4 v3, s[4:7], s22 offen offset:1024 lds
    s_add_u32 m0, s57, 73728
    s_add_u32 s23, s25, 24576
    buffer_load_dwordx4 v3, s[4:7], s23 offen offset:0 lds
    buffer_load_dwordx4 v3, s[4:7], s23 offen offset:1024 lds
    s_add_u32 m0, s58, 73728
    s_add_u32 s22, s26, 24576
    buffer_load_dwordx4 v3, s[4:7], s22 offen offset:0 lds
    buffer_load_dwordx4 v3, s[4:7], s22 offen offset:1024 lds
    s_add_u32 m0, s59, 73728
    s_add_u32 s23, s27, 24576
    buffer_load_dwordx4 v3, s[4:7], s23 offen offset:0 lds
    buffer_load_dwordx4 v3, s[4:7], s23 offen offset:1024 lds
    s_add_u32 m0, s60, 73728
    s_add_u32 s22, s28, 24576
    buffer_load_dwordx4 v3, s[4:7], s22 offen offset:0 lds
    s_waitcnt vmcnt(54)
    s_barrier
    s_add_u32 m0, s56, 92160
    s_add_u32 s22, s24, 26624
    buffer_load_dwordx4 v3, s[4:7], s22 offen offset:0 lds
    buffer_load_dwordx4 v3, s[4:7], s22 offen offset:1024 lds
    s_add_u32 m0, s57, 92160
    s_add_u32 s23, s25, 26624
    buffer_load_dwordx4 v3, s[4:7], s23 offen offset:0 lds
    buffer_load_dwordx4 v3, s[4:7], s23 offen offset:1024 lds
    s_add_u32 m0, s58, 92160
    s_add_u32 s22, s26, 26624
    buffer_load_dwordx4 v3, s[4:7], s22 offen offset:0 lds
    buffer_load_dwordx4 v3, s[4:7], s22 offen offset:1024 lds
    s_add_u32 m0, s59, 92160
    s_add_u32 s23, s27, 26624
    buffer_load_dwordx4 v3, s[4:7], s23 offen offset:0 lds
    buffer_load_dwordx4 v3, s[4:7], s23 offen offset:1024 lds
    s_add_u32 m0, s60, 92160
    s_add_u32 s22, s28, 26624
    buffer_load_dwordx4 v3, s[4:7], s22 offen offset:0 lds
    s_waitcnt vmcnt(54)
    s_barrier
    s_add_u32 m0, s56, 110592
    s_add_u32 s22, s24, 28672
    buffer_load_dwordx4 v3, s[4:7], s22 offen offset:0 lds
    buffer_load_dwordx4 v3, s[4:7], s22 offen offset:1024 lds
    s_add_u32 m0, s57, 110592
    s_add_u32 s23, s25, 28672
    buffer_load_dwordx4 v3, s[4:7], s23 offen offset:0 lds
    buffer_load_dwordx4 v3, s[4:7], s23 offen offset:1024 lds
    s_add_u32 m0, s58, 110592
    s_add_u32 s22, s26, 28672
    buffer_load_dwordx4 v3, s[4:7], s22 offen offset:0 lds
    buffer_load_dwordx4 v3, s[4:7], s22 offen offset:1024 lds
    s_add_u32 m0, s59, 110592
    s_add_u32 s23, s27, 28672
    buffer_load_dwordx4 v3, s[4:7], s23 offen offset:0 lds
    buffer_load_dwordx4 v3, s[4:7], s23 offen offset:1024 lds
    s_add_u32 m0, s60, 110592
    s_add_u32 s22, s28, 28672
    buffer_load_dwordx4 v3, s[4:7], s22 offen offset:0 lds
    s_waitcnt vmcnt(54)
    s_barrier
    s_add_u32 m0, s56, 129024
    s_add_u32 s22, s24, 30720
    buffer_load_dwordx4 v3, s[4:7], s22 offen offset:0 lds
    buffer_load_dwordx4 v3, s[4:7], s22 offen offset:1024 lds
    s_add_u32 m0, s57, 129024
    s_add_u32 s23, s25, 30720
    buffer_load_dwordx4 v3, s[4:7], s23 offen offset:0 lds
    buffer_load_dwordx4 v3, s[4:7], s23 offen offset:1024 lds
    s_add_u32 m0, s58, 129024
    s_add_u32 s22, s26, 30720
    buffer_load_dwordx4 v3, s[4:7], s22 offen offset:0 lds
    buffer_load_dwordx4 v3, s[4:7], s22 offen offset:1024 lds
    s_add_u32 m0, s59, 129024
    s_add_u32 s23, s27, 30720
    buffer_load_dwordx4 v3, s[4:7], s23 offen offset:0 lds
    buffer_load_dwordx4 v3, s[4:7], s23 offen offset:1024 lds
    s_add_u32 m0, s60, 129024
    s_add_u32 s22, s28, 30720
    buffer_load_dwordx4 v3, s[4:7], s22 offen offset:0 lds
    s_waitcnt vmcnt(54)
    s_barrier
    s_add_u32 m0, s56, 0
    s_add_u32 s22, s24, 32768
    buffer_load_dwordx4 v3, s[4:7], s22 offen offset:0 lds
    buffer_load_dwordx4 v3, s[4:7], s22 offen offset:1024 lds
    s_add_u32 m0, s57, 0
    s_add_u32 s23, s25, 32768
    buffer_load_dwordx4 v3, s[4:7], s23 offen offset:0 lds
    buffer_load_dwordx4 v3, s[4:7], s23 offen offset:1024 lds
    s_add_u32 m0, s58, 0
    s_add_u32 s22, s26, 32768
    buffer_load_dwordx4 v3, s[4:7], s22 offen offset:0 lds
    buffer_load_dwordx4 v3, s[4:7], s22 offen offset:1024 lds
    s_add_u32 m0, s59, 0
    s_add_u32 s23, s27, 32768
    buffer_load_dwordx4 v3, s[4:7], s23 offen offset:0 lds
    buffer_load_dwordx4 v3, s[4:7], s23 offen offset:1024 lds
    s_add_u32 m0, s60, 0
    s_add_u32 s22, s28, 32768
    buffer_load_dwordx4 v3, s[4:7], s22 offen offset:0 lds
    s_waitcnt vmcnt(54)
    s_barrier
    s_add_u32 m0, s56, 18432
    s_add_u32 s22, s24, 34816
    buffer_load_dwordx4 v3, s[4:7], s22 offen offset:0 lds
    buffer_load_dwordx4 v3, s[4:7], s22 offen offset:1024 lds
    s_add_u32 m0, s57, 18432
    s_add_u32 s23, s25, 34816
    buffer_load_dwordx4 v3, s[4:7], s23 offen offset:0 lds
    buffer_load_dwordx4 v3, s[4:7], s23 offen offset:1024 lds
    s_add_u32 m0, s58, 18432
    s_add_u32 s22, s26, 34816
    buffer_load_dwordx4 v3, s[4:7], s22 offen offset:0 lds
    buffer_load_dwordx4 v3, s[4:7], s22 offen offset:1024 lds
    s_add_u32 m0, s59, 18432
    s_add_u32 s23, s27, 34816
    buffer_load_dwordx4 v3, s[4:7], s23 offen offset:0 lds
    buffer_load_dwordx4 v3, s[4:7], s23 offen offset:1024 lds
    s_add_u32 m0, s60, 18432
    s_add_u32 s22, s28, 34816
    buffer_load_dwordx4 v3, s[4:7], s22 offen offset:0 lds
    s_waitcnt vmcnt(54)
    s_barrier
    s_add_u32 m0, s56, 36864
    s_add_u32 s22, s24, 36864
    buffer_load_dwordx4 v3, s[4:7], s22 offen offset:0 lds
    buffer_load_dwordx4 v3, s[4:7], s22 offen offset:1024 lds
    s_add_u32 m0, s57, 36864
    s_add_u32 s23, s25, 36864
    buffer_load_dwordx4 v3, s[4:7], s23 offen offset:0 lds
    buffer_load_dwordx4 v3, s[4:7], s23 offen offset:1024 lds
    s_add_u32 m0, s58, 36864
    s_add_u32 s22, s26, 36864
    buffer_load_dwordx4 v3, s[4:7], s22 offen offset:0 lds
    buffer_load_dwordx4 v3, s[4:7], s22 offen offset:1024 lds
    s_add_u32 m0, s59, 36864
    s_add_u32 s23, s27, 36864
    buffer_load_dwordx4 v3, s[4:7], s23 offen offset:0 lds
    buffer_load_dwordx4 v3, s[4:7], s23 offen offset:1024 lds
    s_add_u32 m0, s60, 36864
    s_add_u32 s22, s28, 36864
    buffer_load_dwordx4 v3, s[4:7], s22 offen offset:0 lds
    s_waitcnt vmcnt(54)
    s_barrier
    s_add_u32 m0, s56, 55296
    s_add_u32 s22, s24, 38912
    buffer_load_dwordx4 v3, s[4:7], s22 offen offset:0 lds
    buffer_load_dwordx4 v3, s[4:7], s22 offen offset:1024 lds
    s_add_u32 m0, s57, 55296
    s_add_u32 s23, s25, 38912
    buffer_load_dwordx4 v3, s[4:7], s23 offen offset:0 lds
    buffer_load_dwordx4 v3, s[4:7], s23 offen offset:1024 lds
    s_add_u32 m0, s58, 55296
    s_add_u32 s22, s26, 38912
    buffer_load_dwordx4 v3, s[4:7], s22 offen offset:0 lds
    buffer_load_dwordx4 v3, s[4:7], s22 offen offset:1024 lds
    s_add_u32 m0, s59, 55296
    s_add_u32 s23, s27, 38912
    buffer_load_dwordx4 v3, s[4:7], s23 offen offset:0 lds
    buffer_load_dwordx4 v3, s[4:7], s23 offen offset:1024 lds
    s_add_u32 m0, s60, 55296
    s_add_u32 s22, s28, 38912
    buffer_load_dwordx4 v3, s[4:7], s22 offen offset:0 lds
    s_waitcnt vmcnt(54)
    s_barrier
    s_add_u32 m0, s56, 73728
    s_add_u32 s22, s24, 40960
    buffer_load_dwordx4 v3, s[4:7], s22 offen offset:0 lds
    buffer_load_dwordx4 v3, s[4:7], s22 offen offset:1024 lds
    s_add_u32 m0, s57, 73728
    s_add_u32 s23, s25, 40960
    buffer_load_dwordx4 v3, s[4:7], s23 offen offset:0 lds
    buffer_load_dwordx4 v3, s[4:7], s23 offen offset:1024 lds
    s_add_u32 m0, s58, 73728
    s_add_u32 s22, s26, 40960
    buffer_load_dwordx4 v3, s[4:7], s22 offen offset:0 lds
    buffer_load_dwordx4 v3, s[4:7], s22 offen offset:1024 lds
    s_add_u32 m0, s59, 73728
    s_add_u32 s23, s27, 40960
    buffer_load_dwordx4 v3, s[4:7], s23 offen offset:0 lds
    buffer_load_dwordx4 v3, s[4:7], s23 offen offset:1024 lds
    s_add_u32 m0, s60, 73728
    s_add_u32 s22, s28, 40960
    buffer_load_dwordx4 v3, s[4:7], s22 offen offset:0 lds
    s_waitcnt vmcnt(54)
    s_barrier
    s_add_u32 m0, s56, 92160
    s_add_u32 s22, s24, 43008
    buffer_load_dwordx4 v3, s[4:7], s22 offen offset:0 lds
    buffer_load_dwordx4 v3, s[4:7], s22 offen offset:1024 lds
    s_add_u32 m0, s57, 92160
    s_add_u32 s23, s25, 43008
    buffer_load_dwordx4 v3, s[4:7], s23 offen offset:0 lds
    buffer_load_dwordx4 v3, s[4:7], s23 offen offset:1024 lds
    s_add_u32 m0, s58, 92160
    s_add_u32 s22, s26, 43008
    buffer_load_dwordx4 v3, s[4:7], s22 offen offset:0 lds
    buffer_load_dwordx4 v3, s[4:7], s22 offen offset:1024 lds
    s_add_u32 m0, s59, 92160
    s_add_u32 s23, s27, 43008
    buffer_load_dwordx4 v3, s[4:7], s23 offen offset:0 lds
    buffer_load_dwordx4 v3, s[4:7], s23 offen offset:1024 lds
    s_add_u32 m0, s60, 92160
    s_add_u32 s22, s28, 43008
    buffer_load_dwordx4 v3, s[4:7], s22 offen offset:0 lds
    s_waitcnt vmcnt(54)
    s_barrier
    s_add_u32 m0, s56, 110592
    s_add_u32 s22, s24, 45056
    buffer_load_dwordx4 v3, s[4:7], s22 offen offset:0 lds
    buffer_load_dwordx4 v3, s[4:7], s22 offen offset:1024 lds
    s_add_u32 m0, s57, 110592
    s_add_u32 s23, s25, 45056
    buffer_load_dwordx4 v3, s[4:7], s23 offen offset:0 lds
    buffer_load_dwordx4 v3, s[4:7], s23 offen offset:1024 lds
    s_add_u32 m0, s58, 110592
    s_add_u32 s22, s26, 45056
    buffer_load_dwordx4 v3, s[4:7], s22 offen offset:0 lds
    buffer_load_dwordx4 v3, s[4:7], s22 offen offset:1024 lds
    s_add_u32 m0, s59, 110592
    s_add_u32 s23, s27, 45056
    buffer_load_dwordx4 v3, s[4:7], s23 offen offset:0 lds
    buffer_load_dwordx4 v3, s[4:7], s23 offen offset:1024 lds
    s_add_u32 m0, s60, 110592
    s_add_u32 s22, s28, 45056
    buffer_load_dwordx4 v3, s[4:7], s22 offen offset:0 lds
    s_waitcnt vmcnt(54)
    s_barrier
    s_add_u32 m0, s56, 129024
    s_add_u32 s22, s24, 47104
    buffer_load_dwordx4 v3, s[4:7], s22 offen offset:0 lds
    buffer_load_dwordx4 v3, s[4:7], s22 offen offset:1024 lds
    s_add_u32 m0, s57, 129024
    s_add_u32 s23, s25, 47104
    buffer_load_dwordx4 v3, s[4:7], s23 offen offset:0 lds
    buffer_load_dwordx4 v3, s[4:7], s23 offen offset:1024 lds
    s_add_u32 m0, s58, 129024
    s_add_u32 s22, s26, 47104
    buffer_load_dwordx4 v3, s[4:7], s22 offen offset:0 lds
    buffer_load_dwordx4 v3, s[4:7], s22 offen offset:1024 lds
    s_add_u32 m0, s59, 129024
    s_add_u32 s23, s27, 47104
    buffer_load_dwordx4 v3, s[4:7], s23 offen offset:0 lds
    buffer_load_dwordx4 v3, s[4:7], s23 offen offset:1024 lds
    s_add_u32 m0, s60, 129024
    s_add_u32 s22, s28, 47104
    buffer_load_dwordx4 v3, s[4:7], s22 offen offset:0 lds
    s_waitcnt vmcnt(54)
    s_barrier
    s_waitcnt vmcnt(45)
    s_barrier
    s_waitcnt vmcnt(36)
    s_barrier
    s_waitcnt vmcnt(27)
    s_barrier
    s_waitcnt vmcnt(18)
    s_barrier
    s_waitcnt vmcnt(9)
    s_barrier
    s_waitcnt vmcnt(0)
    s_barrier
    s_endpgm
dn1_kernel_comp:
    s_mov_b32 s15, s12
    s_mov_b32 s16, 0
    s_mul_i32 s17, s15, 2048
    s_mul_i32 s18, s16, 10240
    v_add_u32 v4, s17, v3
    v_add_u32 v7, s18, v3
    v_add_u32 v5, s17, v3
    v_add_u32 v8, s18, v3
    v_add_u32 v5, 65536, v5
    v_add_u32 v8, 65536, v8
    v_add_u32 v6, s17, v3
    v_add_u32 v9, s18, v3
    v_add_u32 v6, 131072, v6
    v_add_u32 v9, 131072, v9
    s_waitcnt lgkmcnt(0)
    s_and_b32 s5, s5, 0xffff
    s_mov_b32 s6, 268435456
    s_mov_b32 s7, 0x00020000
    s_lshl_b32 s17, s13, 2
    s_add_u32 s17, s17, s15
    s_mul_i32 s18, s14, 5
    s_add_u32 s19, s18, 0
    s_lshr_b32 s20, s19, 1
    s_and_b32 s21, s19, 1
    s_lshl_b32 s21, s21, 3
    s_mul_i32 s22, s17, 20
    s_add_u32 s22, s22, s20
    s_lshl_b32 s22, s22, 10
    s_add_u32 s40, s22, s21
    s_add_u32 s22, s40, 12582912
    buffer_load_dwordx2 v[10:11], v3, s[4:7], s22 offen
    s_add_u32 s19, s18, 1
    s_lshr_b32 s20, s19, 1
    s_and_b32 s21, s19, 1
    s_lshl_b32 s21, s21, 3
    s_mul_i32 s22, s17, 20
    s_add_u32 s22, s22, s20
    s_lshl_b32 s22, s22, 10
    s_add_u32 s41, s22, s21
    s_add_u32 s22, s41, 12582912
    buffer_load_dwordx2 v[12:13], v3, s[4:7], s22 offen
    s_add_u32 s19, s18, 2
    s_lshr_b32 s20, s19, 1
    s_and_b32 s21, s19, 1
    s_lshl_b32 s21, s21, 3
    s_mul_i32 s22, s17, 20
    s_add_u32 s22, s22, s20
    s_lshl_b32 s22, s22, 10
    s_add_u32 s42, s22, s21
    s_add_u32 s22, s42, 12582912
    buffer_load_dwordx2 v[14:15], v3, s[4:7], s22 offen
    s_add_u32 s19, s18, 3
    s_lshr_b32 s20, s19, 1
    s_and_b32 s21, s19, 1
    s_lshl_b32 s21, s21, 3
    s_mul_i32 s22, s17, 20
    s_add_u32 s22, s22, s20
    s_lshl_b32 s22, s22, 10
    s_add_u32 s43, s22, s21
    s_add_u32 s22, s43, 12582912
    buffer_load_dwordx2 v[16:17], v3, s[4:7], s22 offen
    s_add_u32 s19, s18, 4
    s_lshr_b32 s20, s19, 1
    s_and_b32 s21, s19, 1
    s_lshl_b32 s21, s21, 3
    s_mul_i32 s22, s17, 20
    s_add_u32 s22, s22, s20
    s_lshl_b32 s22, s22, 10
    s_add_u32 s44, s22, s21
    s_add_u32 s22, s44, 12582912
    buffer_load_dwordx2 v[18:19], v3, s[4:7], s22 offen
    s_waitcnt lgkmcnt(0)
    s_barrier
    ds_read_b128 v[52:55], v4 offset:0
    ds_read_b128 v[56:59], v7 offset:8192
    ds_read_b128 v[60:63], v7 offset:10240
    ds_read_b128 v[64:67], v7 offset:12288
    ds_read_b128 v[68:71], v7 offset:14336
    ds_read_b128 v[72:75], v7 offset:16384
    s_waitcnt lgkmcnt(0)
    v_mfma_f32_16x16x32_bf16 v[32:35], v[56:59], v[52:55], 0
    ds_read_b128 v[76:79], v4 offset:1024
    ds_read_b128 v[80:83], v7 offset:9216
    v_mfma_f32_16x16x32_bf16 v[36:39], v[60:63], v[52:55], 0
    ds_read_b128 v[84:87], v7 offset:11264
    ds_read_b128 v[88:91], v7 offset:13312
    v_mfma_f32_16x16x32_bf16 v[40:43], v[64:67], v[52:55], 0
    ds_read_b128 v[92:95], v7 offset:15360
    ds_read_b128 v[96:99], v7 offset:17408
    v_mfma_f32_16x16x32_bf16 v[44:47], v[68:71], v[52:55], 0
    v_mfma_f32_16x16x32_bf16 v[48:51], v[72:75], v[52:55], 0
    s_waitcnt lgkmcnt(0)
    s_barrier
    v_mfma_f32_16x16x32_bf16 v[32:35], v[80:83], v[76:79], v[32:35]
    ds_read_b128 v[52:55], v4 offset:18432
    ds_read_b128 v[56:59], v7 offset:26624
    v_mfma_f32_16x16x32_bf16 v[36:39], v[84:87], v[76:79], v[36:39]
    ds_read_b128 v[60:63], v7 offset:28672
    ds_read_b128 v[64:67], v7 offset:30720
    v_mfma_f32_16x16x32_bf16 v[40:43], v[88:91], v[76:79], v[40:43]
    ds_read_b128 v[68:71], v7 offset:32768
    ds_read_b128 v[72:75], v7 offset:34816
    v_mfma_f32_16x16x32_bf16 v[44:47], v[92:95], v[76:79], v[44:47]
    v_mfma_f32_16x16x32_bf16 v[48:51], v[96:99], v[76:79], v[48:51]
    s_waitcnt lgkmcnt(0)
    v_mfma_f32_16x16x32_bf16 v[32:35], v[56:59], v[52:55], v[32:35]
    ds_read_b128 v[76:79], v4 offset:19456
    ds_read_b128 v[80:83], v7 offset:27648
    v_mfma_f32_16x16x32_bf16 v[36:39], v[60:63], v[52:55], v[36:39]
    ds_read_b128 v[84:87], v7 offset:29696
    ds_read_b128 v[88:91], v7 offset:31744
    v_mfma_f32_16x16x32_bf16 v[40:43], v[64:67], v[52:55], v[40:43]
    ds_read_b128 v[92:95], v7 offset:33792
    ds_read_b128 v[96:99], v7 offset:35840
    v_mfma_f32_16x16x32_bf16 v[44:47], v[68:71], v[52:55], v[44:47]
    v_mfma_f32_16x16x32_bf16 v[48:51], v[72:75], v[52:55], v[48:51]
    s_waitcnt lgkmcnt(0)
    s_barrier
    v_mfma_f32_16x16x32_bf16 v[32:35], v[80:83], v[76:79], v[32:35]
    ds_read_b128 v[52:55], v4 offset:36864
    ds_read_b128 v[56:59], v7 offset:45056
    v_mfma_f32_16x16x32_bf16 v[36:39], v[84:87], v[76:79], v[36:39]
    ds_read_b128 v[60:63], v7 offset:47104
    ds_read_b128 v[64:67], v7 offset:49152
    v_mfma_f32_16x16x32_bf16 v[40:43], v[88:91], v[76:79], v[40:43]
    ds_read_b128 v[68:71], v7 offset:51200
    ds_read_b128 v[72:75], v7 offset:53248
    v_mfma_f32_16x16x32_bf16 v[44:47], v[92:95], v[76:79], v[44:47]
    v_mfma_f32_16x16x32_bf16 v[48:51], v[96:99], v[76:79], v[48:51]
    s_waitcnt lgkmcnt(0)
    v_mfma_f32_16x16x32_bf16 v[32:35], v[56:59], v[52:55], v[32:35]
    ds_read_b128 v[76:79], v4 offset:37888
    ds_read_b128 v[80:83], v7 offset:46080
    v_mfma_f32_16x16x32_bf16 v[36:39], v[60:63], v[52:55], v[36:39]
    ds_read_b128 v[84:87], v7 offset:48128
    ds_read_b128 v[88:91], v7 offset:50176
    v_mfma_f32_16x16x32_bf16 v[40:43], v[64:67], v[52:55], v[40:43]
    ds_read_b128 v[92:95], v7 offset:52224
    ds_read_b128 v[96:99], v7 offset:54272
    v_mfma_f32_16x16x32_bf16 v[44:47], v[68:71], v[52:55], v[44:47]
    v_mfma_f32_16x16x32_bf16 v[48:51], v[72:75], v[52:55], v[48:51]
    s_waitcnt lgkmcnt(0)
    s_barrier
    v_mfma_f32_16x16x32_bf16 v[32:35], v[80:83], v[76:79], v[32:35]
    ds_read_b128 v[52:55], v4 offset:55296
    ds_read_b128 v[56:59], v7 offset:63488
    v_mfma_f32_16x16x32_bf16 v[36:39], v[84:87], v[76:79], v[36:39]
    ds_read_b128 v[60:63], v8 offset:0
    ds_read_b128 v[64:67], v8 offset:2048
    v_mfma_f32_16x16x32_bf16 v[40:43], v[88:91], v[76:79], v[40:43]
    ds_read_b128 v[68:71], v8 offset:4096
    ds_read_b128 v[72:75], v8 offset:6144
    v_mfma_f32_16x16x32_bf16 v[44:47], v[92:95], v[76:79], v[44:47]
    v_mfma_f32_16x16x32_bf16 v[48:51], v[96:99], v[76:79], v[48:51]
    s_waitcnt lgkmcnt(0)
    v_mfma_f32_16x16x32_bf16 v[32:35], v[56:59], v[52:55], v[32:35]
    ds_read_b128 v[76:79], v4 offset:56320
    ds_read_b128 v[80:83], v7 offset:64512
    v_mfma_f32_16x16x32_bf16 v[36:39], v[60:63], v[52:55], v[36:39]
    ds_read_b128 v[84:87], v8 offset:1024
    ds_read_b128 v[88:91], v8 offset:3072
    v_mfma_f32_16x16x32_bf16 v[40:43], v[64:67], v[52:55], v[40:43]
    ds_read_b128 v[92:95], v8 offset:5120
    ds_read_b128 v[96:99], v8 offset:7168
    v_mfma_f32_16x16x32_bf16 v[44:47], v[68:71], v[52:55], v[44:47]
    v_mfma_f32_16x16x32_bf16 v[48:51], v[72:75], v[52:55], v[48:51]
    s_waitcnt lgkmcnt(0)
    s_barrier
    v_mfma_f32_16x16x32_bf16 v[32:35], v[80:83], v[76:79], v[32:35]
    ds_read_b128 v[52:55], v5 offset:8192
    ds_read_b128 v[56:59], v8 offset:16384
    v_mfma_f32_16x16x32_bf16 v[36:39], v[84:87], v[76:79], v[36:39]
    ds_read_b128 v[60:63], v8 offset:18432
    ds_read_b128 v[64:67], v8 offset:20480
    v_mfma_f32_16x16x32_bf16 v[40:43], v[88:91], v[76:79], v[40:43]
    ds_read_b128 v[68:71], v8 offset:22528
    ds_read_b128 v[72:75], v8 offset:24576
    v_mfma_f32_16x16x32_bf16 v[44:47], v[92:95], v[76:79], v[44:47]
    v_mfma_f32_16x16x32_bf16 v[48:51], v[96:99], v[76:79], v[48:51]
    s_waitcnt lgkmcnt(0)
    v_mfma_f32_16x16x32_bf16 v[32:35], v[56:59], v[52:55], v[32:35]
    ds_read_b128 v[76:79], v5 offset:9216
    ds_read_b128 v[80:83], v8 offset:17408
    v_mfma_f32_16x16x32_bf16 v[36:39], v[60:63], v[52:55], v[36:39]
    ds_read_b128 v[84:87], v8 offset:19456
    ds_read_b128 v[88:91], v8 offset:21504
    v_mfma_f32_16x16x32_bf16 v[40:43], v[64:67], v[52:55], v[40:43]
    ds_read_b128 v[92:95], v8 offset:23552
    ds_read_b128 v[96:99], v8 offset:25600
    v_mfma_f32_16x16x32_bf16 v[44:47], v[68:71], v[52:55], v[44:47]
    v_mfma_f32_16x16x32_bf16 v[48:51], v[72:75], v[52:55], v[48:51]
    s_waitcnt lgkmcnt(0)
    s_barrier
    v_mfma_f32_16x16x32_bf16 v[32:35], v[80:83], v[76:79], v[32:35]
    ds_read_b128 v[52:55], v5 offset:26624
    ds_read_b128 v[56:59], v8 offset:34816
    v_mfma_f32_16x16x32_bf16 v[36:39], v[84:87], v[76:79], v[36:39]
    ds_read_b128 v[60:63], v8 offset:36864
    ds_read_b128 v[64:67], v8 offset:38912
    v_mfma_f32_16x16x32_bf16 v[40:43], v[88:91], v[76:79], v[40:43]
    ds_read_b128 v[68:71], v8 offset:40960
    ds_read_b128 v[72:75], v8 offset:43008
    v_mfma_f32_16x16x32_bf16 v[44:47], v[92:95], v[76:79], v[44:47]
    v_mfma_f32_16x16x32_bf16 v[48:51], v[96:99], v[76:79], v[48:51]
    s_waitcnt lgkmcnt(0)
    v_mfma_f32_16x16x32_bf16 v[32:35], v[56:59], v[52:55], v[32:35]
    ds_read_b128 v[76:79], v5 offset:27648
    ds_read_b128 v[80:83], v8 offset:35840
    v_mfma_f32_16x16x32_bf16 v[36:39], v[60:63], v[52:55], v[36:39]
    ds_read_b128 v[84:87], v8 offset:37888
    ds_read_b128 v[88:91], v8 offset:39936
    v_mfma_f32_16x16x32_bf16 v[40:43], v[64:67], v[52:55], v[40:43]
    ds_read_b128 v[92:95], v8 offset:41984
    ds_read_b128 v[96:99], v8 offset:44032
    v_mfma_f32_16x16x32_bf16 v[44:47], v[68:71], v[52:55], v[44:47]
    v_mfma_f32_16x16x32_bf16 v[48:51], v[72:75], v[52:55], v[48:51]
    s_waitcnt lgkmcnt(0)
    s_barrier
    v_mfma_f32_16x16x32_bf16 v[32:35], v[80:83], v[76:79], v[32:35]
    ds_read_b128 v[52:55], v5 offset:45056
    ds_read_b128 v[56:59], v8 offset:53248
    v_mfma_f32_16x16x32_bf16 v[36:39], v[84:87], v[76:79], v[36:39]
    ds_read_b128 v[60:63], v8 offset:55296
    ds_read_b128 v[64:67], v8 offset:57344
    v_mfma_f32_16x16x32_bf16 v[40:43], v[88:91], v[76:79], v[40:43]
    ds_read_b128 v[68:71], v8 offset:59392
    ds_read_b128 v[72:75], v8 offset:61440
    v_mfma_f32_16x16x32_bf16 v[44:47], v[92:95], v[76:79], v[44:47]
    v_mfma_f32_16x16x32_bf16 v[48:51], v[96:99], v[76:79], v[48:51]
    s_waitcnt lgkmcnt(0)
    v_mfma_f32_16x16x32_bf16 v[32:35], v[56:59], v[52:55], v[32:35]
    ds_read_b128 v[76:79], v5 offset:46080
    ds_read_b128 v[80:83], v8 offset:54272
    v_mfma_f32_16x16x32_bf16 v[36:39], v[60:63], v[52:55], v[36:39]
    ds_read_b128 v[84:87], v8 offset:56320
    ds_read_b128 v[88:91], v8 offset:58368
    v_mfma_f32_16x16x32_bf16 v[40:43], v[64:67], v[52:55], v[40:43]
    ds_read_b128 v[92:95], v8 offset:60416
    ds_read_b128 v[96:99], v8 offset:62464
    v_mfma_f32_16x16x32_bf16 v[44:47], v[68:71], v[52:55], v[44:47]
    v_mfma_f32_16x16x32_bf16 v[48:51], v[72:75], v[52:55], v[48:51]
    s_waitcnt lgkmcnt(0)
    s_barrier
    v_mfma_f32_16x16x32_bf16 v[32:35], v[80:83], v[76:79], v[32:35]
    ds_read_b128 v[52:55], v5 offset:63488
    ds_read_b128 v[56:59], v9 offset:6144
    v_mfma_f32_16x16x32_bf16 v[36:39], v[84:87], v[76:79], v[36:39]
    ds_read_b128 v[60:63], v9 offset:8192
    ds_read_b128 v[64:67], v9 offset:10240
    v_mfma_f32_16x16x32_bf16 v[40:43], v[88:91], v[76:79], v[40:43]
    ds_read_b128 v[68:71], v9 offset:12288
    ds_read_b128 v[72:75], v9 offset:14336
    v_mfma_f32_16x16x32_bf16 v[44:47], v[92:95], v[76:79], v[44:47]
    v_mfma_f32_16x16x32_bf16 v[48:51], v[96:99], v[76:79], v[48:51]
    s_waitcnt lgkmcnt(0)
    v_mfma_f32_16x16x32_bf16 v[32:35], v[56:59], v[52:55], v[32:35]
    ds_read_b128 v[76:79], v5 offset:64512
    ds_read_b128 v[80:83], v9 offset:7168
    v_mfma_f32_16x16x32_bf16 v[36:39], v[60:63], v[52:55], v[36:39]
    ds_read_b128 v[84:87], v9 offset:9216
    ds_read_b128 v[88:91], v9 offset:11264
    v_mfma_f32_16x16x32_bf16 v[40:43], v[64:67], v[52:55], v[40:43]
    ds_read_b128 v[92:95], v9 offset:13312
    ds_read_b128 v[96:99], v9 offset:15360
    v_mfma_f32_16x16x32_bf16 v[44:47], v[68:71], v[52:55], v[44:47]
    v_mfma_f32_16x16x32_bf16 v[48:51], v[72:75], v[52:55], v[48:51]
    s_waitcnt lgkmcnt(0)
    s_barrier
    v_mfma_f32_16x16x32_bf16 v[32:35], v[80:83], v[76:79], v[32:35]
    ds_read_b128 v[52:55], v4 offset:0
    ds_read_b128 v[56:59], v7 offset:8192
    v_mfma_f32_16x16x32_bf16 v[36:39], v[84:87], v[76:79], v[36:39]
    ds_read_b128 v[60:63], v7 offset:10240
    ds_read_b128 v[64:67], v7 offset:12288
    v_mfma_f32_16x16x32_bf16 v[40:43], v[88:91], v[76:79], v[40:43]
    ds_read_b128 v[68:71], v7 offset:14336
    ds_read_b128 v[72:75], v7 offset:16384
    v_mfma_f32_16x16x32_bf16 v[44:47], v[92:95], v[76:79], v[44:47]
    v_mfma_f32_16x16x32_bf16 v[48:51], v[96:99], v[76:79], v[48:51]
    s_waitcnt lgkmcnt(0)
    v_mfma_f32_16x16x32_bf16 v[32:35], v[56:59], v[52:55], v[32:35]
    ds_read_b128 v[76:79], v4 offset:1024
    ds_read_b128 v[80:83], v7 offset:9216
    v_mfma_f32_16x16x32_bf16 v[36:39], v[60:63], v[52:55], v[36:39]
    ds_read_b128 v[84:87], v7 offset:11264
    ds_read_b128 v[88:91], v7 offset:13312
    v_mfma_f32_16x16x32_bf16 v[40:43], v[64:67], v[52:55], v[40:43]
    ds_read_b128 v[92:95], v7 offset:15360
    ds_read_b128 v[96:99], v7 offset:17408
    v_mfma_f32_16x16x32_bf16 v[44:47], v[68:71], v[52:55], v[44:47]
    v_mfma_f32_16x16x32_bf16 v[48:51], v[72:75], v[52:55], v[48:51]
    s_waitcnt lgkmcnt(0)
    s_barrier
    v_mfma_f32_16x16x32_bf16 v[32:35], v[80:83], v[76:79], v[32:35]
    ds_read_b128 v[52:55], v4 offset:18432
    ds_read_b128 v[56:59], v7 offset:26624
    v_mfma_f32_16x16x32_bf16 v[36:39], v[84:87], v[76:79], v[36:39]
    ds_read_b128 v[60:63], v7 offset:28672
    ds_read_b128 v[64:67], v7 offset:30720
    v_mfma_f32_16x16x32_bf16 v[40:43], v[88:91], v[76:79], v[40:43]
    ds_read_b128 v[68:71], v7 offset:32768
    ds_read_b128 v[72:75], v7 offset:34816
    v_mfma_f32_16x16x32_bf16 v[44:47], v[92:95], v[76:79], v[44:47]
    v_mfma_f32_16x16x32_bf16 v[48:51], v[96:99], v[76:79], v[48:51]
    s_waitcnt lgkmcnt(0)
    v_mfma_f32_16x16x32_bf16 v[32:35], v[56:59], v[52:55], v[32:35]
    ds_read_b128 v[76:79], v4 offset:19456
    ds_read_b128 v[80:83], v7 offset:27648
    v_mfma_f32_16x16x32_bf16 v[36:39], v[60:63], v[52:55], v[36:39]
    ds_read_b128 v[84:87], v7 offset:29696
    ds_read_b128 v[88:91], v7 offset:31744
    v_mfma_f32_16x16x32_bf16 v[40:43], v[64:67], v[52:55], v[40:43]
    ds_read_b128 v[92:95], v7 offset:33792
    ds_read_b128 v[96:99], v7 offset:35840
    v_mfma_f32_16x16x32_bf16 v[44:47], v[68:71], v[52:55], v[44:47]
    v_mfma_f32_16x16x32_bf16 v[48:51], v[72:75], v[52:55], v[48:51]
    s_waitcnt lgkmcnt(0)
    s_barrier
    v_mfma_f32_16x16x32_bf16 v[32:35], v[80:83], v[76:79], v[32:35]
    ds_read_b128 v[52:55], v4 offset:36864
    ds_read_b128 v[56:59], v7 offset:45056
    v_mfma_f32_16x16x32_bf16 v[36:39], v[84:87], v[76:79], v[36:39]
    ds_read_b128 v[60:63], v7 offset:47104
    ds_read_b128 v[64:67], v7 offset:49152
    v_mfma_f32_16x16x32_bf16 v[40:43], v[88:91], v[76:79], v[40:43]
    ds_read_b128 v[68:71], v7 offset:51200
    ds_read_b128 v[72:75], v7 offset:53248
    v_mfma_f32_16x16x32_bf16 v[44:47], v[92:95], v[76:79], v[44:47]
    v_mfma_f32_16x16x32_bf16 v[48:51], v[96:99], v[76:79], v[48:51]
    s_waitcnt lgkmcnt(0)
    v_mfma_f32_16x16x32_bf16 v[32:35], v[56:59], v[52:55], v[32:35]
    ds_read_b128 v[76:79], v4 offset:37888
    ds_read_b128 v[80:83], v7 offset:46080
    v_mfma_f32_16x16x32_bf16 v[36:39], v[60:63], v[52:55], v[36:39]
    ds_read_b128 v[84:87], v7 offset:48128
    ds_read_b128 v[88:91], v7 offset:50176
    v_mfma_f32_16x16x32_bf16 v[40:43], v[64:67], v[52:55], v[40:43]
    ds_read_b128 v[92:95], v7 offset:52224
    ds_read_b128 v[96:99], v7 offset:54272
    v_mfma_f32_16x16x32_bf16 v[44:47], v[68:71], v[52:55], v[44:47]
    v_mfma_f32_16x16x32_bf16 v[48:51], v[72:75], v[52:55], v[48:51]
    s_waitcnt lgkmcnt(0)
    s_barrier
    v_mfma_f32_16x16x32_bf16 v[32:35], v[80:83], v[76:79], v[32:35]
    ds_read_b128 v[52:55], v4 offset:55296
    ds_read_b128 v[56:59], v7 offset:63488
    v_mfma_f32_16x16x32_bf16 v[36:39], v[84:87], v[76:79], v[36:39]
    ds_read_b128 v[60:63], v8 offset:0
    ds_read_b128 v[64:67], v8 offset:2048
    v_mfma_f32_16x16x32_bf16 v[40:43], v[88:91], v[76:79], v[40:43]
    ds_read_b128 v[68:71], v8 offset:4096
    ds_read_b128 v[72:75], v8 offset:6144
    v_mfma_f32_16x16x32_bf16 v[44:47], v[92:95], v[76:79], v[44:47]
    v_mfma_f32_16x16x32_bf16 v[48:51], v[96:99], v[76:79], v[48:51]
    s_waitcnt lgkmcnt(0)
    v_mfma_f32_16x16x32_bf16 v[32:35], v[56:59], v[52:55], v[32:35]
    ds_read_b128 v[76:79], v4 offset:56320
    ds_read_b128 v[80:83], v7 offset:64512
    v_mfma_f32_16x16x32_bf16 v[36:39], v[60:63], v[52:55], v[36:39]
    ds_read_b128 v[84:87], v8 offset:1024
    ds_read_b128 v[88:91], v8 offset:3072
    v_mfma_f32_16x16x32_bf16 v[40:43], v[64:67], v[52:55], v[40:43]
    ds_read_b128 v[92:95], v8 offset:5120
    ds_read_b128 v[96:99], v8 offset:7168
    v_mfma_f32_16x16x32_bf16 v[44:47], v[68:71], v[52:55], v[44:47]
    v_mfma_f32_16x16x32_bf16 v[48:51], v[72:75], v[52:55], v[48:51]
    s_waitcnt lgkmcnt(0)
    s_barrier
    v_mfma_f32_16x16x32_bf16 v[32:35], v[80:83], v[76:79], v[32:35]
    ds_read_b128 v[52:55], v5 offset:8192
    ds_read_b128 v[56:59], v8 offset:16384
    v_mfma_f32_16x16x32_bf16 v[36:39], v[84:87], v[76:79], v[36:39]
    ds_read_b128 v[60:63], v8 offset:18432
    ds_read_b128 v[64:67], v8 offset:20480
    v_mfma_f32_16x16x32_bf16 v[40:43], v[88:91], v[76:79], v[40:43]
    ds_read_b128 v[68:71], v8 offset:22528
    ds_read_b128 v[72:75], v8 offset:24576
    v_mfma_f32_16x16x32_bf16 v[44:47], v[92:95], v[76:79], v[44:47]
    v_mfma_f32_16x16x32_bf16 v[48:51], v[96:99], v[76:79], v[48:51]
    s_waitcnt lgkmcnt(0)
    v_mfma_f32_16x16x32_bf16 v[32:35], v[56:59], v[52:55], v[32:35]
    ds_read_b128 v[76:79], v5 offset:9216
    ds_read_b128 v[80:83], v8 offset:17408
    v_mfma_f32_16x16x32_bf16 v[36:39], v[60:63], v[52:55], v[36:39]
    ds_read_b128 v[84:87], v8 offset:19456
    ds_read_b128 v[88:91], v8 offset:21504
    v_mfma_f32_16x16x32_bf16 v[40:43], v[64:67], v[52:55], v[40:43]
    ds_read_b128 v[92:95], v8 offset:23552
    ds_read_b128 v[96:99], v8 offset:25600
    v_mfma_f32_16x16x32_bf16 v[44:47], v[68:71], v[52:55], v[44:47]
    v_mfma_f32_16x16x32_bf16 v[48:51], v[72:75], v[52:55], v[48:51]
    s_waitcnt lgkmcnt(0)
    s_barrier
    v_mfma_f32_16x16x32_bf16 v[32:35], v[80:83], v[76:79], v[32:35]
    ds_read_b128 v[52:55], v5 offset:26624
    ds_read_b128 v[56:59], v8 offset:34816
    v_mfma_f32_16x16x32_bf16 v[36:39], v[84:87], v[76:79], v[36:39]
    ds_read_b128 v[60:63], v8 offset:36864
    ds_read_b128 v[64:67], v8 offset:38912
    v_mfma_f32_16x16x32_bf16 v[40:43], v[88:91], v[76:79], v[40:43]
    ds_read_b128 v[68:71], v8 offset:40960
    ds_read_b128 v[72:75], v8 offset:43008
    v_mfma_f32_16x16x32_bf16 v[44:47], v[92:95], v[76:79], v[44:47]
    v_mfma_f32_16x16x32_bf16 v[48:51], v[96:99], v[76:79], v[48:51]
    s_waitcnt lgkmcnt(0)
    v_mfma_f32_16x16x32_bf16 v[32:35], v[56:59], v[52:55], v[32:35]
    ds_read_b128 v[76:79], v5 offset:27648
    ds_read_b128 v[80:83], v8 offset:35840
    v_mfma_f32_16x16x32_bf16 v[36:39], v[60:63], v[52:55], v[36:39]
    ds_read_b128 v[84:87], v8 offset:37888
    ds_read_b128 v[88:91], v8 offset:39936
    v_mfma_f32_16x16x32_bf16 v[40:43], v[64:67], v[52:55], v[40:43]
    ds_read_b128 v[92:95], v8 offset:41984
    ds_read_b128 v[96:99], v8 offset:44032
    v_mfma_f32_16x16x32_bf16 v[44:47], v[68:71], v[52:55], v[44:47]
    v_mfma_f32_16x16x32_bf16 v[48:51], v[72:75], v[52:55], v[48:51]
    s_waitcnt lgkmcnt(0)
    s_barrier
    v_mfma_f32_16x16x32_bf16 v[32:35], v[80:83], v[76:79], v[32:35]
    ds_read_b128 v[52:55], v5 offset:45056
    ds_read_b128 v[56:59], v8 offset:53248
    v_mfma_f32_16x16x32_bf16 v[36:39], v[84:87], v[76:79], v[36:39]
    ds_read_b128 v[60:63], v8 offset:55296
    ds_read_b128 v[64:67], v8 offset:57344
    v_mfma_f32_16x16x32_bf16 v[40:43], v[88:91], v[76:79], v[40:43]
    ds_read_b128 v[68:71], v8 offset:59392
    ds_read_b128 v[72:75], v8 offset:61440
    v_mfma_f32_16x16x32_bf16 v[44:47], v[92:95], v[76:79], v[44:47]
    v_mfma_f32_16x16x32_bf16 v[48:51], v[96:99], v[76:79], v[48:51]
    s_waitcnt lgkmcnt(0)
    v_mfma_f32_16x16x32_bf16 v[32:35], v[56:59], v[52:55], v[32:35]
    ds_read_b128 v[76:79], v5 offset:46080
    ds_read_b128 v[80:83], v8 offset:54272
    v_mfma_f32_16x16x32_bf16 v[36:39], v[60:63], v[52:55], v[36:39]
    ds_read_b128 v[84:87], v8 offset:56320
    ds_read_b128 v[88:91], v8 offset:58368
    v_mfma_f32_16x16x32_bf16 v[40:43], v[64:67], v[52:55], v[40:43]
    ds_read_b128 v[92:95], v8 offset:60416
    ds_read_b128 v[96:99], v8 offset:62464
    v_mfma_f32_16x16x32_bf16 v[44:47], v[68:71], v[52:55], v[44:47]
    v_mfma_f32_16x16x32_bf16 v[48:51], v[72:75], v[52:55], v[48:51]
    s_waitcnt lgkmcnt(0)
    s_barrier
    v_mfma_f32_16x16x32_bf16 v[32:35], v[80:83], v[76:79], v[32:35]
    ds_read_b128 v[52:55], v5 offset:63488
    ds_read_b128 v[56:59], v9 offset:6144
    v_mfma_f32_16x16x32_bf16 v[36:39], v[84:87], v[76:79], v[36:39]
    ds_read_b128 v[60:63], v9 offset:8192
    ds_read_b128 v[64:67], v9 offset:10240
    v_mfma_f32_16x16x32_bf16 v[40:43], v[88:91], v[76:79], v[40:43]
    ds_read_b128 v[68:71], v9 offset:12288
    ds_read_b128 v[72:75], v9 offset:14336
    v_mfma_f32_16x16x32_bf16 v[44:47], v[92:95], v[76:79], v[44:47]
    v_mfma_f32_16x16x32_bf16 v[48:51], v[96:99], v[76:79], v[48:51]
    s_waitcnt lgkmcnt(0)
    v_mfma_f32_16x16x32_bf16 v[32:35], v[56:59], v[52:55], v[32:35]
    ds_read_b128 v[76:79], v5 offset:64512
    ds_read_b128 v[80:83], v9 offset:7168
    v_mfma_f32_16x16x32_bf16 v[36:39], v[60:63], v[52:55], v[36:39]
    ds_read_b128 v[84:87], v9 offset:9216
    ds_read_b128 v[88:91], v9 offset:11264
    v_mfma_f32_16x16x32_bf16 v[40:43], v[64:67], v[52:55], v[40:43]
    ds_read_b128 v[92:95], v9 offset:13312
    ds_read_b128 v[96:99], v9 offset:15360
    v_mfma_f32_16x16x32_bf16 v[44:47], v[68:71], v[52:55], v[44:47]
    v_mfma_f32_16x16x32_bf16 v[48:51], v[72:75], v[52:55], v[48:51]
    s_waitcnt lgkmcnt(0)
    s_barrier
    v_mfma_f32_16x16x32_bf16 v[32:35], v[80:83], v[76:79], v[32:35]
    ds_read_b128 v[52:55], v4 offset:0
    ds_read_b128 v[56:59], v7 offset:8192
    v_mfma_f32_16x16x32_bf16 v[36:39], v[84:87], v[76:79], v[36:39]
    ds_read_b128 v[60:63], v7 offset:10240
    ds_read_b128 v[64:67], v7 offset:12288
    v_mfma_f32_16x16x32_bf16 v[40:43], v[88:91], v[76:79], v[40:43]
    ds_read_b128 v[68:71], v7 offset:14336
    ds_read_b128 v[72:75], v7 offset:16384
    v_mfma_f32_16x16x32_bf16 v[44:47], v[92:95], v[76:79], v[44:47]
    v_mfma_f32_16x16x32_bf16 v[48:51], v[96:99], v[76:79], v[48:51]
    s_waitcnt lgkmcnt(0)
    v_mfma_f32_16x16x32_bf16 v[32:35], v[56:59], v[52:55], v[32:35]
    ds_read_b128 v[76:79], v4 offset:1024
    ds_read_b128 v[80:83], v7 offset:9216
    v_mfma_f32_16x16x32_bf16 v[36:39], v[60:63], v[52:55], v[36:39]
    ds_read_b128 v[84:87], v7 offset:11264
    ds_read_b128 v[88:91], v7 offset:13312
    v_mfma_f32_16x16x32_bf16 v[40:43], v[64:67], v[52:55], v[40:43]
    ds_read_b128 v[92:95], v7 offset:15360
    ds_read_b128 v[96:99], v7 offset:17408
    v_mfma_f32_16x16x32_bf16 v[44:47], v[68:71], v[52:55], v[44:47]
    v_mfma_f32_16x16x32_bf16 v[48:51], v[72:75], v[52:55], v[48:51]
    s_waitcnt lgkmcnt(0)
    s_barrier
    v_mfma_f32_16x16x32_bf16 v[32:35], v[80:83], v[76:79], v[32:35]
    ds_read_b128 v[52:55], v4 offset:18432
    ds_read_b128 v[56:59], v7 offset:26624
    v_mfma_f32_16x16x32_bf16 v[36:39], v[84:87], v[76:79], v[36:39]
    ds_read_b128 v[60:63], v7 offset:28672
    ds_read_b128 v[64:67], v7 offset:30720
    v_mfma_f32_16x16x32_bf16 v[40:43], v[88:91], v[76:79], v[40:43]
    ds_read_b128 v[68:71], v7 offset:32768
    ds_read_b128 v[72:75], v7 offset:34816
    v_mfma_f32_16x16x32_bf16 v[44:47], v[92:95], v[76:79], v[44:47]
    v_mfma_f32_16x16x32_bf16 v[48:51], v[96:99], v[76:79], v[48:51]
    s_waitcnt lgkmcnt(0)
    v_mfma_f32_16x16x32_bf16 v[32:35], v[56:59], v[52:55], v[32:35]
    ds_read_b128 v[76:79], v4 offset:19456
    ds_read_b128 v[80:83], v7 offset:27648
    v_mfma_f32_16x16x32_bf16 v[36:39], v[60:63], v[52:55], v[36:39]
    ds_read_b128 v[84:87], v7 offset:29696
    ds_read_b128 v[88:91], v7 offset:31744
    v_mfma_f32_16x16x32_bf16 v[40:43], v[64:67], v[52:55], v[40:43]
    ds_read_b128 v[92:95], v7 offset:33792
    ds_read_b128 v[96:99], v7 offset:35840
    v_mfma_f32_16x16x32_bf16 v[44:47], v[68:71], v[52:55], v[44:47]
    v_mfma_f32_16x16x32_bf16 v[48:51], v[72:75], v[52:55], v[48:51]
    s_waitcnt lgkmcnt(0)
    s_barrier
    v_mfma_f32_16x16x32_bf16 v[32:35], v[80:83], v[76:79], v[32:35]
    ds_read_b128 v[52:55], v4 offset:36864
    ds_read_b128 v[56:59], v7 offset:45056
    v_mfma_f32_16x16x32_bf16 v[36:39], v[84:87], v[76:79], v[36:39]
    ds_read_b128 v[60:63], v7 offset:47104
    ds_read_b128 v[64:67], v7 offset:49152
    v_mfma_f32_16x16x32_bf16 v[40:43], v[88:91], v[76:79], v[40:43]
    ds_read_b128 v[68:71], v7 offset:51200
    ds_read_b128 v[72:75], v7 offset:53248
    v_mfma_f32_16x16x32_bf16 v[44:47], v[92:95], v[76:79], v[44:47]
    v_mfma_f32_16x16x32_bf16 v[48:51], v[96:99], v[76:79], v[48:51]
    s_waitcnt lgkmcnt(0)
    v_mfma_f32_16x16x32_bf16 v[32:35], v[56:59], v[52:55], v[32:35]
    ds_read_b128 v[76:79], v4 offset:37888
    ds_read_b128 v[80:83], v7 offset:46080
    v_mfma_f32_16x16x32_bf16 v[36:39], v[60:63], v[52:55], v[36:39]
    ds_read_b128 v[84:87], v7 offset:48128
    ds_read_b128 v[88:91], v7 offset:50176
    v_mfma_f32_16x16x32_bf16 v[40:43], v[64:67], v[52:55], v[40:43]
    ds_read_b128 v[92:95], v7 offset:52224
    ds_read_b128 v[96:99], v7 offset:54272
    v_mfma_f32_16x16x32_bf16 v[44:47], v[68:71], v[52:55], v[44:47]
    v_mfma_f32_16x16x32_bf16 v[48:51], v[72:75], v[52:55], v[48:51]
    s_waitcnt lgkmcnt(0)
    s_barrier
    v_mfma_f32_16x16x32_bf16 v[32:35], v[80:83], v[76:79], v[32:35]
    ds_read_b128 v[52:55], v4 offset:55296
    ds_read_b128 v[56:59], v7 offset:63488
    v_mfma_f32_16x16x32_bf16 v[36:39], v[84:87], v[76:79], v[36:39]
    ds_read_b128 v[60:63], v8 offset:0
    ds_read_b128 v[64:67], v8 offset:2048
    v_mfma_f32_16x16x32_bf16 v[40:43], v[88:91], v[76:79], v[40:43]
    ds_read_b128 v[68:71], v8 offset:4096
    ds_read_b128 v[72:75], v8 offset:6144
    v_mfma_f32_16x16x32_bf16 v[44:47], v[92:95], v[76:79], v[44:47]
    v_mfma_f32_16x16x32_bf16 v[48:51], v[96:99], v[76:79], v[48:51]
    s_waitcnt lgkmcnt(0)
    v_mfma_f32_16x16x32_bf16 v[32:35], v[56:59], v[52:55], v[32:35]
    ds_read_b128 v[76:79], v4 offset:56320
    ds_read_b128 v[80:83], v7 offset:64512
    v_mfma_f32_16x16x32_bf16 v[36:39], v[60:63], v[52:55], v[36:39]
    ds_read_b128 v[84:87], v8 offset:1024
    ds_read_b128 v[88:91], v8 offset:3072
    v_mfma_f32_16x16x32_bf16 v[40:43], v[64:67], v[52:55], v[40:43]
    ds_read_b128 v[92:95], v8 offset:5120
    ds_read_b128 v[96:99], v8 offset:7168
    v_mfma_f32_16x16x32_bf16 v[44:47], v[68:71], v[52:55], v[44:47]
    v_mfma_f32_16x16x32_bf16 v[48:51], v[72:75], v[52:55], v[48:51]
    s_waitcnt lgkmcnt(0)
    s_barrier
    v_mfma_f32_16x16x32_bf16 v[32:35], v[80:83], v[76:79], v[32:35]
    ds_read_b128 v[52:55], v5 offset:8192
    ds_read_b128 v[56:59], v8 offset:16384
    v_mfma_f32_16x16x32_bf16 v[36:39], v[84:87], v[76:79], v[36:39]
    ds_read_b128 v[60:63], v8 offset:18432
    ds_read_b128 v[64:67], v8 offset:20480
    v_mfma_f32_16x16x32_bf16 v[40:43], v[88:91], v[76:79], v[40:43]
    ds_read_b128 v[68:71], v8 offset:22528
    ds_read_b128 v[72:75], v8 offset:24576
    v_mfma_f32_16x16x32_bf16 v[44:47], v[92:95], v[76:79], v[44:47]
    v_mfma_f32_16x16x32_bf16 v[48:51], v[96:99], v[76:79], v[48:51]
    s_waitcnt lgkmcnt(0)
    v_mfma_f32_16x16x32_bf16 v[32:35], v[56:59], v[52:55], v[32:35]
    ds_read_b128 v[76:79], v5 offset:9216
    ds_read_b128 v[80:83], v8 offset:17408
    v_mfma_f32_16x16x32_bf16 v[36:39], v[60:63], v[52:55], v[36:39]
    ds_read_b128 v[84:87], v8 offset:19456
    ds_read_b128 v[88:91], v8 offset:21504
    v_mfma_f32_16x16x32_bf16 v[40:43], v[64:67], v[52:55], v[40:43]
    ds_read_b128 v[92:95], v8 offset:23552
    ds_read_b128 v[96:99], v8 offset:25600
    v_mfma_f32_16x16x32_bf16 v[44:47], v[68:71], v[52:55], v[44:47]
    v_mfma_f32_16x16x32_bf16 v[48:51], v[72:75], v[52:55], v[48:51]
    s_waitcnt lgkmcnt(0)
    s_barrier
    v_mfma_f32_16x16x32_bf16 v[32:35], v[80:83], v[76:79], v[32:35]
    ds_read_b128 v[52:55], v5 offset:26624
    ds_read_b128 v[56:59], v8 offset:34816
    v_mfma_f32_16x16x32_bf16 v[36:39], v[84:87], v[76:79], v[36:39]
    ds_read_b128 v[60:63], v8 offset:36864
    ds_read_b128 v[64:67], v8 offset:38912
    v_mfma_f32_16x16x32_bf16 v[40:43], v[88:91], v[76:79], v[40:43]
    ds_read_b128 v[68:71], v8 offset:40960
    ds_read_b128 v[72:75], v8 offset:43008
    v_mfma_f32_16x16x32_bf16 v[44:47], v[92:95], v[76:79], v[44:47]
    v_mfma_f32_16x16x32_bf16 v[48:51], v[96:99], v[76:79], v[48:51]
    s_waitcnt lgkmcnt(0)
    v_mfma_f32_16x16x32_bf16 v[32:35], v[56:59], v[52:55], v[32:35]
    ds_read_b128 v[76:79], v5 offset:27648
    ds_read_b128 v[80:83], v8 offset:35840
    v_mfma_f32_16x16x32_bf16 v[36:39], v[60:63], v[52:55], v[36:39]
    ds_read_b128 v[84:87], v8 offset:37888
    ds_read_b128 v[88:91], v8 offset:39936
    v_mfma_f32_16x16x32_bf16 v[40:43], v[64:67], v[52:55], v[40:43]
    ds_read_b128 v[92:95], v8 offset:41984
    ds_read_b128 v[96:99], v8 offset:44032
    v_mfma_f32_16x16x32_bf16 v[44:47], v[68:71], v[52:55], v[44:47]
    v_mfma_f32_16x16x32_bf16 v[48:51], v[72:75], v[52:55], v[48:51]
    s_waitcnt lgkmcnt(0)
    s_barrier
    v_mfma_f32_16x16x32_bf16 v[32:35], v[80:83], v[76:79], v[32:35]
    ds_read_b128 v[52:55], v5 offset:45056
    ds_read_b128 v[56:59], v8 offset:53248
    v_mfma_f32_16x16x32_bf16 v[36:39], v[84:87], v[76:79], v[36:39]
    ds_read_b128 v[60:63], v8 offset:55296
    ds_read_b128 v[64:67], v8 offset:57344
    v_mfma_f32_16x16x32_bf16 v[40:43], v[88:91], v[76:79], v[40:43]
    ds_read_b128 v[68:71], v8 offset:59392
    ds_read_b128 v[72:75], v8 offset:61440
    v_mfma_f32_16x16x32_bf16 v[44:47], v[92:95], v[76:79], v[44:47]
    v_mfma_f32_16x16x32_bf16 v[48:51], v[96:99], v[76:79], v[48:51]
    s_waitcnt lgkmcnt(0)
    v_mfma_f32_16x16x32_bf16 v[32:35], v[56:59], v[52:55], v[32:35]
    ds_read_b128 v[76:79], v5 offset:46080
    ds_read_b128 v[80:83], v8 offset:54272
    v_mfma_f32_16x16x32_bf16 v[36:39], v[60:63], v[52:55], v[36:39]
    ds_read_b128 v[84:87], v8 offset:56320
    ds_read_b128 v[88:91], v8 offset:58368
    v_mfma_f32_16x16x32_bf16 v[40:43], v[64:67], v[52:55], v[40:43]
    ds_read_b128 v[92:95], v8 offset:60416
    ds_read_b128 v[96:99], v8 offset:62464
    v_mfma_f32_16x16x32_bf16 v[44:47], v[68:71], v[52:55], v[44:47]
    v_mfma_f32_16x16x32_bf16 v[48:51], v[72:75], v[52:55], v[48:51]
    s_waitcnt lgkmcnt(0)
    s_barrier
    v_mfma_f32_16x16x32_bf16 v[32:35], v[80:83], v[76:79], v[32:35]
    ds_read_b128 v[52:55], v5 offset:63488
    ds_read_b128 v[56:59], v9 offset:6144
    v_mfma_f32_16x16x32_bf16 v[36:39], v[84:87], v[76:79], v[36:39]
    ds_read_b128 v[60:63], v9 offset:8192
    ds_read_b128 v[64:67], v9 offset:10240
    v_mfma_f32_16x16x32_bf16 v[40:43], v[88:91], v[76:79], v[40:43]
    ds_read_b128 v[68:71], v9 offset:12288
    ds_read_b128 v[72:75], v9 offset:14336
    v_mfma_f32_16x16x32_bf16 v[44:47], v[92:95], v[76:79], v[44:47]
    v_mfma_f32_16x16x32_bf16 v[48:51], v[96:99], v[76:79], v[48:51]
    s_waitcnt lgkmcnt(0)
    v_mfma_f32_16x16x32_bf16 v[32:35], v[56:59], v[52:55], v[32:35]
    ds_read_b128 v[76:79], v5 offset:64512
    ds_read_b128 v[80:83], v9 offset:7168
    v_mfma_f32_16x16x32_bf16 v[36:39], v[60:63], v[52:55], v[36:39]
    ds_read_b128 v[84:87], v9 offset:9216
    ds_read_b128 v[88:91], v9 offset:11264
    v_mfma_f32_16x16x32_bf16 v[40:43], v[64:67], v[52:55], v[40:43]
    ds_read_b128 v[92:95], v9 offset:13312
    ds_read_b128 v[96:99], v9 offset:15360
    v_mfma_f32_16x16x32_bf16 v[44:47], v[68:71], v[52:55], v[44:47]
    v_mfma_f32_16x16x32_bf16 v[48:51], v[72:75], v[52:55], v[48:51]
    s_waitcnt lgkmcnt(0)
    v_mfma_f32_16x16x32_bf16 v[32:35], v[80:83], v[76:79], v[32:35]
    v_mfma_f32_16x16x32_bf16 v[36:39], v[84:87], v[76:79], v[36:39]
    v_mfma_f32_16x16x32_bf16 v[40:43], v[88:91], v[76:79], v[40:43]
    v_mfma_f32_16x16x32_bf16 v[44:47], v[92:95], v[76:79], v[44:47]
    v_mfma_f32_16x16x32_bf16 v[48:51], v[96:99], v[76:79], v[48:51]
    s_waitcnt vmcnt(0)
    v_mov_b32 v20, 0
    v_mov_b32 v21, 0
    s_nop 0
    v_cvt_pk_bf16_f32 v32, v32, v33
    v_cvt_pk_bf16_f32 v34, v34, v35
    v_and_b32 v33, 0xffff0000, v32
    v_lshlrev_b32 v32, 16, v32
    v_and_b32 v35, 0xffff0000, v34
    v_lshlrev_b32 v34, 16, v34
    v_lshlrev_b32 v22, 16, v10
    v_and_b32 v23, 0xffff0000, v10
    v_add_f32 v32, v32, v22
    v_add_f32 v33, v33, v23
    v_lshlrev_b32 v22, 16, v11
    v_and_b32 v23, 0xffff0000, v11
    v_add_f32 v34, v34, v22
    v_add_f32 v35, v35, v23
    v_cvt_pk_bf16_f32 v10, v32, v33
    v_cvt_pk_bf16_f32 v11, v34, v35
    s_add_u32 s22, s40, 15728640
    buffer_store_dwordx2 v[10:11], v3, s[4:7], s22 offen
    v_lshlrev_b32 v22, 16, v10
    v_and_b32 v23, 0xffff0000, v10
    v_add_f32 v20, v20, v22
    v_fma_f32 v21, v22, v22, v21
    v_add_f32 v20, v20, v23
    v_fma_f32 v21, v23, v23, v21
    v_lshlrev_b32 v22, 16, v11
    v_and_b32 v23, 0xffff0000, v11
    v_add_f32 v20, v20, v22
    v_fma_f32 v21, v22, v22, v21
    v_add_f32 v20, v20, v23
    v_fma_f32 v21, v23, v23, v21
    v_cvt_pk_bf16_f32 v36, v36, v37
    v_cvt_pk_bf16_f32 v38, v38, v39
    v_and_b32 v37, 0xffff0000, v36
    v_lshlrev_b32 v36, 16, v36
    v_and_b32 v39, 0xffff0000, v38
    v_lshlrev_b32 v38, 16, v38
    v_lshlrev_b32 v22, 16, v12
    v_and_b32 v23, 0xffff0000, v12
    v_add_f32 v36, v36, v22
    v_add_f32 v37, v37, v23
    v_lshlrev_b32 v22, 16, v13
    v_and_b32 v23, 0xffff0000, v13
    v_add_f32 v38, v38, v22
    v_add_f32 v39, v39, v23
    v_cvt_pk_bf16_f32 v12, v36, v37
    v_cvt_pk_bf16_f32 v13, v38, v39
    s_add_u32 s22, s41, 15728640
    buffer_store_dwordx2 v[12:13], v3, s[4:7], s22 offen
    v_lshlrev_b32 v22, 16, v12
    v_and_b32 v23, 0xffff0000, v12
    v_add_f32 v20, v20, v22
    v_fma_f32 v21, v22, v22, v21
    v_add_f32 v20, v20, v23
    v_fma_f32 v21, v23, v23, v21
    v_lshlrev_b32 v22, 16, v13
    v_and_b32 v23, 0xffff0000, v13
    v_add_f32 v20, v20, v22
    v_fma_f32 v21, v22, v22, v21
    v_add_f32 v20, v20, v23
    v_fma_f32 v21, v23, v23, v21
    v_cvt_pk_bf16_f32 v40, v40, v41
    v_cvt_pk_bf16_f32 v42, v42, v43
    v_and_b32 v41, 0xffff0000, v40
    v_lshlrev_b32 v40, 16, v40
    v_and_b32 v43, 0xffff0000, v42
    v_lshlrev_b32 v42, 16, v42
    v_lshlrev_b32 v22, 16, v14
    v_and_b32 v23, 0xffff0000, v14
    v_add_f32 v40, v40, v22
    v_add_f32 v41, v41, v23
    v_lshlrev_b32 v22, 16, v15
    v_and_b32 v23, 0xffff0000, v15
    v_add_f32 v42, v42, v22
    v_add_f32 v43, v43, v23
    v_cvt_pk_bf16_f32 v14, v40, v41
    v_cvt_pk_bf16_f32 v15, v42, v43
    s_add_u32 s22, s42, 15728640
    buffer_store_dwordx2 v[14:15], v3, s[4:7], s22 offen
    v_lshlrev_b32 v22, 16, v14
    v_and_b32 v23, 0xffff0000, v14
    v_add_f32 v20, v20, v22
    v_fma_f32 v21, v22, v22, v21
    v_add_f32 v20, v20, v23
    v_fma_f32 v21, v23, v23, v21
    v_lshlrev_b32 v22, 16, v15
    v_and_b32 v23, 0xffff0000, v15
    v_add_f32 v20, v20, v22
    v_fma_f32 v21, v22, v22, v21
    v_add_f32 v20, v20, v23
    v_fma_f32 v21, v23, v23, v21
    v_cvt_pk_bf16_f32 v44, v44, v45
    v_cvt_pk_bf16_f32 v46, v46, v47
    v_and_b32 v45, 0xffff0000, v44
    v_lshlrev_b32 v44, 16, v44
    v_and_b32 v47, 0xffff0000, v46
    v_lshlrev_b32 v46, 16, v46
    v_lshlrev_b32 v22, 16, v16
    v_and_b32 v23, 0xffff0000, v16
    v_add_f32 v44, v44, v22
    v_add_f32 v45, v45, v23
    v_lshlrev_b32 v22, 16, v17
    v_and_b32 v23, 0xffff0000, v17
    v_add_f32 v46, v46, v22
    v_add_f32 v47, v47, v23
    v_cvt_pk_bf16_f32 v16, v44, v45
    v_cvt_pk_bf16_f32 v17, v46, v47
    s_add_u32 s22, s43, 15728640
    buffer_store_dwordx2 v[16:17], v3, s[4:7], s22 offen
    v_lshlrev_b32 v22, 16, v16
    v_and_b32 v23, 0xffff0000, v16
    v_add_f32 v20, v20, v22
    v_fma_f32 v21, v22, v22, v21
    v_add_f32 v20, v20, v23
    v_fma_f32 v21, v23, v23, v21
    v_lshlrev_b32 v22, 16, v17
    v_and_b32 v23, 0xffff0000, v17
    v_add_f32 v20, v20, v22
    v_fma_f32 v21, v22, v22, v21
    v_add_f32 v20, v20, v23
    v_fma_f32 v21, v23, v23, v21
    v_cvt_pk_bf16_f32 v48, v48, v49
    v_cvt_pk_bf16_f32 v50, v50, v51
    v_and_b32 v49, 0xffff0000, v48
    v_lshlrev_b32 v48, 16, v48
    v_and_b32 v51, 0xffff0000, v50
    v_lshlrev_b32 v50, 16, v50
    v_lshlrev_b32 v22, 16, v18
    v_and_b32 v23, 0xffff0000, v18
    v_add_f32 v48, v48, v22
    v_add_f32 v49, v49, v23
    v_lshlrev_b32 v22, 16, v19
    v_and_b32 v23, 0xffff0000, v19
    v_add_f32 v50, v50, v22
    v_add_f32 v51, v51, v23
    v_cvt_pk_bf16_f32 v18, v48, v49
    v_cvt_pk_bf16_f32 v19, v50, v51
    s_add_u32 s22, s44, 15728640
    buffer_store_dwordx2 v[18:19], v3, s[4:7], s22 offen
    v_lshlrev_b32 v22, 16, v18
    v_and_b32 v23, 0xffff0000, v18
    v_add_f32 v20, v20, v22
    v_fma_f32 v21, v22, v22, v21
    v_add_f32 v20, v20, v23
    v_fma_f32 v21, v23, v23, v21
    v_lshlrev_b32 v22, 16, v19
    v_and_b32 v23, 0xffff0000, v19
    v_add_f32 v20, v20, v22
    v_fma_f32 v21, v22, v22, v21
    v_add_f32 v20, v20, v23
    v_fma_f32 v21, v23, v23, v21
    v_mov_b32 v22, v20
    s_nop 1
    v_permlane16_swap_b32 v22, v20
    v_add_f32 v20, v20, v22
    v_mov_b32 v22, v21
    s_nop 1
    v_permlane16_swap_b32 v22, v21
    v_add_f32 v21, v21, v22
    v_mov_b32 v22, v20
    s_nop 1
    v_permlane32_swap_b32 v22, v20
    v_add_f32 v20, v20, v22
    v_mov_b32 v22, v21
    s_nop 1
    v_permlane32_swap_b32 v22, v21
    v_add_f32 v21, v21, v22
    v_lshlrev_b32 v22, 6, v1
    s_lshl_b32 s22, s17, 10
    s_lshl_b32 s23, s14, 3
    s_add_u32 s22, s22, s23
    s_add_u32 s22, s22, 22282240
    s_mov_b64 exec, 0xffff
    buffer_store_dwordx2 v[20:21], v22, s[4:7], s22 offen
dn1_kernel_end:
    s_endpgm

.text
.globl qkv2_kernel
.p2align 8
.type qkv2_kernel,@function
qkv2_kernel:
    s_cmp_ge_u32 s2, 240
    s_cbranch_scc1 qkv2_kernel_end
    s_load_dwordx2 s[4:5], s[0:1], 72
    v_lshrrev_b32 v2, 6, v0
    s_nop 0
    v_readfirstlane_b32 s12, v2
    v_and_b32 v1, 63, v0
    v_lshlrev_b32 v3, 4, v1
    s_and_b32 s17, s2, 7
    s_lshr_b32 s18, s2, 3
    s_and_b32 s19, s17, 1
    s_lshr_b32 s17, s17, 1
    s_mul_i32 s19, s19, 30
    s_add_u32 s18, s18, s19
    s_and_b32 s13, s18, 3
    s_lshl_b32 s17, s17, 2
    s_add_u32 s13, s13, s17
    s_lshr_b32 s14, s18, 2
    s_cmp_lt_u32 s12, 4
    s_cbranch_scc1 qkv2_kernel_comp
    s_sub_u32 s12, s12, 4
    s_add_u32 s18, s12, 0
    s_mul_i32 s56, s18, 2048
    s_mul_i32 s20, s13, 8
    s_add_u32 s20, s20, s18
    s_mul_i32 s20, s20, 20480
    s_add_u32 s20, s20, 15728640
    s_mul_i32 s21, s14, 8
    s_add_u32 s21, s21, s18
    s_sub_u32 s21, s21, 8
    s_mul_i32 s21, s21, 20480
    s_add_u32 s21, s21, 0
    s_cmp_lt_u32 s18, 8
    s_cselect_b32 s24, s20, s21
    s_add_u32 s18, s12, 2
    s_mul_i32 s57, s18, 2048
    s_mul_i32 s20, s13, 8
    s_add_u32 s20, s20, s18
    s_mul_i32 s20, s20, 20480
    s_add_u32 s20, s20, 15728640
    s_mul_i32 s21, s14, 8
    s_add_u32 s21, s21, s18
    s_sub_u32 s21, s21, 8
    s_mul_i32 s21, s21, 20480
    s_add_u32 s21, s21, 0
    s_cmp_lt_u32 s18, 8
    s_cselect_b32 s25, s20, s21
    s_add_u32 s18, s12, 4
    s_mul_i32 s58, s18, 2048
    s_mul_i32 s20, s13, 8
    s_add_u32 s20, s20, s18
    s_mul_i32 s20, s20, 20480
    s_add_u32 s20, s20, 15728640
    s_mul_i32 s21, s14, 8
    s_add_u32 s21, s21, s18
    s_sub_u32 s21, s21, 8
    s_mul_i32 s21, s21, 20480
    s_add_u32 s21, s21, 0
    s_cmp_lt_u32 s18, 8
    s_cselect_b32 s26, s20, s21
    s_add_u32 s18, s12, 6
    s_mul_i32 s59, s18, 2048
    s_mul_i32 s20, s13, 8
    s_add_u32 s20, s20, s18
    s_mul_i32 s20, s20, 20480
    s_add_u32 s20, s20, 15728640
    s_mul_i32 s21, s14, 8
    s_add_u32 s21, s21, s18
    s_sub_u32 s21, s21, 8
    s_mul_i32 s21, s21, 20480
    s_add_u32 s21, s21, 0
    s_cmp_lt_u32 s18, 8
    s_cselect_b32 s27, s20, s21
    s_add_u32 s18, s12, 8
    s_mul_i32 s60, s18, 2048
    s_mul_i32 s20, s13, 8
    s_add_u32 s20, s20, s18
    s_mul_i32 s20, s20, 20480
    s_add_u32 s20, s20, 15728640
    s_mul_i32 s21, s14, 8
    s_add_u32 s21, s21, s18
    s_sub_u32 s21, s21, 8
    s_mul_i32 s21, s21, 20480
    s_add_u32 s21, s21, 0
    s_cmp_lt_u32 s18, 8
    s_cselect_b32 s28, s20, s21
    s_add_u32 s18, s12, 10
    s_mul_i32 s61, s18, 2048
    s_mul_i32 s20, s13, 8
    s_add_u32 s20, s20, s18
    s_mul_i32 s20, s20, 20480
    s_add_u32 s20, s20, 15728640
    s_mul_i32 s21, s14, 8
    s_add_u32 s21, s21, s18
    s_sub_u32 s21, s21, 8
    s_mul_i32 s21, s21, 20480
    s_add_u32 s21, s21, 0
    s_cmp_lt_u32 s18, 8
    s_cselect_b32 s29, s20, s21
    s_add_u32 s18, s12, 12
    s_mul_i32 s62, s18, 2048
    s_mul_i32 s20, s13, 8
    s_add_u32 s20, s20, s18
    s_mul_i32 s20, s20, 20480
    s_add_u32 s20, s20, 15728640
    s_mul_i32 s21, s14, 8
    s_add_u32 s21, s21, s18
    s_sub_u32 s21, s21, 8
    s_mul_i32 s21, s21, 20480
    s_add_u32 s21, s21, 0
    s_cmp_lt_u32 s18, 8
    s_cselect_b32 s30, s20, s21
    s_add_u32 s18, s12, 14
    s_mul_i32 s63, s18, 2048
    s_mul_i32 s20, s13, 8
    s_add_u32 s20, s20, s18
    s_mul_i32 s20, s20, 20480
    s_add_u32 s20, s20, 15728640
    s_mul_i32 s21, s14, 8
    s_add_u32 s21, s21, s18
    s_sub_u32 s21, s21, 8
    s_mul_i32 s21, s21, 20480
    s_add_u32 s21, s21, 0
    s_cmp_lt_u32 s18, 8
    s_cselect_b32 s31, s20, s21
    s_waitcnt lgkmcnt(0)
    s_and_b32 s5, s5, 0xffff
    s_mov_b32 s6, 268435456
    s_mov_b32 s7, 0x00020000
    s_add_u32 m0, s56, 0
    s_add_u32 s22, s24, 0
    buffer_load_dwordx4 v3, s[4:7], s22 offen offset:0 lds
    buffer_load_dwordx4 v3, s[4:7], s22 offen offset:1024 lds
    s_add_u32 m0, s57, 0
    s_add_u32 s23, s25, 0
    buffer_load_dwordx4 v3, s[4:7], s23 offen offset:0 lds
    buffer_load_dwordx4 v3, s[4:7], s23 offen offset:1024 lds
    s_add_u32 m0, s58, 0
    s_add_u32 s22, s26, 0
    buffer_load_dwordx4 v3, s[4:7], s22 offen offset:0 lds
    buffer_load_dwordx4 v3, s[4:7], s22 offen offset:1024 lds
    s_add_u32 m0, s59, 0
    s_add_u32 s23, s27, 0
    buffer_load_dwordx4 v3, s[4:7], s23 offen offset:0 lds
    buffer_load_dwordx4 v3, s[4:7], s23 offen offset:1024 lds
    s_add_u32 m0, s60, 0
    s_add_u32 s22, s28, 0
    buffer_load_dwordx4 v3, s[4:7], s22 offen offset:0 lds
    buffer_load_dwordx4 v3, s[4:7], s22 offen offset:1024 lds
    s_add_u32 m0, s61, 0
    s_add_u32 s23, s29, 0
    buffer_load_dwordx4 v3, s[4:7], s23 offen offset:0 lds
    buffer_load_dwordx4 v3, s[4:7], s23 offen offset:1024 lds
    s_add_u32 m0, s62, 0
    s_add_u32 s22, s30, 0
    buffer_load_dwordx4 v3, s[4:7], s22 offen offset:0 lds
    buffer_load_dwordx4 v3, s[4:7], s22 offen offset:1024 lds
    s_add_u32 m0, s63, 0
    s_add_u32 s23, s31, 0
    buffer_load_dwordx4 v3, s[4:7], s23 offen offset:0 lds
    buffer_load_dwordx4 v3, s[4:7], s23 offen offset:1024 lds
    s_add_u32 m0, s56, 32768
    s_add_u32 s22, s24, 2048
    buffer_load_dwordx4 v3, s[4:7], s22 offen offset:0 lds
    buffer_load_dwordx4 v3, s[4:7], s22 offen offset:1024 lds
    s_add_u32 m0, s57, 32768
    s_add_u32 s23, s25, 2048
    buffer_load_dwordx4 v3, s[4:7], s23 offen offset:0 lds
    buffer_load_dwordx4 v3, s[4:7], s23 offen offset:1024 lds
    s_add_u32 m0, s58, 32768
    s_add_u32 s22, s26, 2048
    buffer_load_dwordx4 v3, s[4:7], s22 offen offset:0 lds
    buffer_load_dwordx4 v3, s[4:7], s22 offen offset:1024 lds
    s_add_u32 m0, s59, 32768
    s_add_u32 s23, s27, 2048
    buffer_load_dwordx4 v3, s[4:7], s23 offen offset:0 lds
    buffer_load_dwordx4 v3, s[4:7], s23 offen offset:1024 lds
    s_add_u32 m0, s60, 32768
    s_add_u32 s22, s28, 2048
    buffer_load_dwordx4 v3, s[4:7], s22 offen offset:0 lds
    buffer_load_dwordx4 v3, s[4:7], s22 offen offset:1024 lds
    s_add_u32 m0, s61, 32768
    s_add_u32 s23, s29, 2048
    buffer_load_dwordx4 v3, s[4:7], s23 offen offset:0 lds
    buffer_load_dwordx4 v3, s[4:7], s23 offen offset:1024 lds
    s_add_u32 m0, s62, 32768
    s_add_u32 s22, s30, 2048
    buffer_load_dwordx4 v3, s[4:7], s22 offen offset:0 lds
    buffer_load_dwordx4 v3, s[4:7], s22 offen offset:1024 lds
    s_add_u32 m0, s63, 32768
    s_add_u32 s23, s31, 2048
    buffer_load_dwordx4 v3, s[4:7], s23 offen offset:0 lds
    buffer_load_dwordx4 v3, s[4:7], s23 offen offset:1024 lds
    s_waitcnt vmcnt(16)
    s_barrier
    s_add_u32 m0, s56, 65536
    s_add_u32 s22, s24, 4096
    buffer_load_dwordx4 v3, s[4:7], s22 offen offset:0 lds
    buffer_load_dwordx4 v3, s[4:7], s22 offen offset:1024 lds
    s_add_u32 m0, s57, 65536
    s_add_u32 s23, s25, 4096
    buffer_load_dwordx4 v3, s[4:7], s23 offen offset:0 lds
    buffer_load_dwordx4 v3, s[4:7], s23 offen offset:1024 lds
    s_add_u32 m0, s58, 65536
    s_add_u32 s22, s26, 4096
    buffer_load_dwordx4 v3, s[4:7], s22 offen offset:0 lds
    buffer_load_dwordx4 v3, s[4:7], s22 offen offset:1024 lds
    s_add_u32 m0, s59, 65536
    s_add_u32 s23, s27, 4096
    buffer_load_dwordx4 v3, s[4:7], s23 offen offset:0 lds
    buffer_load_dwordx4 v3, s[4:7], s23 offen offset:1024 lds
    s_add_u32 m0, s60, 65536
    s_add_u32 s22, s28, 4096
    buffer_load_dwordx4 v3, s[4:7], s22 offen offset:0 lds
    buffer_load_dwordx4 v3, s[4:7], s22 offen offset:1024 lds
    s_add_u32 m0, s61, 65536
    s_add_u32 s23, s29, 4096
    buffer_load_dwordx4 v3, s[4:7], s23 offen offset:0 lds
    buffer_load_dwordx4 v3, s[4:7], s23 offen offset:1024 lds
    s_add_u32 m0, s62, 65536
    s_add_u32 s22, s30, 4096
    buffer_load_dwordx4 v3, s[4:7], s22 offen offset:0 lds
    buffer_load_dwordx4 v3, s[4:7], s22 offen offset:1024 lds
    s_add_u32 m0, s63, 65536
    s_add_u32 s23, s31, 4096
    buffer_load_dwordx4 v3, s[4:7], s23 offen offset:0 lds
    buffer_load_dwordx4 v3, s[4:7], s23 offen offset:1024 lds
    s_waitcnt vmcnt(16)
    s_barrier
    s_add_u32 m0, s56, 98304
    s_add_u32 s22, s24, 6144
    buffer_load_dwordx4 v3, s[4:7], s22 offen offset:0 lds
    buffer_load_dwordx4 v3, s[4:7], s22 offen offset:1024 lds
    s_add_u32 m0, s57, 98304
    s_add_u32 s23, s25, 6144
    buffer_load_dwordx4 v3, s[4:7], s23 offen offset:0 lds
    buffer_load_dwordx4 v3, s[4:7], s23 offen offset:1024 lds
    s_add_u32 m0, s58, 98304
    s_add_u32 s22, s26, 6144
    buffer_load_dwordx4 v3, s[4:7], s22 offen offset:0 lds
    buffer_load_dwordx4 v3, s[4:7], s22 offen offset:1024 lds
    s_add_u32 m0, s59, 98304
    s_add_u32 s23, s27, 6144
    buffer_load_dwordx4 v3, s[4:7], s23 offen offset:0 lds
    buffer_load_dwordx4 v3, s[4:7], s23 offen offset:1024 lds
    s_add_u32 m0, s60, 98304
    s_add_u32 s22, s28, 6144
    buffer_load_dwordx4 v3, s[4:7], s22 offen offset:0 lds
    buffer_load_dwordx4 v3, s[4:7], s22 offen offset:1024 lds
    s_add_u32 m0, s61, 98304
    s_add_u32 s23, s29, 6144
    buffer_load_dwordx4 v3, s[4:7], s23 offen offset:0 lds
    buffer_load_dwordx4 v3, s[4:7], s23 offen offset:1024 lds
    s_add_u32 m0, s62, 98304
    s_add_u32 s22, s30, 6144
    buffer_load_dwordx4 v3, s[4:7], s22 offen offset:0 lds
    buffer_load_dwordx4 v3, s[4:7], s22 offen offset:1024 lds
    s_add_u32 m0, s63, 98304
    s_add_u32 s23, s31, 6144
    buffer_load_dwordx4 v3, s[4:7], s23 offen offset:0 lds
    buffer_load_dwordx4 v3, s[4:7], s23 offen offset:1024 lds
    s_waitcnt vmcnt(16)
    s_barrier
    s_add_u32 m0, s56, 0
    s_add_u32 s22, s24, 8192
    buffer_load_dwordx4 v3, s[4:7], s22 offen offset:0 lds
    buffer_load_dwordx4 v3, s[4:7], s22 offen offset:1024 lds
    s_add_u32 m0, s57, 0
    s_add_u32 s23, s25, 8192
    buffer_load_dwordx4 v3, s[4:7], s23 offen offset:0 lds
    buffer_load_dwordx4 v3, s[4:7], s23 offen offset:1024 lds
    s_add_u32 m0, s58, 0
    s_add_u32 s22, s26, 8192
    buffer_load_dwordx4 v3, s[4:7], s22 offen offset:0 lds
    buffer_load_dwordx4 v3, s[4:7], s22 offen offset:1024 lds
    s_add_u32 m0, s59, 0
    s_add_u32 s23, s27, 8192
    buffer_load_dwordx4 v3, s[4:7], s23 offen offset:0 lds
    buffer_load_dwordx4 v3, s[4:7], s23 offen offset:1024 lds
    s_add_u32 m0, s60, 0
    s_add_u32 s22, s28, 8192
    buffer_load_dwordx4 v3, s[4:7], s22 offen offset:0 lds
    buffer_load_dwordx4 v3, s[4:7], s22 offen offset:1024 lds
    s_add_u32 m0, s61, 0
    s_add_u32 s23, s29, 8192
    buffer_load_dwordx4 v3, s[4:7], s23 offen offset:0 lds
    buffer_load_dwordx4 v3, s[4:7], s23 offen offset:1024 lds
    s_add_u32 m0, s62, 0
    s_add_u32 s22, s30, 8192
    buffer_load_dwordx4 v3, s[4:7], s22 offen offset:0 lds
    buffer_load_dwordx4 v3, s[4:7], s22 offen offset:1024 lds
    s_add_u32 m0, s63, 0
    s_add_u32 s23, s31, 8192
    buffer_load_dwordx4 v3, s[4:7], s23 offen offset:0 lds
    buffer_load_dwordx4 v3, s[4:7], s23 offen offset:1024 lds
    s_waitcnt vmcnt(16)
    s_barrier
    s_add_u32 m0, s56, 32768
    s_add_u32 s22, s24, 10240
    buffer_load_dwordx4 v3, s[4:7], s22 offen offset:0 lds
    buffer_load_dwordx4 v3, s[4:7], s22 offen offset:1024 lds
    s_add_u32 m0, s57, 32768
    s_add_u32 s23, s25, 10240
    buffer_load_dwordx4 v3, s[4:7], s23 offen offset:0 lds
    buffer_load_dwordx4 v3, s[4:7], s23 offen offset:1024 lds
    s_add_u32 m0, s58, 32768
    s_add_u32 s22, s26, 10240
    buffer_load_dwordx4 v3, s[4:7], s22 offen offset:0 lds
    buffer_load_dwordx4 v3, s[4:7], s22 offen offset:1024 lds
    s_add_u32 m0, s59, 32768
    s_add_u32 s23, s27, 10240
    buffer_load_dwordx4 v3, s[4:7], s23 offen offset:0 lds
    buffer_load_dwordx4 v3, s[4:7], s23 offen offset:1024 lds
    s_add_u32 m0, s60, 32768
    s_add_u32 s22, s28, 10240
    buffer_load_dwordx4 v3, s[4:7], s22 offen offset:0 lds
    buffer_load_dwordx4 v3, s[4:7], s22 offen offset:1024 lds
    s_add_u32 m0, s61, 32768
    s_add_u32 s23, s29, 10240
    buffer_load_dwordx4 v3, s[4:7], s23 offen offset:0 lds
    buffer_load_dwordx4 v3, s[4:7], s23 offen offset:1024 lds
    s_add_u32 m0, s62, 32768
    s_add_u32 s22, s30, 10240
    buffer_load_dwordx4 v3, s[4:7], s22 offen offset:0 lds
    buffer_load_dwordx4 v3, s[4:7], s22 offen offset:1024 lds
    s_add_u32 m0, s63, 32768
    s_add_u32 s23, s31, 10240
    buffer_load_dwordx4 v3, s[4:7], s23 offen offset:0 lds
    buffer_load_dwordx4 v3, s[4:7], s23 offen offset:1024 lds
    s_waitcnt vmcnt(16)
    s_barrier
    s_add_u32 m0, s56, 65536
    s_add_u32 s22, s24, 12288
    buffer_load_dwordx4 v3, s[4:7], s22 offen offset:0 lds
    buffer_load_dwordx4 v3, s[4:7], s22 offen offset:1024 lds
    s_add_u32 m0, s57, 65536
    s_add_u32 s23, s25, 12288
    buffer_load_dwordx4 v3, s[4:7], s23 offen offset:0 lds
    buffer_load_dwordx4 v3, s[4:7], s23 offen offset:1024 lds
    s_add_u32 m0, s58, 65536
    s_add_u32 s22, s26, 12288
    buffer_load_dwordx4 v3, s[4:7], s22 offen offset:0 lds
    buffer_load_dwordx4 v3, s[4:7], s22 offen offset:1024 lds
    s_add_u32 m0, s59, 65536
    s_add_u32 s23, s27, 12288
    buffer_load_dwordx4 v3, s[4:7], s23 offen offset:0 lds
    buffer_load_dwordx4 v3, s[4:7], s23 offen offset:1024 lds
    s_add_u32 m0, s60, 65536
    s_add_u32 s22, s28, 12288
    buffer_load_dwordx4 v3, s[4:7], s22 offen offset:0 lds
    buffer_load_dwordx4 v3, s[4:7], s22 offen offset:1024 lds
    s_add_u32 m0, s61, 65536
    s_add_u32 s23, s29, 12288
    buffer_load_dwordx4 v3, s[4:7], s23 offen offset:0 lds
    buffer_load_dwordx4 v3, s[4:7], s23 offen offset:1024 lds
    s_add_u32 m0, s62, 65536
    s_add_u32 s22, s30, 12288
    buffer_load_dwordx4 v3, s[4:7], s22 offen offset:0 lds
    buffer_load_dwordx4 v3, s[4:7], s22 offen offset:1024 lds
    s_add_u32 m0, s63, 65536
    s_add_u32 s23, s31, 12288
    buffer_load_dwordx4 v3, s[4:7], s23 offen offset:0 lds
    buffer_load_dwordx4 v3, s[4:7], s23 offen offset:1024 lds
    s_waitcnt vmcnt(16)
    s_barrier
    s_add_u32 m0, s56, 98304
    s_add_u32 s22, s24, 14336
    buffer_load_dwordx4 v3, s[4:7], s22 offen offset:0 lds
    buffer_load_dwordx4 v3, s[4:7], s22 offen offset:1024 lds
    s_add_u32 m0, s57, 98304
    s_add_u32 s23, s25, 14336
    buffer_load_dwordx4 v3, s[4:7], s23 offen offset:0 lds
    buffer_load_dwordx4 v3, s[4:7], s23 offen offset:1024 lds
    s_add_u32 m0, s58, 98304
    s_add_u32 s22, s26, 14336
    buffer_load_dwordx4 v3, s[4:7], s22 offen offset:0 lds
    buffer_load_dwordx4 v3, s[4:7], s22 offen offset:1024 lds
    s_add_u32 m0, s59, 98304
    s_add_u32 s23, s27, 14336
    buffer_load_dwordx4 v3, s[4:7], s23 offen offset:0 lds
    buffer_load_dwordx4 v3, s[4:7], s23 offen offset:1024 lds
    s_add_u32 m0, s60, 98304
    s_add_u32 s22, s28, 14336
    buffer_load_dwordx4 v3, s[4:7], s22 offen offset:0 lds
    buffer_load_dwordx4 v3, s[4:7], s22 offen offset:1024 lds
    s_add_u32 m0, s61, 98304
    s_add_u32 s23, s29, 14336
    buffer_load_dwordx4 v3, s[4:7], s23 offen offset:0 lds
    buffer_load_dwordx4 v3, s[4:7], s23 offen offset:1024 lds
    s_add_u32 m0, s62, 98304
    s_add_u32 s22, s30, 14336
    buffer_load_dwordx4 v3, s[4:7], s22 offen offset:0 lds
    buffer_load_dwordx4 v3, s[4:7], s22 offen offset:1024 lds
    s_add_u32 m0, s63, 98304
    s_add_u32 s23, s31, 14336
    buffer_load_dwordx4 v3, s[4:7], s23 offen offset:0 lds
    buffer_load_dwordx4 v3, s[4:7], s23 offen offset:1024 lds
    s_waitcnt vmcnt(16)
    s_barrier
    s_add_u32 m0, s56, 0
    s_add_u32 s22, s24, 16384
    buffer_load_dwordx4 v3, s[4:7], s22 offen offset:0 lds
    buffer_load_dwordx4 v3, s[4:7], s22 offen offset:1024 lds
    s_add_u32 m0, s57, 0
    s_add_u32 s23, s25, 16384
    buffer_load_dwordx4 v3, s[4:7], s23 offen offset:0 lds
    buffer_load_dwordx4 v3, s[4:7], s23 offen offset:1024 lds
    s_add_u32 m0, s58, 0
    s_add_u32 s22, s26, 16384
    buffer_load_dwordx4 v3, s[4:7], s22 offen offset:0 lds
    buffer_load_dwordx4 v3, s[4:7], s22 offen offset:1024 lds
    s_add_u32 m0, s59, 0
    s_add_u32 s23, s27, 16384
    buffer_load_dwordx4 v3, s[4:7], s23 offen offset:0 lds
    buffer_load_dwordx4 v3, s[4:7], s23 offen offset:1024 lds
    s_add_u32 m0, s60, 0
    s_add_u32 s22, s28, 16384
    buffer_load_dwordx4 v3, s[4:7], s22 offen offset:0 lds
    buffer_load_dwordx4 v3, s[4:7], s22 offen offset:1024 lds
    s_add_u32 m0, s61, 0
    s_add_u32 s23, s29, 16384
    buffer_load_dwordx4 v3, s[4:7], s23 offen offset:0 lds
    buffer_load_dwordx4 v3, s[4:7], s23 offen offset:1024 lds
    s_add_u32 m0, s62, 0
    s_add_u32 s22, s30, 16384
    buffer_load_dwordx4 v3, s[4:7], s22 offen offset:0 lds
    buffer_load_dwordx4 v3, s[4:7], s22 offen offset:1024 lds
    s_add_u32 m0, s63, 0
    s_add_u32 s23, s31, 16384
    buffer_load_dwordx4 v3, s[4:7], s23 offen offset:0 lds
    buffer_load_dwordx4 v3, s[4:7], s23 offen offset:1024 lds
    s_waitcnt vmcnt(16)
    s_barrier
    s_add_u32 m0, s56, 32768
    s_add_u32 s22, s24, 18432
    buffer_load_dwordx4 v3, s[4:7], s22 offen offset:0 lds
    buffer_load_dwordx4 v3, s[4:7], s22 offen offset:1024 lds
    s_add_u32 m0, s57, 32768
    s_add_u32 s23, s25, 18432
    buffer_load_dwordx4 v3, s[4:7], s23 offen offset:0 lds
    buffer_load_dwordx4 v3, s[4:7], s23 offen offset:1024 lds
    s_add_u32 m0, s58, 32768
    s_add_u32 s22, s26, 18432
    buffer_load_dwordx4 v3, s[4:7], s22 offen offset:0 lds
    buffer_load_dwordx4 v3, s[4:7], s22 offen offset:1024 lds
    s_add_u32 m0, s59, 32768
    s_add_u32 s23, s27, 18432
    buffer_load_dwordx4 v3, s[4:7], s23 offen offset:0 lds
    buffer_load_dwordx4 v3, s[4:7], s23 offen offset:1024 lds
    s_add_u32 m0, s60, 32768
    s_add_u32 s22, s28, 18432
    buffer_load_dwordx4 v3, s[4:7], s22 offen offset:0 lds
    buffer_load_dwordx4 v3, s[4:7], s22 offen offset:1024 lds
    s_add_u32 m0, s61, 32768
    s_add_u32 s23, s29, 18432
    buffer_load_dwordx4 v3, s[4:7], s23 offen offset:0 lds
    buffer_load_dwordx4 v3, s[4:7], s23 offen offset:1024 lds
    s_add_u32 m0, s62, 32768
    s_add_u32 s22, s30, 18432
    buffer_load_dwordx4 v3, s[4:7], s22 offen offset:0 lds
    buffer_load_dwordx4 v3, s[4:7], s22 offen offset:1024 lds
    s_add_u32 m0, s63, 32768
    s_add_u32 s23, s31, 18432
    buffer_load_dwordx4 v3, s[4:7], s23 offen offset:0 lds
    buffer_load_dwordx4 v3, s[4:7], s23 offen offset:1024 lds
    s_waitcnt vmcnt(16)
    s_barrier
    s_waitcnt vmcnt(0)
    s_barrier
    s_endpgm
qkv2_kernel_comp:
    s_lshr_b32 s15, s12, 1
    s_and_b32 s16, s12, 1
    s_mul_i32 s17, s15, 8192
    s_mul_i32 s18, s16, 8192
    v_add_u32 v4, s17, v3
    v_add_u32 v7, s18, v3
    v_add_u32 v5, s17, v3
    v_add_u32 v8, s18, v3
    v_add_u32 v5, 65536, v5
    v_add_u32 v8, 65536, v8
    v_add_u32 v6, s17, v3
    v_add_u32 v9, s18, v3
    v_add_u32 v6, 131072, v6
    v_add_u32 v9, 131072, v9
    s_waitcnt lgkmcnt(0)
    s_and_b32 s5, s5, 0xffff
    s_mov_b32 s6, 268435456
    s_mov_b32 s7, 0x00020000
    v_and_b32 v2, 127, v0
    v_lshlrev_b32 v2, 6, v2
    s_lshl_b32 s17, s13, 13
    s_add_u32 s17, s17, 22282240
    buffer_load_dwordx4 v[10:13], v2, s[4:7], s17 offen offset:0
    buffer_load_dwordx4 v[14:17], v2, s[4:7], s17 offen offset:16
    buffer_load_dwordx4 v[18:21], v2, s[4:7], s17 offen offset:32
    buffer_load_dwordx4 v[22:25], v2, s[4:7], s17 offen offset:48
    v_lshrrev_b32 v2, 4, v1
    s_cmp_ge_u32 s14, 10
    s_nop 3
    s_cbranch_scc1 qkv2_kernel_v
    v_lshlrev_b32 v42, 4, v2
    s_lshl_b32 s17, s14, 9
    s_lshl_b32 s18, s16, 8
    s_add_u32 s17, s17, s18
    s_add_u32 s17, s17, 9240576
    buffer_load_dwordx4 v[26:29], v42, s[4:7], s17 offen offset:0
    buffer_load_dwordx4 v[30:33], v42, s[4:7], s17 offen offset:64
    buffer_load_dwordx4 v[34:37], v42, s[4:7], s17 offen offset:128
    buffer_load_dwordx4 v[38:41], v42, s[4:7], s17 offen offset:192
    s_waitcnt vmcnt(4)
    v_add_f32 v10, v10, v12
    v_add_f32 v11, v11, v13
    v_add_f32 v10, v10, v14
    v_add_f32 v11, v11, v15
    v_add_f32 v10, v10, v16
    v_add_f32 v11, v11, v17
    v_add_f32 v10, v10, v18
    v_add_f32 v11, v11, v19
    v_add_f32 v10, v10, v20
    v_add_f32 v11, v11, v21
    v_add_f32 v10, v10, v22
    v_add_f32 v11, v11, v23
    v_add_f32 v10, v10, v24
    v_add_f32 v11, v11, v25
    v_mul_f32 v10, 0x3acccccd, v10
    v_mul_f32 v11, 0x3acccccd, v11
    v_fma_f32 v11, -v10, v10, v11
    v_max_f32 v11, 0, v11
    v_cvt_pk_bf16_f32 v10, v10, v10
    v_lshlrev_b32 v10, 16, v10
    v_cvt_pk_bf16_f32 v11, v11, v11
    v_lshlrev_b32 v11, 16, v11
    v_add_f32 v11, 0x3727c5ac, v11
    v_cvt_pk_bf16_f32 v11, v11, v11
    v_lshlrev_b32 v11, 16, v11
    v_sqrt_f32 v11, v11
    s_nop 0
    v_cvt_pk_bf16_f32 v11, v11, v11
    v_lshlrev_b32 v11, 16, v11
    v_rcp_f32 v11, v11
    v_and_b32 v12, 127, v0
    v_lshlrev_b32 v12, 3, v12
    v_add_u32 v12, 131072, v12
    ds_write_b64 v12, v[10:11]
    s_waitcnt lgkmcnt(0)
    s_barrier
    ds_read_b128 v[112:115], v4 offset:0
    ds_read_b128 v[116:119], v4 offset:2048
    ds_read_b128 v[120:123], v4 offset:4096
    ds_read_b128 v[124:127], v4 offset:6144
    ds_read_b128 v[128:131], v7 offset:16384
    ds_read_b128 v[132:135], v7 offset:18432
    ds_read_b128 v[136:139], v7 offset:20480
    ds_read_b128 v[140:143], v7 offset:22528
    s_waitcnt lgkmcnt(0)
    v_mfma_f32_16x16x32_bf16 v[48:51], v[128:131], v[112:115], 0
    ds_read_b128 v[144:147], v4 offset:1024
    v_mfma_f32_16x16x32_bf16 v[52:55], v[132:135], v[112:115], 0
    ds_read_b128 v[148:151], v4 offset:3072
    v_mfma_f32_16x16x32_bf16 v[56:59], v[136:139], v[112:115], 0
    ds_read_b128 v[152:155], v4 offset:5120
    v_mfma_f32_16x16x32_bf16 v[60:63], v[140:143], v[112:115], 0
    ds_read_b128 v[156:159], v4 offset:7168
    v_mfma_f32_16x16x32_bf16 v[64:67], v[128:131], v[116:119], 0
    ds_read_b128 v[160:163], v7 offset:17408
    v_mfma_f32_16x16x32_bf16 v[68:71], v[132:135], v[116:119], 0
    ds_read_b128 v[164:167], v7 offset:19456
    v_mfma_f32_16x16x32_bf16 v[72:75], v[136:139], v[116:119], 0
    ds_read_b128 v[168:171], v7 offset:21504
    v_mfma_f32_16x16x32_bf16 v[76:79], v[140:143], v[116:119], 0
    ds_read_b128 v[172:175], v7 offset:23552
    v_mfma_f32_16x16x32_bf16 v[80:83], v[128:131], v[120:123], 0
    v_mfma_f32_16x16x32_bf16 v[84:87], v[132:135], v[120:123], 0
    v_mfma_f32_16x16x32_bf16 v[88:91], v[136:139], v[120:123], 0
    v_mfma_f32_16x16x32_bf16 v[92:95], v[140:143], v[120:123], 0
    v_mfma_f32_16x16x32_bf16 v[96:99], v[128:131], v[124:127], 0
    v_mfma_f32_16x16x32_bf16 v[100:103], v[132:135], v[124:127], 0
    v_mfma_f32_16x16x32_bf16 v[104:107], v[136:139], v[124:127], 0
    v_mfma_f32_16x16x32_bf16 v[108:111], v[140:143], v[124:127], 0
    s_waitcnt lgkmcnt(0)
    s_barrier
    v_mfma_f32_16x16x32_bf16 v[48:51], v[160:163], v[144:147], v[48:51]
    ds_read_b128 v[112:115], v4 offset:32768
    v_mfma_f32_16x16x32_bf16 v[52:55], v[164:167], v[144:147], v[52:55]
    ds_read_b128 v[116:119], v4 offset:34816
    v_mfma_f32_16x16x32_bf16 v[56:59], v[168:171], v[144:147], v[56:59]
    ds_read_b128 v[120:123], v4 offset:36864
    v_mfma_f32_16x16x32_bf16 v[60:63], v[172:175], v[144:147], v[60:63]
    ds_read_b128 v[124:127], v4 offset:38912
    v_mfma_f32_16x16x32_bf16 v[64:67], v[160:163], v[148:151], v[64:67]
    ds_read_b128 v[128:131], v7 offset:49152
    v_mfma_f32_16x16x32_bf16 v[68:71], v[164:167], v[148:151], v[68:71]
    ds_read_b128 v[132:135], v7 offset:51200
    v_mfma_f32_16x16x32_bf16 v[72:75], v[168:171], v[148:151], v[72:75]
    ds_read_b128 v[136:139], v7 offset:53248
    v_mfma_f32_16x16x32_bf16 v[76:79], v[172:175], v[148:151], v[76:79]
    ds_read_b128 v[140:143], v7 offset:55296
    v_mfma_f32_16x16x32_bf16 v[80:83], v[160:163], v[152:155], v[80:83]
    v_mfma_f32_16x16x32_bf16 v[84:87], v[164:167], v[152:155], v[84:87]
    v_mfma_f32_16x16x32_bf16 v[88:91], v[168:171], v[152:155], v[88:91]
    v_mfma_f32_16x16x32_bf16 v[92:95], v[172:175], v[152:155], v[92:95]
    v_mfma_f32_16x16x32_bf16 v[96:99], v[160:163], v[156:159], v[96:99]
    v_mfma_f32_16x16x32_bf16 v[100:103], v[164:167], v[156:159], v[100:103]
    v_mfma_f32_16x16x32_bf16 v[104:107], v[168:171], v[156:159], v[104:107]
    v_mfma_f32_16x16x32_bf16 v[108:111], v[172:175], v[156:159], v[108:111]
    s_waitcnt lgkmcnt(0)
    v_mfma_f32_16x16x32_bf16 v[48:51], v[128:131], v[112:115], v[48:51]
    ds_read_b128 v[144:147], v4 offset:33792
    v_mfma_f32_16x16x32_bf16 v[52:55], v[132:135], v[112:115], v[52:55]
    ds_read_b128 v[148:151], v4 offset:35840
    v_mfma_f32_16x16x32_bf16 v[56:59], v[136:139], v[112:115], v[56:59]
    ds_read_b128 v[152:155], v4 offset:37888
    v_mfma_f32_16x16x32_bf16 v[60:63], v[140:143], v[112:115], v[60:63]
    ds_read_b128 v[156:159], v4 offset:39936
    v_mfma_f32_16x16x32_bf16 v[64:67], v[128:131], v[116:119], v[64:67]
    ds_read_b128 v[160:163], v7 offset:50176
    v_mfma_f32_16x16x32_bf16 v[68:71], v[132:135], v[116:119], v[68:71]
    ds_read_b128 v[164:167], v7 offset:52224
    v_mfma_f32_16x16x32_bf16 v[72:75], v[136:139], v[116:119], v[72:75]
    ds_read_b128 v[168:171], v7 offset:54272
    v_mfma_f32_16x16x32_bf16 v[76:79], v[140:143], v[116:119], v[76:79]
    ds_read_b128 v[172:175], v7 offset:56320
    v_mfma_f32_16x16x32_bf16 v[80:83], v[128:131], v[120:123], v[80:83]
    v_mfma_f32_16x16x32_bf16 v[84:87], v[132:135], v[120:123], v[84:87]
    v_mfma_f32_16x16x32_bf16 v[88:91], v[136:139], v[120:123], v[88:91]
    v_mfma_f32_16x16x32_bf16 v[92:95], v[140:143], v[120:123], v[92:95]
    v_mfma_f32_16x16x32_bf16 v[96:99], v[128:131], v[124:127], v[96:99]
    v_mfma_f32_16x16x32_bf16 v[100:103], v[132:135], v[124:127], v[100:103]
    v_mfma_f32_16x16x32_bf16 v[104:107], v[136:139], v[124:127], v[104:107]
    v_mfma_f32_16x16x32_bf16 v[108:111], v[140:143], v[124:127], v[108:111]
    s_waitcnt lgkmcnt(0)
    s_barrier
    v_mfma_f32_16x16x32_bf16 v[48:51], v[160:163], v[144:147], v[48:51]
    ds_read_b128 v[112:115], v5 offset:0
    v_mfma_f32_16x16x32_bf16 v[52:55], v[164:167], v[144:147], v[52:55]
    ds_read_b128 v[116:119], v5 offset:2048
    v_mfma_f32_16x16x32_bf16 v[56:59], v[168:171], v[144:147], v[56:59]
    ds_read_b128 v[120:123], v5 offset:4096
    v_mfma_f32_16x16x32_bf16 v[60:63], v[172:175], v[144:147], v[60:63]
    ds_read_b128 v[124:127], v5 offset:6144
    v_mfma_f32_16x16x32_bf16 v[64:67], v[160:163], v[148:151], v[64:67]
    ds_read_b128 v[128:131], v8 offset:16384
    v_mfma_f32_16x16x32_bf16 v[68:71], v[164:167], v[148:151], v[68:71]
    ds_read_b128 v[132:135], v8 offset:18432
    v_mfma_f32_16x16x32_bf16 v[72:75], v[168:171], v[148:151], v[72:75]
    ds_read_b128 v[136:139], v8 offset:20480
    v_mfma_f32_16x16x32_bf16 v[76:79], v[172:175], v[148:151], v[76:79]
    ds_read_b128 v[140:143], v8 offset:22528
    v_mfma_f32_16x16x32_bf16 v[80:83], v[160:163], v[152:155], v[80:83]
    v_mfma_f32_16x16x32_bf16 v[84:87], v[164:167], v[152:155], v[84:87]
    v_mfma_f32_16x16x32_bf16 v[88:91], v[168:171], v[152:155], v[88:91]
    v_mfma_f32_16x16x32_bf16 v[92:95], v[172:175], v[152:155], v[92:95]
    v_mfma_f32_16x16x32_bf16 v[96:99], v[160:163], v[156:159], v[96:99]
    v_mfma_f32_16x16x32_bf16 v[100:103], v[164:167], v[156:159], v[100:103]
    v_mfma_f32_16x16x32_bf16 v[104:107], v[168:171], v[156:159], v[104:107]
    v_mfma_f32_16x16x32_bf16 v[108:111], v[172:175], v[156:159], v[108:111]
    s_waitcnt lgkmcnt(0)
    v_mfma_f32_16x16x32_bf16 v[48:51], v[128:131], v[112:115], v[48:51]
    ds_read_b128 v[144:147], v5 offset:1024
    v_mfma_f32_16x16x32_bf16 v[52:55], v[132:135], v[112:115], v[52:55]
    ds_read_b128 v[148:151], v5 offset:3072
    v_mfma_f32_16x16x32_bf16 v[56:59], v[136:139], v[112:115], v[56:59]
    ds_read_b128 v[152:155], v5 offset:5120
    v_mfma_f32_16x16x32_bf16 v[60:63], v[140:143], v[112:115], v[60:63]
    ds_read_b128 v[156:159], v5 offset:7168
    v_mfma_f32_16x16x32_bf16 v[64:67], v[128:131], v[116:119], v[64:67]
    ds_read_b128 v[160:163], v8 offset:17408
    v_mfma_f32_16x16x32_bf16 v[68:71], v[132:135], v[116:119], v[68:71]
    ds_read_b128 v[164:167], v8 offset:19456
    v_mfma_f32_16x16x32_bf16 v[72:75], v[136:139], v[116:119], v[72:75]
    ds_read_b128 v[168:171], v8 offset:21504
    v_mfma_f32_16x16x32_bf16 v[76:79], v[140:143], v[116:119], v[76:79]
    ds_read_b128 v[172:175], v8 offset:23552
    v_mfma_f32_16x16x32_bf16 v[80:83], v[128:131], v[120:123], v[80:83]
    v_mfma_f32_16x16x32_bf16 v[84:87], v[132:135], v[120:123], v[84:87]
    v_mfma_f32_16x16x32_bf16 v[88:91], v[136:139], v[120:123], v[88:91]
    v_mfma_f32_16x16x32_bf16 v[92:95], v[140:143], v[120:123], v[92:95]
    v_mfma_f32_16x16x32_bf16 v[96:99], v[128:131], v[124:127], v[96:99]
    v_mfma_f32_16x16x32_bf16 v[100:103], v[132:135], v[124:127], v[100:103]
    v_mfma_f32_16x16x32_bf16 v[104:107], v[136:139], v[124:127], v[104:107]
    v_mfma_f32_16x16x32_bf16 v[108:111], v[140:143], v[124:127], v[108:111]
    s_waitcnt lgkmcnt(0)
    s_barrier
    v_mfma_f32_16x16x32_bf16 v[48:51], v[160:163], v[144:147], v[48:51]
    ds_read_b128 v[112:115], v5 offset:32768
    v_mfma_f32_16x16x32_bf16 v[52:55], v[164:167], v[144:147], v[52:55]
    ds_read_b128 v[116:119], v5 offset:34816
    v_mfma_f32_16x16x32_bf16 v[56:59], v[168:171], v[144:147], v[56:59]
    ds_read_b128 v[120:123], v5 offset:36864
    v_mfma_f32_16x16x32_bf16 v[60:63], v[172:175], v[144:147], v[60:63]
    ds_read_b128 v[124:127], v5 offset:38912
    v_mfma_f32_16x16x32_bf16 v[64:67], v[160:163], v[148:151], v[64:67]
    ds_read_b128 v[128:131], v8 offset:49152
    v_mfma_f32_16x16x32_bf16 v[68:71], v[164:167], v[148:151], v[68:71]
    ds_read_b128 v[132:135], v8 offset:51200
    v_mfma_f32_16x16x32_bf16 v[72:75], v[168:171], v[148:151], v[72:75]
    ds_read_b128 v[136:139], v8 offset:53248
    v_mfma_f32_16x16x32_bf16 v[76:79], v[172:175], v[148:151], v[76:79]
    ds_read_b128 v[140:143], v8 offset:55296
    v_mfma_f32_16x16x32_bf16 v[80:83], v[160:163], v[152:155], v[80:83]
    v_mfma_f32_16x16x32_bf16 v[84:87], v[164:167], v[152:155], v[84:87]
    v_mfma_f32_16x16x32_bf16 v[88:91], v[168:171], v[152:155], v[88:91]
    v_mfma_f32_16x16x32_bf16 v[92:95], v[172:175], v[152:155], v[92:95]
    v_mfma_f32_16x16x32_bf16 v[96:99], v[160:163], v[156:159], v[96:99]
    v_mfma_f32_16x16x32_bf16 v[100:103], v[164:167], v[156:159], v[100:103]
    v_mfma_f32_16x16x32_bf16 v[104:107], v[168:171], v[156:159], v[104:107]
    v_mfma_f32_16x16x32_bf16 v[108:111], v[172:175], v[156:159], v[108:111]
    s_waitcnt lgkmcnt(0)
    v_mfma_f32_16x16x32_bf16 v[48:51], v[128:131], v[112:115], v[48:51]
    ds_read_b128 v[144:147], v5 offset:33792
    v_mfma_f32_16x16x32_bf16 v[52:55], v[132:135], v[112:115], v[52:55]
    ds_read_b128 v[148:151], v5 offset:35840
    v_mfma_f32_16x16x32_bf16 v[56:59], v[136:139], v[112:115], v[56:59]
    ds_read_b128 v[152:155], v5 offset:37888
    v_mfma_f32_16x16x32_bf16 v[60:63], v[140:143], v[112:115], v[60:63]
    ds_read_b128 v[156:159], v5 offset:39936
    v_mfma_f32_16x16x32_bf16 v[64:67], v[128:131], v[116:119], v[64:67]
    ds_read_b128 v[160:163], v8 offset:50176
    v_mfma_f32_16x16x32_bf16 v[68:71], v[132:135], v[116:119], v[68:71]
    ds_read_b128 v[164:167], v8 offset:52224
    v_mfma_f32_16x16x32_bf16 v[72:75], v[136:139], v[116:119], v[72:75]
    ds_read_b128 v[168:171], v8 offset:54272
    v_mfma_f32_16x16x32_bf16 v[76:79], v[140:143], v[116:119], v[76:79]
    ds_read_b128 v[172:175], v8 offset:56320
    v_mfma_f32_16x16x32_bf16 v[80:83], v[128:131], v[120:123], v[80:83]
    v_mfma_f32_16x16x32_bf16 v[84:87], v[132:135], v[120:123], v[84:87]
    v_mfma_f32_16x16x32_bf16 v[88:91], v[136:139], v[120:123], v[88:91]
    v_mfma_f32_16x16x32_bf16 v[92:95], v[140:143], v[120:123], v[92:95]
    v_mfma_f32_16x16x32_bf16 v[96:99], v[128:131], v[124:127], v[96:99]
    v_mfma_f32_16x16x32_bf16 v[100:103], v[132:135], v[124:127], v[100:103]
    v_mfma_f32_16x16x32_bf16 v[104:107], v[136:139], v[124:127], v[104:107]
    v_mfma_f32_16x16x32_bf16 v[108:111], v[140:143], v[124:127], v[108:111]
    s_waitcnt lgkmcnt(0)
    s_barrier
    v_mfma_f32_16x16x32_bf16 v[48:51], v[160:163], v[144:147], v[48:51]
    ds_read_b128 v[112:115], v4 offset:0
    v_mfma_f32_16x16x32_bf16 v[52:55], v[164:167], v[144:147], v[52:55]
    ds_read_b128 v[116:119], v4 offset:2048
    v_mfma_f32_16x16x32_bf16 v[56:59], v[168:171], v[144:147], v[56:59]
    ds_read_b128 v[120:123], v4 offset:4096
    v_mfma_f32_16x16x32_bf16 v[60:63], v[172:175], v[144:147], v[60:63]
    ds_read_b128 v[124:127], v4 offset:6144
    v_mfma_f32_16x16x32_bf16 v[64:67], v[160:163], v[148:151], v[64:67]
    ds_read_b128 v[128:131], v7 offset:16384
    v_mfma_f32_16x16x32_bf16 v[68:71], v[164:167], v[148:151], v[68:71]
    ds_read_b128 v[132:135], v7 offset:18432
    v_mfma_f32_16x16x32_bf16 v[72:75], v[168:171], v[148:151], v[72:75]
    ds_read_b128 v[136:139], v7 offset:20480
    v_mfma_f32_16x16x32_bf16 v[76:79], v[172:175], v[148:151], v[76:79]
    ds_read_b128 v[140:143], v7 offset:22528
    v_mfma_f32_16x16x32_bf16 v[80:83], v[160:163], v[152:155], v[80:83]
    v_mfma_f32_16x16x32_bf16 v[84:87], v[164:167], v[152:155], v[84:87]
    v_mfma_f32_16x16x32_bf16 v[88:91], v[168:171], v[152:155], v[88:91]
    v_mfma_f32_16x16x32_bf16 v[92:95], v[172:175], v[152:155], v[92:95]
    v_mfma_f32_16x16x32_bf16 v[96:99], v[160:163], v[156:159], v[96:99]
    v_mfma_f32_16x16x32_bf16 v[100:103], v[164:167], v[156:159], v[100:103]
    v_mfma_f32_16x16x32_bf16 v[104:107], v[168:171], v[156:159], v[104:107]
    v_mfma_f32_16x16x32_bf16 v[108:111], v[172:175], v[156:159], v[108:111]
    s_waitcnt lgkmcnt(0)
    v_mfma_f32_16x16x32_bf16 v[48:51], v[128:131], v[112:115], v[48:51]
    ds_read_b128 v[144:147], v4 offset:1024
    v_mfma_f32_16x16x32_bf16 v[52:55], v[132:135], v[112:115], v[52:55]
    ds_read_b128 v[148:151], v4 offset:3072
    v_mfma_f32_16x16x32_bf16 v[56:59], v[136:139], v[112:115], v[56:59]
    ds_read_b128 v[152:155], v4 offset:5120
    v_mfma_f32_16x16x32_bf16 v[60:63], v[140:143], v[112:115], v[60:63]
    ds_read_b128 v[156:159], v4 offset:7168
    v_mfma_f32_16x16x32_bf16 v[64:67], v[128:131], v[116:119], v[64:67]
    ds_read_b128 v[160:163], v7 offset:17408
    v_mfma_f32_16x16x32_bf16 v[68:71], v[132:135], v[116:119], v[68:71]
    ds_read_b128 v[164:167], v7 offset:19456
    v_mfma_f32_16x16x32_bf16 v[72:75], v[136:139], v[116:119], v[72:75]
    ds_read_b128 v[168:171], v7 offset:21504
    v_mfma_f32_16x16x32_bf16 v[76:79], v[140:143], v[116:119], v[76:79]
    ds_read_b128 v[172:175], v7 offset:23552
    v_mfma_f32_16x16x32_bf16 v[80:83], v[128:131], v[120:123], v[80:83]
    v_mfma_f32_16x16x32_bf16 v[84:87], v[132:135], v[120:123], v[84:87]
    v_mfma_f32_16x16x32_bf16 v[88:91], v[136:139], v[120:123], v[88:91]
    v_mfma_f32_16x16x32_bf16 v[92:95], v[140:143], v[120:123], v[92:95]
    v_mfma_f32_16x16x32_bf16 v[96:99], v[128:131], v[124:127], v[96:99]
    v_mfma_f32_16x16x32_bf16 v[100:103], v[132:135], v[124:127], v[100:103]
    v_mfma_f32_16x16x32_bf16 v[104:107], v[136:139], v[124:127], v[104:107]
    v_mfma_f32_16x16x32_bf16 v[108:111], v[140:143], v[124:127], v[108:111]
    s_waitcnt lgkmcnt(0)
    s_barrier
    v_mfma_f32_16x16x32_bf16 v[48:51], v[160:163], v[144:147], v[48:51]
    ds_read_b128 v[112:115], v4 offset:32768
    v_mfma_f32_16x16x32_bf16 v[52:55], v[164:167], v[144:147], v[52:55]
    ds_read_b128 v[116:119], v4 offset:34816
    v_mfma_f32_16x16x32_bf16 v[56:59], v[168:171], v[144:147], v[56:59]
    ds_read_b128 v[120:123], v4 offset:36864
    v_mfma_f32_16x16x32_bf16 v[60:63], v[172:175], v[144:147], v[60:63]
    ds_read_b128 v[124:127], v4 offset:38912
    v_mfma_f32_16x16x32_bf16 v[64:67], v[160:163], v[148:151], v[64:67]
    ds_read_b128 v[128:131], v7 offset:49152
    v_mfma_f32_16x16x32_bf16 v[68:71], v[164:167], v[148:151], v[68:71]
    ds_read_b128 v[132:135], v7 offset:51200
    v_mfma_f32_16x16x32_bf16 v[72:75], v[168:171], v[148:151], v[72:75]
    ds_read_b128 v[136:139], v7 offset:53248
    v_mfma_f32_16x16x32_bf16 v[76:79], v[172:175], v[148:151], v[76:79]
    ds_read_b128 v[140:143], v7 offset:55296
    v_mfma_f32_16x16x32_bf16 v[80:83], v[160:163], v[152:155], v[80:83]
    v_mfma_f32_16x16x32_bf16 v[84:87], v[164:167], v[152:155], v[84:87]
    v_mfma_f32_16x16x32_bf16 v[88:91], v[168:171], v[152:155], v[88:91]
    v_mfma_f32_16x16x32_bf16 v[92:95], v[172:175], v[152:155], v[92:95]
    v_mfma_f32_16x16x32_bf16 v[96:99], v[160:163], v[156:159], v[96:99]
    v_mfma_f32_16x16x32_bf16 v[100:103], v[164:167], v[156:159], v[100:103]
    v_mfma_f32_16x16x32_bf16 v[104:107], v[168:171], v[156:159], v[104:107]
    v_mfma_f32_16x16x32_bf16 v[108:111], v[172:175], v[156:159], v[108:111]
    s_waitcnt lgkmcnt(0)
    v_mfma_f32_16x16x32_bf16 v[48:51], v[128:131], v[112:115], v[48:51]
    ds_read_b128 v[144:147], v4 offset:33792
    v_mfma_f32_16x16x32_bf16 v[52:55], v[132:135], v[112:115], v[52:55]
    ds_read_b128 v[148:151], v4 offset:35840
    v_mfma_f32_16x16x32_bf16 v[56:59], v[136:139], v[112:115], v[56:59]
    ds_read_b128 v[152:155], v4 offset:37888
    v_mfma_f32_16x16x32_bf16 v[60:63], v[140:143], v[112:115], v[60:63]
    ds_read_b128 v[156:159], v4 offset:39936
    v_mfma_f32_16x16x32_bf16 v[64:67], v[128:131], v[116:119], v[64:67]
    ds_read_b128 v[160:163], v7 offset:50176
    v_mfma_f32_16x16x32_bf16 v[68:71], v[132:135], v[116:119], v[68:71]
    ds_read_b128 v[164:167], v7 offset:52224
    v_mfma_f32_16x16x32_bf16 v[72:75], v[136:139], v[116:119], v[72:75]
    ds_read_b128 v[168:171], v7 offset:54272
    v_mfma_f32_16x16x32_bf16 v[76:79], v[140:143], v[116:119], v[76:79]
    ds_read_b128 v[172:175], v7 offset:56320
    v_mfma_f32_16x16x32_bf16 v[80:83], v[128:131], v[120:123], v[80:83]
    v_mfma_f32_16x16x32_bf16 v[84:87], v[132:135], v[120:123], v[84:87]
    v_mfma_f32_16x16x32_bf16 v[88:91], v[136:139], v[120:123], v[88:91]
    v_mfma_f32_16x16x32_bf16 v[92:95], v[140:143], v[120:123], v[92:95]
    v_mfma_f32_16x16x32_bf16 v[96:99], v[128:131], v[124:127], v[96:99]
    v_mfma_f32_16x16x32_bf16 v[100:103], v[132:135], v[124:127], v[100:103]
    v_mfma_f32_16x16x32_bf16 v[104:107], v[136:139], v[124:127], v[104:107]
    v_mfma_f32_16x16x32_bf16 v[108:111], v[140:143], v[124:127], v[108:111]
    s_waitcnt lgkmcnt(0)
    s_barrier
    v_mfma_f32_16x16x32_bf16 v[48:51], v[160:163], v[144:147], v[48:51]
    ds_read_b128 v[112:115], v5 offset:0
    v_mfma_f32_16x16x32_bf16 v[52:55], v[164:167], v[144:147], v[52:55]
    ds_read_b128 v[116:119], v5 offset:2048
    v_mfma_f32_16x16x32_bf16 v[56:59], v[168:171], v[144:147], v[56:59]
    ds_read_b128 v[120:123], v5 offset:4096
    v_mfma_f32_16x16x32_bf16 v[60:63], v[172:175], v[144:147], v[60:63]
    ds_read_b128 v[124:127], v5 offset:6144
    v_mfma_f32_16x16x32_bf16 v[64:67], v[160:163], v[148:151], v[64:67]
    ds_read_b128 v[128:131], v8 offset:16384
    v_mfma_f32_16x16x32_bf16 v[68:71], v[164:167], v[148:151], v[68:71]
    ds_read_b128 v[132:135], v8 offset:18432
    v_mfma_f32_16x16x32_bf16 v[72:75], v[168:171], v[148:151], v[72:75]
    ds_read_b128 v[136:139], v8 offset:20480
    v_mfma_f32_16x16x32_bf16 v[76:79], v[172:175], v[148:151], v[76:79]
    ds_read_b128 v[140:143], v8 offset:22528
    v_mfma_f32_16x16x32_bf16 v[80:83], v[160:163], v[152:155], v[80:83]
    v_mfma_f32_16x16x32_bf16 v[84:87], v[164:167], v[152:155], v[84:87]
    v_mfma_f32_16x16x32_bf16 v[88:91], v[168:171], v[152:155], v[88:91]
    v_mfma_f32_16x16x32_bf16 v[92:95], v[172:175], v[152:155], v[92:95]
    v_mfma_f32_16x16x32_bf16 v[96:99], v[160:163], v[156:159], v[96:99]
    v_mfma_f32_16x16x32_bf16 v[100:103], v[164:167], v[156:159], v[100:103]
    v_mfma_f32_16x16x32_bf16 v[104:107], v[168:171], v[156:159], v[104:107]
    v_mfma_f32_16x16x32_bf16 v[108:111], v[172:175], v[156:159], v[108:111]
    s_waitcnt lgkmcnt(0)
    v_mfma_f32_16x16x32_bf16 v[48:51], v[128:131], v[112:115], v[48:51]
    ds_read_b128 v[144:147], v5 offset:1024
    v_mfma_f32_16x16x32_bf16 v[52:55], v[132:135], v[112:115], v[52:55]
    ds_read_b128 v[148:151], v5 offset:3072
    v_mfma_f32_16x16x32_bf16 v[56:59], v[136:139], v[112:115], v[56:59]
    ds_read_b128 v[152:155], v5 offset:5120
    v_mfma_f32_16x16x32_bf16 v[60:63], v[140:143], v[112:115], v[60:63]
    ds_read_b128 v[156:159], v5 offset:7168
    v_mfma_f32_16x16x32_bf16 v[64:67], v[128:131], v[116:119], v[64:67]
    ds_read_b128 v[160:163], v8 offset:17408
    v_mfma_f32_16x16x32_bf16 v[68:71], v[132:135], v[116:119], v[68:71]
    ds_read_b128 v[164:167], v8 offset:19456
    v_mfma_f32_16x16x32_bf16 v[72:75], v[136:139], v[116:119], v[72:75]
    ds_read_b128 v[168:171], v8 offset:21504
    v_mfma_f32_16x16x32_bf16 v[76:79], v[140:143], v[116:119], v[76:79]
    ds_read_b128 v[172:175], v8 offset:23552
    v_mfma_f32_16x16x32_bf16 v[80:83], v[128:131], v[120:123], v[80:83]
    v_mfma_f32_16x16x32_bf16 v[84:87], v[132:135], v[120:123], v[84:87]
    v_mfma_f32_16x16x32_bf16 v[88:91], v[136:139], v[120:123], v[88:91]
    v_mfma_f32_16x16x32_bf16 v[92:95], v[140:143], v[120:123], v[92:95]
    v_mfma_f32_16x16x32_bf16 v[96:99], v[128:131], v[124:127], v[96:99]
    v_mfma_f32_16x16x32_bf16 v[100:103], v[132:135], v[124:127], v[100:103]
    v_mfma_f32_16x16x32_bf16 v[104:107], v[136:139], v[124:127], v[104:107]
    v_mfma_f32_16x16x32_bf16 v[108:111], v[140:143], v[124:127], v[108:111]
    s_waitcnt lgkmcnt(0)
    s_barrier
    v_mfma_f32_16x16x32_bf16 v[48:51], v[160:163], v[144:147], v[48:51]
    ds_read_b128 v[112:115], v5 offset:32768
    v_mfma_f32_16x16x32_bf16 v[52:55], v[164:167], v[144:147], v[52:55]
    ds_read_b128 v[116:119], v5 offset:34816
    v_mfma_f32_16x16x32_bf16 v[56:59], v[168:171], v[144:147], v[56:59]
    ds_read_b128 v[120:123], v5 offset:36864
    v_mfma_f32_16x16x32_bf16 v[60:63], v[172:175], v[144:147], v[60:63]
    ds_read_b128 v[124:127], v5 offset:38912
    v_mfma_f32_16x16x32_bf16 v[64:67], v[160:163], v[148:151], v[64:67]
    ds_read_b128 v[128:131], v8 offset:49152
    v_mfma_f32_16x16x32_bf16 v[68:71], v[164:167], v[148:151], v[68:71]
    ds_read_b128 v[132:135], v8 offset:51200
    v_mfma_f32_16x16x32_bf16 v[72:75], v[168:171], v[148:151], v[72:75]
    ds_read_b128 v[136:139], v8 offset:53248
    v_mfma_f32_16x16x32_bf16 v[76:79], v[172:175], v[148:151], v[76:79]
    ds_read_b128 v[140:143], v8 offset:55296
    v_mfma_f32_16x16x32_bf16 v[80:83], v[160:163], v[152:155], v[80:83]
    v_mfma_f32_16x16x32_bf16 v[84:87], v[164:167], v[152:155], v[84:87]
    v_mfma_f32_16x16x32_bf16 v[88:91], v[168:171], v[152:155], v[88:91]
    v_mfma_f32_16x16x32_bf16 v[92:95], v[172:175], v[152:155], v[92:95]
    v_mfma_f32_16x16x32_bf16 v[96:99], v[160:163], v[156:159], v[96:99]
    v_mfma_f32_16x16x32_bf16 v[100:103], v[164:167], v[156:159], v[100:103]
    v_mfma_f32_16x16x32_bf16 v[104:107], v[168:171], v[156:159], v[104:107]
    v_mfma_f32_16x16x32_bf16 v[108:111], v[172:175], v[156:159], v[108:111]
    s_waitcnt lgkmcnt(0)
    v_mfma_f32_16x16x32_bf16 v[48:51], v[128:131], v[112:115], v[48:51]
    ds_read_b128 v[144:147], v5 offset:33792
    v_mfma_f32_16x16x32_bf16 v[52:55], v[132:135], v[112:115], v[52:55]
    ds_read_b128 v[148:151], v5 offset:35840
    v_mfma_f32_16x16x32_bf16 v[56:59], v[136:139], v[112:115], v[56:59]
    ds_read_b128 v[152:155], v5 offset:37888
    v_mfma_f32_16x16x32_bf16 v[60:63], v[140:143], v[112:115], v[60:63]
    ds_read_b128 v[156:159], v5 offset:39936
    v_mfma_f32_16x16x32_bf16 v[64:67], v[128:131], v[116:119], v[64:67]
    ds_read_b128 v[160:163], v8 offset:50176
    v_mfma_f32_16x16x32_bf16 v[68:71], v[132:135], v[116:119], v[68:71]
    ds_read_b128 v[164:167], v8 offset:52224
    v_mfma_f32_16x16x32_bf16 v[72:75], v[136:139], v[116:119], v[72:75]
    ds_read_b128 v[168:171], v8 offset:54272
    v_mfma_f32_16x16x32_bf16 v[76:79], v[140:143], v[116:119], v[76:79]
    ds_read_b128 v[172:175], v8 offset:56320
    v_mfma_f32_16x16x32_bf16 v[80:83], v[128:131], v[120:123], v[80:83]
    v_mfma_f32_16x16x32_bf16 v[84:87], v[132:135], v[120:123], v[84:87]
    v_mfma_f32_16x16x32_bf16 v[88:91], v[136:139], v[120:123], v[88:91]
    v_mfma_f32_16x16x32_bf16 v[92:95], v[140:143], v[120:123], v[92:95]
    v_mfma_f32_16x16x32_bf16 v[96:99], v[128:131], v[124:127], v[96:99]
    v_mfma_f32_16x16x32_bf16 v[100:103], v[132:135], v[124:127], v[100:103]
    v_mfma_f32_16x16x32_bf16 v[104:107], v[136:139], v[124:127], v[104:107]
    v_mfma_f32_16x16x32_bf16 v[108:111], v[140:143], v[124:127], v[108:111]
    s_waitcnt lgkmcnt(0)
    s_barrier
    v_mfma_f32_16x16x32_bf16 v[48:51], v[160:163], v[144:147], v[48:51]
    ds_read_b128 v[112:115], v4 offset:0
    v_mfma_f32_16x16x32_bf16 v[52:55], v[164:167], v[144:147], v[52:55]
    ds_read_b128 v[116:119], v4 offset:2048
    v_mfma_f32_16x16x32_bf16 v[56:59], v[168:171], v[144:147], v[56:59]
    ds_read_b128 v[120:123], v4 offset:4096
    v_mfma_f32_16x16x32_bf16 v[60:63], v[172:175], v[144:147], v[60:63]
    ds_read_b128 v[124:127], v4 offset:6144
    v_mfma_f32_16x16x32_bf16 v[64:67], v[160:163], v[148:151], v[64:67]
    ds_read_b128 v[128:131], v7 offset:16384
    v_mfma_f32_16x16x32_bf16 v[68:71], v[164:167], v[148:151], v[68:71]
    ds_read_b128 v[132:135], v7 offset:18432
    v_mfma_f32_16x16x32_bf16 v[72:75], v[168:171], v[148:151], v[72:75]
    ds_read_b128 v[136:139], v7 offset:20480
    v_mfma_f32_16x16x32_bf16 v[76:79], v[172:175], v[148:151], v[76:79]
    ds_read_b128 v[140:143], v7 offset:22528
    v_mfma_f32_16x16x32_bf16 v[80:83], v[160:163], v[152:155], v[80:83]
    v_mfma_f32_16x16x32_bf16 v[84:87], v[164:167], v[152:155], v[84:87]
    v_mfma_f32_16x16x32_bf16 v[88:91], v[168:171], v[152:155], v[88:91]
    v_mfma_f32_16x16x32_bf16 v[92:95], v[172:175], v[152:155], v[92:95]
    v_mfma_f32_16x16x32_bf16 v[96:99], v[160:163], v[156:159], v[96:99]
    v_mfma_f32_16x16x32_bf16 v[100:103], v[164:167], v[156:159], v[100:103]
    v_mfma_f32_16x16x32_bf16 v[104:107], v[168:171], v[156:159], v[104:107]
    v_mfma_f32_16x16x32_bf16 v[108:111], v[172:175], v[156:159], v[108:111]
    s_waitcnt lgkmcnt(0)
    v_mfma_f32_16x16x32_bf16 v[48:51], v[128:131], v[112:115], v[48:51]
    ds_read_b128 v[144:147], v4 offset:1024
    v_mfma_f32_16x16x32_bf16 v[52:55], v[132:135], v[112:115], v[52:55]
    ds_read_b128 v[148:151], v4 offset:3072
    v_mfma_f32_16x16x32_bf16 v[56:59], v[136:139], v[112:115], v[56:59]
    ds_read_b128 v[152:155], v4 offset:5120
    v_mfma_f32_16x16x32_bf16 v[60:63], v[140:143], v[112:115], v[60:63]
    ds_read_b128 v[156:159], v4 offset:7168
    v_mfma_f32_16x16x32_bf16 v[64:67], v[128:131], v[116:119], v[64:67]
    ds_read_b128 v[160:163], v7 offset:17408
    v_mfma_f32_16x16x32_bf16 v[68:71], v[132:135], v[116:119], v[68:71]
    ds_read_b128 v[164:167], v7 offset:19456
    v_mfma_f32_16x16x32_bf16 v[72:75], v[136:139], v[116:119], v[72:75]
    ds_read_b128 v[168:171], v7 offset:21504
    v_mfma_f32_16x16x32_bf16 v[76:79], v[140:143], v[116:119], v[76:79]
    ds_read_b128 v[172:175], v7 offset:23552
    v_mfma_f32_16x16x32_bf16 v[80:83], v[128:131], v[120:123], v[80:83]
    v_mfma_f32_16x16x32_bf16 v[84:87], v[132:135], v[120:123], v[84:87]
    v_mfma_f32_16x16x32_bf16 v[88:91], v[136:139], v[120:123], v[88:91]
    v_mfma_f32_16x16x32_bf16 v[92:95], v[140:143], v[120:123], v[92:95]
    v_mfma_f32_16x16x32_bf16 v[96:99], v[128:131], v[124:127], v[96:99]
    v_mfma_f32_16x16x32_bf16 v[100:103], v[132:135], v[124:127], v[100:103]
    v_mfma_f32_16x16x32_bf16 v[104:107], v[136:139], v[124:127], v[104:107]
    v_mfma_f32_16x16x32_bf16 v[108:111], v[140:143], v[124:127], v[108:111]
    s_waitcnt lgkmcnt(0)
    s_barrier
    v_mfma_f32_16x16x32_bf16 v[48:51], v[160:163], v[144:147], v[48:51]
    ds_read_b128 v[112:115], v4 offset:32768
    v_mfma_f32_16x16x32_bf16 v[52:55], v[164:167], v[144:147], v[52:55]
    ds_read_b128 v[116:119], v4 offset:34816
    v_mfma_f32_16x16x32_bf16 v[56:59], v[168:171], v[144:147], v[56:59]
    ds_read_b128 v[120:123], v4 offset:36864
    v_mfma_f32_16x16x32_bf16 v[60:63], v[172:175], v[144:147], v[60:63]
    ds_read_b128 v[124:127], v4 offset:38912
    v_mfma_f32_16x16x32_bf16 v[64:67], v[160:163], v[148:151], v[64:67]
    ds_read_b128 v[128:131], v7 offset:49152
    v_mfma_f32_16x16x32_bf16 v[68:71], v[164:167], v[148:151], v[68:71]
    ds_read_b128 v[132:135], v7 offset:51200
    v_mfma_f32_16x16x32_bf16 v[72:75], v[168:171], v[148:151], v[72:75]
    ds_read_b128 v[136:139], v7 offset:53248
    v_mfma_f32_16x16x32_bf16 v[76:79], v[172:175], v[148:151], v[76:79]
    ds_read_b128 v[140:143], v7 offset:55296
    v_mfma_f32_16x16x32_bf16 v[80:83], v[160:163], v[152:155], v[80:83]
    v_mfma_f32_16x16x32_bf16 v[84:87], v[164:167], v[152:155], v[84:87]
    v_mfma_f32_16x16x32_bf16 v[88:91], v[168:171], v[152:155], v[88:91]
    v_mfma_f32_16x16x32_bf16 v[92:95], v[172:175], v[152:155], v[92:95]
    v_mfma_f32_16x16x32_bf16 v[96:99], v[160:163], v[156:159], v[96:99]
    v_mfma_f32_16x16x32_bf16 v[100:103], v[164:167], v[156:159], v[100:103]
    v_mfma_f32_16x16x32_bf16 v[104:107], v[168:171], v[156:159], v[104:107]
    v_mfma_f32_16x16x32_bf16 v[108:111], v[172:175], v[156:159], v[108:111]
    s_waitcnt lgkmcnt(0)
    v_mfma_f32_16x16x32_bf16 v[48:51], v[128:131], v[112:115], v[48:51]
    ds_read_b128 v[144:147], v4 offset:33792
    v_mfma_f32_16x16x32_bf16 v[52:55], v[132:135], v[112:115], v[52:55]
    ds_read_b128 v[148:151], v4 offset:35840
    v_mfma_f32_16x16x32_bf16 v[56:59], v[136:139], v[112:115], v[56:59]
    ds_read_b128 v[152:155], v4 offset:37888
    v_mfma_f32_16x16x32_bf16 v[60:63], v[140:143], v[112:115], v[60:63]
    ds_read_b128 v[156:159], v4 offset:39936
    v_mfma_f32_16x16x32_bf16 v[64:67], v[128:131], v[116:119], v[64:67]
    ds_read_b128 v[160:163], v7 offset:50176
    v_mfma_f32_16x16x32_bf16 v[68:71], v[132:135], v[116:119], v[68:71]
    ds_read_b128 v[164:167], v7 offset:52224
    v_mfma_f32_16x16x32_bf16 v[72:75], v[136:139], v[116:119], v[72:75]
    ds_read_b128 v[168:171], v7 offset:54272
    v_mfma_f32_16x16x32_bf16 v[76:79], v[140:143], v[116:119], v[76:79]
    ds_read_b128 v[172:175], v7 offset:56320
    v_mfma_f32_16x16x32_bf16 v[80:83], v[128:131], v[120:123], v[80:83]
    v_mfma_f32_16x16x32_bf16 v[84:87], v[132:135], v[120:123], v[84:87]
    v_mfma_f32_16x16x32_bf16 v[88:91], v[136:139], v[120:123], v[88:91]
    v_mfma_f32_16x16x32_bf16 v[92:95], v[140:143], v[120:123], v[92:95]
    v_mfma_f32_16x16x32_bf16 v[96:99], v[128:131], v[124:127], v[96:99]
    v_mfma_f32_16x16x32_bf16 v[100:103], v[132:135], v[124:127], v[100:103]
    v_mfma_f32_16x16x32_bf16 v[104:107], v[136:139], v[124:127], v[104:107]
    v_mfma_f32_16x16x32_bf16 v[108:111], v[140:143], v[124:127], v[108:111]
    s_waitcnt lgkmcnt(0)
    v_mfma_f32_16x16x32_bf16 v[48:51], v[160:163], v[144:147], v[48:51]
    v_mfma_f32_16x16x32_bf16 v[52:55], v[164:167], v[144:147], v[52:55]
    v_mfma_f32_16x16x32_bf16 v[56:59], v[168:171], v[144:147], v[56:59]
    v_mfma_f32_16x16x32_bf16 v[60:63], v[172:175], v[144:147], v[60:63]
    v_mfma_f32_16x16x32_bf16 v[64:67], v[160:163], v[148:151], v[64:67]
    v_mfma_f32_16x16x32_bf16 v[68:71], v[164:167], v[148:151], v[68:71]
    v_mfma_f32_16x16x32_bf16 v[72:75], v[168:171], v[148:151], v[72:75]
    v_mfma_f32_16x16x32_bf16 v[76:79], v[172:175], v[148:151], v[76:79]
    v_mfma_f32_16x16x32_bf16 v[80:83], v[160:163], v[152:155], v[80:83]
    v_mfma_f32_16x16x32_bf16 v[84:87], v[164:167], v[152:155], v[84:87]
    v_mfma_f32_16x16x32_bf16 v[88:91], v[168:171], v[152:155], v[88:91]
    v_mfma_f32_16x16x32_bf16 v[92:95], v[172:175], v[152:155], v[92:95]
    v_mfma_f32_16x16x32_bf16 v[96:99], v[160:163], v[156:159], v[96:99]
    v_mfma_f32_16x16x32_bf16 v[100:103], v[164:167], v[156:159], v[100:103]
    v_mfma_f32_16x16x32_bf16 v[104:107], v[168:171], v[156:159], v[104:107]
    v_mfma_f32_16x16x32_bf16 v[108:111], v[172:175], v[156:159], v[108:111]
    s_waitcnt vmcnt(0)
    v_and_b32 v43, 15, v1
    v_lshlrev_b32 v44, 3, v43
    s_lshl_b32 s17, s15, 9
    s_add_u32 s17, s17, 131072
    v_add_u32 v44, s17, v44
    ds_read_b64 v[10:11], v44 offset:0
    ds_read_b64 v[12:13], v44 offset:128
    ds_read_b64 v[14:15], v44 offset:256
    ds_read_b64 v[16:17], v44 offset:384
    s_waitcnt lgkmcnt(0)
    v_pk_fma_f32 v[48:49], v[10:11], v[26:27], v[48:49] op_sel_hi:[0,1,1] neg_lo:[1,0,0] neg_hi:[1,0,0]
    v_pk_mul_f32 v[48:49], v[10:11], v[48:49] op_sel:[1,0] op_sel_hi:[1,1]
    v_pk_fma_f32 v[50:51], v[10:11], v[28:29], v[50:51] op_sel_hi:[0,1,1] neg_lo:[1,0,0] neg_hi:[1,0,0]
    v_pk_mul_f32 v[50:51], v[10:11], v[50:51] op_sel:[1,0] op_sel_hi:[1,1]
    v_pk_fma_f32 v[52:53], v[10:11], v[30:31], v[52:53] op_sel_hi:[0,1,1] neg_lo:[1,0,0] neg_hi:[1,0,0]
    v_pk_mul_f32 v[52:53], v[10:11], v[52:53] op_sel:[1,0] op_sel_hi:[1,1]
    v_pk_fma_f32 v[54:55], v[10:11], v[32:33], v[54:55] op_sel_hi:[0,1,1] neg_lo:[1,0,0] neg_hi:[1,0,0]
    v_pk_mul_f32 v[54:55], v[10:11], v[54:55] op_sel:[1,0] op_sel_hi:[1,1]
    v_pk_fma_f32 v[56:57], v[10:11], v[34:35], v[56:57] op_sel_hi:[0,1,1] neg_lo:[1,0,0] neg_hi:[1,0,0]
    v_pk_mul_f32 v[56:57], v[10:11], v[56:57] op_sel:[1,0] op_sel_hi:[1,1]
    v_pk_fma_f32 v[58:59], v[10:11], v[36:37], v[58:59] op_sel_hi:[0,1,1] neg_lo:[1,0,0] neg_hi:[1,0,0]
    v_pk_mul_f32 v[58:59], v[10:11], v[58:59] op_sel:[1,0] op_sel_hi:[1,1]
    v_pk_fma_f32 v[60:61], v[10:11], v[38:39], v[60:61] op_sel_hi:[0,1,1] neg_lo:[1,0,0] neg_hi:[1,0,0]
    v_pk_mul_f32 v[60:61], v[10:11], v[60:61] op_sel:[1,0] op_sel_hi:[1,1]
    v_pk_fma_f32 v[62:63], v[10:11], v[40:41], v[62:63] op_sel_hi:[0,1,1] neg_lo:[1,0,0] neg_hi:[1,0,0]
    v_pk_mul_f32 v[62:63], v[10:11], v[62:63] op_sel:[1,0] op_sel_hi:[1,1]
    v_pk_fma_f32 v[64:65], v[12:13], v[26:27], v[64:65] op_sel_hi:[0,1,1] neg_lo:[1,0,0] neg_hi:[1,0,0]
    v_pk_mul_f32 v[64:65], v[12:13], v[64:65] op_sel:[1,0] op_sel_hi:[1,1]
    v_pk_fma_f32 v[66:67], v[12:13], v[28:29], v[66:67] op_sel_hi:[0,1,1] neg_lo:[1,0,0] neg_hi:[1,0,0]
    v_pk_mul_f32 v[66:67], v[12:13], v[66:67] op_sel:[1,0] op_sel_hi:[1,1]
    v_pk_fma_f32 v[68:69], v[12:13], v[30:31], v[68:69] op_sel_hi:[0,1,1] neg_lo:[1,0,0] neg_hi:[1,0,0]
    v_pk_mul_f32 v[68:69], v[12:13], v[68:69] op_sel:[1,0] op_sel_hi:[1,1]
    v_pk_fma_f32 v[70:71], v[12:13], v[32:33], v[70:71] op_sel_hi:[0,1,1] neg_lo:[1,0,0] neg_hi:[1,0,0]
    v_pk_mul_f32 v[70:71], v[12:13], v[70:71] op_sel:[1,0] op_sel_hi:[1,1]
    v_pk_fma_f32 v[72:73], v[12:13], v[34:35], v[72:73] op_sel_hi:[0,1,1] neg_lo:[1,0,0] neg_hi:[1,0,0]
    v_pk_mul_f32 v[72:73], v[12:13], v[72:73] op_sel:[1,0] op_sel_hi:[1,1]
    v_pk_fma_f32 v[74:75], v[12:13], v[36:37], v[74:75] op_sel_hi:[0,1,1] neg_lo:[1,0,0] neg_hi:[1,0,0]
    v_pk_mul_f32 v[74:75], v[12:13], v[74:75] op_sel:[1,0] op_sel_hi:[1,1]
    v_pk_fma_f32 v[76:77], v[12:13], v[38:39], v[76:77] op_sel_hi:[0,1,1] neg_lo:[1,0,0] neg_hi:[1,0,0]
    v_pk_mul_f32 v[76:77], v[12:13], v[76:77] op_sel:[1,0] op_sel_hi:[1,1]
    v_pk_fma_f32 v[78:79], v[12:13], v[40:41], v[78:79] op_sel_hi:[0,1,1] neg_lo:[1,0,0] neg_hi:[1,0,0]
    v_pk_mul_f32 v[78:79], v[12:13], v[78:79] op_sel:[1,0] op_sel_hi:[1,1]
    v_pk_fma_f32 v[80:81], v[14:15], v[26:27], v[80:81] op_sel_hi:[0,1,1] neg_lo:[1,0,0] neg_hi:[1,0,0]
    v_pk_mul_f32 v[80:81], v[14:15], v[80:81] op_sel:[1,0] op_sel_hi:[1,1]
    v_pk_fma_f32 v[82:83], v[14:15], v[28:29], v[82:83] op_sel_hi:[0,1,1] neg_lo:[1,0,0] neg_hi:[1,0,0]
    v_pk_mul_f32 v[82:83], v[14:15], v[82:83] op_sel:[1,0] op_sel_hi:[1,1]
    v_pk_fma_f32 v[84:85], v[14:15], v[30:31], v[84:85] op_sel_hi:[0,1,1] neg_lo:[1,0,0] neg_hi:[1,0,0]
    v_pk_mul_f32 v[84:85], v[14:15], v[84:85] op_sel:[1,0] op_sel_hi:[1,1]
    v_pk_fma_f32 v[86:87], v[14:15], v[32:33], v[86:87] op_sel_hi:[0,1,1] neg_lo:[1,0,0] neg_hi:[1,0,0]
    v_pk_mul_f32 v[86:87], v[14:15], v[86:87] op_sel:[1,0] op_sel_hi:[1,1]
    v_pk_fma_f32 v[88:89], v[14:15], v[34:35], v[88:89] op_sel_hi:[0,1,1] neg_lo:[1,0,0] neg_hi:[1,0,0]
    v_pk_mul_f32 v[88:89], v[14:15], v[88:89] op_sel:[1,0] op_sel_hi:[1,1]
    v_pk_fma_f32 v[90:91], v[14:15], v[36:37], v[90:91] op_sel_hi:[0,1,1] neg_lo:[1,0,0] neg_hi:[1,0,0]
    v_pk_mul_f32 v[90:91], v[14:15], v[90:91] op_sel:[1,0] op_sel_hi:[1,1]
    v_pk_fma_f32 v[92:93], v[14:15], v[38:39], v[92:93] op_sel_hi:[0,1,1] neg_lo:[1,0,0] neg_hi:[1,0,0]
    v_pk_mul_f32 v[92:93], v[14:15], v[92:93] op_sel:[1,0] op_sel_hi:[1,1]
    v_pk_fma_f32 v[94:95], v[14:15], v[40:41], v[94:95] op_sel_hi:[0,1,1] neg_lo:[1,0,0] neg_hi:[1,0,0]
    v_pk_mul_f32 v[94:95], v[14:15], v[94:95] op_sel:[1,0] op_sel_hi:[1,1]
    v_pk_fma_f32 v[96:97], v[16:17], v[26:27], v[96:97] op_sel_hi:[0,1,1] neg_lo:[1,0,0] neg_hi:[1,0,0]
    v_pk_mul_f32 v[96:97], v[16:17], v[96:97] op_sel:[1,0] op_sel_hi:[1,1]
    v_pk_fma_f32 v[98:99], v[16:17], v[28:29], v[98:99] op_sel_hi:[0,1,1] neg_lo:[1,0,0] neg_hi:[1,0,0]
    v_pk_mul_f32 v[98:99], v[16:17], v[98:99] op_sel:[1,0] op_sel_hi:[1,1]
    v_pk_fma_f32 v[100:101], v[16:17], v[30:31], v[100:101] op_sel_hi:[0,1,1] neg_lo:[1,0,0] neg_hi:[1,0,0]
    v_pk_mul_f32 v[100:101], v[16:17], v[100:101] op_sel:[1,0] op_sel_hi:[1,1]
    v_pk_fma_f32 v[102:103], v[16:17], v[32:33], v[102:103] op_sel_hi:[0,1,1] neg_lo:[1,0,0] neg_hi:[1,0,0]
    v_pk_mul_f32 v[102:103], v[16:17], v[102:103] op_sel:[1,0] op_sel_hi:[1,1]
    v_pk_fma_f32 v[104:105], v[16:17], v[34:35], v[104:105] op_sel_hi:[0,1,1] neg_lo:[1,0,0] neg_hi:[1,0,0]
    v_pk_mul_f32 v[104:105], v[16:17], v[104:105] op_sel:[1,0] op_sel_hi:[1,1]
    v_pk_fma_f32 v[106:107], v[16:17], v[36:37], v[106:107] op_sel_hi:[0,1,1] neg_lo:[1,0,0] neg_hi:[1,0,0]
    v_pk_mul_f32 v[106:107], v[16:17], v[106:107] op_sel:[1,0] op_sel_hi:[1,1]
    v_pk_fma_f32 v[108:109], v[16:17], v[38:39], v[108:109] op_sel_hi:[0,1,1] neg_lo:[1,0,0] neg_hi:[1,0,0]
    v_pk_mul_f32 v[108:109], v[16:17], v[108:109] op_sel:[1,0] op_sel_hi:[1,1]
    v_pk_fma_f32 v[110:111], v[16:17], v[40:41], v[110:111] op_sel_hi:[0,1,1] neg_lo:[1,0,0] neg_hi:[1,0,0]
    v_pk_mul_f32 v[110:111], v[16:17], v[110:111] op_sel:[1,0] op_sel_hi:[1,1]
    s_cmp_ge_u32 s14, 5
    s_cselect_b32 s17, 1, 0
    s_mul_i32 s18, s17, 5
    s_sub_u32 s18, s14, s18
    s_lshl_b32 s19, s13, 7
    s_lshl_b32 s20, s15, 6
    s_add_u32 s19, s19, s20
    s_cmp_eq_u32 s18, 4
    s_cbranch_scc1 qkv2_kernel_tail
    v_lshrrev_b32 v44, 1, v2
    v_lshlrev_b32 v44, 16, v44
    v_lshlrev_b32 v45, 5, v43
    v_add_u32 v44, v44, v45
    v_and_b32 v45, 1, v2
    v_lshlrev_b32 v45, 4, v45
    v_add_u32 v44, v44, v45
    s_lshl_b32 s20, s17, 21
    s_add_u32 s20, s20, 23068672
    s_lshl_b32 s21, s18, 19
    s_add_u32 s20, s20, s21
    s_lshl_b32 s21, s16, 18
    s_add_u32 s20, s20, s21
    s_lshl_b32 s21, s19, 5
    s_add_u32 s20, s20, s21
    s_add_u32 s21, s20, 131072
    v_cvt_pk_bf16_f32 v18, v48, v49
    v_cvt_pk_bf16_f32 v19, v50, v51
    v_cvt_pk_bf16_f32 v20, v52, v53
    v_cvt_pk_bf16_f32 v21, v54, v55
    buffer_store_dwordx4 v[18:21], v44, s[4:7], s20 offen offset:0
    v_cvt_pk_bf16_f32 v22, v56, v57
    v_cvt_pk_bf16_f32 v23, v58, v59
    v_cvt_pk_bf16_f32 v24, v60, v61
    v_cvt_pk_bf16_f32 v25, v62, v63
    buffer_store_dwordx4 v[22:25], v44, s[4:7], s21 offen offset:0
    v_cvt_pk_bf16_f32 v18, v64, v65
    v_cvt_pk_bf16_f32 v19, v66, v67
    v_cvt_pk_bf16_f32 v20, v68, v69
    v_cvt_pk_bf16_f32 v21, v70, v71
    buffer_store_dwordx4 v[18:21], v44, s[4:7], s20 offen offset:512
    v_cvt_pk_bf16_f32 v22, v72, v73
    v_cvt_pk_bf16_f32 v23, v74, v75
    v_cvt_pk_bf16_f32 v24, v76, v77
    v_cvt_pk_bf16_f32 v25, v78, v79
    buffer_store_dwordx4 v[22:25], v44, s[4:7], s21 offen offset:512
    v_cvt_pk_bf16_f32 v18, v80, v81
    v_cvt_pk_bf16_f32 v19, v82, v83
    v_cvt_pk_bf16_f32 v20, v84, v85
    v_cvt_pk_bf16_f32 v21, v86, v87
    buffer_store_dwordx4 v[18:21], v44, s[4:7], s20 offen offset:1024
    v_cvt_pk_bf16_f32 v22, v88, v89
    v_cvt_pk_bf16_f32 v23, v90, v91
    v_cvt_pk_bf16_f32 v24, v92, v93
    v_cvt_pk_bf16_f32 v25, v94, v95
    buffer_store_dwordx4 v[22:25], v44, s[4:7], s21 offen offset:1024
    v_cvt_pk_bf16_f32 v18, v96, v97
    v_cvt_pk_bf16_f32 v19, v98, v99
    v_cvt_pk_bf16_f32 v20, v100, v101
    v_cvt_pk_bf16_f32 v21, v102, v103
    buffer_store_dwordx4 v[18:21], v44, s[4:7], s20 offen offset:1536
    v_cvt_pk_bf16_f32 v22, v104, v105
    v_cvt_pk_bf16_f32 v23, v106, v107
    v_cvt_pk_bf16_f32 v24, v108, v109
    v_cvt_pk_bf16_f32 v25, v110, v111
    buffer_store_dwordx4 v[22:25], v44, s[4:7], s21 offen offset:1536
    s_endpgm
    s_nop 2
qkv2_kernel_tail:
    v_lshlrev_b32 v44, 15, v2
    v_lshlrev_b32 v45, 3, v43
    v_add_u32 v44, v44, v45
    s_lshl_b32 s20, s17, 19
    s_add_u32 s20, s20, 27262976
    s_lshl_b32 s21, s16, 18
    s_add_u32 s20, s20, s21
    s_lshl_b32 s21, s19, 3
    s_add_u32 s20, s20, s21
    s_add_u32 s40, s20, 0
    s_add_u32 s41, s20, 16384
    s_add_u32 s42, s20, 131072
    s_add_u32 s43, s20, 147456
    v_cvt_pk_bf16_f32 v18, v48, v49
    v_cvt_pk_bf16_f32 v19, v50, v51
    buffer_store_dwordx2 v[18:19], v44, s[4:7], s40 offen offset:0
    v_cvt_pk_bf16_f32 v20, v52, v53
    v_cvt_pk_bf16_f32 v21, v54, v55
    buffer_store_dwordx2 v[20:21], v44, s[4:7], s41 offen offset:0
    v_cvt_pk_bf16_f32 v22, v56, v57
    v_cvt_pk_bf16_f32 v23, v58, v59
    buffer_store_dwordx2 v[22:23], v44, s[4:7], s42 offen offset:0
    v_cvt_pk_bf16_f32 v24, v60, v61
    v_cvt_pk_bf16_f32 v25, v62, v63
    buffer_store_dwordx2 v[24:25], v44, s[4:7], s43 offen offset:0
    v_cvt_pk_bf16_f32 v18, v64, v65
    v_cvt_pk_bf16_f32 v19, v66, v67
    buffer_store_dwordx2 v[18:19], v44, s[4:7], s40 offen offset:128
    v_cvt_pk_bf16_f32 v20, v68, v69
    v_cvt_pk_bf16_f32 v21, v70, v71
    buffer_store_dwordx2 v[20:21], v44, s[4:7], s41 offen offset:128
    v_cvt_pk_bf16_f32 v22, v72, v73
    v_cvt_pk_bf16_f32 v23, v74, v75
    buffer_store_dwordx2 v[22:23], v44, s[4:7], s42 offen offset:128
    v_cvt_pk_bf16_f32 v24, v76, v77
    v_cvt_pk_bf16_f32 v25, v78, v79
    buffer_store_dwordx2 v[24:25], v44, s[4:7], s43 offen offset:128
    v_cvt_pk_bf16_f32 v18, v80, v81
    v_cvt_pk_bf16_f32 v19, v82, v83
    buffer_store_dwordx2 v[18:19], v44, s[4:7], s40 offen offset:256
    v_cvt_pk_bf16_f32 v20, v84, v85
    v_cvt_pk_bf16_f32 v21, v86, v87
    buffer_store_dwordx2 v[20:21], v44, s[4:7], s41 offen offset:256
    v_cvt_pk_bf16_f32 v22, v88, v89
    v_cvt_pk_bf16_f32 v23, v90, v91
    buffer_store_dwordx2 v[22:23], v44, s[4:7], s42 offen offset:256
    v_cvt_pk_bf16_f32 v24, v92, v93
    v_cvt_pk_bf16_f32 v25, v94, v95
    buffer_store_dwordx2 v[24:25], v44, s[4:7], s43 offen offset:256
    v_cvt_pk_bf16_f32 v18, v96, v97
    v_cvt_pk_bf16_f32 v19, v98, v99
    buffer_store_dwordx2 v[18:19], v44, s[4:7], s40 offen offset:384
    v_cvt_pk_bf16_f32 v20, v100, v101
    v_cvt_pk_bf16_f32 v21, v102, v103
    buffer_store_dwordx2 v[20:21], v44, s[4:7], s41 offen offset:384
    v_cvt_pk_bf16_f32 v22, v104, v105
    v_cvt_pk_bf16_f32 v23, v106, v107
    buffer_store_dwordx2 v[22:23], v44, s[4:7], s42 offen offset:384
    v_cvt_pk_bf16_f32 v24, v108, v109
    v_cvt_pk_bf16_f32 v25, v110, v111
    buffer_store_dwordx2 v[24:25], v44, s[4:7], s43 offen offset:384
    s_endpgm
    s_nop 2
qkv2_kernel_v:
    v_and_b32 v43, 15, v1
    v_lshlrev_b32 v42, 2, v43
    s_lshl_b32 s17, s14, 9
    s_lshl_b32 s18, s16, 8
    s_add_u32 s17, s17, s18
    s_add_u32 s17, s17, 9240576
    buffer_load_dword v26, v42, s[4:7], s17 offen offset:0
    buffer_load_dword v27, v42, s[4:7], s17 offen offset:64
    buffer_load_dword v28, v42, s[4:7], s17 offen offset:128
    buffer_load_dword v29, v42, s[4:7], s17 offen offset:192
    s_waitcnt vmcnt(4)
    v_add_f32 v10, v10, v12
    v_add_f32 v11, v11, v13
    v_add_f32 v10, v10, v14
    v_add_f32 v11, v11, v15
    v_add_f32 v10, v10, v16
    v_add_f32 v11, v11, v17
    v_add_f32 v10, v10, v18
    v_add_f32 v11, v11, v19
    v_add_f32 v10, v10, v20
    v_add_f32 v11, v11, v21
    v_add_f32 v10, v10, v22
    v_add_f32 v11, v11, v23
    v_add_f32 v10, v10, v24
    v_add_f32 v11, v11, v25
    v_mul_f32 v10, 0x3acccccd, v10
    v_mul_f32 v11, 0x3acccccd, v11
    v_fma_f32 v11, -v10, v10, v11
    v_max_f32 v11, 0, v11
    v_cvt_pk_bf16_f32 v10, v10, v10
    v_lshlrev_b32 v10, 16, v10
    v_cvt_pk_bf16_f32 v11, v11, v11
    v_lshlrev_b32 v11, 16, v11
    v_add_f32 v11, 0x3727c5ac, v11
    v_cvt_pk_bf16_f32 v11, v11, v11
    v_lshlrev_b32 v11, 16, v11
    v_sqrt_f32 v11, v11
    s_nop 0
    v_cvt_pk_bf16_f32 v11, v11, v11
    v_lshlrev_b32 v11, 16, v11
    v_rcp_f32 v11, v11
    v_and_b32 v12, 127, v0
    v_lshlrev_b32 v12, 3, v12
    v_add_u32 v12, 131072, v12
    ds_write_b64 v12, v[10:11]
    s_waitcnt lgkmcnt(0)
    s_barrier
    ds_read_b128 v[112:115], v4 offset:0
    ds_read_b128 v[116:119], v4 offset:2048
    ds_read_b128 v[120:123], v4 offset:4096
    ds_read_b128 v[124:127], v4 offset:6144
    ds_read_b128 v[128:131], v7 offset:16384
    ds_read_b128 v[132:135], v7 offset:18432
    ds_read_b128 v[136:139], v7 offset:20480
    ds_read_b128 v[140:143], v7 offset:22528
    s_waitcnt lgkmcnt(0)
    v_mfma_f32_16x16x32_bf16 v[48:51], v[112:115], v[128:131], 0
    ds_read_b128 v[144:147], v4 offset:1024
    v_mfma_f32_16x16x32_bf16 v[52:55], v[112:115], v[132:135], 0
    ds_read_b128 v[148:151], v4 offset:3072
    v_mfma_f32_16x16x32_bf16 v[56:59], v[112:115], v[136:139], 0
    ds_read_b128 v[152:155], v4 offset:5120
    v_mfma_f32_16x16x32_bf16 v[60:63], v[112:115], v[140:143], 0
    ds_read_b128 v[156:159], v4 offset:7168
    v_mfma_f32_16x16x32_bf16 v[64:67], v[116:119], v[128:131], 0
    ds_read_b128 v[160:163], v7 offset:17408
    v_mfma_f32_16x16x32_bf16 v[68:71], v[116:119], v[132:135], 0
    ds_read_b128 v[164:167], v7 offset:19456
    v_mfma_f32_16x16x32_bf16 v[72:75], v[116:119], v[136:139], 0
    ds_read_b128 v[168:171], v7 offset:21504
    v_mfma_f32_16x16x32_bf16 v[76:79], v[116:119], v[140:143], 0
    ds_read_b128 v[172:175], v7 offset:23552
    v_mfma_f32_16x16x32_bf16 v[80:83], v[120:123], v[128:131], 0
    v_mfma_f32_16x16x32_bf16 v[84:87], v[120:123], v[132:135], 0
    v_mfma_f32_16x16x32_bf16 v[88:91], v[120:123], v[136:139], 0
    v_mfma_f32_16x16x32_bf16 v[92:95], v[120:123], v[140:143], 0
    v_mfma_f32_16x16x32_bf16 v[96:99], v[124:127], v[128:131], 0
    v_mfma_f32_16x16x32_bf16 v[100:103], v[124:127], v[132:135], 0
    v_mfma_f32_16x16x32_bf16 v[104:107], v[124:127], v[136:139], 0
    v_mfma_f32_16x16x32_bf16 v[108:111], v[124:127], v[140:143], 0
    s_waitcnt lgkmcnt(0)
    s_barrier
    v_mfma_f32_16x16x32_bf16 v[48:51], v[144:147], v[160:163], v[48:51]
    ds_read_b128 v[112:115], v4 offset:32768
    v_mfma_f32_16x16x32_bf16 v[52:55], v[144:147], v[164:167], v[52:55]
    ds_read_b128 v[116:119], v4 offset:34816
    v_mfma_f32_16x16x32_bf16 v[56:59], v[144:147], v[168:171], v[56:59]
    ds_read_b128 v[120:123], v4 offset:36864
    v_mfma_f32_16x16x32_bf16 v[60:63], v[144:147], v[172:175], v[60:63]
    ds_read_b128 v[124:127], v4 offset:38912
    v_mfma_f32_16x16x32_bf16 v[64:67], v[148:151], v[160:163], v[64:67]
    ds_read_b128 v[128:131], v7 offset:49152
    v_mfma_f32_16x16x32_bf16 v[68:71], v[148:151], v[164:167], v[68:71]
    ds_read_b128 v[132:135], v7 offset:51200
    v_mfma_f32_16x16x32_bf16 v[72:75], v[148:151], v[168:171], v[72:75]
    ds_read_b128 v[136:139], v7 offset:53248
    v_mfma_f32_16x16x32_bf16 v[76:79], v[148:151], v[172:175], v[76:79]
    ds_read_b128 v[140:143], v7 offset:55296
    v_mfma_f32_16x16x32_bf16 v[80:83], v[152:155], v[160:163], v[80:83]
    v_mfma_f32_16x16x32_bf16 v[84:87], v[152:155], v[164:167], v[84:87]
    v_mfma_f32_16x16x32_bf16 v[88:91], v[152:155], v[168:171], v[88:91]
    v_mfma_f32_16x16x32_bf16 v[92:95], v[152:155], v[172:175], v[92:95]
    v_mfma_f32_16x16x32_bf16 v[96:99], v[156:159], v[160:163], v[96:99]
    v_mfma_f32_16x16x32_bf16 v[100:103], v[156:159], v[164:167], v[100:103]
    v_mfma_f32_16x16x32_bf16 v[104:107], v[156:159], v[168:171], v[104:107]
    v_mfma_f32_16x16x32_bf16 v[108:111], v[156:159], v[172:175], v[108:111]
    s_waitcnt lgkmcnt(0)
    v_mfma_f32_16x16x32_bf16 v[48:51], v[112:115], v[128:131], v[48:51]
    ds_read_b128 v[144:147], v4 offset:33792
    v_mfma_f32_16x16x32_bf16 v[52:55], v[112:115], v[132:135], v[52:55]
    ds_read_b128 v[148:151], v4 offset:35840
    v_mfma_f32_16x16x32_bf16 v[56:59], v[112:115], v[136:139], v[56:59]
    ds_read_b128 v[152:155], v4 offset:37888
    v_mfma_f32_16x16x32_bf16 v[60:63], v[112:115], v[140:143], v[60:63]
    ds_read_b128 v[156:159], v4 offset:39936
    v_mfma_f32_16x16x32_bf16 v[64:67], v[116:119], v[128:131], v[64:67]
    ds_read_b128 v[160:163], v7 offset:50176
    v_mfma_f32_16x16x32_bf16 v[68:71], v[116:119], v[132:135], v[68:71]
    ds_read_b128 v[164:167], v7 offset:52224
    v_mfma_f32_16x16x32_bf16 v[72:75], v[116:119], v[136:139], v[72:75]
    ds_read_b128 v[168:171], v7 offset:54272
    v_mfma_f32_16x16x32_bf16 v[76:79], v[116:119], v[140:143], v[76:79]
    ds_read_b128 v[172:175], v7 offset:56320
    v_mfma_f32_16x16x32_bf16 v[80:83], v[120:123], v[128:131], v[80:83]
    v_mfma_f32_16x16x32_bf16 v[84:87], v[120:123], v[132:135], v[84:87]
    v_mfma_f32_16x16x32_bf16 v[88:91], v[120:123], v[136:139], v[88:91]
    v_mfma_f32_16x16x32_bf16 v[92:95], v[120:123], v[140:143], v[92:95]
    v_mfma_f32_16x16x32_bf16 v[96:99], v[124:127], v[128:131], v[96:99]
    v_mfma_f32_16x16x32_bf16 v[100:103], v[124:127], v[132:135], v[100:103]
    v_mfma_f32_16x16x32_bf16 v[104:107], v[124:127], v[136:139], v[104:107]
    v_mfma_f32_16x16x32_bf16 v[108:111], v[124:127], v[140:143], v[108:111]
    s_waitcnt lgkmcnt(0)
    s_barrier
    v_mfma_f32_16x16x32_bf16 v[48:51], v[144:147], v[160:163], v[48:51]
    ds_read_b128 v[112:115], v5 offset:0
    v_mfma_f32_16x16x32_bf16 v[52:55], v[144:147], v[164:167], v[52:55]
    ds_read_b128 v[116:119], v5 offset:2048
    v_mfma_f32_16x16x32_bf16 v[56:59], v[144:147], v[168:171], v[56:59]
    ds_read_b128 v[120:123], v5 offset:4096
    v_mfma_f32_16x16x32_bf16 v[60:63], v[144:147], v[172:175], v[60:63]
    ds_read_b128 v[124:127], v5 offset:6144
    v_mfma_f32_16x16x32_bf16 v[64:67], v[148:151], v[160:163], v[64:67]
    ds_read_b128 v[128:131], v8 offset:16384
    v_mfma_f32_16x16x32_bf16 v[68:71], v[148:151], v[164:167], v[68:71]
    ds_read_b128 v[132:135], v8 offset:18432
    v_mfma_f32_16x16x32_bf16 v[72:75], v[148:151], v[168:171], v[72:75]
    ds_read_b128 v[136:139], v8 offset:20480
    v_mfma_f32_16x16x32_bf16 v[76:79], v[148:151], v[172:175], v[76:79]
    ds_read_b128 v[140:143], v8 offset:22528
    v_mfma_f32_16x16x32_bf16 v[80:83], v[152:155], v[160:163], v[80:83]
    v_mfma_f32_16x16x32_bf16 v[84:87], v[152:155], v[164:167], v[84:87]
    v_mfma_f32_16x16x32_bf16 v[88:91], v[152:155], v[168:171], v[88:91]
    v_mfma_f32_16x16x32_bf16 v[92:95], v[152:155], v[172:175], v[92:95]
    v_mfma_f32_16x16x32_bf16 v[96:99], v[156:159], v[160:163], v[96:99]
    v_mfma_f32_16x16x32_bf16 v[100:103], v[156:159], v[164:167], v[100:103]
    v_mfma_f32_16x16x32_bf16 v[104:107], v[156:159], v[168:171], v[104:107]
    v_mfma_f32_16x16x32_bf16 v[108:111], v[156:159], v[172:175], v[108:111]
    s_waitcnt lgkmcnt(0)
    v_mfma_f32_16x16x32_bf16 v[48:51], v[112:115], v[128:131], v[48:51]
    ds_read_b128 v[144:147], v5 offset:1024
    v_mfma_f32_16x16x32_bf16 v[52:55], v[112:115], v[132:135], v[52:55]
    ds_read_b128 v[148:151], v5 offset:3072
    v_mfma_f32_16x16x32_bf16 v[56:59], v[112:115], v[136:139], v[56:59]
    ds_read_b128 v[152:155], v5 offset:5120
    v_mfma_f32_16x16x32_bf16 v[60:63], v[112:115], v[140:143], v[60:63]
    ds_read_b128 v[156:159], v5 offset:7168
    v_mfma_f32_16x16x32_bf16 v[64:67], v[116:119], v[128:131], v[64:67]
    ds_read_b128 v[160:163], v8 offset:17408
    v_mfma_f32_16x16x32_bf16 v[68:71], v[116:119], v[132:135], v[68:71]
    ds_read_b128 v[164:167], v8 offset:19456
    v_mfma_f32_16x16x32_bf16 v[72:75], v[116:119], v[136:139], v[72:75]
    ds_read_b128 v[168:171], v8 offset:21504
    v_mfma_f32_16x16x32_bf16 v[76:79], v[116:119], v[140:143], v[76:79]
    ds_read_b128 v[172:175], v8 offset:23552
    v_mfma_f32_16x16x32_bf16 v[80:83], v[120:123], v[128:131], v[80:83]
    v_mfma_f32_16x16x32_bf16 v[84:87], v[120:123], v[132:135], v[84:87]
    v_mfma_f32_16x16x32_bf16 v[88:91], v[120:123], v[136:139], v[88:91]
    v_mfma_f32_16x16x32_bf16 v[92:95], v[120:123], v[140:143], v[92:95]
    v_mfma_f32_16x16x32_bf16 v[96:99], v[124:127], v[128:131], v[96:99]
    v_mfma_f32_16x16x32_bf16 v[100:103], v[124:127], v[132:135], v[100:103]
    v_mfma_f32_16x16x32_bf16 v[104:107], v[124:127], v[136:139], v[104:107]
    v_mfma_f32_16x16x32_bf16 v[108:111], v[124:127], v[140:143], v[108:111]
    s_waitcnt lgkmcnt(0)
    s_barrier
    v_mfma_f32_16x16x32_bf16 v[48:51], v[144:147], v[160:163], v[48:51]
    ds_read_b128 v[112:115], v5 offset:32768
    v_mfma_f32_16x16x32_bf16 v[52:55], v[144:147], v[164:167], v[52:55]
    ds_read_b128 v[116:119], v5 offset:34816
    v_mfma_f32_16x16x32_bf16 v[56:59], v[144:147], v[168:171], v[56:59]
    ds_read_b128 v[120:123], v5 offset:36864
    v_mfma_f32_16x16x32_bf16 v[60:63], v[144:147], v[172:175], v[60:63]
    ds_read_b128 v[124:127], v5 offset:38912
    v_mfma_f32_16x16x32_bf16 v[64:67], v[148:151], v[160:163], v[64:67]
    ds_read_b128 v[128:131], v8 offset:49152
    v_mfma_f32_16x16x32_bf16 v[68:71], v[148:151], v[164:167], v[68:71]
    ds_read_b128 v[132:135], v8 offset:51200
    v_mfma_f32_16x16x32_bf16 v[72:75], v[148:151], v[168:171], v[72:75]
    ds_read_b128 v[136:139], v8 offset:53248
    v_mfma_f32_16x16x32_bf16 v[76:79], v[148:151], v[172:175], v[76:79]
    ds_read_b128 v[140:143], v8 offset:55296
    v_mfma_f32_16x16x32_bf16 v[80:83], v[152:155], v[160:163], v[80:83]
    v_mfma_f32_16x16x32_bf16 v[84:87], v[152:155], v[164:167], v[84:87]
    v_mfma_f32_16x16x32_bf16 v[88:91], v[152:155], v[168:171], v[88:91]
    v_mfma_f32_16x16x32_bf16 v[92:95], v[152:155], v[172:175], v[92:95]
    v_mfma_f32_16x16x32_bf16 v[96:99], v[156:159], v[160:163], v[96:99]
    v_mfma_f32_16x16x32_bf16 v[100:103], v[156:159], v[164:167], v[100:103]
    v_mfma_f32_16x16x32_bf16 v[104:107], v[156:159], v[168:171], v[104:107]
    v_mfma_f32_16x16x32_bf16 v[108:111], v[156:159], v[172:175], v[108:111]
    s_waitcnt lgkmcnt(0)
    v_mfma_f32_16x16x32_bf16 v[48:51], v[112:115], v[128:131], v[48:51]
    ds_read_b128 v[144:147], v5 offset:33792
    v_mfma_f32_16x16x32_bf16 v[52:55], v[112:115], v[132:135], v[52:55]
    ds_read_b128 v[148:151], v5 offset:35840
    v_mfma_f32_16x16x32_bf16 v[56:59], v[112:115], v[136:139], v[56:59]
    ds_read_b128 v[152:155], v5 offset:37888
    v_mfma_f32_16x16x32_bf16 v[60:63], v[112:115], v[140:143], v[60:63]
    ds_read_b128 v[156:159], v5 offset:39936
    v_mfma_f32_16x16x32_bf16 v[64:67], v[116:119], v[128:131], v[64:67]
    ds_read_b128 v[160:163], v8 offset:50176
    v_mfma_f32_16x16x32_bf16 v[68:71], v[116:119], v[132:135], v[68:71]
    ds_read_b128 v[164:167], v8 offset:52224
    v_mfma_f32_16x16x32_bf16 v[72:75], v[116:119], v[136:139], v[72:75]
    ds_read_b128 v[168:171], v8 offset:54272
    v_mfma_f32_16x16x32_bf16 v[76:79], v[116:119], v[140:143], v[76:79]
    ds_read_b128 v[172:175], v8 offset:56320
    v_mfma_f32_16x16x32_bf16 v[80:83], v[120:123], v[128:131], v[80:83]
    v_mfma_f32_16x16x32_bf16 v[84:87], v[120:123], v[132:135], v[84:87]
    v_mfma_f32_16x16x32_bf16 v[88:91], v[120:123], v[136:139], v[88:91]
    v_mfma_f32_16x16x32_bf16 v[92:95], v[120:123], v[140:143], v[92:95]
    v_mfma_f32_16x16x32_bf16 v[96:99], v[124:127], v[128:131], v[96:99]
    v_mfma_f32_16x16x32_bf16 v[100:103], v[124:127], v[132:135], v[100:103]
    v_mfma_f32_16x16x32_bf16 v[104:107], v[124:127], v[136:139], v[104:107]
    v_mfma_f32_16x16x32_bf16 v[108:111], v[124:127], v[140:143], v[108:111]
    s_waitcnt lgkmcnt(0)
    s_barrier
    v_mfma_f32_16x16x32_bf16 v[48:51], v[144:147], v[160:163], v[48:51]
    ds_read_b128 v[112:115], v4 offset:0
    v_mfma_f32_16x16x32_bf16 v[52:55], v[144:147], v[164:167], v[52:55]
    ds_read_b128 v[116:119], v4 offset:2048
    v_mfma_f32_16x16x32_bf16 v[56:59], v[144:147], v[168:171], v[56:59]
    ds_read_b128 v[120:123], v4 offset:4096
    v_mfma_f32_16x16x32_bf16 v[60:63], v[144:147], v[172:175], v[60:63]
    ds_read_b128 v[124:127], v4 offset:6144
    v_mfma_f32_16x16x32_bf16 v[64:67], v[148:151], v[160:163], v[64:67]
    ds_read_b128 v[128:131], v7 offset:16384
    v_mfma_f32_16x16x32_bf16 v[68:71], v[148:151], v[164:167], v[68:71]
    ds_read_b128 v[132:135], v7 offset:18432
    v_mfma_f32_16x16x32_bf16 v[72:75], v[148:151], v[168:171], v[72:75]
    ds_read_b128 v[136:139], v7 offset:20480
    v_mfma_f32_16x16x32_bf16 v[76:79], v[148:151], v[172:175], v[76:79]
    ds_read_b128 v[140:143], v7 offset:22528
    v_mfma_f32_16x16x32_bf16 v[80:83], v[152:155], v[160:163], v[80:83]
    v_mfma_f32_16x16x32_bf16 v[84:87], v[152:155], v[164:167], v[84:87]
    v_mfma_f32_16x16x32_bf16 v[88:91], v[152:155], v[168:171], v[88:91]
    v_mfma_f32_16x16x32_bf16 v[92:95], v[152:155], v[172:175], v[92:95]
    v_mfma_f32_16x16x32_bf16 v[96:99], v[156:159], v[160:163], v[96:99]
    v_mfma_f32_16x16x32_bf16 v[100:103], v[156:159], v[164:167], v[100:103]
    v_mfma_f32_16x16x32_bf16 v[104:107], v[156:159], v[168:171], v[104:107]
    v_mfma_f32_16x16x32_bf16 v[108:111], v[156:159], v[172:175], v[108:111]
    s_waitcnt lgkmcnt(0)
    v_mfma_f32_16x16x32_bf16 v[48:51], v[112:115], v[128:131], v[48:51]
    ds_read_b128 v[144:147], v4 offset:1024
    v_mfma_f32_16x16x32_bf16 v[52:55], v[112:115], v[132:135], v[52:55]
    ds_read_b128 v[148:151], v4 offset:3072
    v_mfma_f32_16x16x32_bf16 v[56:59], v[112:115], v[136:139], v[56:59]
    ds_read_b128 v[152:155], v4 offset:5120
    v_mfma_f32_16x16x32_bf16 v[60:63], v[112:115], v[140:143], v[60:63]
    ds_read_b128 v[156:159], v4 offset:7168
    v_mfma_f32_16x16x32_bf16 v[64:67], v[116:119], v[128:131], v[64:67]
    ds_read_b128 v[160:163], v7 offset:17408
    v_mfma_f32_16x16x32_bf16 v[68:71], v[116:119], v[132:135], v[68:71]
    ds_read_b128 v[164:167], v7 offset:19456
    v_mfma_f32_16x16x32_bf16 v[72:75], v[116:119], v[136:139], v[72:75]
    ds_read_b128 v[168:171], v7 offset:21504
    v_mfma_f32_16x16x32_bf16 v[76:79], v[116:119], v[140:143], v[76:79]
    ds_read_b128 v[172:175], v7 offset:23552
    v_mfma_f32_16x16x32_bf16 v[80:83], v[120:123], v[128:131], v[80:83]
    v_mfma_f32_16x16x32_bf16 v[84:87], v[120:123], v[132:135], v[84:87]
    v_mfma_f32_16x16x32_bf16 v[88:91], v[120:123], v[136:139], v[88:91]
    v_mfma_f32_16x16x32_bf16 v[92:95], v[120:123], v[140:143], v[92:95]
    v_mfma_f32_16x16x32_bf16 v[96:99], v[124:127], v[128:131], v[96:99]
    v_mfma_f32_16x16x32_bf16 v[100:103], v[124:127], v[132:135], v[100:103]
    v_mfma_f32_16x16x32_bf16 v[104:107], v[124:127], v[136:139], v[104:107]
    v_mfma_f32_16x16x32_bf16 v[108:111], v[124:127], v[140:143], v[108:111]
    s_waitcnt lgkmcnt(0)
    s_barrier
    v_mfma_f32_16x16x32_bf16 v[48:51], v[144:147], v[160:163], v[48:51]
    ds_read_b128 v[112:115], v4 offset:32768
    v_mfma_f32_16x16x32_bf16 v[52:55], v[144:147], v[164:167], v[52:55]
    ds_read_b128 v[116:119], v4 offset:34816
    v_mfma_f32_16x16x32_bf16 v[56:59], v[144:147], v[168:171], v[56:59]
    ds_read_b128 v[120:123], v4 offset:36864
    v_mfma_f32_16x16x32_bf16 v[60:63], v[144:147], v[172:175], v[60:63]
    ds_read_b128 v[124:127], v4 offset:38912
    v_mfma_f32_16x16x32_bf16 v[64:67], v[148:151], v[160:163], v[64:67]
    ds_read_b128 v[128:131], v7 offset:49152
    v_mfma_f32_16x16x32_bf16 v[68:71], v[148:151], v[164:167], v[68:71]
    ds_read_b128 v[132:135], v7 offset:51200
    v_mfma_f32_16x16x32_bf16 v[72:75], v[148:151], v[168:171], v[72:75]
    ds_read_b128 v[136:139], v7 offset:53248
    v_mfma_f32_16x16x32_bf16 v[76:79], v[148:151], v[172:175], v[76:79]
    ds_read_b128 v[140:143], v7 offset:55296
    v_mfma_f32_16x16x32_bf16 v[80:83], v[152:155], v[160:163], v[80:83]
    v_mfma_f32_16x16x32_bf16 v[84:87], v[152:155], v[164:167], v[84:87]
    v_mfma_f32_16x16x32_bf16 v[88:91], v[152:155], v[168:171], v[88:91]
    v_mfma_f32_16x16x32_bf16 v[92:95], v[152:155], v[172:175], v[92:95]
    v_mfma_f32_16x16x32_bf16 v[96:99], v[156:159], v[160:163], v[96:99]
    v_mfma_f32_16x16x32_bf16 v[100:103], v[156:159], v[164:167], v[100:103]
    v_mfma_f32_16x16x32_bf16 v[104:107], v[156:159], v[168:171], v[104:107]
    v_mfma_f32_16x16x32_bf16 v[108:111], v[156:159], v[172:175], v[108:111]
    s_waitcnt lgkmcnt(0)
    v_mfma_f32_16x16x32_bf16 v[48:51], v[112:115], v[128:131], v[48:51]
    ds_read_b128 v[144:147], v4 offset:33792
    v_mfma_f32_16x16x32_bf16 v[52:55], v[112:115], v[132:135], v[52:55]
    ds_read_b128 v[148:151], v4 offset:35840
    v_mfma_f32_16x16x32_bf16 v[56:59], v[112:115], v[136:139], v[56:59]
    ds_read_b128 v[152:155], v4 offset:37888
    v_mfma_f32_16x16x32_bf16 v[60:63], v[112:115], v[140:143], v[60:63]
    ds_read_b128 v[156:159], v4 offset:39936
    v_mfma_f32_16x16x32_bf16 v[64:67], v[116:119], v[128:131], v[64:67]
    ds_read_b128 v[160:163], v7 offset:50176
    v_mfma_f32_16x16x32_bf16 v[68:71], v[116:119], v[132:135], v[68:71]
    ds_read_b128 v[164:167], v7 offset:52224
    v_mfma_f32_16x16x32_bf16 v[72:75], v[116:119], v[136:139], v[72:75]
    ds_read_b128 v[168:171], v7 offset:54272
    v_mfma_f32_16x16x32_bf16 v[76:79], v[116:119], v[140:143], v[76:79]
    ds_read_b128 v[172:175], v7 offset:56320
    v_mfma_f32_16x16x32_bf16 v[80:83], v[120:123], v[128:131], v[80:83]
    v_mfma_f32_16x16x32_bf16 v[84:87], v[120:123], v[132:135], v[84:87]
    v_mfma_f32_16x16x32_bf16 v[88:91], v[120:123], v[136:139], v[88:91]
    v_mfma_f32_16x16x32_bf16 v[92:95], v[120:123], v[140:143], v[92:95]
    v_mfma_f32_16x16x32_bf16 v[96:99], v[124:127], v[128:131], v[96:99]
    v_mfma_f32_16x16x32_bf16 v[100:103], v[124:127], v[132:135], v[100:103]
    v_mfma_f32_16x16x32_bf16 v[104:107], v[124:127], v[136:139], v[104:107]
    v_mfma_f32_16x16x32_bf16 v[108:111], v[124:127], v[140:143], v[108:111]
    s_waitcnt lgkmcnt(0)
    s_barrier
    v_mfma_f32_16x16x32_bf16 v[48:51], v[144:147], v[160:163], v[48:51]
    ds_read_b128 v[112:115], v5 offset:0
    v_mfma_f32_16x16x32_bf16 v[52:55], v[144:147], v[164:167], v[52:55]
    ds_read_b128 v[116:119], v5 offset:2048
    v_mfma_f32_16x16x32_bf16 v[56:59], v[144:147], v[168:171], v[56:59]
    ds_read_b128 v[120:123], v5 offset:4096
    v_mfma_f32_16x16x32_bf16 v[60:63], v[144:147], v[172:175], v[60:63]
    ds_read_b128 v[124:127], v5 offset:6144
    v_mfma_f32_16x16x32_bf16 v[64:67], v[148:151], v[160:163], v[64:67]
    ds_read_b128 v[128:131], v8 offset:16384
    v_mfma_f32_16x16x32_bf16 v[68:71], v[148:151], v[164:167], v[68:71]
    ds_read_b128 v[132:135], v8 offset:18432
    v_mfma_f32_16x16x32_bf16 v[72:75], v[148:151], v[168:171], v[72:75]
    ds_read_b128 v[136:139], v8 offset:20480
    v_mfma_f32_16x16x32_bf16 v[76:79], v[148:151], v[172:175], v[76:79]
    ds_read_b128 v[140:143], v8 offset:22528
    v_mfma_f32_16x16x32_bf16 v[80:83], v[152:155], v[160:163], v[80:83]
    v_mfma_f32_16x16x32_bf16 v[84:87], v[152:155], v[164:167], v[84:87]
    v_mfma_f32_16x16x32_bf16 v[88:91], v[152:155], v[168:171], v[88:91]
    v_mfma_f32_16x16x32_bf16 v[92:95], v[152:155], v[172:175], v[92:95]
    v_mfma_f32_16x16x32_bf16 v[96:99], v[156:159], v[160:163], v[96:99]
    v_mfma_f32_16x16x32_bf16 v[100:103], v[156:159], v[164:167], v[100:103]
    v_mfma_f32_16x16x32_bf16 v[104:107], v[156:159], v[168:171], v[104:107]
    v_mfma_f32_16x16x32_bf16 v[108:111], v[156:159], v[172:175], v[108:111]
    s_waitcnt lgkmcnt(0)
    v_mfma_f32_16x16x32_bf16 v[48:51], v[112:115], v[128:131], v[48:51]
    ds_read_b128 v[144:147], v5 offset:1024
    v_mfma_f32_16x16x32_bf16 v[52:55], v[112:115], v[132:135], v[52:55]
    ds_read_b128 v[148:151], v5 offset:3072
    v_mfma_f32_16x16x32_bf16 v[56:59], v[112:115], v[136:139], v[56:59]
    ds_read_b128 v[152:155], v5 offset:5120
    v_mfma_f32_16x16x32_bf16 v[60:63], v[112:115], v[140:143], v[60:63]
    ds_read_b128 v[156:159], v5 offset:7168
    v_mfma_f32_16x16x32_bf16 v[64:67], v[116:119], v[128:131], v[64:67]
    ds_read_b128 v[160:163], v8 offset:17408
    v_mfma_f32_16x16x32_bf16 v[68:71], v[116:119], v[132:135], v[68:71]
    ds_read_b128 v[164:167], v8 offset:19456
    v_mfma_f32_16x16x32_bf16 v[72:75], v[116:119], v[136:139], v[72:75]
    ds_read_b128 v[168:171], v8 offset:21504
    v_mfma_f32_16x16x32_bf16 v[76:79], v[116:119], v[140:143], v[76:79]
    ds_read_b128 v[172:175], v8 offset:23552
    v_mfma_f32_16x16x32_bf16 v[80:83], v[120:123], v[128:131], v[80:83]
    v_mfma_f32_16x16x32_bf16 v[84:87], v[120:123], v[132:135], v[84:87]
    v_mfma_f32_16x16x32_bf16 v[88:91], v[120:123], v[136:139], v[88:91]
    v_mfma_f32_16x16x32_bf16 v[92:95], v[120:123], v[140:143], v[92:95]
    v_mfma_f32_16x16x32_bf16 v[96:99], v[124:127], v[128:131], v[96:99]
    v_mfma_f32_16x16x32_bf16 v[100:103], v[124:127], v[132:135], v[100:103]
    v_mfma_f32_16x16x32_bf16 v[104:107], v[124:127], v[136:139], v[104:107]
    v_mfma_f32_16x16x32_bf16 v[108:111], v[124:127], v[140:143], v[108:111]
    s_waitcnt lgkmcnt(0)
    s_barrier
    v_mfma_f32_16x16x32_bf16 v[48:51], v[144:147], v[160:163], v[48:51]
    ds_read_b128 v[112:115], v5 offset:32768
    v_mfma_f32_16x16x32_bf16 v[52:55], v[144:147], v[164:167], v[52:55]
    ds_read_b128 v[116:119], v5 offset:34816
    v_mfma_f32_16x16x32_bf16 v[56:59], v[144:147], v[168:171], v[56:59]
    ds_read_b128 v[120:123], v5 offset:36864
    v_mfma_f32_16x16x32_bf16 v[60:63], v[144:147], v[172:175], v[60:63]
    ds_read_b128 v[124:127], v5 offset:38912
    v_mfma_f32_16x16x32_bf16 v[64:67], v[148:151], v[160:163], v[64:67]
    ds_read_b128 v[128:131], v8 offset:49152
    v_mfma_f32_16x16x32_bf16 v[68:71], v[148:151], v[164:167], v[68:71]
    ds_read_b128 v[132:135], v8 offset:51200
    v_mfma_f32_16x16x32_bf16 v[72:75], v[148:151], v[168:171], v[72:75]
    ds_read_b128 v[136:139], v8 offset:53248
    v_mfma_f32_16x16x32_bf16 v[76:79], v[148:151], v[172:175], v[76:79]
    ds_read_b128 v[140:143], v8 offset:55296
    v_mfma_f32_16x16x32_bf16 v[80:83], v[152:155], v[160:163], v[80:83]
    v_mfma_f32_16x16x32_bf16 v[84:87], v[152:155], v[164:167], v[84:87]
    v_mfma_f32_16x16x32_bf16 v[88:91], v[152:155], v[168:171], v[88:91]
    v_mfma_f32_16x16x32_bf16 v[92:95], v[152:155], v[172:175], v[92:95]
    v_mfma_f32_16x16x32_bf16 v[96:99], v[156:159], v[160:163], v[96:99]
    v_mfma_f32_16x16x32_bf16 v[100:103], v[156:159], v[164:167], v[100:103]
    v_mfma_f32_16x16x32_bf16 v[104:107], v[156:159], v[168:171], v[104:107]
    v_mfma_f32_16x16x32_bf16 v[108:111], v[156:159], v[172:175], v[108:111]
    s_waitcnt lgkmcnt(0)
    v_mfma_f32_16x16x32_bf16 v[48:51], v[112:115], v[128:131], v[48:51]
    ds_read_b128 v[144:147], v5 offset:33792
    v_mfma_f32_16x16x32_bf16 v[52:55], v[112:115], v[132:135], v[52:55]
    ds_read_b128 v[148:151], v5 offset:35840
    v_mfma_f32_16x16x32_bf16 v[56:59], v[112:115], v[136:139], v[56:59]
    ds_read_b128 v[152:155], v5 offset:37888
    v_mfma_f32_16x16x32_bf16 v[60:63], v[112:115], v[140:143], v[60:63]
    ds_read_b128 v[156:159], v5 offset:39936
    v_mfma_f32_16x16x32_bf16 v[64:67], v[116:119], v[128:131], v[64:67]
    ds_read_b128 v[160:163], v8 offset:50176
    v_mfma_f32_16x16x32_bf16 v[68:71], v[116:119], v[132:135], v[68:71]
    ds_read_b128 v[164:167], v8 offset:52224
    v_mfma_f32_16x16x32_bf16 v[72:75], v[116:119], v[136:139], v[72:75]
    ds_read_b128 v[168:171], v8 offset:54272
    v_mfma_f32_16x16x32_bf16 v[76:79], v[116:119], v[140:143], v[76:79]
    ds_read_b128 v[172:175], v8 offset:56320
    v_mfma_f32_16x16x32_bf16 v[80:83], v[120:123], v[128:131], v[80:83]
    v_mfma_f32_16x16x32_bf16 v[84:87], v[120:123], v[132:135], v[84:87]
    v_mfma_f32_16x16x32_bf16 v[88:91], v[120:123], v[136:139], v[88:91]
    v_mfma_f32_16x16x32_bf16 v[92:95], v[120:123], v[140:143], v[92:95]
    v_mfma_f32_16x16x32_bf16 v[96:99], v[124:127], v[128:131], v[96:99]
    v_mfma_f32_16x16x32_bf16 v[100:103], v[124:127], v[132:135], v[100:103]
    v_mfma_f32_16x16x32_bf16 v[104:107], v[124:127], v[136:139], v[104:107]
    v_mfma_f32_16x16x32_bf16 v[108:111], v[124:127], v[140:143], v[108:111]
    s_waitcnt lgkmcnt(0)
    s_barrier
    v_mfma_f32_16x16x32_bf16 v[48:51], v[144:147], v[160:163], v[48:51]
    ds_read_b128 v[112:115], v4 offset:0
    v_mfma_f32_16x16x32_bf16 v[52:55], v[144:147], v[164:167], v[52:55]
    ds_read_b128 v[116:119], v4 offset:2048
    v_mfma_f32_16x16x32_bf16 v[56:59], v[144:147], v[168:171], v[56:59]
    ds_read_b128 v[120:123], v4 offset:4096
    v_mfma_f32_16x16x32_bf16 v[60:63], v[144:147], v[172:175], v[60:63]
    ds_read_b128 v[124:127], v4 offset:6144
    v_mfma_f32_16x16x32_bf16 v[64:67], v[148:151], v[160:163], v[64:67]
    ds_read_b128 v[128:131], v7 offset:16384
    v_mfma_f32_16x16x32_bf16 v[68:71], v[148:151], v[164:167], v[68:71]
    ds_read_b128 v[132:135], v7 offset:18432
    v_mfma_f32_16x16x32_bf16 v[72:75], v[148:151], v[168:171], v[72:75]
    ds_read_b128 v[136:139], v7 offset:20480
    v_mfma_f32_16x16x32_bf16 v[76:79], v[148:151], v[172:175], v[76:79]
    ds_read_b128 v[140:143], v7 offset:22528
    v_mfma_f32_16x16x32_bf16 v[80:83], v[152:155], v[160:163], v[80:83]
    v_mfma_f32_16x16x32_bf16 v[84:87], v[152:155], v[164:167], v[84:87]
    v_mfma_f32_16x16x32_bf16 v[88:91], v[152:155], v[168:171], v[88:91]
    v_mfma_f32_16x16x32_bf16 v[92:95], v[152:155], v[172:175], v[92:95]
    v_mfma_f32_16x16x32_bf16 v[96:99], v[156:159], v[160:163], v[96:99]
    v_mfma_f32_16x16x32_bf16 v[100:103], v[156:159], v[164:167], v[100:103]
    v_mfma_f32_16x16x32_bf16 v[104:107], v[156:159], v[168:171], v[104:107]
    v_mfma_f32_16x16x32_bf16 v[108:111], v[156:159], v[172:175], v[108:111]
    s_waitcnt lgkmcnt(0)
    v_mfma_f32_16x16x32_bf16 v[48:51], v[112:115], v[128:131], v[48:51]
    ds_read_b128 v[144:147], v4 offset:1024
    v_mfma_f32_16x16x32_bf16 v[52:55], v[112:115], v[132:135], v[52:55]
    ds_read_b128 v[148:151], v4 offset:3072
    v_mfma_f32_16x16x32_bf16 v[56:59], v[112:115], v[136:139], v[56:59]
    ds_read_b128 v[152:155], v4 offset:5120
    v_mfma_f32_16x16x32_bf16 v[60:63], v[112:115], v[140:143], v[60:63]
    ds_read_b128 v[156:159], v4 offset:7168
    v_mfma_f32_16x16x32_bf16 v[64:67], v[116:119], v[128:131], v[64:67]
    ds_read_b128 v[160:163], v7 offset:17408
    v_mfma_f32_16x16x32_bf16 v[68:71], v[116:119], v[132:135], v[68:71]
    ds_read_b128 v[164:167], v7 offset:19456
    v_mfma_f32_16x16x32_bf16 v[72:75], v[116:119], v[136:139], v[72:75]
    ds_read_b128 v[168:171], v7 offset:21504
    v_mfma_f32_16x16x32_bf16 v[76:79], v[116:119], v[140:143], v[76:79]
    ds_read_b128 v[172:175], v7 offset:23552
    v_mfma_f32_16x16x32_bf16 v[80:83], v[120:123], v[128:131], v[80:83]
    v_mfma_f32_16x16x32_bf16 v[84:87], v[120:123], v[132:135], v[84:87]
    v_mfma_f32_16x16x32_bf16 v[88:91], v[120:123], v[136:139], v[88:91]
    v_mfma_f32_16x16x32_bf16 v[92:95], v[120:123], v[140:143], v[92:95]
    v_mfma_f32_16x16x32_bf16 v[96:99], v[124:127], v[128:131], v[96:99]
    v_mfma_f32_16x16x32_bf16 v[100:103], v[124:127], v[132:135], v[100:103]
    v_mfma_f32_16x16x32_bf16 v[104:107], v[124:127], v[136:139], v[104:107]
    v_mfma_f32_16x16x32_bf16 v[108:111], v[124:127], v[140:143], v[108:111]
    s_waitcnt lgkmcnt(0)
    s_barrier
    v_mfma_f32_16x16x32_bf16 v[48:51], v[144:147], v[160:163], v[48:51]
    ds_read_b128 v[112:115], v4 offset:32768
    v_mfma_f32_16x16x32_bf16 v[52:55], v[144:147], v[164:167], v[52:55]
    ds_read_b128 v[116:119], v4 offset:34816
    v_mfma_f32_16x16x32_bf16 v[56:59], v[144:147], v[168:171], v[56:59]
    ds_read_b128 v[120:123], v4 offset:36864
    v_mfma_f32_16x16x32_bf16 v[60:63], v[144:147], v[172:175], v[60:63]
    ds_read_b128 v[124:127], v4 offset:38912
    v_mfma_f32_16x16x32_bf16 v[64:67], v[148:151], v[160:163], v[64:67]
    ds_read_b128 v[128:131], v7 offset:49152
    v_mfma_f32_16x16x32_bf16 v[68:71], v[148:151], v[164:167], v[68:71]
    ds_read_b128 v[132:135], v7 offset:51200
    v_mfma_f32_16x16x32_bf16 v[72:75], v[148:151], v[168:171], v[72:75]
    ds_read_b128 v[136:139], v7 offset:53248
    v_mfma_f32_16x16x32_bf16 v[76:79], v[148:151], v[172:175], v[76:79]
    ds_read_b128 v[140:143], v7 offset:55296
    v_mfma_f32_16x16x32_bf16 v[80:83], v[152:155], v[160:163], v[80:83]
    v_mfma_f32_16x16x32_bf16 v[84:87], v[152:155], v[164:167], v[84:87]
    v_mfma_f32_16x16x32_bf16 v[88:91], v[152:155], v[168:171], v[88:91]
    v_mfma_f32_16x16x32_bf16 v[92:95], v[152:155], v[172:175], v[92:95]
    v_mfma_f32_16x16x32_bf16 v[96:99], v[156:159], v[160:163], v[96:99]
    v_mfma_f32_16x16x32_bf16 v[100:103], v[156:159], v[164:167], v[100:103]
    v_mfma_f32_16x16x32_bf16 v[104:107], v[156:159], v[168:171], v[104:107]
    v_mfma_f32_16x16x32_bf16 v[108:111], v[156:159], v[172:175], v[108:111]
    s_waitcnt lgkmcnt(0)
    v_mfma_f32_16x16x32_bf16 v[48:51], v[112:115], v[128:131], v[48:51]
    ds_read_b128 v[144:147], v4 offset:33792
    v_mfma_f32_16x16x32_bf16 v[52:55], v[112:115], v[132:135], v[52:55]
    ds_read_b128 v[148:151], v4 offset:35840
    v_mfma_f32_16x16x32_bf16 v[56:59], v[112:115], v[136:139], v[56:59]
    ds_read_b128 v[152:155], v4 offset:37888
    v_mfma_f32_16x16x32_bf16 v[60:63], v[112:115], v[140:143], v[60:63]
    ds_read_b128 v[156:159], v4 offset:39936
    v_mfma_f32_16x16x32_bf16 v[64:67], v[116:119], v[128:131], v[64:67]
    ds_read_b128 v[160:163], v7 offset:50176
    v_mfma_f32_16x16x32_bf16 v[68:71], v[116:119], v[132:135], v[68:71]
    ds_read_b128 v[164:167], v7 offset:52224
    v_mfma_f32_16x16x32_bf16 v[72:75], v[116:119], v[136:139], v[72:75]
    ds_read_b128 v[168:171], v7 offset:54272
    v_mfma_f32_16x16x32_bf16 v[76:79], v[116:119], v[140:143], v[76:79]
    ds_read_b128 v[172:175], v7 offset:56320
    v_mfma_f32_16x16x32_bf16 v[80:83], v[120:123], v[128:131], v[80:83]
    v_mfma_f32_16x16x32_bf16 v[84:87], v[120:123], v[132:135], v[84:87]
    v_mfma_f32_16x16x32_bf16 v[88:91], v[120:123], v[136:139], v[88:91]
    v_mfma_f32_16x16x32_bf16 v[92:95], v[120:123], v[140:143], v[92:95]
    v_mfma_f32_16x16x32_bf16 v[96:99], v[124:127], v[128:131], v[96:99]
    v_mfma_f32_16x16x32_bf16 v[100:103], v[124:127], v[132:135], v[100:103]
    v_mfma_f32_16x16x32_bf16 v[104:107], v[124:127], v[136:139], v[104:107]
    v_mfma_f32_16x16x32_bf16 v[108:111], v[124:127], v[140:143], v[108:111]
    s_waitcnt lgkmcnt(0)
    v_mfma_f32_16x16x32_bf16 v[48:51], v[144:147], v[160:163], v[48:51]
    v_mfma_f32_16x16x32_bf16 v[52:55], v[144:147], v[164:167], v[52:55]
    v_mfma_f32_16x16x32_bf16 v[56:59], v[144:147], v[168:171], v[56:59]
    v_mfma_f32_16x16x32_bf16 v[60:63], v[144:147], v[172:175], v[60:63]
    v_mfma_f32_16x16x32_bf16 v[64:67], v[148:151], v[160:163], v[64:67]
    v_mfma_f32_16x16x32_bf16 v[68:71], v[148:151], v[164:167], v[68:71]
    v_mfma_f32_16x16x32_bf16 v[72:75], v[148:151], v[168:171], v[72:75]
    v_mfma_f32_16x16x32_bf16 v[76:79], v[148:151], v[172:175], v[76:79]
    v_mfma_f32_16x16x32_bf16 v[80:83], v[152:155], v[160:163], v[80:83]
    v_mfma_f32_16x16x32_bf16 v[84:87], v[152:155], v[164:167], v[84:87]
    v_mfma_f32_16x16x32_bf16 v[88:91], v[152:155], v[168:171], v[88:91]
    v_mfma_f32_16x16x32_bf16 v[92:95], v[152:155], v[172:175], v[92:95]
    v_mfma_f32_16x16x32_bf16 v[96:99], v[156:159], v[160:163], v[96:99]
    v_mfma_f32_16x16x32_bf16 v[100:103], v[156:159], v[164:167], v[100:103]
    v_mfma_f32_16x16x32_bf16 v[104:107], v[156:159], v[168:171], v[104:107]
    v_mfma_f32_16x16x32_bf16 v[108:111], v[156:159], v[172:175], v[108:111]
    s_waitcnt vmcnt(0)
    s_sub_u32 s17, s14, 10
    s_lshl_b32 s17, s17, 7
    s_lshl_b32 s18, s16, 6
    s_add_u32 s17, s17, s18
    v_add_u32 v44, s17, v43
    v_and_b32 v45, 1, v2
    v_lshlrev_b32 v45, 4, v45
    v_lshrrev_b32 v46, 1, v2
    v_lshlrev_b32 v46, 3, v46
    v_add_u32 v45, v45, v46
    s_mov_b32 s18, 3277
    v_add_u32 v46, 0, v44
    v_mul_lo_u32 v47, v46, s18
    v_lshrrev_b32 v47, 16, v47
    v_mul_u32_u24 v30, 20, v47
    v_sub_u32 v30, v46, v30
    v_lshlrev_b32 v30, 5, v30
    v_lshlrev_b32 v47, 17, v47
    v_add_u32 v30, v30, v47
    v_add_u32 v30, v30, v45
    v_add_u32 v46, 16, v44
    v_mul_lo_u32 v47, v46, s18
    v_lshrrev_b32 v47, 16, v47
    v_mul_u32_u24 v31, 20, v47
    v_sub_u32 v31, v46, v31
    v_lshlrev_b32 v31, 5, v31
    v_lshlrev_b32 v47, 17, v47
    v_add_u32 v31, v31, v47
    v_add_u32 v31, v31, v45
    v_add_u32 v46, 32, v44
    v_mul_lo_u32 v47, v46, s18
    v_lshrrev_b32 v47, 16, v47
    v_mul_u32_u24 v32, 20, v47
    v_sub_u32 v32, v46, v32
    v_lshlrev_b32 v32, 5, v32
    v_lshlrev_b32 v47, 17, v47
    v_add_u32 v32, v32, v47
    v_add_u32 v32, v32, v45
    v_add_u32 v46, 48, v44
    v_mul_lo_u32 v47, v46, s18
    v_lshrrev_b32 v47, 16, v47
    v_mul_u32_u24 v33, 20, v47
    v_sub_u32 v33, v46, v33
    v_lshlrev_b32 v33, 5, v33
    v_lshlrev_b32 v47, 17, v47
    v_add_u32 v33, v33, v47
    v_add_u32 v33, v33, v45
    s_lshl_b32 s20, s13, 13
    s_lshl_b32 s21, s15, 12
    s_add_u32 s20, s20, s21
    s_add_u32 s20, s20, 28311552
    v_lshlrev_b32 v44, 5, v2
    s_lshl_b32 s17, s15, 9
    s_add_u32 s17, s17, 131072
    v_add_u32 v44, s17, v44
    ds_read_b128 v[10:13], v44 offset:0
    ds_read_b128 v[14:17], v44 offset:16
    s_waitcnt lgkmcnt(0)
    v_fma_f32 v48, -v10, v26, v48
    v_mul_f32 v48, v11, v48
    v_fma_f32 v49, -v12, v26, v49
    v_mul_f32 v49, v13, v49
    v_fma_f32 v50, -v14, v26, v50
    v_mul_f32 v50, v15, v50
    v_fma_f32 v51, -v16, v26, v51
    v_mul_f32 v51, v17, v51
    v_cvt_pk_bf16_f32 v18, v48, v49
    v_cvt_pk_bf16_f32 v19, v50, v51
    buffer_store_dwordx2 v[18:19], v30, s[4:7], s20 offen offset:0
    v_fma_f32 v52, -v10, v27, v52
    v_mul_f32 v52, v11, v52
    v_fma_f32 v53, -v12, v27, v53
    v_mul_f32 v53, v13, v53
    v_fma_f32 v54, -v14, v27, v54
    v_mul_f32 v54, v15, v54
    v_fma_f32 v55, -v16, v27, v55
    v_mul_f32 v55, v17, v55
    v_cvt_pk_bf16_f32 v20, v52, v53
    v_cvt_pk_bf16_f32 v21, v54, v55
    buffer_store_dwordx2 v[20:21], v31, s[4:7], s20 offen offset:0
    v_fma_f32 v56, -v10, v28, v56
    v_mul_f32 v56, v11, v56
    v_fma_f32 v57, -v12, v28, v57
    v_mul_f32 v57, v13, v57
    v_fma_f32 v58, -v14, v28, v58
    v_mul_f32 v58, v15, v58
    v_fma_f32 v59, -v16, v28, v59
    v_mul_f32 v59, v17, v59
    v_cvt_pk_bf16_f32 v22, v56, v57
    v_cvt_pk_bf16_f32 v23, v58, v59
    buffer_store_dwordx2 v[22:23], v32, s[4:7], s20 offen offset:0
    v_fma_f32 v60, -v10, v29, v60
    v_mul_f32 v60, v11, v60
    v_fma_f32 v61, -v12, v29, v61
    v_mul_f32 v61, v13, v61
    v_fma_f32 v62, -v14, v29, v62
    v_mul_f32 v62, v15, v62
    v_fma_f32 v63, -v16, v29, v63
    v_mul_f32 v63, v17, v63
    v_cvt_pk_bf16_f32 v24, v60, v61
    v_cvt_pk_bf16_f32 v25, v62, v63
    buffer_store_dwordx2 v[24:25], v33, s[4:7], s20 offen offset:0
    ds_read_b128 v[10:13], v44 offset:128
    ds_read_b128 v[14:17], v44 offset:144
    s_waitcnt lgkmcnt(0)
    v_fma_f32 v64, -v10, v26, v64
    v_mul_f32 v64, v11, v64
    v_fma_f32 v65, -v12, v26, v65
    v_mul_f32 v65, v13, v65
    v_fma_f32 v66, -v14, v26, v66
    v_mul_f32 v66, v15, v66
    v_fma_f32 v67, -v16, v26, v67
    v_mul_f32 v67, v17, v67
    v_cvt_pk_bf16_f32 v18, v64, v65
    v_cvt_pk_bf16_f32 v19, v66, v67
    buffer_store_dwordx2 v[18:19], v30, s[4:7], s20 offen offset:1024
    v_fma_f32 v68, -v10, v27, v68
    v_mul_f32 v68, v11, v68
    v_fma_f32 v69, -v12, v27, v69
    v_mul_f32 v69, v13, v69
    v_fma_f32 v70, -v14, v27, v70
    v_mul_f32 v70, v15, v70
    v_fma_f32 v71, -v16, v27, v71
    v_mul_f32 v71, v17, v71
    v_cvt_pk_bf16_f32 v20, v68, v69
    v_cvt_pk_bf16_f32 v21, v70, v71
    buffer_store_dwordx2 v[20:21], v31, s[4:7], s20 offen offset:1024
    v_fma_f32 v72, -v10, v28, v72
    v_mul_f32 v72, v11, v72
    v_fma_f32 v73, -v12, v28, v73
    v_mul_f32 v73, v13, v73
    v_fma_f32 v74, -v14, v28, v74
    v_mul_f32 v74, v15, v74
    v_fma_f32 v75, -v16, v28, v75
    v_mul_f32 v75, v17, v75
    v_cvt_pk_bf16_f32 v22, v72, v73
    v_cvt_pk_bf16_f32 v23, v74, v75
    buffer_store_dwordx2 v[22:23], v32, s[4:7], s20 offen offset:1024
    v_fma_f32 v76, -v10, v29, v76
    v_mul_f32 v76, v11, v76
    v_fma_f32 v77, -v12, v29, v77
    v_mul_f32 v77, v13, v77
    v_fma_f32 v78, -v14, v29, v78
    v_mul_f32 v78, v15, v78
    v_fma_f32 v79, -v16, v29, v79
    v_mul_f32 v79, v17, v79
    v_cvt_pk_bf16_f32 v24, v76, v77
    v_cvt_pk_bf16_f32 v25, v78, v79
    buffer_store_dwordx2 v[24:25], v33, s[4:7], s20 offen offset:1024
    ds_read_b128 v[10:13], v44 offset:256
    ds_read_b128 v[14:17], v44 offset:272
    s_waitcnt lgkmcnt(0)
    v_fma_f32 v80, -v10, v26, v80
    v_mul_f32 v80, v11, v80
    v_fma_f32 v81, -v12, v26, v81
    v_mul_f32 v81, v13, v81
    v_fma_f32 v82, -v14, v26, v82
    v_mul_f32 v82, v15, v82
    v_fma_f32 v83, -v16, v26, v83
    v_mul_f32 v83, v17, v83
    v_cvt_pk_bf16_f32 v18, v80, v81
    v_cvt_pk_bf16_f32 v19, v82, v83
    buffer_store_dwordx2 v[18:19], v30, s[4:7], s20 offen offset:2048
    v_fma_f32 v84, -v10, v27, v84
    v_mul_f32 v84, v11, v84
    v_fma_f32 v85, -v12, v27, v85
    v_mul_f32 v85, v13, v85
    v_fma_f32 v86, -v14, v27, v86
    v_mul_f32 v86, v15, v86
    v_fma_f32 v87, -v16, v27, v87
    v_mul_f32 v87, v17, v87
    v_cvt_pk_bf16_f32 v20, v84, v85
    v_cvt_pk_bf16_f32 v21, v86, v87
    buffer_store_dwordx2 v[20:21], v31, s[4:7], s20 offen offset:2048
    v_fma_f32 v88, -v10, v28, v88
    v_mul_f32 v88, v11, v88
    v_fma_f32 v89, -v12, v28, v89
    v_mul_f32 v89, v13, v89
    v_fma_f32 v90, -v14, v28, v90
    v_mul_f32 v90, v15, v90
    v_fma_f32 v91, -v16, v28, v91
    v_mul_f32 v91, v17, v91
    v_cvt_pk_bf16_f32 v22, v88, v89
    v_cvt_pk_bf16_f32 v23, v90, v91
    buffer_store_dwordx2 v[22:23], v32, s[4:7], s20 offen offset:2048
    v_fma_f32 v92, -v10, v29, v92
    v_mul_f32 v92, v11, v92
    v_fma_f32 v93, -v12, v29, v93
    v_mul_f32 v93, v13, v93
    v_fma_f32 v94, -v14, v29, v94
    v_mul_f32 v94, v15, v94
    v_fma_f32 v95, -v16, v29, v95
    v_mul_f32 v95, v17, v95
    v_cvt_pk_bf16_f32 v24, v92, v93
    v_cvt_pk_bf16_f32 v25, v94, v95
    buffer_store_dwordx2 v[24:25], v33, s[4:7], s20 offen offset:2048
    ds_read_b128 v[10:13], v44 offset:384
    ds_read_b128 v[14:17], v44 offset:400
    s_waitcnt lgkmcnt(0)
    v_fma_f32 v96, -v10, v26, v96
    v_mul_f32 v96, v11, v96
    v_fma_f32 v97, -v12, v26, v97
    v_mul_f32 v97, v13, v97
    v_fma_f32 v98, -v14, v26, v98
    v_mul_f32 v98, v15, v98
    v_fma_f32 v99, -v16, v26, v99
    v_mul_f32 v99, v17, v99
    v_cvt_pk_bf16_f32 v18, v96, v97
    v_cvt_pk_bf16_f32 v19, v98, v99
    buffer_store_dwordx2 v[18:19], v30, s[4:7], s20 offen offset:3072
    v_fma_f32 v100, -v10, v27, v100
    v_mul_f32 v100, v11, v100
    v_fma_f32 v101, -v12, v27, v101
    v_mul_f32 v101, v13, v101
    v_fma_f32 v102, -v14, v27, v102
    v_mul_f32 v102, v15, v102
    v_fma_f32 v103, -v16, v27, v103
    v_mul_f32 v103, v17, v103
    v_cvt_pk_bf16_f32 v20, v100, v101
    v_cvt_pk_bf16_f32 v21, v102, v103
    buffer_store_dwordx2 v[20:21], v31, s[4:7], s20 offen offset:3072
    v_fma_f32 v104, -v10, v28, v104
    v_mul_f32 v104, v11, v104
    v_fma_f32 v105, -v12, v28, v105
    v_mul_f32 v105, v13, v105
    v_fma_f32 v106, -v14, v28, v106
    v_mul_f32 v106, v15, v106
    v_fma_f32 v107, -v16, v28, v107
    v_mul_f32 v107, v17, v107
    v_cvt_pk_bf16_f32 v22, v104, v105
    v_cvt_pk_bf16_f32 v23, v106, v107
    buffer_store_dwordx2 v[22:23], v32, s[4:7], s20 offen offset:3072
    v_fma_f32 v108, -v10, v29, v108
    v_mul_f32 v108, v11, v108
    v_fma_f32 v109, -v12, v29, v109
    v_mul_f32 v109, v13, v109
    v_fma_f32 v110, -v14, v29, v110
    v_mul_f32 v110, v15, v110
    v_fma_f32 v111, -v16, v29, v111
    v_mul_f32 v111, v17, v111
    v_cvt_pk_bf16_f32 v24, v108, v109
    v_cvt_pk_bf16_f32 v25, v110, v111
    buffer_store_dwordx2 v[24:25], v33, s[4:7], s20 offen offset:3072
    s_nop 3
qkv2_kernel_end:
    s_endpgm

.text
.globl wo2_kernel
.p2align 8
.type wo2_kernel,@function
wo2_kernel:
    s_cmp_ge_u32 s2, 256
    s_cbranch_scc1 wo2_kernel_end
    s_load_dwordx2 s[4:5], s[0:1], 72
    v_lshrrev_b32 v2, 6, v0
    s_nop 0
    v_readfirstlane_b32 s12, v2
    v_and_b32 v1, 63, v0
    v_lshlrev_b32 v3, 4, v1
    s_and_b32 s17, s2, 7
    s_lshr_b32 s18, s2, 3
    s_and_b32 s19, s17, 1
    s_lshr_b32 s17, s17, 1
    s_mul_i32 s19, s19, 32
    s_add_u32 s18, s18, s19
    s_and_b32 s13, s18, 7
    s_lshl_b32 s17, s17, 3
    s_add_u32 s13, s13, s17
    s_lshr_b32 s14, s18, 3
    s_cmp_lt_u32 s12, 4
    s_cbranch_scc1 wo2_kernel_comp
    s_sub_u32 s12, s12, 4
    s_add_u32 s18, s12, 0
    s_mul_i32 s56, s18, 2048
    s_mul_i32 s20, s13, 4
    s_add_u32 s20, s20, s18
    s_mul_i32 s20, s20, 20480
    s_add_u32 s20, s20, 32505856
    s_mul_i32 s21, s14, 5
    s_add_u32 s21, s21, s18
    s_sub_u32 s21, s21, 4
    s_mul_i32 s21, s21, 20480
    s_add_u32 s21, s21, 2490368
    s_cmp_lt_u32 s18, 4
    s_cselect_b32 s24, s20, s21
    s_add_u32 s18, s12, 2
    s_mul_i32 s57, s18, 2048
    s_mul_i32 s20, s13, 4
    s_add_u32 s20, s20, s18
    s_mul_i32 s20, s20, 20480
    s_add_u32 s20, s20, 32505856
    s_mul_i32 s21, s14, 5
    s_add_u32 s21, s21, s18
    s_sub_u32 s21, s21, 4
    s_mul_i32 s21, s21, 20480
    s_add_u32 s21, s21, 2490368
    s_cmp_lt_u32 s18, 4
    s_cselect_b32 s25, s20, s21
    s_add_u32 s18, s12, 4
    s_mul_i32 s58, s18, 2048
    s_mul_i32 s20, s13, 4
    s_add_u32 s20, s20, s18
    s_mul_i32 s20, s20, 20480
    s_add_u32 s20, s20, 32505856
    s_mul_i32 s21, s14, 5
    s_add_u32 s21, s21, s18
    s_sub_u32 s21, s21, 4
    s_mul_i32 s21, s21, 20480
    s_add_u32 s21, s21, 2490368
    s_cmp_lt_u32 s18, 4
    s_cselect_b32 s26, s20, s21
    s_add_u32 s18, s12, 6
    s_mul_i32 s59, s18, 2048
    s_mul_i32 s20, s13, 4
    s_add_u32 s20, s20, s18
    s_mul_i32 s20, s20, 20480
    s_add_u32 s20, s20, 32505856
    s_mul_i32 s21, s14, 5
    s_add_u32 s21, s21, s18
    s_sub_u32 s21, s21, 4
    s_mul_i32 s21, s21, 20480
    s_add_u32 s21, s21, 2490368
    s_cmp_lt_u32 s18, 4
    s_cselect_b32 s27, s20, s21
    s_mov_b32 s18, 8
    s_mul_i32 s60, s18, 2048
    s_mul_i32 s20, s13, 4
    s_add_u32 s20, s20, s18
    s_mul_i32 s20, s20, 20480
    s_add_u32 s20, s20, 32505856
    s_mul_i32 s21, s14, 5
    s_add_u32 s21, s21, s18
    s_sub_u32 s21, s21, 4
    s_mul_i32 s21, s21, 20480
    s_add_u32 s21, s21, 2490368
    s_cmp_lt_u32 s18, 4
    s_cselect_b32 s28, s20, s21
    s_lshl_b32 s18, s12, 10
    s_add_u32 s28, s28, s18
    s_add_u32 s60, s60, s18
    s_waitcnt lgkmcnt(0)
    s_and_b32 s5, s5, 0xffff
    s_mov_b32 s6, 268435456
    s_mov_b32 s7, 0x00020000
    s_add_u32 m0, s56, 0
    s_add_u32 s22, s24, 0
    buffer_load_dwordx4 v3, s[4:7], s22 offen offset:0 lds
    buffer_load_dwordx4 v3, s[4:7], s22 offen offset:1024 lds
    s_add_u32 m0, s57, 0
    s_add_u32 s23, s25, 0
    buffer_load_dwordx4 v3, s[4:7], s23 offen offset:0 lds
    buffer_load_dwordx4 v3, s[4:7], s23 offen offset:1024 lds
    s_add_u32 m0, s58, 0
    s_add_u32 s22, s26, 0
    buffer_load_dwordx4 v3, s[4:7], s22 offen offset:0 lds
    buffer_load_dwordx4 v3, s[4:7], s22 offen offset:1024 lds
    s_add_u32 m0, s59, 0
    s_add_u32 s23, s27, 0
    buffer_load_dwordx4 v3, s[4:7], s23 offen offset:0 lds
    buffer_load_dwordx4 v3, s[4:7], s23 offen offset:1024 lds
    s_add_u32 m0, s60, 0
    s_add_u32 s22, s28, 0
    buffer_load_dwordx4 v3, s[4:7], s22 offen offset:0 lds
    s_add_u32 m0, s56, 18432
    s_add_u32 s22, s24, 2048
    buffer_load_dwordx4 v3, s[4:7], s22 offen offset:0 lds
    buffer_load_dwordx4 v3, s[4:7], s22 offen offset:1024 lds
    s_add_u32 m0, s57, 18432
    s_add_u32 s23, s25, 2048
    buffer_load_dwordx4 v3, s[4:7], s23 offen offset:0 lds
    buffer_load_dwordx4 v3, s[4:7], s23 offen offset:1024 lds
    s_add_u32 m0, s58, 18432
    s_add_u32 s22, s26, 2048
    buffer_load_dwordx4 v3, s[4:7], s22 offen offset:0 lds
    buffer_load_dwordx4 v3, s[4:7], s22 offen offset:1024 lds
    s_add_u32 m0, s59, 18432
    s_add_u32 s23, s27, 2048
    buffer_load_dwordx4 v3, s[4:7], s23 offen offset:0 lds
    buffer_load_dwordx4 v3, s[4:7], s23 offen offset:1024 lds
    s_add_u32 m0, s60, 18432
    s_add_u32 s22, s28, 2048
    buffer_load_dwordx4 v3, s[4:7], s22 offen offset:0 lds
    s_waitcnt vmcnt(9)
    s_barrier
    s_add_u32 m0, s56, 36864
    s_add_u32 s22, s24, 4096
    buffer_load_dwordx4 v3, s[4:7], s22 offen offset:0 lds
    buffer_load_dwordx4 v3, s[4:7], s22 offen offset:1024 lds
    s_add_u32 m0, s57, 36864
    s_add_u32 s23, s25, 4096
    buffer_load_dwordx4 v3, s[4:7], s23 offen offset:0 lds
    buffer_load_dwordx4 v3, s[4:7], s23 offen offset:1024 lds
    s_add_u32 m0, s58, 36864
    s_add_u32 s22, s26, 4096
    buffer_load_dwordx4 v3, s[4:7], s22 offen offset:0 lds
    buffer_load_dwordx4 v3, s[4:7], s22 offen offset:1024 lds
    s_add_u32 m0, s59, 36864
    s_add_u32 s23, s27, 4096
    buffer_load_dwordx4 v3, s[4:7], s23 offen offset:0 lds
    buffer_load_dwordx4 v3, s[4:7], s23 offen offset:1024 lds
    s_add_u32 m0, s60, 36864
    s_add_u32 s22, s28, 4096
    buffer_load_dwordx4 v3, s[4:7], s22 offen offset:0 lds
    s_add_u32 m0, s56, 55296
    s_add_u32 s22, s24, 6144
    buffer_load_dwordx4 v3, s[4:7], s22 offen offset:0 lds
    buffer_load_dwordx4 v3, s[4:7], s22 offen offset:1024 lds
    s_add_u32 m0, s57, 55296
    s_add_u32 s23, s25, 6144
    buffer_load_dwordx4 v3, s[4:7], s23 offen offset:0 lds
    buffer_load_dwordx4 v3, s[4:7], s23 offen offset:1024 lds
    s_add_u32 m0, s58, 55296
    s_add_u32 s22, s26, 6144
    buffer_load_dwordx4 v3, s[4:7], s22 offen offset:0 lds
    buffer_load_dwordx4 v3, s[4:7], s22 offen offset:1024 lds
    s_add_u32 m0, s59, 55296
    s_add_u32 s23, s27, 6144
    buffer_load_dwordx4 v3, s[4:7], s23 offen offset:0 lds
    buffer_load_dwordx4 v3, s[4:7], s23 offen offset:1024 lds
    s_add_u32 m0, s60, 55296
    s_add_u32 s22, s28, 6144
    buffer_load_dwordx4 v3, s[4:7], s22 offen offset:0 lds
    s_waitcnt vmcnt(18)
    s_barrier
    s_add_u32 m0, s56, 73728
    s_add_u32 s22, s24, 8192
    buffer_load_dwordx4 v3, s[4:7], s22 offen offset:0 lds
    buffer_load_dwordx4 v3, s[4:7], s22 offen offset:1024 lds
    s_add_u32 m0, s57, 73728
    s_add_u32 s23, s25, 8192
    buffer_load_dwordx4 v3, s[4:7], s23 offen offset:0 lds
    buffer_load_dwordx4 v3, s[4:7], s23 offen offset:1024 lds
    s_add_u32 m0, s58, 73728
    s_add_u32 s22, s26, 8192
    buffer_load_dwordx4 v3, s[4:7], s22 offen offset:0 lds
    buffer_load_dwordx4 v3, s[4:7], s22 offen offset:1024 lds
    s_add_u32 m0, s59, 73728
    s_add_u32 s23, s27, 8192
    buffer_load_dwordx4 v3, s[4:7], s23 offen offset:0 lds
    buffer_load_dwordx4 v3, s[4:7], s23 offen offset:1024 lds
    s_add_u32 m0, s60, 73728
    s_add_u32 s22, s28, 8192
    buffer_load_dwordx4 v3, s[4:7], s22 offen offset:0 lds
    s_add_u32 m0, s56, 92160
    s_add_u32 s22, s24, 10240
    buffer_load_dwordx4 v3, s[4:7], s22 offen offset:0 lds
    buffer_load_dwordx4 v3, s[4:7], s22 offen offset:1024 lds
    s_add_u32 m0, s57, 92160
    s_add_u32 s23, s25, 10240
    buffer_load_dwordx4 v3, s[4:7], s23 offen offset:0 lds
    buffer_load_dwordx4 v3, s[4:7], s23 offen offset:1024 lds
    s_add_u32 m0, s58, 92160
    s_add_u32 s22, s26, 10240
    buffer_load_dwordx4 v3, s[4:7], s22 offen offset:0 lds
    buffer_load_dwordx4 v3, s[4:7], s22 offen offset:1024 lds
    s_add_u32 m0, s59, 92160
    s_add_u32 s23, s27, 10240
    buffer_load_dwordx4 v3, s[4:7], s23 offen offset:0 lds
    buffer_load_dwordx4 v3, s[4:7], s23 offen offset:1024 lds
    s_add_u32 m0, s60, 92160
    s_add_u32 s22, s28, 10240
    buffer_load_dwordx4 v3, s[4:7], s22 offen offset:0 lds
    s_waitcnt vmcnt(27)
    s_barrier
    s_add_u32 m0, s56, 110592
    s_add_u32 s22, s24, 12288
    buffer_load_dwordx4 v3, s[4:7], s22 offen offset:0 lds
    buffer_load_dwordx4 v3, s[4:7], s22 offen offset:1024 lds
    s_add_u32 m0, s57, 110592
    s_add_u32 s23, s25, 12288
    buffer_load_dwordx4 v3, s[4:7], s23 offen offset:0 lds
    buffer_load_dwordx4 v3, s[4:7], s23 offen offset:1024 lds
    s_add_u32 m0, s58, 110592
    s_add_u32 s22, s26, 12288
    buffer_load_dwordx4 v3, s[4:7], s22 offen offset:0 lds
    buffer_load_dwordx4 v3, s[4:7], s22 offen offset:1024 lds
    s_add_u32 m0, s59, 110592
    s_add_u32 s23, s27, 12288
    buffer_load_dwordx4 v3, s[4:7], s23 offen offset:0 lds
    buffer_load_dwordx4 v3, s[4:7], s23 offen offset:1024 lds
    s_add_u32 m0, s60, 110592
    s_add_u32 s22, s28, 12288
    buffer_load_dwordx4 v3, s[4:7], s22 offen offset:0 lds
    s_add_u32 m0, s56, 129024
    s_add_u32 s22, s24, 14336
    buffer_load_dwordx4 v3, s[4:7], s22 offen offset:0 lds
    buffer_load_dwordx4 v3, s[4:7], s22 offen offset:1024 lds
    s_add_u32 m0, s57, 129024
    s_add_u32 s23, s25, 14336
    buffer_load_dwordx4 v3, s[4:7], s23 offen offset:0 lds
    buffer_load_dwordx4 v3, s[4:7], s23 offen offset:1024 lds
    s_add_u32 m0, s58, 129024
    s_add_u32 s22, s26, 14336
    buffer_load_dwordx4 v3, s[4:7], s22 offen offset:0 lds
    buffer_load_dwordx4 v3, s[4:7], s22 offen offset:1024 lds
    s_add_u32 m0, s59, 129024
    s_add_u32 s23, s27, 14336
    buffer_load_dwordx4 v3, s[4:7], s23 offen offset:0 lds
    buffer_load_dwordx4 v3, s[4:7], s23 offen offset:1024 lds
    s_add_u32 m0, s60, 129024
    s_add_u32 s22, s28, 14336
    buffer_load_dwordx4 v3, s[4:7], s22 offen offset:0 lds
    s_waitcnt vmcnt(36)
    s_barrier
    s_add_u32 m0, s56, 0
    s_add_u32 s22, s24, 16384
    buffer_load_dwordx4 v3, s[4:7], s22 offen offset:0 lds
    buffer_load_dwordx4 v3, s[4:7], s22 offen offset:1024 lds
    s_add_u32 m0, s57, 0
    s_add_u32 s23, s25, 16384
    buffer_load_dwordx4 v3, s[4:7], s23 offen offset:0 lds
    buffer_load_dwordx4 v3, s[4:7], s23 offen offset:1024 lds
    s_add_u32 m0, s58, 0
    s_add_u32 s22, s26, 16384
    buffer_load_dwordx4 v3, s[4:7], s22 offen offset:0 lds
    buffer_load_dwordx4 v3, s[4:7], s22 offen offset:1024 lds
    s_add_u32 m0, s59, 0
    s_add_u32 s23, s27, 16384
    buffer_load_dwordx4 v3, s[4:7], s23 offen offset:0 lds
    buffer_load_dwordx4 v3, s[4:7], s23 offen offset:1024 lds
    s_add_u32 m0, s60, 0
    s_add_u32 s22, s28, 16384
    buffer_load_dwordx4 v3, s[4:7], s22 offen offset:0 lds
    s_add_u32 m0, s56, 18432
    s_add_u32 s22, s24, 18432
    buffer_load_dwordx4 v3, s[4:7], s22 offen offset:0 lds
    buffer_load_dwordx4 v3, s[4:7], s22 offen offset:1024 lds
    s_add_u32 m0, s57, 18432
    s_add_u32 s23, s25, 18432
    buffer_load_dwordx4 v3, s[4:7], s23 offen offset:0 lds
    buffer_load_dwordx4 v3, s[4:7], s23 offen offset:1024 lds
    s_add_u32 m0, s58, 18432
    s_add_u32 s22, s26, 18432
    buffer_load_dwordx4 v3, s[4:7], s22 offen offset:0 lds
    buffer_load_dwordx4 v3, s[4:7], s22 offen offset:1024 lds
    s_add_u32 m0, s59, 18432
    s_add_u32 s23, s27, 18432
    buffer_load_dwordx4 v3, s[4:7], s23 offen offset:0 lds
    buffer_load_dwordx4 v3, s[4:7], s23 offen offset:1024 lds
    s_add_u32 m0, s60, 18432
    s_add_u32 s22, s28, 18432
    buffer_load_dwordx4 v3, s[4:7], s22 offen offset:0 lds
    s_waitcnt vmcnt(45)
    s_barrier
    s_waitcnt vmcnt(36)
    s_barrier
    s_waitcnt vmcnt(27)
    s_barrier
    s_waitcnt vmcnt(18)
    s_barrier
    s_waitcnt vmcnt(9)
    s_barrier
    s_waitcnt vmcnt(0)
    s_barrier
    s_endpgm
wo2_kernel_comp:
    s_mov_b32 s15, s12
    s_mov_b32 s16, 0
    s_mul_i32 s17, s15, 2048
    s_mul_i32 s18, s16, 10240
    v_add_u32 v4, s17, v3
    v_add_u32 v7, s18, v3
    v_add_u32 v5, s17, v3
    v_add_u32 v8, s18, v3
    v_add_u32 v5, 65536, v5
    v_add_u32 v8, 65536, v8
    v_add_u32 v6, s17, v3
    v_add_u32 v9, s18, v3
    v_add_u32 v6, 131072, v6
    v_add_u32 v9, 131072, v9
    s_waitcnt lgkmcnt(0)
    s_and_b32 s5, s5, 0xffff
    s_mov_b32 s6, 268435456
    s_mov_b32 s7, 0x00020000
    s_lshl_b32 s17, s13, 2
    s_add_u32 s17, s17, s15
    s_mul_i32 s18, s14, 5
    s_add_u32 s19, s18, 0
    s_lshr_b32 s20, s19, 1
    s_and_b32 s21, s19, 1
    s_lshl_b32 s21, s21, 3
    s_mul_i32 s22, s17, 20
    s_add_u32 s22, s22, s20
    s_lshl_b32 s22, s22, 10
    s_add_u32 s40, s22, s21
    s_add_u32 s22, s40, 15728640
    buffer_load_dwordx2 v[10:11], v3, s[4:7], s22 offen
    s_add_u32 s19, s18, 1
    s_lshr_b32 s20, s19, 1
    s_and_b32 s21, s19, 1
    s_lshl_b32 s21, s21, 3
    s_mul_i32 s22, s17, 20
    s_add_u32 s22, s22, s20
    s_lshl_b32 s22, s22, 10
    s_add_u32 s41, s22, s21
    s_add_u32 s22, s41, 15728640
    buffer_load_dwordx2 v[12:13], v3, s[4:7], s22 offen
    s_add_u32 s19, s18, 2
    s_lshr_b32 s20, s19, 1
    s_and_b32 s21, s19, 1
    s_lshl_b32 s21, s21, 3
    s_mul_i32 s22, s17, 20
    s_add_u32 s22, s22, s20
    s_lshl_b32 s22, s22, 10
    s_add_u32 s42, s22, s21
    s_add_u32 s22, s42, 15728640
    buffer_load_dwordx2 v[14:15], v3, s[4:7], s22 offen
    s_add_u32 s19, s18, 3
    s_lshr_b32 s20, s19, 1
    s_and_b32 s21, s19, 1
    s_lshl_b32 s21, s21, 3
    s_mul_i32 s22, s17, 20
    s_add_u32 s22, s22, s20
    s_lshl_b32 s22, s22, 10
    s_add_u32 s43, s22, s21
    s_add_u32 s22, s43, 15728640
    buffer_load_dwordx2 v[16:17], v3, s[4:7], s22 offen
    s_add_u32 s19, s18, 4
    s_lshr_b32 s20, s19, 1
    s_and_b32 s21, s19, 1
    s_lshl_b32 s21, s21, 3
    s_mul_i32 s22, s17, 20
    s_add_u32 s22, s22, s20
    s_lshl_b32 s22, s22, 10
    s_add_u32 s44, s22, s21
    s_add_u32 s22, s44, 15728640
    buffer_load_dwordx2 v[18:19], v3, s[4:7], s22 offen
    s_waitcnt lgkmcnt(0)
    s_barrier
    ds_read_b128 v[52:55], v4 offset:0
    ds_read_b128 v[56:59], v7 offset:8192
    ds_read_b128 v[60:63], v7 offset:10240
    ds_read_b128 v[64:67], v7 offset:12288
    ds_read_b128 v[68:71], v7 offset:14336
    ds_read_b128 v[72:75], v7 offset:16384
    s_waitcnt lgkmcnt(0)
    v_mfma_f32_16x16x32_bf16 v[32:35], v[56:59], v[52:55], 0
    ds_read_b128 v[76:79], v4 offset:1024
    ds_read_b128 v[80:83], v7 offset:9216
    v_mfma_f32_16x16x32_bf16 v[36:39], v[60:63], v[52:55], 0
    ds_read_b128 v[84:87], v7 offset:11264
    ds_read_b128 v[88:91], v7 offset:13312
    v_mfma_f32_16x16x32_bf16 v[40:43], v[64:67], v[52:55], 0
    ds_read_b128 v[92:95], v7 offset:15360
    ds_read_b128 v[96:99], v7 offset:17408
    v_mfma_f32_16x16x32_bf16 v[44:47], v[68:71], v[52:55], 0
    v_mfma_f32_16x16x32_bf16 v[48:51], v[72:75], v[52:55], 0
    s_waitcnt lgkmcnt(0)
    s_barrier
    v_mfma_f32_16x16x32_bf16 v[32:35], v[80:83], v[76:79], v[32:35]
    ds_read_b128 v[52:55], v4 offset:18432
    ds_read_b128 v[56:59], v7 offset:26624
    v_mfma_f32_16x16x32_bf16 v[36:39], v[84:87], v[76:79], v[36:39]
    ds_read_b128 v[60:63], v7 offset:28672
    ds_read_b128 v[64:67], v7 offset:30720
    v_mfma_f32_16x16x32_bf16 v[40:43], v[88:91], v[76:79], v[40:43]
    ds_read_b128 v[68:71], v7 offset:32768
    ds_read_b128 v[72:75], v7 offset:34816
    v_mfma_f32_16x16x32_bf16 v[44:47], v[92:95], v[76:79], v[44:47]
    v_mfma_f32_16x16x32_bf16 v[48:51], v[96:99], v[76:79], v[48:51]
    s_waitcnt lgkmcnt(0)
    v_mfma_f32_16x16x32_bf16 v[32:35], v[56:59], v[52:55], v[32:35]
    ds_read_b128 v[76:79], v4 offset:19456
    ds_read_b128 v[80:83], v7 offset:27648
    v_mfma_f32_16x16x32_bf16 v[36:39], v[60:63], v[52:55], v[36:39]
    ds_read_b128 v[84:87], v7 offset:29696
    ds_read_b128 v[88:91], v7 offset:31744
    v_mfma_f32_16x16x32_bf16 v[40:43], v[64:67], v[52:55], v[40:43]
    ds_read_b128 v[92:95], v7 offset:33792
    ds_read_b128 v[96:99], v7 offset:35840
    v_mfma_f32_16x16x32_bf16 v[44:47], v[68:71], v[52:55], v[44:47]
    v_mfma_f32_16x16x32_bf16 v[48:51], v[72:75], v[52:55], v[48:51]
    s_waitcnt lgkmcnt(0)
    s_barrier
    v_mfma_f32_16x16x32_bf16 v[32:35], v[80:83], v[76:79], v[32:35]
    ds_read_b128 v[52:55], v4 offset:36864
    ds_read_b128 v[56:59], v7 offset:45056
    v_mfma_f32_16x16x32_bf16 v[36:39], v[84:87], v[76:79], v[36:39]
    ds_read_b128 v[60:63], v7 offset:47104
    ds_read_b128 v[64:67], v7 offset:49152
    v_mfma_f32_16x16x32_bf16 v[40:43], v[88:91], v[76:79], v[40:43]
    ds_read_b128 v[68:71], v7 offset:51200
    ds_read_b128 v[72:75], v7 offset:53248
    v_mfma_f32_16x16x32_bf16 v[44:47], v[92:95], v[76:79], v[44:47]
    v_mfma_f32_16x16x32_bf16 v[48:51], v[96:99], v[76:79], v[48:51]
    s_waitcnt lgkmcnt(0)
    v_mfma_f32_16x16x32_bf16 v[32:35], v[56:59], v[52:55], v[32:35]
    ds_read_b128 v[76:79], v4 offset:37888
    ds_read_b128 v[80:83], v7 offset:46080
    v_mfma_f32_16x16x32_bf16 v[36:39], v[60:63], v[52:55], v[36:39]
    ds_read_b128 v[84:87], v7 offset:48128
    ds_read_b128 v[88:91], v7 offset:50176
    v_mfma_f32_16x16x32_bf16 v[40:43], v[64:67], v[52:55], v[40:43]
    ds_read_b128 v[92:95], v7 offset:52224
    ds_read_b128 v[96:99], v7 offset:54272
    v_mfma_f32_16x16x32_bf16 v[44:47], v[68:71], v[52:55], v[44:47]
    v_mfma_f32_16x16x32_bf16 v[48:51], v[72:75], v[52:55], v[48:51]
    s_waitcnt lgkmcnt(0)
    s_barrier
    v_mfma_f32_16x16x32_bf16 v[32:35], v[80:83], v[76:79], v[32:35]
    ds_read_b128 v[52:55], v4 offset:55296
    ds_read_b128 v[56:59], v7 offset:63488
    v_mfma_f32_16x16x32_bf16 v[36:39], v[84:87], v[76:79], v[36:39]
    ds_read_b128 v[60:63], v8 offset:0
    ds_read_b128 v[64:67], v8 offset:2048
    v_mfma_f32_16x16x32_bf16 v[40:43], v[88:91], v[76:79], v[40:43]
    ds_read_b128 v[68:71], v8 offset:4096
    ds_read_b128 v[72:75], v8 offset:6144
    v_mfma_f32_16x16x32_bf16 v[44:47], v[92:95], v[76:79], v[44:47]
    v_mfma_f32_16x16x32_bf16 v[48:51], v[96:99], v[76:79], v[48:51]
    s_waitcnt lgkmcnt(0)
    v_mfma_f32_16x16x32_bf16 v[32:35], v[56:59], v[52:55], v[32:35]
    ds_read_b128 v[76:79], v4 offset:56320
    ds_read_b128 v[80:83], v7 offset:64512
    v_mfma_f32_16x16x32_bf16 v[36:39], v[60:63], v[52:55], v[36:39]
    ds_read_b128 v[84:87], v8 offset:1024
    ds_read_b128 v[88:91], v8 offset:3072
    v_mfma_f32_16x16x32_bf16 v[40:43], v[64:67], v[52:55], v[40:43]
    ds_read_b128 v[92:95], v8 offset:5120
    ds_read_b128 v[96:99], v8 offset:7168
    v_mfma_f32_16x16x32_bf16 v[44:47], v[68:71], v[52:55], v[44:47]
    v_mfma_f32_16x16x32_bf16 v[48:51], v[72:75], v[52:55], v[48:51]
    s_waitcnt lgkmcnt(0)
    s_barrier
    v_mfma_f32_16x16x32_bf16 v[32:35], v[80:83], v[76:79], v[32:35]
    ds_read_b128 v[52:55], v5 offset:8192
    ds_read_b128 v[56:59], v8 offset:16384
    v_mfma_f32_16x16x32_bf16 v[36:39], v[84:87], v[76:79], v[36:39]
    ds_read_b128 v[60:63], v8 offset:18432
    ds_read_b128 v[64:67], v8 offset:20480
    v_mfma_f32_16x16x32_bf16 v[40:43], v[88:91], v[76:79], v[40:43]
    ds_read_b128 v[68:71], v8 offset:22528
    ds_read_b128 v[72:75], v8 offset:24576
    v_mfma_f32_16x16x32_bf16 v[44:47], v[92:95], v[76:79], v[44:47]
    v_mfma_f32_16x16x32_bf16 v[48:51], v[96:99], v[76:79], v[48:51]
    s_waitcnt lgkmcnt(0)
    v_mfma_f32_16x16x32_bf16 v[32:35], v[56:59], v[52:55], v[32:35]
    ds_read_b128 v[76:79], v5 offset:9216
    ds_read_b128 v[80:83], v8 offset:17408
    v_mfma_f32_16x16x32_bf16 v[36:39], v[60:63], v[52:55], v[36:39]
    ds_read_b128 v[84:87], v8 offset:19456
    ds_read_b128 v[88:91], v8 offset:21504
    v_mfma_f32_16x16x32_bf16 v[40:43], v[64:67], v[52:55], v[40:43]
    ds_read_b128 v[92:95], v8 offset:23552
    ds_read_b128 v[96:99], v8 offset:25600
    v_mfma_f32_16x16x32_bf16 v[44:47], v[68:71], v[52:55], v[44:47]
    v_mfma_f32_16x16x32_bf16 v[48:51], v[72:75], v[52:55], v[48:51]
    s_waitcnt lgkmcnt(0)
    s_barrier
    v_mfma_f32_16x16x32_bf16 v[32:35], v[80:83], v[76:79], v[32:35]
    ds_read_b128 v[52:55], v5 offset:26624
    ds_read_b128 v[56:59], v8 offset:34816
    v_mfma_f32_16x16x32_bf16 v[36:39], v[84:87], v[76:79], v[36:39]
    ds_read_b128 v[60:63], v8 offset:36864
    ds_read_b128 v[64:67], v8 offset:38912
    v_mfma_f32_16x16x32_bf16 v[40:43], v[88:91], v[76:79], v[40:43]
    ds_read_b128 v[68:71], v8 offset:40960
    ds_read_b128 v[72:75], v8 offset:43008
    v_mfma_f32_16x16x32_bf16 v[44:47], v[92:95], v[76:79], v[44:47]
    v_mfma_f32_16x16x32_bf16 v[48:51], v[96:99], v[76:79], v[48:51]
    s_waitcnt lgkmcnt(0)
    v_mfma_f32_16x16x32_bf16 v[32:35], v[56:59], v[52:55], v[32:35]
    ds_read_b128 v[76:79], v5 offset:27648
    ds_read_b128 v[80:83], v8 offset:35840
    v_mfma_f32_16x16x32_bf16 v[36:39], v[60:63], v[52:55], v[36:39]
    ds_read_b128 v[84:87], v8 offset:37888
    ds_read_b128 v[88:91], v8 offset:39936
    v_mfma_f32_16x16x32_bf16 v[40:43], v[64:67], v[52:55], v[40:43]
    ds_read_b128 v[92:95], v8 offset:41984
    ds_read_b128 v[96:99], v8 offset:44032
    v_mfma_f32_16x16x32_bf16 v[44:47], v[68:71], v[52:55], v[44:47]
    v_mfma_f32_16x16x32_bf16 v[48:51], v[72:75], v[52:55], v[48:51]
    s_waitcnt lgkmcnt(0)
    s_barrier
    v_mfma_f32_16x16x32_bf16 v[32:35], v[80:83], v[76:79], v[32:35]
    ds_read_b128 v[52:55], v5 offset:45056
    ds_read_b128 v[56:59], v8 offset:53248
    v_mfma_f32_16x16x32_bf16 v[36:39], v[84:87], v[76:79], v[36:39]
    ds_read_b128 v[60:63], v8 offset:55296
    ds_read_b128 v[64:67], v8 offset:57344
    v_mfma_f32_16x16x32_bf16 v[40:43], v[88:91], v[76:79], v[40:43]
    ds_read_b128 v[68:71], v8 offset:59392
    ds_read_b128 v[72:75], v8 offset:61440
    v_mfma_f32_16x16x32_bf16 v[44:47], v[92:95], v[76:79], v[44:47]
    v_mfma_f32_16x16x32_bf16 v[48:51], v[96:99], v[76:79], v[48:51]
    s_waitcnt lgkmcnt(0)
    v_mfma_f32_16x16x32_bf16 v[32:35], v[56:59], v[52:55], v[32:35]
    ds_read_b128 v[76:79], v5 offset:46080
    ds_read_b128 v[80:83], v8 offset:54272
    v_mfma_f32_16x16x32_bf16 v[36:39], v[60:63], v[52:55], v[36:39]
    ds_read_b128 v[84:87], v8 offset:56320
    ds_read_b128 v[88:91], v8 offset:58368
    v_mfma_f32_16x16x32_bf16 v[40:43], v[64:67], v[52:55], v[40:43]
    ds_read_b128 v[92:95], v8 offset:60416
    ds_read_b128 v[96:99], v8 offset:62464
    v_mfma_f32_16x16x32_bf16 v[44:47], v[68:71], v[52:55], v[44:47]
    v_mfma_f32_16x16x32_bf16 v[48:51], v[72:75], v[52:55], v[48:51]
    s_waitcnt lgkmcnt(0)
    s_barrier
    v_mfma_f32_16x16x32_bf16 v[32:35], v[80:83], v[76:79], v[32:35]
    ds_read_b128 v[52:55], v5 offset:63488
    ds_read_b128 v[56:59], v9 offset:6144
    v_mfma_f32_16x16x32_bf16 v[36:39], v[84:87], v[76:79], v[36:39]
    ds_read_b128 v[60:63], v9 offset:8192
    ds_read_b128 v[64:67], v9 offset:10240
    v_mfma_f32_16x16x32_bf16 v[40:43], v[88:91], v[76:79], v[40:43]
    ds_read_b128 v[68:71], v9 offset:12288
    ds_read_b128 v[72:75], v9 offset:14336
    v_mfma_f32_16x16x32_bf16 v[44:47], v[92:95], v[76:79], v[44:47]
    v_mfma_f32_16x16x32_bf16 v[48:51], v[96:99], v[76:79], v[48:51]
    s_waitcnt lgkmcnt(0)
    v_mfma_f32_16x16x32_bf16 v[32:35], v[56:59], v[52:55], v[32:35]
    ds_read_b128 v[76:79], v5 offset:64512
    ds_read_b128 v[80:83], v9 offset:7168
    v_mfma_f32_16x16x32_bf16 v[36:39], v[60:63], v[52:55], v[36:39]
    ds_read_b128 v[84:87], v9 offset:9216
    ds_read_b128 v[88:91], v9 offset:11264
    v_mfma_f32_16x16x32_bf16 v[40:43], v[64:67], v[52:55], v[40:43]
    ds_read_b128 v[92:95], v9 offset:13312
    ds_read_b128 v[96:99], v9 offset:15360
    v_mfma_f32_16x16x32_bf16 v[44:47], v[68:71], v[52:55], v[44:47]
    v_mfma_f32_16x16x32_bf16 v[48:51], v[72:75], v[52:55], v[48:51]
    s_waitcnt lgkmcnt(0)
    s_barrier
    v_mfma_f32_16x16x32_bf16 v[32:35], v[80:83], v[76:79], v[32:35]
    ds_read_b128 v[52:55], v4 offset:0
    ds_read_b128 v[56:59], v7 offset:8192
    v_mfma_f32_16x16x32_bf16 v[36:39], v[84:87], v[76:79], v[36:39]
    ds_read_b128 v[60:63], v7 offset:10240
    ds_read_b128 v[64:67], v7 offset:12288
    v_mfma_f32_16x16x32_bf16 v[40:43], v[88:91], v[76:79], v[40:43]
    ds_read_b128 v[68:71], v7 offset:14336
    ds_read_b128 v[72:75], v7 offset:16384
    v_mfma_f32_16x16x32_bf16 v[44:47], v[92:95], v[76:79], v[44:47]
    v_mfma_f32_16x16x32_bf16 v[48:51], v[96:99], v[76:79], v[48:51]
    s_waitcnt lgkmcnt(0)
    v_mfma_f32_16x16x32_bf16 v[32:35], v[56:59], v[52:55], v[32:35]
    ds_read_b128 v[76:79], v4 offset:1024
    ds_read_b128 v[80:83], v7 offset:9216
    v_mfma_f32_16x16x32_bf16 v[36:39], v[60:63], v[52:55], v[36:39]
    ds_read_b128 v[84:87], v7 offset:11264
    ds_read_b128 v[88:91], v7 offset:13312
    v_mfma_f32_16x16x32_bf16 v[40:43], v[64:67], v[52:55], v[40:43]
    ds_read_b128 v[92:95], v7 offset:15360
    ds_read_b128 v[96:99], v7 offset:17408
    v_mfma_f32_16x16x32_bf16 v[44:47], v[68:71], v[52:55], v[44:47]
    v_mfma_f32_16x16x32_bf16 v[48:51], v[72:75], v[52:55], v[48:51]
    s_waitcnt lgkmcnt(0)
    s_barrier
    v_mfma_f32_16x16x32_bf16 v[32:35], v[80:83], v[76:79], v[32:35]
    ds_read_b128 v[52:55], v4 offset:18432
    ds_read_b128 v[56:59], v7 offset:26624
    v_mfma_f32_16x16x32_bf16 v[36:39], v[84:87], v[76:79], v[36:39]
    ds_read_b128 v[60:63], v7 offset:28672
    ds_read_b128 v[64:67], v7 offset:30720
    v_mfma_f32_16x16x32_bf16 v[40:43], v[88:91], v[76:79], v[40:43]
    ds_read_b128 v[68:71], v7 offset:32768
    ds_read_b128 v[72:75], v7 offset:34816
    v_mfma_f32_16x16x32_bf16 v[44:47], v[92:95], v[76:79], v[44:47]
    v_mfma_f32_16x16x32_bf16 v[48:51], v[96:99], v[76:79], v[48:51]
    s_waitcnt lgkmcnt(0)
    v_mfma_f32_16x16x32_bf16 v[32:35], v[56:59], v[52:55], v[32:35]
    ds_read_b128 v[76:79], v4 offset:19456
    ds_read_b128 v[80:83], v7 offset:27648
    v_mfma_f32_16x16x32_bf16 v[36:39], v[60:63], v[52:55], v[36:39]
    ds_read_b128 v[84:87], v7 offset:29696
    ds_read_b128 v[88:91], v7 offset:31744
    v_mfma_f32_16x16x32_bf16 v[40:43], v[64:67], v[52:55], v[40:43]
    ds_read_b128 v[92:95], v7 offset:33792
    ds_read_b128 v[96:99], v7 offset:35840
    v_mfma_f32_16x16x32_bf16 v[44:47], v[68:71], v[52:55], v[44:47]
    v_mfma_f32_16x16x32_bf16 v[48:51], v[72:75], v[52:55], v[48:51]
    s_waitcnt lgkmcnt(0)
    v_mfma_f32_16x16x32_bf16 v[32:35], v[80:83], v[76:79], v[32:35]
    v_mfma_f32_16x16x32_bf16 v[36:39], v[84:87], v[76:79], v[36:39]
    v_mfma_f32_16x16x32_bf16 v[40:43], v[88:91], v[76:79], v[40:43]
    v_mfma_f32_16x16x32_bf16 v[44:47], v[92:95], v[76:79], v[44:47]
    v_mfma_f32_16x16x32_bf16 v[48:51], v[96:99], v[76:79], v[48:51]
    s_waitcnt vmcnt(0)
    v_mov_b32 v20, 0
    v_mov_b32 v21, 0
    s_nop 0
    v_cvt_pk_bf16_f32 v32, v32, v33
    v_cvt_pk_bf16_f32 v34, v34, v35
    v_and_b32 v33, 0xffff0000, v32
    v_lshlrev_b32 v32, 16, v32
    v_and_b32 v35, 0xffff0000, v34
    v_lshlrev_b32 v34, 16, v34
    v_lshlrev_b32 v22, 16, v10
    v_and_b32 v23, 0xffff0000, v10
    v_add_f32 v32, v32, v22
    v_add_f32 v33, v33, v23
    v_lshlrev_b32 v22, 16, v11
    v_and_b32 v23, 0xffff0000, v11
    v_add_f32 v34, v34, v22
    v_add_f32 v35, v35, v23
    v_cvt_pk_bf16_f32 v10, v32, v33
    v_cvt_pk_bf16_f32 v11, v34, v35
    s_add_u32 s22, s40, 18874368
    buffer_store_dwordx2 v[10:11], v3, s[4:7], s22 offen
    v_lshlrev_b32 v22, 16, v10
    v_and_b32 v23, 0xffff0000, v10
    v_add_f32 v20, v20, v22
    v_fma_f32 v21, v22, v22, v21
    v_add_f32 v20, v20, v23
    v_fma_f32 v21, v23, v23, v21
    v_lshlrev_b32 v22, 16, v11
    v_and_b32 v23, 0xffff0000, v11
    v_add_f32 v20, v20, v22
    v_fma_f32 v21, v22, v22, v21
    v_add_f32 v20, v20, v23
    v_fma_f32 v21, v23, v23, v21
    v_cvt_pk_bf16_f32 v36, v36, v37
    v_cvt_pk_bf16_f32 v38, v38, v39
    v_and_b32 v37, 0xffff0000, v36
    v_lshlrev_b32 v36, 16, v36
    v_and_b32 v39, 0xffff0000, v38
    v_lshlrev_b32 v38, 16, v38
    v_lshlrev_b32 v22, 16, v12
    v_and_b32 v23, 0xffff0000, v12
    v_add_f32 v36, v36, v22
    v_add_f32 v37, v37, v23
    v_lshlrev_b32 v22, 16, v13
    v_and_b32 v23, 0xffff0000, v13
    v_add_f32 v38, v38, v22
    v_add_f32 v39, v39, v23
    v_cvt_pk_bf16_f32 v12, v36, v37
    v_cvt_pk_bf16_f32 v13, v38, v39
    s_add_u32 s22, s41, 18874368
    buffer_store_dwordx2 v[12:13], v3, s[4:7], s22 offen
    v_lshlrev_b32 v22, 16, v12
    v_and_b32 v23, 0xffff0000, v12
    v_add_f32 v20, v20, v22
    v_fma_f32 v21, v22, v22, v21
    v_add_f32 v20, v20, v23
    v_fma_f32 v21, v23, v23, v21
    v_lshlrev_b32 v22, 16, v13
    v_and_b32 v23, 0xffff0000, v13
    v_add_f32 v20, v20, v22
    v_fma_f32 v21, v22, v22, v21
    v_add_f32 v20, v20, v23
    v_fma_f32 v21, v23, v23, v21
    v_cvt_pk_bf16_f32 v40, v40, v41
    v_cvt_pk_bf16_f32 v42, v42, v43
    v_and_b32 v41, 0xffff0000, v40
    v_lshlrev_b32 v40, 16, v40
    v_and_b32 v43, 0xffff0000, v42
    v_lshlrev_b32 v42, 16, v42
    v_lshlrev_b32 v22, 16, v14
    v_and_b32 v23, 0xffff0000, v14
    v_add_f32 v40, v40, v22
    v_add_f32 v41, v41, v23
    v_lshlrev_b32 v22, 16, v15
    v_and_b32 v23, 0xffff0000, v15
    v_add_f32 v42, v42, v22
    v_add_f32 v43, v43, v23
    v_cvt_pk_bf16_f32 v14, v40, v41
    v_cvt_pk_bf16_f32 v15, v42, v43
    s_add_u32 s22, s42, 18874368
    buffer_store_dwordx2 v[14:15], v3, s[4:7], s22 offen
    v_lshlrev_b32 v22, 16, v14
    v_and_b32 v23, 0xffff0000, v14
    v_add_f32 v20, v20, v22
    v_fma_f32 v21, v22, v22, v21
    v_add_f32 v20, v20, v23
    v_fma_f32 v21, v23, v23, v21
    v_lshlrev_b32 v22, 16, v15
    v_and_b32 v23, 0xffff0000, v15
    v_add_f32 v20, v20, v22
    v_fma_f32 v21, v22, v22, v21
    v_add_f32 v20, v20, v23
    v_fma_f32 v21, v23, v23, v21
    v_cvt_pk_bf16_f32 v44, v44, v45
    v_cvt_pk_bf16_f32 v46, v46, v47
    v_and_b32 v45, 0xffff0000, v44
    v_lshlrev_b32 v44, 16, v44
    v_and_b32 v47, 0xffff0000, v46
    v_lshlrev_b32 v46, 16, v46
    v_lshlrev_b32 v22, 16, v16
    v_and_b32 v23, 0xffff0000, v16
    v_add_f32 v44, v44, v22
    v_add_f32 v45, v45, v23
    v_lshlrev_b32 v22, 16, v17
    v_and_b32 v23, 0xffff0000, v17
    v_add_f32 v46, v46, v22
    v_add_f32 v47, v47, v23
    v_cvt_pk_bf16_f32 v16, v44, v45
    v_cvt_pk_bf16_f32 v17, v46, v47
    s_add_u32 s22, s43, 18874368
    buffer_store_dwordx2 v[16:17], v3, s[4:7], s22 offen
    v_lshlrev_b32 v22, 16, v16
    v_and_b32 v23, 0xffff0000, v16
    v_add_f32 v20, v20, v22
    v_fma_f32 v21, v22, v22, v21
    v_add_f32 v20, v20, v23
    v_fma_f32 v21, v23, v23, v21
    v_lshlrev_b32 v22, 16, v17
    v_and_b32 v23, 0xffff0000, v17
    v_add_f32 v20, v20, v22
    v_fma_f32 v21, v22, v22, v21
    v_add_f32 v20, v20, v23
    v_fma_f32 v21, v23, v23, v21
    v_cvt_pk_bf16_f32 v48, v48, v49
    v_cvt_pk_bf16_f32 v50, v50, v51
    v_and_b32 v49, 0xffff0000, v48
    v_lshlrev_b32 v48, 16, v48
    v_and_b32 v51, 0xffff0000, v50
    v_lshlrev_b32 v50, 16, v50
    v_lshlrev_b32 v22, 16, v18
    v_and_b32 v23, 0xffff0000, v18
    v_add_f32 v48, v48, v22
    v_add_f32 v49, v49, v23
    v_lshlrev_b32 v22, 16, v19
    v_and_b32 v23, 0xffff0000, v19
    v_add_f32 v50, v50, v22
    v_add_f32 v51, v51, v23
    v_cvt_pk_bf16_f32 v18, v48, v49
    v_cvt_pk_bf16_f32 v19, v50, v51
    s_add_u32 s22, s44, 18874368
    buffer_store_dwordx2 v[18:19], v3, s[4:7], s22 offen
    v_lshlrev_b32 v22, 16, v18
    v_and_b32 v23, 0xffff0000, v18
    v_add_f32 v20, v20, v22
    v_fma_f32 v21, v22, v22, v21
    v_add_f32 v20, v20, v23
    v_fma_f32 v21, v23, v23, v21
    v_lshlrev_b32 v22, 16, v19
    v_and_b32 v23, 0xffff0000, v19
    v_add_f32 v20, v20, v22
    v_fma_f32 v21, v22, v22, v21
    v_add_f32 v20, v20, v23
    v_fma_f32 v21, v23, v23, v21
    v_mov_b32 v22, v20
    s_nop 1
    v_permlane16_swap_b32 v22, v20
    v_add_f32 v20, v20, v22
    v_mov_b32 v22, v21
    s_nop 1
    v_permlane16_swap_b32 v22, v21
    v_add_f32 v21, v21, v22
    v_mov_b32 v22, v20
    s_nop 1
    v_permlane32_swap_b32 v22, v20
    v_add_f32 v20, v20, v22
    v_mov_b32 v22, v21
    s_nop 1
    v_permlane32_swap_b32 v22, v21
    v_add_f32 v21, v21, v22
    v_lshlrev_b32 v22, 6, v1
    s_lshl_b32 s22, s17, 10
    s_lshl_b32 s23, s14, 3
    s_add_u32 s22, s22, s23
    s_add_u32 s22, s22, 22413312
    s_mov_b64 exec, 0xffff
    buffer_store_dwordx2 v[20:21], v22, s[4:7], s22 offen
wo2_kernel_end:
    s_endpgm

.text
.globl gu2_kernel
.p2align 8
.type gu2_kernel,@function
gu2_kernel:
    s_cmp_ge_u32 s2, 256
    s_cbranch_scc1 gu2_kernel_end
    s_load_dwordx2 s[4:5], s[0:1], 72
    v_lshrrev_b32 v2, 6, v0
    s_nop 0
    v_readfirstlane_b32 s12, v2
    v_and_b32 v1, 63, v0
    v_lshlrev_b32 v3, 4, v1
    s_and_b32 s17, s2, 7
    s_lshr_b32 s18, s2, 3
    s_and_b32 s19, s17, 3
    s_lshr_b32 s17, s17, 2
    s_mul_i32 s19, s19, 32
    s_add_u32 s18, s18, s19
    s_and_b32 s13, s18, 7
    s_lshl_b32 s17, s17, 3
    s_add_u32 s13, s13, s17
    s_lshr_b32 s14, s18, 3
    s_cmp_lt_u32 s12, 4
    s_cbranch_scc1 gu2_kernel_comp
    s_sub_u32 s12, s12, 4
    s_add_u32 s18, s12, 0
    s_mul_i32 s56, s18, 2048
    s_mul_i32 s20, s13, 8
    s_add_u32 s20, s20, s18
    s_mul_i32 s20, s20, 20480
    s_add_u32 s20, s20, 18874368
    s_mul_i32 s21, s14, 12
    s_add_u32 s21, s21, s18
    s_sub_u32 s21, s21, 8
    s_mul_i32 s21, s21, 20480
    s_add_u32 s21, s21, 3342336
    s_cmp_lt_u32 s18, 8
    s_cselect_b32 s24, s20, s21
    s_add_u32 s18, s12, 2
    s_mul_i32 s57, s18, 2048
    s_mul_i32 s20, s13, 8
    s_add_u32 s20, s20, s18
    s_mul_i32 s20, s20, 20480
    s_add_u32 s20, s20, 18874368
    s_mul_i32 s21, s14, 12
    s_add_u32 s21, s21, s18
    s_sub_u32 s21, s21, 8
    s_mul_i32 s21, s21, 20480
    s_add_u32 s21, s21, 3342336
    s_cmp_lt_u32 s18, 8
    s_cselect_b32 s25, s20, s21
    s_add_u32 s18, s12, 4
    s_mul_i32 s58, s18, 2048
    s_mul_i32 s20, s13, 8
    s_add_u32 s20, s20, s18
    s_mul_i32 s20, s20, 20480
    s_add_u32 s20, s20, 18874368
    s_mul_i32 s21, s14, 12
    s_add_u32 s21, s21, s18
    s_sub_u32 s21, s21, 8
    s_mul_i32 s21, s21, 20480
    s_add_u32 s21, s21, 3342336
    s_cmp_lt_u32 s18, 8
    s_cselect_b32 s26, s20, s21
    s_add_u32 s18, s12, 6
    s_mul_i32 s59, s18, 2048
    s_mul_i32 s20, s13, 8
    s_add_u32 s20, s20, s18
    s_mul_i32 s20, s20, 20480
    s_add_u32 s20, s20, 18874368
    s_mul_i32 s21, s14, 12
    s_add_u32 s21, s21, s18
    s_sub_u32 s21, s21, 8
    s_mul_i32 s21, s21, 20480
    s_add_u32 s21, s21, 3342336
    s_cmp_lt_u32 s18, 8
    s_cselect_b32 s27, s20, s21
    s_add_u32 s18, s12, 8
    s_mul_i32 s60, s18, 2048
    s_mul_i32 s20, s13, 8
    s_add_u32 s20, s20, s18
    s_mul_i32 s20, s20, 20480
    s_add_u32 s20, s20, 18874368
    s_mul_i32 s21, s14, 12
    s_add_u32 s21, s21, s18
    s_sub_u32 s21, s21, 8
    s_mul_i32 s21, s21, 20480
    s_add_u32 s21, s21, 3342336
    s_cmp_lt_u32 s18, 8
    s_cselect_b32 s28, s20, s21
    s_add_u32 s18, s12, 10
    s_mul_i32 s61, s18, 2048
    s_mul_i32 s20, s13, 8
    s_add_u32 s20, s20, s18
    s_mul_i32 s20, s20, 20480
    s_add_u32 s20, s20, 18874368
    s_mul_i32 s21, s14, 12
    s_add_u32 s21, s21, s18
    s_sub_u32 s21, s21, 8
    s_mul_i32 s21, s21, 20480
    s_add_u32 s21, s21, 3342336
    s_cmp_lt_u32 s18, 8
    s_cselect_b32 s29, s20, s21
    s_add_u32 s18, s12, 12
    s_mul_i32 s62, s18, 2048
    s_mul_i32 s20, s13, 8
    s_add_u32 s20, s20, s18
    s_mul_i32 s20, s20, 20480
    s_add_u32 s20, s20, 18874368
    s_mul_i32 s21, s14, 12
    s_add_u32 s21, s21, s18
    s_sub_u32 s21, s21, 8
    s_mul_i32 s21, s21, 20480
    s_add_u32 s21, s21, 3342336
    s_cmp_lt_u32 s18, 8
    s_cselect_b32 s30, s20, s21
    s_add_u32 s18, s12, 14
    s_mul_i32 s63, s18, 2048
    s_mul_i32 s20, s13, 8
    s_add_u32 s20, s20, s18
    s_mul_i32 s20, s20, 20480
    s_add_u32 s20, s20, 18874368
    s_mul_i32 s21, s14, 12
    s_add_u32 s21, s21, s18
    s_sub_u32 s21, s21, 8
    s_mul_i32 s21, s21, 20480
    s_add_u32 s21, s21, 3342336
    s_cmp_lt_u32 s18, 8
    s_cselect_b32 s31, s20, s21
    s_add_u32 s18, s12, 16
    s_mul_i32 s64, s18, 2048
    s_mul_i32 s20, s13, 8
    s_add_u32 s20, s20, s18
    s_mul_i32 s20, s20, 20480
    s_add_u32 s20, s20, 18874368
    s_mul_i32 s21, s14, 12
    s_add_u32 s21, s21, s18
    s_sub_u32 s21, s21, 8
    s_mul_i32 s21, s21, 20480
    s_add_u32 s21, s21, 3342336
    s_cmp_lt_u32 s18, 8
    s_cselect_b32 s32, s20, s21
    s_add_u32 s18, s12, 18
    s_mul_i32 s65, s18, 2048
    s_mul_i32 s20, s13, 8
    s_add_u32 s20, s20, s18
    s_mul_i32 s20, s20, 20480
    s_add_u32 s20, s20, 18874368
    s_mul_i32 s21, s14, 12
    s_add_u32 s21, s21, s18
    s_sub_u32 s21, s21, 8
    s_mul_i32 s21, s21, 20480
    s_add_u32 s21, s21, 3342336
    s_cmp_lt_u32 s18, 8
    s_cselect_b32 s33, s20, s21
    s_waitcnt lgkmcnt(0)
    s_and_b32 s5, s5, 0xffff
    s_mov_b32 s6, 268435456
    s_mov_b32 s7, 0x00020000
    s_add_u32 m0, s56, 0
    s_add_u32 s22, s24, 0
    buffer_load_dwordx4 v3, s[4:7], s22 offen offset:0 lds
    buffer_load_dwordx4 v3, s[4:7], s22 offen offset:1024 lds
    s_add_u32 m0, s57, 0
    s_add_u32 s23, s25, 0
    buffer_load_dwordx4 v3, s[4:7], s23 offen offset:0 lds
    buffer_load_dwordx4 v3, s[4:7], s23 offen offset:1024 lds
    s_add_u32 m0, s58, 0
    s_add_u32 s22, s26, 0
    buffer_load_dwordx4 v3, s[4:7], s22 offen offset:0 lds
    buffer_load_dwordx4 v3, s[4:7], s22 offen offset:1024 lds
    s_add_u32 m0, s59, 0
    s_add_u32 s23, s27, 0
    buffer_load_dwordx4 v3, s[4:7], s23 offen offset:0 lds
    buffer_load_dwordx4 v3, s[4:7], s23 offen offset:1024 lds
    s_add_u32 m0, s60, 0
    s_add_u32 s22, s28, 0
    buffer_load_dwordx4 v3, s[4:7], s22 offen offset:0 lds
    buffer_load_dwordx4 v3, s[4:7], s22 offen offset:1024 lds
    s_add_u32 m0, s61, 0
    s_add_u32 s23, s29, 0
    buffer_load_dwordx4 v3, s[4:7], s23 offen offset:0 lds
    buffer_load_dwordx4 v3, s[4:7], s23 offen offset:1024 lds
    s_add_u32 m0, s62, 0
    s_add_u32 s22, s30, 0
    buffer_load_dwordx4 v3, s[4:7], s22 offen offset:0 lds
    buffer_load_dwordx4 v3, s[4:7], s22 offen offset:1024 lds
    s_add_u32 m0, s63, 0
    s_add_u32 s23, s31, 0
    buffer_load_dwordx4 v3, s[4:7], s23 offen offset:0 lds
    buffer_load_dwordx4 v3, s[4:7], s23 offen offset:1024 lds
    s_add_u32 m0, s64, 0
    s_add_u32 s22, s32, 0
    buffer_load_dwordx4 v3, s[4:7], s22 offen offset:0 lds
    buffer_load_dwordx4 v3, s[4:7], s22 offen offset:1024 lds
    s_add_u32 m0, s65, 0
    s_add_u32 s23, s33, 0
    buffer_load_dwordx4 v3, s[4:7], s23 offen offset:0 lds
    buffer_load_dwordx4 v3, s[4:7], s23 offen offset:1024 lds
    s_add_u32 m0, s56, 40960
    s_add_u32 s22, s24, 2048
    buffer_load_dwordx4 v3, s[4:7], s22 offen offset:0 lds
    buffer_load_dwordx4 v3, s[4:7], s22 offen offset:1024 lds
    s_add_u32 m0, s57, 40960
    s_add_u32 s23, s25, 2048
    buffer_load_dwordx4 v3, s[4:7], s23 offen offset:0 lds
    buffer_load_dwordx4 v3, s[4:7], s23 offen offset:1024 lds
    s_add_u32 m0, s58, 40960
    s_add_u32 s22, s26, 2048
    buffer_load_dwordx4 v3, s[4:7], s22 offen offset:0 lds
    buffer_load_dwordx4 v3, s[4:7], s22 offen offset:1024 lds
    s_add_u32 m0, s59, 40960
    s_add_u32 s23, s27, 2048
    buffer_load_dwordx4 v3, s[4:7], s23 offen offset:0 lds
    buffer_load_dwordx4 v3, s[4:7], s23 offen offset:1024 lds
    s_add_u32 m0, s60, 40960
    s_add_u32 s22, s28, 2048
    buffer_load_dwordx4 v3, s[4:7], s22 offen offset:0 lds
    buffer_load_dwordx4 v3, s[4:7], s22 offen offset:1024 lds
    s_add_u32 m0, s61, 40960
    s_add_u32 s23, s29, 2048
    buffer_load_dwordx4 v3, s[4:7], s23 offen offset:0 lds
    buffer_load_dwordx4 v3, s[4:7], s23 offen offset:1024 lds
    s_add_u32 m0, s62, 40960
    s_add_u32 s22, s30, 2048
    buffer_load_dwordx4 v3, s[4:7], s22 offen offset:0 lds
    buffer_load_dwordx4 v3, s[4:7], s22 offen offset:1024 lds
    s_add_u32 m0, s63, 40960
    s_add_u32 s23, s31, 2048
    buffer_load_dwordx4 v3, s[4:7], s23 offen offset:0 lds
    buffer_load_dwordx4 v3, s[4:7], s23 offen offset:1024 lds
    s_add_u32 m0, s64, 40960
    s_add_u32 s22, s32, 2048
    buffer_load_dwordx4 v3, s[4:7], s22 offen offset:0 lds
    buffer_load_dwordx4 v3, s[4:7], s22 offen offset:1024 lds
    s_add_u32 m0, s65, 40960
    s_add_u32 s23, s33, 2048
    buffer_load_dwordx4 v3, s[4:7], s23 offen offset:0 lds
    buffer_load_dwordx4 v3, s[4:7], s23 offen offset:1024 lds
    s_waitcnt vmcnt(20)
    s_barrier
    s_add_u32 m0, s56, 81920
    s_add_u32 s22, s24, 4096
    buffer_load_dwordx4 v3, s[4:7], s22 offen offset:0 lds
    buffer_load_dwordx4 v3, s[4:7], s22 offen offset:1024 lds
    s_add_u32 m0, s57, 81920
    s_add_u32 s23, s25, 4096
    buffer_load_dwordx4 v3, s[4:7], s23 offen offset:0 lds
    buffer_load_dwordx4 v3, s[4:7], s23 offen offset:1024 lds
    s_add_u32 m0, s58, 81920
    s_add_u32 s22, s26, 4096
    buffer_load_dwordx4 v3, s[4:7], s22 offen offset:0 lds
    buffer_load_dwordx4 v3, s[4:7], s22 offen offset:1024 lds
    s_add_u32 m0, s59, 81920
    s_add_u32 s23, s27, 4096
    buffer_load_dwordx4 v3, s[4:7], s23 offen offset:0 lds
    buffer_load_dwordx4 v3, s[4:7], s23 offen offset:1024 lds
    s_add_u32 m0, s60, 81920
    s_add_u32 s22, s28, 4096
    buffer_load_dwordx4 v3, s[4:7], s22 offen offset:0 lds
    buffer_load_dwordx4 v3, s[4:7], s22 offen offset:1024 lds
    s_add_u32 m0, s61, 81920
    s_add_u32 s23, s29, 4096
    buffer_load_dwordx4 v3, s[4:7], s23 offen offset:0 lds
    buffer_load_dwordx4 v3, s[4:7], s23 offen offset:1024 lds
    s_add_u32 m0, s62, 81920
    s_add_u32 s22, s30, 4096
    buffer_load_dwordx4 v3, s[4:7], s22 offen offset:0 lds
    buffer_load_dwordx4 v3, s[4:7], s22 offen offset:1024 lds
    s_add_u32 m0, s63, 81920
    s_add_u32 s23, s31, 4096
    buffer_load_dwordx4 v3, s[4:7], s23 offen offset:0 lds
    buffer_load_dwordx4 v3, s[4:7], s23 offen offset:1024 lds
    s_add_u32 m0, s64, 81920
    s_add_u32 s22, s32, 4096
    buffer_load_dwordx4 v3, s[4:7], s22 offen offset:0 lds
    buffer_load_dwordx4 v3, s[4:7], s22 offen offset:1024 lds
    s_add_u32 m0, s65, 81920
    s_add_u32 s23, s33, 4096
    buffer_load_dwordx4 v3, s[4:7], s23 offen offset:0 lds
    buffer_load_dwordx4 v3, s[4:7], s23 offen offset:1024 lds
    s_waitcnt vmcnt(20)
    s_barrier
    s_add_u32 m0, s56, 0
    s_add_u32 s22, s24, 6144
    buffer_load_dwordx4 v3, s[4:7], s22 offen offset:0 lds
    buffer_load_dwordx4 v3, s[4:7], s22 offen offset:1024 lds
    s_add_u32 m0, s57, 0
    s_add_u32 s23, s25, 6144
    buffer_load_dwordx4 v3, s[4:7], s23 offen offset:0 lds
    buffer_load_dwordx4 v3, s[4:7], s23 offen offset:1024 lds
    s_add_u32 m0, s58, 0
    s_add_u32 s22, s26, 6144
    buffer_load_dwordx4 v3, s[4:7], s22 offen offset:0 lds
    buffer_load_dwordx4 v3, s[4:7], s22 offen offset:1024 lds
    s_add_u32 m0, s59, 0
    s_add_u32 s23, s27, 6144
    buffer_load_dwordx4 v3, s[4:7], s23 offen offset:0 lds
    buffer_load_dwordx4 v3, s[4:7], s23 offen offset:1024 lds
    s_add_u32 m0, s60, 0
    s_add_u32 s22, s28, 6144
    buffer_load_dwordx4 v3, s[4:7], s22 offen offset:0 lds
    buffer_load_dwordx4 v3, s[4:7], s22 offen offset:1024 lds
    s_add_u32 m0, s61, 0
    s_add_u32 s23, s29, 6144
    buffer_load_dwordx4 v3, s[4:7], s23 offen offset:0 lds
    buffer_load_dwordx4 v3, s[4:7], s23 offen offset:1024 lds
    s_add_u32 m0, s62, 0
    s_add_u32 s22, s30, 6144
    buffer_load_dwordx4 v3, s[4:7], s22 offen offset:0 lds
    buffer_load_dwordx4 v3, s[4:7], s22 offen offset:1024 lds
    s_add_u32 m0, s63, 0
    s_add_u32 s23, s31, 6144
    buffer_load_dwordx4 v3, s[4:7], s23 offen offset:0 lds
    buffer_load_dwordx4 v3, s[4:7], s23 offen offset:1024 lds
    s_add_u32 m0, s64, 0
    s_add_u32 s22, s32, 6144
    buffer_load_dwordx4 v3, s[4:7], s22 offen offset:0 lds
    buffer_load_dwordx4 v3, s[4:7], s22 offen offset:1024 lds
    s_add_u32 m0, s65, 0
    s_add_u32 s23, s33, 6144
    buffer_load_dwordx4 v3, s[4:7], s23 offen offset:0 lds
    buffer_load_dwordx4 v3, s[4:7], s23 offen offset:1024 lds
    s_waitcnt vmcnt(20)
    s_barrier
    s_add_u32 m0, s56, 40960
    s_add_u32 s22, s24, 8192
    buffer_load_dwordx4 v3, s[4:7], s22 offen offset:0 lds
    buffer_load_dwordx4 v3, s[4:7], s22 offen offset:1024 lds
    s_add_u32 m0, s57, 40960
    s_add_u32 s23, s25, 8192
    buffer_load_dwordx4 v3, s[4:7], s23 offen offset:0 lds
    buffer_load_dwordx4 v3, s[4:7], s23 offen offset:1024 lds
    s_add_u32 m0, s58, 40960
    s_add_u32 s22, s26, 8192
    buffer_load_dwordx4 v3, s[4:7], s22 offen offset:0 lds
    buffer_load_dwordx4 v3, s[4:7], s22 offen offset:1024 lds
    s_add_u32 m0, s59, 40960
    s_add_u32 s23, s27, 8192
    buffer_load_dwordx4 v3, s[4:7], s23 offen offset:0 lds
    buffer_load_dwordx4 v3, s[4:7], s23 offen offset:1024 lds
    s_add_u32 m0, s60, 40960
    s_add_u32 s22, s28, 8192
    buffer_load_dwordx4 v3, s[4:7], s22 offen offset:0 lds
    buffer_load_dwordx4 v3, s[4:7], s22 offen offset:1024 lds
    s_add_u32 m0, s61, 40960
    s_add_u32 s23, s29, 8192
    buffer_load_dwordx4 v3, s[4:7], s23 offen offset:0 lds
    buffer_load_dwordx4 v3, s[4:7], s23 offen offset:1024 lds
    s_add_u32 m0, s62, 40960
    s_add_u32 s22, s30, 8192
    buffer_load_dwordx4 v3, s[4:7], s22 offen offset:0 lds
    buffer_load_dwordx4 v3, s[4:7], s22 offen offset:1024 lds
    s_add_u32 m0, s63, 40960
    s_add_u32 s23, s31, 8192
    buffer_load_dwordx4 v3, s[4:7], s23 offen offset:0 lds
    buffer_load_dwordx4 v3, s[4:7], s23 offen offset:1024 lds
    s_add_u32 m0, s64, 40960
    s_add_u32 s22, s32, 8192
    buffer_load_dwordx4 v3, s[4:7], s22 offen offset:0 lds
    buffer_load_dwordx4 v3, s[4:7], s22 offen offset:1024 lds
    s_add_u32 m0, s65, 40960
    s_add_u32 s23, s33, 8192
    buffer_load_dwordx4 v3, s[4:7], s23 offen offset:0 lds
    buffer_load_dwordx4 v3, s[4:7], s23 offen offset:1024 lds
    s_waitcnt vmcnt(20)
    s_barrier
    s_add_u32 m0, s56, 81920
    s_add_u32 s22, s24, 10240
    buffer_load_dwordx4 v3, s[4:7], s22 offen offset:0 lds
    buffer_load_dwordx4 v3, s[4:7], s22 offen offset:1024 lds
    s_add_u32 m0, s57, 81920
    s_add_u32 s23, s25, 10240
    buffer_load_dwordx4 v3, s[4:7], s23 offen offset:0 lds
    buffer_load_dwordx4 v3, s[4:7], s23 offen offset:1024 lds
    s_add_u32 m0, s58, 81920
    s_add_u32 s22, s26, 10240
    buffer_load_dwordx4 v3, s[4:7], s22 offen offset:0 lds
    buffer_load_dwordx4 v3, s[4:7], s22 offen offset:1024 lds
    s_add_u32 m0, s59, 81920
    s_add_u32 s23, s27, 10240
    buffer_load_dwordx4 v3, s[4:7], s23 offen offset:0 lds
    buffer_load_dwordx4 v3, s[4:7], s23 offen offset:1024 lds
    s_add_u32 m0, s60, 81920
    s_add_u32 s22, s28, 10240
    buffer_load_dwordx4 v3, s[4:7], s22 offen offset:0 lds
    buffer_load_dwordx4 v3, s[4:7], s22 offen offset:1024 lds
    s_add_u32 m0, s61, 81920
    s_add_u32 s23, s29, 10240
    buffer_load_dwordx4 v3, s[4:7], s23 offen offset:0 lds
    buffer_load_dwordx4 v3, s[4:7], s23 offen offset:1024 lds
    s_add_u32 m0, s62, 81920
    s_add_u32 s22, s30, 10240
    buffer_load_dwordx4 v3, s[4:7], s22 offen offset:0 lds
    buffer_load_dwordx4 v3, s[4:7], s22 offen offset:1024 lds
    s_add_u32 m0, s63, 81920
    s_add_u32 s23, s31, 10240
    buffer_load_dwordx4 v3, s[4:7], s23 offen offset:0 lds
    buffer_load_dwordx4 v3, s[4:7], s23 offen offset:1024 lds
    s_add_u32 m0, s64, 81920
    s_add_u32 s22, s32, 10240
    buffer_load_dwordx4 v3, s[4:7], s22 offen offset:0 lds
    buffer_load_dwordx4 v3, s[4:7], s22 offen offset:1024 lds
    s_add_u32 m0, s65, 81920
    s_add_u32 s23, s33, 10240
    buffer_load_dwordx4 v3, s[4:7], s23 offen offset:0 lds
    buffer_load_dwordx4 v3, s[4:7], s23 offen offset:1024 lds
    s_waitcnt vmcnt(20)
    s_barrier
    s_add_u32 m0, s56, 0
    s_add_u32 s22, s24, 12288
    buffer_load_dwordx4 v3, s[4:7], s22 offen offset:0 lds
    buffer_load_dwordx4 v3, s[4:7], s22 offen offset:1024 lds
    s_add_u32 m0, s57, 0
    s_add_u32 s23, s25, 12288
    buffer_load_dwordx4 v3, s[4:7], s23 offen offset:0 lds
    buffer_load_dwordx4 v3, s[4:7], s23 offen offset:1024 lds
    s_add_u32 m0, s58, 0
    s_add_u32 s22, s26, 12288
    buffer_load_dwordx4 v3, s[4:7], s22 offen offset:0 lds
    buffer_load_dwordx4 v3, s[4:7], s22 offen offset:1024 lds
    s_add_u32 m0, s59, 0
    s_add_u32 s23, s27, 12288
    buffer_load_dwordx4 v3, s[4:7], s23 offen offset:0 lds
    buffer_load_dwordx4 v3, s[4:7], s23 offen offset:1024 lds
    s_add_u32 m0, s60, 0
    s_add_u32 s22, s28, 12288
    buffer_load_dwordx4 v3, s[4:7], s22 offen offset:0 lds
    buffer_load_dwordx4 v3, s[4:7], s22 offen offset:1024 lds
    s_add_u32 m0, s61, 0
    s_add_u32 s23, s29, 12288
    buffer_load_dwordx4 v3, s[4:7], s23 offen offset:0 lds
    buffer_load_dwordx4 v3, s[4:7], s23 offen offset:1024 lds
    s_add_u32 m0, s62, 0
    s_add_u32 s22, s30, 12288
    buffer_load_dwordx4 v3, s[4:7], s22 offen offset:0 lds
    buffer_load_dwordx4 v3, s[4:7], s22 offen offset:1024 lds
    s_add_u32 m0, s63, 0
    s_add_u32 s23, s31, 12288
    buffer_load_dwordx4 v3, s[4:7], s23 offen offset:0 lds
    buffer_load_dwordx4 v3, s[4:7], s23 offen offset:1024 lds
    s_add_u32 m0, s64, 0
    s_add_u32 s22, s32, 12288
    buffer_load_dwordx4 v3, s[4:7], s22 offen offset:0 lds
    buffer_load_dwordx4 v3, s[4:7], s22 offen offset:1024 lds
    s_add_u32 m0, s65, 0
    s_add_u32 s23, s33, 12288
    buffer_load_dwordx4 v3, s[4:7], s23 offen offset:0 lds
    buffer_load_dwordx4 v3, s[4:7], s23 offen offset:1024 lds
    s_waitcnt vmcnt(20)
    s_barrier
    s_add_u32 m0, s56, 40960
    s_add_u32 s22, s24, 14336
    buffer_load_dwordx4 v3, s[4:7], s22 offen offset:0 lds
    buffer_load_dwordx4 v3, s[4:7], s22 offen offset:1024 lds
    s_add_u32 m0, s57, 40960
    s_add_u32 s23, s25, 14336
    buffer_load_dwordx4 v3, s[4:7], s23 offen offset:0 lds
    buffer_load_dwordx4 v3, s[4:7], s23 offen offset:1024 lds
    s_add_u32 m0, s58, 40960
    s_add_u32 s22, s26, 14336
    buffer_load_dwordx4 v3, s[4:7], s22 offen offset:0 lds
    buffer_load_dwordx4 v3, s[4:7], s22 offen offset:1024 lds
    s_add_u32 m0, s59, 40960
    s_add_u32 s23, s27, 14336
    buffer_load_dwordx4 v3, s[4:7], s23 offen offset:0 lds
    buffer_load_dwordx4 v3, s[4:7], s23 offen offset:1024 lds
    s_add_u32 m0, s60, 40960
    s_add_u32 s22, s28, 14336
    buffer_load_dwordx4 v3, s[4:7], s22 offen offset:0 lds
    buffer_load_dwordx4 v3, s[4:7], s22 offen offset:1024 lds
    s_add_u32 m0, s61, 40960
    s_add_u32 s23, s29, 14336
    buffer_load_dwordx4 v3, s[4:7], s23 offen offset:0 lds
    buffer_load_dwordx4 v3, s[4:7], s23 offen offset:1024 lds
    s_add_u32 m0, s62, 40960
    s_add_u32 s22, s30, 14336
    buffer_load_dwordx4 v3, s[4:7], s22 offen offset:0 lds
    buffer_load_dwordx4 v3, s[4:7], s22 offen offset:1024 lds
    s_add_u32 m0, s63, 40960
    s_add_u32 s23, s31, 14336
    buffer_load_dwordx4 v3, s[4:7], s23 offen offset:0 lds
    buffer_load_dwordx4 v3, s[4:7], s23 offen offset:1024 lds
    s_add_u32 m0, s64, 40960
    s_add_u32 s22, s32, 14336
    buffer_load_dwordx4 v3, s[4:7], s22 offen offset:0 lds
    buffer_load_dwordx4 v3, s[4:7], s22 offen offset:1024 lds
    s_add_u32 m0, s65, 40960
    s_add_u32 s23, s33, 14336
    buffer_load_dwordx4 v3, s[4:7], s23 offen offset:0 lds
    buffer_load_dwordx4 v3, s[4:7], s23 offen offset:1024 lds
    s_waitcnt vmcnt(20)
    s_barrier
    s_add_u32 m0, s56, 81920
    s_add_u32 s22, s24, 16384
    buffer_load_dwordx4 v3, s[4:7], s22 offen offset:0 lds
    buffer_load_dwordx4 v3, s[4:7], s22 offen offset:1024 lds
    s_add_u32 m0, s57, 81920
    s_add_u32 s23, s25, 16384
    buffer_load_dwordx4 v3, s[4:7], s23 offen offset:0 lds
    buffer_load_dwordx4 v3, s[4:7], s23 offen offset:1024 lds
    s_add_u32 m0, s58, 81920
    s_add_u32 s22, s26, 16384
    buffer_load_dwordx4 v3, s[4:7], s22 offen offset:0 lds
    buffer_load_dwordx4 v3, s[4:7], s22 offen offset:1024 lds
    s_add_u32 m0, s59, 81920
    s_add_u32 s23, s27, 16384
    buffer_load_dwordx4 v3, s[4:7], s23 offen offset:0 lds
    buffer_load_dwordx4 v3, s[4:7], s23 offen offset:1024 lds
    s_add_u32 m0, s60, 81920
    s_add_u32 s22, s28, 16384
    buffer_load_dwordx4 v3, s[4:7], s22 offen offset:0 lds
    buffer_load_dwordx4 v3, s[4:7], s22 offen offset:1024 lds
    s_add_u32 m0, s61, 81920
    s_add_u32 s23, s29, 16384
    buffer_load_dwordx4 v3, s[4:7], s23 offen offset:0 lds
    buffer_load_dwordx4 v3, s[4:7], s23 offen offset:1024 lds
    s_add_u32 m0, s62, 81920
    s_add_u32 s22, s30, 16384
    buffer_load_dwordx4 v3, s[4:7], s22 offen offset:0 lds
    buffer_load_dwordx4 v3, s[4:7], s22 offen offset:1024 lds
    s_add_u32 m0, s63, 81920
    s_add_u32 s23, s31, 16384
    buffer_load_dwordx4 v3, s[4:7], s23 offen offset:0 lds
    buffer_load_dwordx4 v3, s[4:7], s23 offen offset:1024 lds
    s_add_u32 m0, s64, 81920
    s_add_u32 s22, s32, 16384
    buffer_load_dwordx4 v3, s[4:7], s22 offen offset:0 lds
    buffer_load_dwordx4 v3, s[4:7], s22 offen offset:1024 lds
    s_add_u32 m0, s65, 81920
    s_add_u32 s23, s33, 16384
    buffer_load_dwordx4 v3, s[4:7], s23 offen offset:0 lds
    buffer_load_dwordx4 v3, s[4:7], s23 offen offset:1024 lds
    s_waitcnt vmcnt(20)
    s_barrier
    s_add_u32 m0, s56, 0
    s_add_u32 s22, s24, 18432
    buffer_load_dwordx4 v3, s[4:7], s22 offen offset:0 lds
    buffer_load_dwordx4 v3, s[4:7], s22 offen offset:1024 lds
    s_add_u32 m0, s57, 0
    s_add_u32 s23, s25, 18432
    buffer_load_dwordx4 v3, s[4:7], s23 offen offset:0 lds
    buffer_load_dwordx4 v3, s[4:7], s23 offen offset:1024 lds
    s_add_u32 m0, s58, 0
    s_add_u32 s22, s26, 18432
    buffer_load_dwordx4 v3, s[4:7], s22 offen offset:0 lds
    buffer_load_dwordx4 v3, s[4:7], s22 offen offset:1024 lds
    s_add_u32 m0, s59, 0
    s_add_u32 s23, s27, 18432
    buffer_load_dwordx4 v3, s[4:7], s23 offen offset:0 lds
    buffer_load_dwordx4 v3, s[4:7], s23 offen offset:1024 lds
    s_add_u32 m0, s60, 0
    s_add_u32 s22, s28, 18432
    buffer_load_dwordx4 v3, s[4:7], s22 offen offset:0 lds
    buffer_load_dwordx4 v3, s[4:7], s22 offen offset:1024 lds
    s_add_u32 m0, s61, 0
    s_add_u32 s23, s29, 18432
    buffer_load_dwordx4 v3, s[4:7], s23 offen offset:0 lds
    buffer_load_dwordx4 v3, s[4:7], s23 offen offset:1024 lds
    s_add_u32 m0, s62, 0
    s_add_u32 s22, s30, 18432
    buffer_load_dwordx4 v3, s[4:7], s22 offen offset:0 lds
    buffer_load_dwordx4 v3, s[4:7], s22 offen offset:1024 lds
    s_add_u32 m0, s63, 0
    s_add_u32 s23, s31, 18432
    buffer_load_dwordx4 v3, s[4:7], s23 offen offset:0 lds
    buffer_load_dwordx4 v3, s[4:7], s23 offen offset:1024 lds
    s_add_u32 m0, s64, 0
    s_add_u32 s22, s32, 18432
    buffer_load_dwordx4 v3, s[4:7], s22 offen offset:0 lds
    buffer_load_dwordx4 v3, s[4:7], s22 offen offset:1024 lds
    s_add_u32 m0, s65, 0
    s_add_u32 s23, s33, 18432
    buffer_load_dwordx4 v3, s[4:7], s23 offen offset:0 lds
    buffer_load_dwordx4 v3, s[4:7], s23 offen offset:1024 lds
    s_waitcnt vmcnt(20)
    s_barrier
    s_waitcnt vmcnt(0)
    s_barrier
    s_endpgm
gu2_kernel_comp:
    s_mov_b32 s15, s12
    s_mov_b32 s16, 0
    s_mul_i32 s17, s15, 4096
    s_mul_i32 s18, s16, 24576
    v_add_u32 v4, s17, v3
    v_add_u32 v7, s18, v3
    v_add_u32 v5, s17, v3
    v_add_u32 v8, s18, v3
    v_add_u32 v5, 65536, v5
    v_add_u32 v8, 65536, v8
    v_add_u32 v6, s17, v3
    v_add_u32 v9, s18, v3
    v_add_u32 v6, 131072, v6
    v_add_u32 v9, 131072, v9
    s_waitcnt lgkmcnt(0)
    s_and_b32 s5, s5, 0xffff
    s_mov_b32 s6, 268435456
    s_mov_b32 s7, 0x00020000
    v_and_b32 v2, 127, v0
    v_lshlrev_b32 v2, 6, v2
    s_lshl_b32 s17, s13, 13
    s_add_u32 s17, s17, 22413312
    buffer_load_dwordx4 v[10:13], v2, s[4:7], s17 offen offset:0
    buffer_load_dwordx4 v[14:17], v2, s[4:7], s17 offen offset:16
    buffer_load_dwordx4 v[18:21], v2, s[4:7], s17 offen offset:32
    buffer_load_dwordx4 v[22:25], v2, s[4:7], s17 offen offset:48
    v_lshlrev_b32 v26, 2, v0
    s_mul_i32 s17, s14, 768
    s_add_u32 s17, s17, 9248768
    buffer_load_dword v27, v26, s[4:7], s17 offen
    s_waitcnt vmcnt(1)
    v_add_f32 v10, v10, v12
    v_add_f32 v11, v11, v13
    v_add_f32 v10, v10, v14
    v_add_f32 v11, v11, v15
    v_add_f32 v10, v10, v16
    v_add_f32 v11, v11, v17
    v_add_f32 v10, v10, v18
    v_add_f32 v11, v11, v19
    v_add_f32 v10, v10, v20
    v_add_f32 v11, v11, v21
    v_add_f32 v10, v10, v22
    v_add_f32 v11, v11, v23
    v_add_f32 v10, v10, v24
    v_add_f32 v11, v11, v25
    v_mul_f32 v10, 0x3acccccd, v10
    v_mul_f32 v11, 0x3acccccd, v11
    v_fma_f32 v11, -v10, v10, v11
    v_max_f32 v11, 0, v11
    v_cvt_pk_bf16_f32 v10, v10, v10
    v_lshlrev_b32 v10, 16, v10
    v_cvt_pk_bf16_f32 v11, v11, v11
    v_lshlrev_b32 v11, 16, v11
    v_add_f32 v11, 0x3727c5ac, v11
    v_cvt_pk_bf16_f32 v11, v11, v11
    v_lshlrev_b32 v11, 16, v11
    v_sqrt_f32 v11, v11
    s_nop 0
    v_cvt_pk_bf16_f32 v11, v11, v11
    v_lshlrev_b32 v11, 16, v11
    v_rcp_f32 v11, v11
    v_and_b32 v12, 127, v0
    v_lshlrev_b32 v12, 3, v12
    v_add_u32 v12, 122880, v12
    ds_write_b64 v12, v[10:11]
    s_waitcnt vmcnt(0)
    v_add_u32 v26, 123904, v26
    ds_write_b32 v26, v27
    s_waitcnt lgkmcnt(0)
    s_barrier
    ds_read_b128 v[128:131], v4 offset:0
    ds_read_b128 v[132:135], v4 offset:2048
    ds_read_b128 v[136:139], v7 offset:16384
    ds_read_b128 v[140:143], v7 offset:18432
    ds_read_b128 v[144:147], v7 offset:20480
    ds_read_b128 v[148:151], v7 offset:22528
    ds_read_b128 v[152:155], v7 offset:24576
    ds_read_b128 v[156:159], v7 offset:26624
    ds_read_b128 v[160:163], v7 offset:28672
    ds_read_b128 v[164:167], v7 offset:30720
    ds_read_b128 v[168:171], v7 offset:32768
    ds_read_b128 v[172:175], v7 offset:34816
    ds_read_b128 v[176:179], v7 offset:36864
    ds_read_b128 v[180:183], v7 offset:38912
    s_waitcnt lgkmcnt(0)
    v_mfma_f32_16x16x32_bf16 v[32:35], v[136:139], v[128:131], 0
    ds_read_b128 v[184:187], v4 offset:1024
    v_mfma_f32_16x16x32_bf16 v[36:39], v[140:143], v[128:131], 0
    ds_read_b128 v[188:191], v4 offset:3072
    v_mfma_f32_16x16x32_bf16 v[40:43], v[144:147], v[128:131], 0
    ds_read_b128 v[192:195], v7 offset:17408
    v_mfma_f32_16x16x32_bf16 v[44:47], v[148:151], v[128:131], 0
    ds_read_b128 v[196:199], v7 offset:19456
    v_mfma_f32_16x16x32_bf16 v[48:51], v[152:155], v[128:131], 0
    ds_read_b128 v[200:203], v7 offset:21504
    v_mfma_f32_16x16x32_bf16 v[52:55], v[156:159], v[128:131], 0
    ds_read_b128 v[204:207], v7 offset:23552
    v_mfma_f32_16x16x32_bf16 v[56:59], v[160:163], v[128:131], 0
    ds_read_b128 v[208:211], v7 offset:25600
    v_mfma_f32_16x16x32_bf16 v[60:63], v[164:167], v[128:131], 0
    ds_read_b128 v[212:215], v7 offset:27648
    v_mfma_f32_16x16x32_bf16 v[64:67], v[168:171], v[128:131], 0
    ds_read_b128 v[216:219], v7 offset:29696
    v_mfma_f32_16x16x32_bf16 v[68:71], v[172:175], v[128:131], 0
    ds_read_b128 v[220:223], v7 offset:31744
    v_mfma_f32_16x16x32_bf16 v[72:75], v[176:179], v[128:131], 0
    ds_read_b128 v[224:227], v7 offset:33792
    v_mfma_f32_16x16x32_bf16 v[76:79], v[180:183], v[128:131], 0
    ds_read_b128 v[228:231], v7 offset:35840
    v_mfma_f32_16x16x32_bf16 v[80:83], v[136:139], v[132:135], 0
    ds_read_b128 v[232:235], v7 offset:37888
    v_mfma_f32_16x16x32_bf16 v[84:87], v[140:143], v[132:135], 0
    ds_read_b128 v[236:239], v7 offset:39936
    v_mfma_f32_16x16x32_bf16 v[88:91], v[144:147], v[132:135], 0
    v_mfma_f32_16x16x32_bf16 v[92:95], v[148:151], v[132:135], 0
    v_mfma_f32_16x16x32_bf16 v[96:99], v[152:155], v[132:135], 0
    v_mfma_f32_16x16x32_bf16 v[100:103], v[156:159], v[132:135], 0
    v_mfma_f32_16x16x32_bf16 v[104:107], v[160:163], v[132:135], 0
    v_mfma_f32_16x16x32_bf16 v[108:111], v[164:167], v[132:135], 0
    v_mfma_f32_16x16x32_bf16 v[112:115], v[168:171], v[132:135], 0
    v_mfma_f32_16x16x32_bf16 v[116:119], v[172:175], v[132:135], 0
    v_mfma_f32_16x16x32_bf16 v[120:123], v[176:179], v[132:135], 0
    v_mfma_f32_16x16x32_bf16 v[124:127], v[180:183], v[132:135], 0
    s_waitcnt lgkmcnt(0)
    s_barrier
    v_mfma_f32_16x16x32_bf16 v[32:35], v[192:195], v[184:187], v[32:35]
    ds_read_b128 v[128:131], v4 offset:40960
    v_mfma_f32_16x16x32_bf16 v[36:39], v[196:199], v[184:187], v[36:39]
    ds_read_b128 v[132:135], v4 offset:43008
    v_mfma_f32_16x16x32_bf16 v[40:43], v[200:203], v[184:187], v[40:43]
    ds_read_b128 v[136:139], v7 offset:57344
    v_mfma_f32_16x16x32_bf16 v[44:47], v[204:207], v[184:187], v[44:47]
    ds_read_b128 v[140:143], v7 offset:59392
    v_mfma_f32_16x16x32_bf16 v[48:51], v[208:211], v[184:187], v[48:51]
    ds_read_b128 v[144:147], v7 offset:61440
    v_mfma_f32_16x16x32_bf16 v[52:55], v[212:215], v[184:187], v[52:55]
    ds_read_b128 v[148:151], v7 offset:63488
    v_mfma_f32_16x16x32_bf16 v[56:59], v[216:219], v[184:187], v[56:59]
    ds_read_b128 v[152:155], v8 offset:0
    v_mfma_f32_16x16x32_bf16 v[60:63], v[220:223], v[184:187], v[60:63]
    ds_read_b128 v[156:159], v8 offset:2048
    v_mfma_f32_16x16x32_bf16 v[64:67], v[224:227], v[184:187], v[64:67]
    ds_read_b128 v[160:163], v8 offset:4096
    v_mfma_f32_16x16x32_bf16 v[68:71], v[228:231], v[184:187], v[68:71]
    ds_read_b128 v[164:167], v8 offset:6144
    v_mfma_f32_16x16x32_bf16 v[72:75], v[232:235], v[184:187], v[72:75]
    ds_read_b128 v[168:171], v8 offset:8192
    v_mfma_f32_16x16x32_bf16 v[76:79], v[236:239], v[184:187], v[76:79]
    ds_read_b128 v[172:175], v8 offset:10240
    v_mfma_f32_16x16x32_bf16 v[80:83], v[192:195], v[188:191], v[80:83]
    ds_read_b128 v[176:179], v8 offset:12288
    v_mfma_f32_16x16x32_bf16 v[84:87], v[196:199], v[188:191], v[84:87]
    ds_read_b128 v[180:183], v8 offset:14336
    v_mfma_f32_16x16x32_bf16 v[88:91], v[200:203], v[188:191], v[88:91]
    v_mfma_f32_16x16x32_bf16 v[92:95], v[204:207], v[188:191], v[92:95]
    v_mfma_f32_16x16x32_bf16 v[96:99], v[208:211], v[188:191], v[96:99]
    v_mfma_f32_16x16x32_bf16 v[100:103], v[212:215], v[188:191], v[100:103]
    v_mfma_f32_16x16x32_bf16 v[104:107], v[216:219], v[188:191], v[104:107]
    v_mfma_f32_16x16x32_bf16 v[108:111], v[220:223], v[188:191], v[108:111]
    v_mfma_f32_16x16x32_bf16 v[112:115], v[224:227], v[188:191], v[112:115]
    v_mfma_f32_16x16x32_bf16 v[116:119], v[228:231], v[188:191], v[116:119]
    v_mfma_f32_16x16x32_bf16 v[120:123], v[232:235], v[188:191], v[120:123]
    v_mfma_f32_16x16x32_bf16 v[124:127], v[236:239], v[188:191], v[124:127]
    s_waitcnt lgkmcnt(0)
    v_mfma_f32_16x16x32_bf16 v[32:35], v[136:139], v[128:131], v[32:35]
    ds_read_b128 v[184:187], v4 offset:41984
    v_mfma_f32_16x16x32_bf16 v[36:39], v[140:143], v[128:131], v[36:39]
    ds_read_b128 v[188:191], v4 offset:44032
    v_mfma_f32_16x16x32_bf16 v[40:43], v[144:147], v[128:131], v[40:43]
    ds_read_b128 v[192:195], v7 offset:58368
    v_mfma_f32_16x16x32_bf16 v[44:47], v[148:151], v[128:131], v[44:47]
    ds_read_b128 v[196:199], v7 offset:60416
    v_mfma_f32_16x16x32_bf16 v[48:51], v[152:155], v[128:131], v[48:51]
    ds_read_b128 v[200:203], v7 offset:62464
    v_mfma_f32_16x16x32_bf16 v[52:55], v[156:159], v[128:131], v[52:55]
    ds_read_b128 v[204:207], v7 offset:64512
    v_mfma_f32_16x16x32_bf16 v[56:59], v[160:163], v[128:131], v[56:59]
    ds_read_b128 v[208:211], v8 offset:1024
    v_mfma_f32_16x16x32_bf16 v[60:63], v[164:167], v[128:131], v[60:63]
    ds_read_b128 v[212:215], v8 offset:3072
    v_mfma_f32_16x16x32_bf16 v[64:67], v[168:171], v[128:131], v[64:67]
    ds_read_b128 v[216:219], v8 offset:5120
    v_mfma_f32_16x16x32_bf16 v[68:71], v[172:175], v[128:131], v[68:71]
    ds_read_b128 v[220:223], v8 offset:7168
    v_mfma_f32_16x16x32_bf16 v[72:75], v[176:179], v[128:131], v[72:75]
    ds_read_b128 v[224:227], v8 offset:9216
    v_mfma_f32_16x16x32_bf16 v[76:79], v[180:183], v[128:131], v[76:79]
    ds_read_b128 v[228:231], v8 offset:11264
    v_mfma_f32_16x16x32_bf16 v[80:83], v[136:139], v[132:135], v[80:83]
    ds_read_b128 v[232:235], v8 offset:13312
    v_mfma_f32_16x16x32_bf16 v[84:87], v[140:143], v[132:135], v[84:87]
    ds_read_b128 v[236:239], v8 offset:15360
    v_mfma_f32_16x16x32_bf16 v[88:91], v[144:147], v[132:135], v[88:91]
    v_mfma_f32_16x16x32_bf16 v[92:95], v[148:151], v[132:135], v[92:95]
    v_mfma_f32_16x16x32_bf16 v[96:99], v[152:155], v[132:135], v[96:99]
    v_mfma_f32_16x16x32_bf16 v[100:103], v[156:159], v[132:135], v[100:103]
    v_mfma_f32_16x16x32_bf16 v[104:107], v[160:163], v[132:135], v[104:107]
    v_mfma_f32_16x16x32_bf16 v[108:111], v[164:167], v[132:135], v[108:111]
    v_mfma_f32_16x16x32_bf16 v[112:115], v[168:171], v[132:135], v[112:115]
    v_mfma_f32_16x16x32_bf16 v[116:119], v[172:175], v[132:135], v[116:119]
    v_mfma_f32_16x16x32_bf16 v[120:123], v[176:179], v[132:135], v[120:123]
    v_mfma_f32_16x16x32_bf16 v[124:127], v[180:183], v[132:135], v[124:127]
    s_waitcnt lgkmcnt(0)
    s_barrier
    v_mfma_f32_16x16x32_bf16 v[32:35], v[192:195], v[184:187], v[32:35]
    ds_read_b128 v[128:131], v5 offset:16384
    v_mfma_f32_16x16x32_bf16 v[36:39], v[196:199], v[184:187], v[36:39]
    ds_read_b128 v[132:135], v5 offset:18432
    v_mfma_f32_16x16x32_bf16 v[40:43], v[200:203], v[184:187], v[40:43]
    ds_read_b128 v[136:139], v8 offset:32768
    v_mfma_f32_16x16x32_bf16 v[44:47], v[204:207], v[184:187], v[44:47]
    ds_read_b128 v[140:143], v8 offset:34816
    v_mfma_f32_16x16x32_bf16 v[48:51], v[208:211], v[184:187], v[48:51]
    ds_read_b128 v[144:147], v8 offset:36864
    v_mfma_f32_16x16x32_bf16 v[52:55], v[212:215], v[184:187], v[52:55]
    ds_read_b128 v[148:151], v8 offset:38912
    v_mfma_f32_16x16x32_bf16 v[56:59], v[216:219], v[184:187], v[56:59]
    ds_read_b128 v[152:155], v8 offset:40960
    v_mfma_f32_16x16x32_bf16 v[60:63], v[220:223], v[184:187], v[60:63]
    ds_read_b128 v[156:159], v8 offset:43008
    v_mfma_f32_16x16x32_bf16 v[64:67], v[224:227], v[184:187], v[64:67]
    ds_read_b128 v[160:163], v8 offset:45056
    v_mfma_f32_16x16x32_bf16 v[68:71], v[228:231], v[184:187], v[68:71]
    ds_read_b128 v[164:167], v8 offset:47104
    v_mfma_f32_16x16x32_bf16 v[72:75], v[232:235], v[184:187], v[72:75]
    ds_read_b128 v[168:171], v8 offset:49152
    v_mfma_f32_16x16x32_bf16 v[76:79], v[236:239], v[184:187], v[76:79]
    ds_read_b128 v[172:175], v8 offset:51200
    v_mfma_f32_16x16x32_bf16 v[80:83], v[192:195], v[188:191], v[80:83]
    ds_read_b128 v[176:179], v8 offset:53248
    v_mfma_f32_16x16x32_bf16 v[84:87], v[196:199], v[188:191], v[84:87]
    ds_read_b128 v[180:183], v8 offset:55296
    v_mfma_f32_16x16x32_bf16 v[88:91], v[200:203], v[188:191], v[88:91]
    v_mfma_f32_16x16x32_bf16 v[92:95], v[204:207], v[188:191], v[92:95]
    v_mfma_f32_16x16x32_bf16 v[96:99], v[208:211], v[188:191], v[96:99]
    v_mfma_f32_16x16x32_bf16 v[100:103], v[212:215], v[188:191], v[100:103]
    v_mfma_f32_16x16x32_bf16 v[104:107], v[216:219], v[188:191], v[104:107]
    v_mfma_f32_16x16x32_bf16 v[108:111], v[220:223], v[188:191], v[108:111]
    v_mfma_f32_16x16x32_bf16 v[112:115], v[224:227], v[188:191], v[112:115]
    v_mfma_f32_16x16x32_bf16 v[116:119], v[228:231], v[188:191], v[116:119]
    v_mfma_f32_16x16x32_bf16 v[120:123], v[232:235], v[188:191], v[120:123]
    v_mfma_f32_16x16x32_bf16 v[124:127], v[236:239], v[188:191], v[124:127]
    s_waitcnt lgkmcnt(0)
    v_mfma_f32_16x16x32_bf16 v[32:35], v[136:139], v[128:131], v[32:35]
    ds_read_b128 v[184:187], v5 offset:17408
    v_mfma_f32_16x16x32_bf16 v[36:39], v[140:143], v[128:131], v[36:39]
    ds_read_b128 v[188:191], v5 offset:19456
    v_mfma_f32_16x16x32_bf16 v[40:43], v[144:147], v[128:131], v[40:43]
    ds_read_b128 v[192:195], v8 offset:33792
    v_mfma_f32_16x16x32_bf16 v[44:47], v[148:151], v[128:131], v[44:47]
    ds_read_b128 v[196:199], v8 offset:35840
    v_mfma_f32_16x16x32_bf16 v[48:51], v[152:155], v[128:131], v[48:51]
    ds_read_b128 v[200:203], v8 offset:37888
    v_mfma_f32_16x16x32_bf16 v[52:55], v[156:159], v[128:131], v[52:55]
    ds_read_b128 v[204:207], v8 offset:39936
    v_mfma_f32_16x16x32_bf16 v[56:59], v[160:163], v[128:131], v[56:59]
    ds_read_b128 v[208:211], v8 offset:41984
    v_mfma_f32_16x16x32_bf16 v[60:63], v[164:167], v[128:131], v[60:63]
    ds_read_b128 v[212:215], v8 offset:44032
    v_mfma_f32_16x16x32_bf16 v[64:67], v[168:171], v[128:131], v[64:67]
    ds_read_b128 v[216:219], v8 offset:46080
    v_mfma_f32_16x16x32_bf16 v[68:71], v[172:175], v[128:131], v[68:71]
    ds_read_b128 v[220:223], v8 offset:48128
    v_mfma_f32_16x16x32_bf16 v[72:75], v[176:179], v[128:131], v[72:75]
    ds_read_b128 v[224:227], v8 offset:50176
    v_mfma_f32_16x16x32_bf16 v[76:79], v[180:183], v[128:131], v[76:79]
    ds_read_b128 v[228:231], v8 offset:52224
    v_mfma_f32_16x16x32_bf16 v[80:83], v[136:139], v[132:135], v[80:83]
    ds_read_b128 v[232:235], v8 offset:54272
    v_mfma_f32_16x16x32_bf16 v[84:87], v[140:143], v[132:135], v[84:87]
    ds_read_b128 v[236:239], v8 offset:56320
    v_mfma_f32_16x16x32_bf16 v[88:91], v[144:147], v[132:135], v[88:91]
    v_mfma_f32_16x16x32_bf16 v[92:95], v[148:151], v[132:135], v[92:95]
    v_mfma_f32_16x16x32_bf16 v[96:99], v[152:155], v[132:135], v[96:99]
    v_mfma_f32_16x16x32_bf16 v[100:103], v[156:159], v[132:135], v[100:103]
    v_mfma_f32_16x16x32_bf16 v[104:107], v[160:163], v[132:135], v[104:107]
    v_mfma_f32_16x16x32_bf16 v[108:111], v[164:167], v[132:135], v[108:111]
    v_mfma_f32_16x16x32_bf16 v[112:115], v[168:171], v[132:135], v[112:115]
    v_mfma_f32_16x16x32_bf16 v[116:119], v[172:175], v[132:135], v[116:119]
    v_mfma_f32_16x16x32_bf16 v[120:123], v[176:179], v[132:135], v[120:123]
    v_mfma_f32_16x16x32_bf16 v[124:127], v[180:183], v[132:135], v[124:127]
    s_waitcnt lgkmcnt(0)
    s_barrier
    v_mfma_f32_16x16x32_bf16 v[32:35], v[192:195], v[184:187], v[32:35]
    ds_read_b128 v[128:131], v4 offset:0
    v_mfma_f32_16x16x32_bf16 v[36:39], v[196:199], v[184:187], v[36:39]
    ds_read_b128 v[132:135], v4 offset:2048
    v_mfma_f32_16x16x32_bf16 v[40:43], v[200:203], v[184:187], v[40:43]
    ds_read_b128 v[136:139], v7 offset:16384
    v_mfma_f32_16x16x32_bf16 v[44:47], v[204:207], v[184:187], v[44:47]
    ds_read_b128 v[140:143], v7 offset:18432
    v_mfma_f32_16x16x32_bf16 v[48:51], v[208:211], v[184:187], v[48:51]
    ds_read_b128 v[144:147], v7 offset:20480
    v_mfma_f32_16x16x32_bf16 v[52:55], v[212:215], v[184:187], v[52:55]
    ds_read_b128 v[148:151], v7 offset:22528
    v_mfma_f32_16x16x32_bf16 v[56:59], v[216:219], v[184:187], v[56:59]
    ds_read_b128 v[152:155], v7 offset:24576
    v_mfma_f32_16x16x32_bf16 v[60:63], v[220:223], v[184:187], v[60:63]
    ds_read_b128 v[156:159], v7 offset:26624
    v_mfma_f32_16x16x32_bf16 v[64:67], v[224:227], v[184:187], v[64:67]
    ds_read_b128 v[160:163], v7 offset:28672
    v_mfma_f32_16x16x32_bf16 v[68:71], v[228:231], v[184:187], v[68:71]
    ds_read_b128 v[164:167], v7 offset:30720
    v_mfma_f32_16x16x32_bf16 v[72:75], v[232:235], v[184:187], v[72:75]
    ds_read_b128 v[168:171], v7 offset:32768
    v_mfma_f32_16x16x32_bf16 v[76:79], v[236:239], v[184:187], v[76:79]
    ds_read_b128 v[172:175], v7 offset:34816
    v_mfma_f32_16x16x32_bf16 v[80:83], v[192:195], v[188:191], v[80:83]
    ds_read_b128 v[176:179], v7 offset:36864
    v_mfma_f32_16x16x32_bf16 v[84:87], v[196:199], v[188:191], v[84:87]
    ds_read_b128 v[180:183], v7 offset:38912
    v_mfma_f32_16x16x32_bf16 v[88:91], v[200:203], v[188:191], v[88:91]
    v_mfma_f32_16x16x32_bf16 v[92:95], v[204:207], v[188:191], v[92:95]
    v_mfma_f32_16x16x32_bf16 v[96:99], v[208:211], v[188:191], v[96:99]
    v_mfma_f32_16x16x32_bf16 v[100:103], v[212:215], v[188:191], v[100:103]
    v_mfma_f32_16x16x32_bf16 v[104:107], v[216:219], v[188:191], v[104:107]
    v_mfma_f32_16x16x32_bf16 v[108:111], v[220:223], v[188:191], v[108:111]
    v_mfma_f32_16x16x32_bf16 v[112:115], v[224:227], v[188:191], v[112:115]
    v_mfma_f32_16x16x32_bf16 v[116:119], v[228:231], v[188:191], v[116:119]
    v_mfma_f32_16x16x32_bf16 v[120:123], v[232:235], v[188:191], v[120:123]
    v_mfma_f32_16x16x32_bf16 v[124:127], v[236:239], v[188:191], v[124:127]
    s_waitcnt lgkmcnt(0)
    v_mfma_f32_16x16x32_bf16 v[32:35], v[136:139], v[128:131], v[32:35]
    ds_read_b128 v[184:187], v4 offset:1024
    v_mfma_f32_16x16x32_bf16 v[36:39], v[140:143], v[128:131], v[36:39]
    ds_read_b128 v[188:191], v4 offset:3072
    v_mfma_f32_16x16x32_bf16 v[40:43], v[144:147], v[128:131], v[40:43]
    ds_read_b128 v[192:195], v7 offset:17408
    v_mfma_f32_16x16x32_bf16 v[44:47], v[148:151], v[128:131], v[44:47]
    ds_read_b128 v[196:199], v7 offset:19456
    v_mfma_f32_16x16x32_bf16 v[48:51], v[152:155], v[128:131], v[48:51]
    ds_read_b128 v[200:203], v7 offset:21504
    v_mfma_f32_16x16x32_bf16 v[52:55], v[156:159], v[128:131], v[52:55]
    ds_read_b128 v[204:207], v7 offset:23552
    v_mfma_f32_16x16x32_bf16 v[56:59], v[160:163], v[128:131], v[56:59]
    ds_read_b128 v[208:211], v7 offset:25600
    v_mfma_f32_16x16x32_bf16 v[60:63], v[164:167], v[128:131], v[60:63]
    ds_read_b128 v[212:215], v7 offset:27648
    v_mfma_f32_16x16x32_bf16 v[64:67], v[168:171], v[128:131], v[64:67]
    ds_read_b128 v[216:219], v7 offset:29696
    v_mfma_f32_16x16x32_bf16 v[68:71], v[172:175], v[128:131], v[68:71]
    ds_read_b128 v[220:223], v7 offset:31744
    v_mfma_f32_16x16x32_bf16 v[72:75], v[176:179], v[128:131], v[72:75]
    ds_read_b128 v[224:227], v7 offset:33792
    v_mfma_f32_16x16x32_bf16 v[76:79], v[180:183], v[128:131], v[76:79]
    ds_read_b128 v[228:231], v7 offset:35840
    v_mfma_f32_16x16x32_bf16 v[80:83], v[136:139], v[132:135], v[80:83]
    ds_read_b128 v[232:235], v7 offset:37888
    v_mfma_f32_16x16x32_bf16 v[84:87], v[140:143], v[132:135], v[84:87]
    ds_read_b128 v[236:239], v7 offset:39936
    v_mfma_f32_16x16x32_bf16 v[88:91], v[144:147], v[132:135], v[88:91]
    v_mfma_f32_16x16x32_bf16 v[92:95], v[148:151], v[132:135], v[92:95]
    v_mfma_f32_16x16x32_bf16 v[96:99], v[152:155], v[132:135], v[96:99]
    v_mfma_f32_16x16x32_bf16 v[100:103], v[156:159], v[132:135], v[100:103]
    v_mfma_f32_16x16x32_bf16 v[104:107], v[160:163], v[132:135], v[104:107]
    v_mfma_f32_16x16x32_bf16 v[108:111], v[164:167], v[132:135], v[108:111]
    v_mfma_f32_16x16x32_bf16 v[112:115], v[168:171], v[132:135], v[112:115]
    v_mfma_f32_16x16x32_bf16 v[116:119], v[172:175], v[132:135], v[116:119]
    v_mfma_f32_16x16x32_bf16 v[120:123], v[176:179], v[132:135], v[120:123]
    v_mfma_f32_16x16x32_bf16 v[124:127], v[180:183], v[132:135], v[124:127]
    s_waitcnt lgkmcnt(0)
    s_barrier
    v_mfma_f32_16x16x32_bf16 v[32:35], v[192:195], v[184:187], v[32:35]
    ds_read_b128 v[128:131], v4 offset:40960
    v_mfma_f32_16x16x32_bf16 v[36:39], v[196:199], v[184:187], v[36:39]
    ds_read_b128 v[132:135], v4 offset:43008
    v_mfma_f32_16x16x32_bf16 v[40:43], v[200:203], v[184:187], v[40:43]
    ds_read_b128 v[136:139], v7 offset:57344
    v_mfma_f32_16x16x32_bf16 v[44:47], v[204:207], v[184:187], v[44:47]
    ds_read_b128 v[140:143], v7 offset:59392
    v_mfma_f32_16x16x32_bf16 v[48:51], v[208:211], v[184:187], v[48:51]
    ds_read_b128 v[144:147], v7 offset:61440
    v_mfma_f32_16x16x32_bf16 v[52:55], v[212:215], v[184:187], v[52:55]
    ds_read_b128 v[148:151], v7 offset:63488
    v_mfma_f32_16x16x32_bf16 v[56:59], v[216:219], v[184:187], v[56:59]
    ds_read_b128 v[152:155], v8 offset:0
    v_mfma_f32_16x16x32_bf16 v[60:63], v[220:223], v[184:187], v[60:63]
    ds_read_b128 v[156:159], v8 offset:2048
    v_mfma_f32_16x16x32_bf16 v[64:67], v[224:227], v[184:187], v[64:67]
    ds_read_b128 v[160:163], v8 offset:4096
    v_mfma_f32_16x16x32_bf16 v[68:71], v[228:231], v[184:187], v[68:71]
    ds_read_b128 v[164:167], v8 offset:6144
    v_mfma_f32_16x16x32_bf16 v[72:75], v[232:235], v[184:187], v[72:75]
    ds_read_b128 v[168:171], v8 offset:8192
    v_mfma_f32_16x16x32_bf16 v[76:79], v[236:239], v[184:187], v[76:79]
    ds_read_b128 v[172:175], v8 offset:10240
    v_mfma_f32_16x16x32_bf16 v[80:83], v[192:195], v[188:191], v[80:83]
    ds_read_b128 v[176:179], v8 offset:12288
    v_mfma_f32_16x16x32_bf16 v[84:87], v[196:199], v[188:191], v[84:87]
    ds_read_b128 v[180:183], v8 offset:14336
    v_mfma_f32_16x16x32_bf16 v[88:91], v[200:203], v[188:191], v[88:91]
    v_mfma_f32_16x16x32_bf16 v[92:95], v[204:207], v[188:191], v[92:95]
    v_mfma_f32_16x16x32_bf16 v[96:99], v[208:211], v[188:191], v[96:99]
    v_mfma_f32_16x16x32_bf16 v[100:103], v[212:215], v[188:191], v[100:103]
    v_mfma_f32_16x16x32_bf16 v[104:107], v[216:219], v[188:191], v[104:107]
    v_mfma_f32_16x16x32_bf16 v[108:111], v[220:223], v[188:191], v[108:111]
    v_mfma_f32_16x16x32_bf16 v[112:115], v[224:227], v[188:191], v[112:115]
    v_mfma_f32_16x16x32_bf16 v[116:119], v[228:231], v[188:191], v[116:119]
    v_mfma_f32_16x16x32_bf16 v[120:123], v[232:235], v[188:191], v[120:123]
    v_mfma_f32_16x16x32_bf16 v[124:127], v[236:239], v[188:191], v[124:127]
    s_waitcnt lgkmcnt(0)
    v_mfma_f32_16x16x32_bf16 v[32:35], v[136:139], v[128:131], v[32:35]
    ds_read_b128 v[184:187], v4 offset:41984
    v_mfma_f32_16x16x32_bf16 v[36:39], v[140:143], v[128:131], v[36:39]
    ds_read_b128 v[188:191], v4 offset:44032
    v_mfma_f32_16x16x32_bf16 v[40:43], v[144:147], v[128:131], v[40:43]
    ds_read_b128 v[192:195], v7 offset:58368
    v_mfma_f32_16x16x32_bf16 v[44:47], v[148:151], v[128:131], v[44:47]
    ds_read_b128 v[196:199], v7 offset:60416
    v_mfma_f32_16x16x32_bf16 v[48:51], v[152:155], v[128:131], v[48:51]
    ds_read_b128 v[200:203], v7 offset:62464
    v_mfma_f32_16x16x32_bf16 v[52:55], v[156:159], v[128:131], v[52:55]
    ds_read_b128 v[204:207], v7 offset:64512
    v_mfma_f32_16x16x32_bf16 v[56:59], v[160:163], v[128:131], v[56:59]
    ds_read_b128 v[208:211], v8 offset:1024
    v_mfma_f32_16x16x32_bf16 v[60:63], v[164:167], v[128:131], v[60:63]
    ds_read_b128 v[212:215], v8 offset:3072
    v_mfma_f32_16x16x32_bf16 v[64:67], v[168:171], v[128:131], v[64:67]
    ds_read_b128 v[216:219], v8 offset:5120
    v_mfma_f32_16x16x32_bf16 v[68:71], v[172:175], v[128:131], v[68:71]
    ds_read_b128 v[220:223], v8 offset:7168
    v_mfma_f32_16x16x32_bf16 v[72:75], v[176:179], v[128:131], v[72:75]
    ds_read_b128 v[224:227], v8 offset:9216
    v_mfma_f32_16x16x32_bf16 v[76:79], v[180:183], v[128:131], v[76:79]
    ds_read_b128 v[228:231], v8 offset:11264
    v_mfma_f32_16x16x32_bf16 v[80:83], v[136:139], v[132:135], v[80:83]
    ds_read_b128 v[232:235], v8 offset:13312
    v_mfma_f32_16x16x32_bf16 v[84:87], v[140:143], v[132:135], v[84:87]
    ds_read_b128 v[236:239], v8 offset:15360
    v_mfma_f32_16x16x32_bf16 v[88:91], v[144:147], v[132:135], v[88:91]
    v_mfma_f32_16x16x32_bf16 v[92:95], v[148:151], v[132:135], v[92:95]
    v_mfma_f32_16x16x32_bf16 v[96:99], v[152:155], v[132:135], v[96:99]
    v_mfma_f32_16x16x32_bf16 v[100:103], v[156:159], v[132:135], v[100:103]
    v_mfma_f32_16x16x32_bf16 v[104:107], v[160:163], v[132:135], v[104:107]
    v_mfma_f32_16x16x32_bf16 v[108:111], v[164:167], v[132:135], v[108:111]
    v_mfma_f32_16x16x32_bf16 v[112:115], v[168:171], v[132:135], v[112:115]
    v_mfma_f32_16x16x32_bf16 v[116:119], v[172:175], v[132:135], v[116:119]
    v_mfma_f32_16x16x32_bf16 v[120:123], v[176:179], v[132:135], v[120:123]
    v_mfma_f32_16x16x32_bf16 v[124:127], v[180:183], v[132:135], v[124:127]
    s_waitcnt lgkmcnt(0)
    s_barrier
    v_mfma_f32_16x16x32_bf16 v[32:35], v[192:195], v[184:187], v[32:35]
    ds_read_b128 v[128:131], v5 offset:16384
    v_mfma_f32_16x16x32_bf16 v[36:39], v[196:199], v[184:187], v[36:39]
    ds_read_b128 v[132:135], v5 offset:18432
    v_mfma_f32_16x16x32_bf16 v[40:43], v[200:203], v[184:187], v[40:43]
    ds_read_b128 v[136:139], v8 offset:32768
    v_mfma_f32_16x16x32_bf16 v[44:47], v[204:207], v[184:187], v[44:47]
    ds_read_b128 v[140:143], v8 offset:34816
    v_mfma_f32_16x16x32_bf16 v[48:51], v[208:211], v[184:187], v[48:51]
    ds_read_b128 v[144:147], v8 offset:36864
    v_mfma_f32_16x16x32_bf16 v[52:55], v[212:215], v[184:187], v[52:55]
    ds_read_b128 v[148:151], v8 offset:38912
    v_mfma_f32_16x16x32_bf16 v[56:59], v[216:219], v[184:187], v[56:59]
    ds_read_b128 v[152:155], v8 offset:40960
    v_mfma_f32_16x16x32_bf16 v[60:63], v[220:223], v[184:187], v[60:63]
    ds_read_b128 v[156:159], v8 offset:43008
    v_mfma_f32_16x16x32_bf16 v[64:67], v[224:227], v[184:187], v[64:67]
    ds_read_b128 v[160:163], v8 offset:45056
    v_mfma_f32_16x16x32_bf16 v[68:71], v[228:231], v[184:187], v[68:71]
    ds_read_b128 v[164:167], v8 offset:47104
    v_mfma_f32_16x16x32_bf16 v[72:75], v[232:235], v[184:187], v[72:75]
    ds_read_b128 v[168:171], v8 offset:49152
    v_mfma_f32_16x16x32_bf16 v[76:79], v[236:239], v[184:187], v[76:79]
    ds_read_b128 v[172:175], v8 offset:51200
    v_mfma_f32_16x16x32_bf16 v[80:83], v[192:195], v[188:191], v[80:83]
    ds_read_b128 v[176:179], v8 offset:53248
    v_mfma_f32_16x16x32_bf16 v[84:87], v[196:199], v[188:191], v[84:87]
    ds_read_b128 v[180:183], v8 offset:55296
    v_mfma_f32_16x16x32_bf16 v[88:91], v[200:203], v[188:191], v[88:91]
    v_mfma_f32_16x16x32_bf16 v[92:95], v[204:207], v[188:191], v[92:95]
    v_mfma_f32_16x16x32_bf16 v[96:99], v[208:211], v[188:191], v[96:99]
    v_mfma_f32_16x16x32_bf16 v[100:103], v[212:215], v[188:191], v[100:103]
    v_mfma_f32_16x16x32_bf16 v[104:107], v[216:219], v[188:191], v[104:107]
    v_mfma_f32_16x16x32_bf16 v[108:111], v[220:223], v[188:191], v[108:111]
    v_mfma_f32_16x16x32_bf16 v[112:115], v[224:227], v[188:191], v[112:115]
    v_mfma_f32_16x16x32_bf16 v[116:119], v[228:231], v[188:191], v[116:119]
    v_mfma_f32_16x16x32_bf16 v[120:123], v[232:235], v[188:191], v[120:123]
    v_mfma_f32_16x16x32_bf16 v[124:127], v[236:239], v[188:191], v[124:127]
    s_waitcnt lgkmcnt(0)
    v_mfma_f32_16x16x32_bf16 v[32:35], v[136:139], v[128:131], v[32:35]
    ds_read_b128 v[184:187], v5 offset:17408
    v_mfma_f32_16x16x32_bf16 v[36:39], v[140:143], v[128:131], v[36:39]
    ds_read_b128 v[188:191], v5 offset:19456
    v_mfma_f32_16x16x32_bf16 v[40:43], v[144:147], v[128:131], v[40:43]
    ds_read_b128 v[192:195], v8 offset:33792
    v_mfma_f32_16x16x32_bf16 v[44:47], v[148:151], v[128:131], v[44:47]
    ds_read_b128 v[196:199], v8 offset:35840
    v_mfma_f32_16x16x32_bf16 v[48:51], v[152:155], v[128:131], v[48:51]
    ds_read_b128 v[200:203], v8 offset:37888
    v_mfma_f32_16x16x32_bf16 v[52:55], v[156:159], v[128:131], v[52:55]
    ds_read_b128 v[204:207], v8 offset:39936
    v_mfma_f32_16x16x32_bf16 v[56:59], v[160:163], v[128:131], v[56:59]
    ds_read_b128 v[208:211], v8 offset:41984
    v_mfma_f32_16x16x32_bf16 v[60:63], v[164:167], v[128:131], v[60:63]
    ds_read_b128 v[212:215], v8 offset:44032
    v_mfma_f32_16x16x32_bf16 v[64:67], v[168:171], v[128:131], v[64:67]
    ds_read_b128 v[216:219], v8 offset:46080
    v_mfma_f32_16x16x32_bf16 v[68:71], v[172:175], v[128:131], v[68:71]
    ds_read_b128 v[220:223], v8 offset:48128
    v_mfma_f32_16x16x32_bf16 v[72:75], v[176:179], v[128:131], v[72:75]
    ds_read_b128 v[224:227], v8 offset:50176
    v_mfma_f32_16x16x32_bf16 v[76:79], v[180:183], v[128:131], v[76:79]
    ds_read_b128 v[228:231], v8 offset:52224
    v_mfma_f32_16x16x32_bf16 v[80:83], v[136:139], v[132:135], v[80:83]
    ds_read_b128 v[232:235], v8 offset:54272
    v_mfma_f32_16x16x32_bf16 v[84:87], v[140:143], v[132:135], v[84:87]
    ds_read_b128 v[236:239], v8 offset:56320
    v_mfma_f32_16x16x32_bf16 v[88:91], v[144:147], v[132:135], v[88:91]
    v_mfma_f32_16x16x32_bf16 v[92:95], v[148:151], v[132:135], v[92:95]
    v_mfma_f32_16x16x32_bf16 v[96:99], v[152:155], v[132:135], v[96:99]
    v_mfma_f32_16x16x32_bf16 v[100:103], v[156:159], v[132:135], v[100:103]
    v_mfma_f32_16x16x32_bf16 v[104:107], v[160:163], v[132:135], v[104:107]
    v_mfma_f32_16x16x32_bf16 v[108:111], v[164:167], v[132:135], v[108:111]
    v_mfma_f32_16x16x32_bf16 v[112:115], v[168:171], v[132:135], v[112:115]
    v_mfma_f32_16x16x32_bf16 v[116:119], v[172:175], v[132:135], v[116:119]
    v_mfma_f32_16x16x32_bf16 v[120:123], v[176:179], v[132:135], v[120:123]
    v_mfma_f32_16x16x32_bf16 v[124:127], v[180:183], v[132:135], v[124:127]
    s_waitcnt lgkmcnt(0)
    s_barrier
    v_mfma_f32_16x16x32_bf16 v[32:35], v[192:195], v[184:187], v[32:35]
    ds_read_b128 v[128:131], v4 offset:0
    v_mfma_f32_16x16x32_bf16 v[36:39], v[196:199], v[184:187], v[36:39]
    ds_read_b128 v[132:135], v4 offset:2048
    v_mfma_f32_16x16x32_bf16 v[40:43], v[200:203], v[184:187], v[40:43]
    ds_read_b128 v[136:139], v7 offset:16384
    v_mfma_f32_16x16x32_bf16 v[44:47], v[204:207], v[184:187], v[44:47]
    ds_read_b128 v[140:143], v7 offset:18432
    v_mfma_f32_16x16x32_bf16 v[48:51], v[208:211], v[184:187], v[48:51]
    ds_read_b128 v[144:147], v7 offset:20480
    v_mfma_f32_16x16x32_bf16 v[52:55], v[212:215], v[184:187], v[52:55]
    ds_read_b128 v[148:151], v7 offset:22528
    v_mfma_f32_16x16x32_bf16 v[56:59], v[216:219], v[184:187], v[56:59]
    ds_read_b128 v[152:155], v7 offset:24576
    v_mfma_f32_16x16x32_bf16 v[60:63], v[220:223], v[184:187], v[60:63]
    ds_read_b128 v[156:159], v7 offset:26624
    v_mfma_f32_16x16x32_bf16 v[64:67], v[224:227], v[184:187], v[64:67]
    ds_read_b128 v[160:163], v7 offset:28672
    v_mfma_f32_16x16x32_bf16 v[68:71], v[228:231], v[184:187], v[68:71]
    ds_read_b128 v[164:167], v7 offset:30720
    v_mfma_f32_16x16x32_bf16 v[72:75], v[232:235], v[184:187], v[72:75]
    ds_read_b128 v[168:171], v7 offset:32768
    v_mfma_f32_16x16x32_bf16 v[76:79], v[236:239], v[184:187], v[76:79]
    ds_read_b128 v[172:175], v7 offset:34816
    v_mfma_f32_16x16x32_bf16 v[80:83], v[192:195], v[188:191], v[80:83]
    ds_read_b128 v[176:179], v7 offset:36864
    v_mfma_f32_16x16x32_bf16 v[84:87], v[196:199], v[188:191], v[84:87]
    ds_read_b128 v[180:183], v7 offset:38912
    v_mfma_f32_16x16x32_bf16 v[88:91], v[200:203], v[188:191], v[88:91]
    v_mfma_f32_16x16x32_bf16 v[92:95], v[204:207], v[188:191], v[92:95]
    v_mfma_f32_16x16x32_bf16 v[96:99], v[208:211], v[188:191], v[96:99]
    v_mfma_f32_16x16x32_bf16 v[100:103], v[212:215], v[188:191], v[100:103]
    v_mfma_f32_16x16x32_bf16 v[104:107], v[216:219], v[188:191], v[104:107]
    v_mfma_f32_16x16x32_bf16 v[108:111], v[220:223], v[188:191], v[108:111]
    v_mfma_f32_16x16x32_bf16 v[112:115], v[224:227], v[188:191], v[112:115]
    v_mfma_f32_16x16x32_bf16 v[116:119], v[228:231], v[188:191], v[116:119]
    v_mfma_f32_16x16x32_bf16 v[120:123], v[232:235], v[188:191], v[120:123]
    v_mfma_f32_16x16x32_bf16 v[124:127], v[236:239], v[188:191], v[124:127]
    s_waitcnt lgkmcnt(0)
    v_mfma_f32_16x16x32_bf16 v[32:35], v[136:139], v[128:131], v[32:35]
    ds_read_b128 v[184:187], v4 offset:1024
    v_mfma_f32_16x16x32_bf16 v[36:39], v[140:143], v[128:131], v[36:39]
    ds_read_b128 v[188:191], v4 offset:3072
    v_mfma_f32_16x16x32_bf16 v[40:43], v[144:147], v[128:131], v[40:43]
    ds_read_b128 v[192:195], v7 offset:17408
    v_mfma_f32_16x16x32_bf16 v[44:47], v[148:151], v[128:131], v[44:47]
    ds_read_b128 v[196:199], v7 offset:19456
    v_mfma_f32_16x16x32_bf16 v[48:51], v[152:155], v[128:131], v[48:51]
    ds_read_b128 v[200:203], v7 offset:21504
    v_mfma_f32_16x16x32_bf16 v[52:55], v[156:159], v[128:131], v[52:55]
    ds_read_b128 v[204:207], v7 offset:23552
    v_mfma_f32_16x16x32_bf16 v[56:59], v[160:163], v[128:131], v[56:59]
    ds_read_b128 v[208:211], v7 offset:25600
    v_mfma_f32_16x16x32_bf16 v[60:63], v[164:167], v[128:131], v[60:63]
    ds_read_b128 v[212:215], v7 offset:27648
    v_mfma_f32_16x16x32_bf16 v[64:67], v[168:171], v[128:131], v[64:67]
    ds_read_b128 v[216:219], v7 offset:29696
    v_mfma_f32_16x16x32_bf16 v[68:71], v[172:175], v[128:131], v[68:71]
    ds_read_b128 v[220:223], v7 offset:31744
    v_mfma_f32_16x16x32_bf16 v[72:75], v[176:179], v[128:131], v[72:75]
    ds_read_b128 v[224:227], v7 offset:33792
    v_mfma_f32_16x16x32_bf16 v[76:79], v[180:183], v[128:131], v[76:79]
    ds_read_b128 v[228:231], v7 offset:35840
    v_mfma_f32_16x16x32_bf16 v[80:83], v[136:139], v[132:135], v[80:83]
    ds_read_b128 v[232:235], v7 offset:37888
    v_mfma_f32_16x16x32_bf16 v[84:87], v[140:143], v[132:135], v[84:87]
    ds_read_b128 v[236:239], v7 offset:39936
    v_mfma_f32_16x16x32_bf16 v[88:91], v[144:147], v[132:135], v[88:91]
    v_mfma_f32_16x16x32_bf16 v[92:95], v[148:151], v[132:135], v[92:95]
    v_mfma_f32_16x16x32_bf16 v[96:99], v[152:155], v[132:135], v[96:99]
    v_mfma_f32_16x16x32_bf16 v[100:103], v[156:159], v[132:135], v[100:103]
    v_mfma_f32_16x16x32_bf16 v[104:107], v[160:163], v[132:135], v[104:107]
    v_mfma_f32_16x16x32_bf16 v[108:111], v[164:167], v[132:135], v[108:111]
    v_mfma_f32_16x16x32_bf16 v[112:115], v[168:171], v[132:135], v[112:115]
    v_mfma_f32_16x16x32_bf16 v[116:119], v[172:175], v[132:135], v[116:119]
    v_mfma_f32_16x16x32_bf16 v[120:123], v[176:179], v[132:135], v[120:123]
    v_mfma_f32_16x16x32_bf16 v[124:127], v[180:183], v[132:135], v[124:127]
    s_waitcnt lgkmcnt(0)
    s_barrier
    v_mfma_f32_16x16x32_bf16 v[32:35], v[192:195], v[184:187], v[32:35]
    ds_read_b128 v[128:131], v4 offset:40960
    v_mfma_f32_16x16x32_bf16 v[36:39], v[196:199], v[184:187], v[36:39]
    ds_read_b128 v[132:135], v4 offset:43008
    v_mfma_f32_16x16x32_bf16 v[40:43], v[200:203], v[184:187], v[40:43]
    ds_read_b128 v[136:139], v7 offset:57344
    v_mfma_f32_16x16x32_bf16 v[44:47], v[204:207], v[184:187], v[44:47]
    ds_read_b128 v[140:143], v7 offset:59392
    v_mfma_f32_16x16x32_bf16 v[48:51], v[208:211], v[184:187], v[48:51]
    ds_read_b128 v[144:147], v7 offset:61440
    v_mfma_f32_16x16x32_bf16 v[52:55], v[212:215], v[184:187], v[52:55]
    ds_read_b128 v[148:151], v7 offset:63488
    v_mfma_f32_16x16x32_bf16 v[56:59], v[216:219], v[184:187], v[56:59]
    ds_read_b128 v[152:155], v8 offset:0
    v_mfma_f32_16x16x32_bf16 v[60:63], v[220:223], v[184:187], v[60:63]
    ds_read_b128 v[156:159], v8 offset:2048
    v_mfma_f32_16x16x32_bf16 v[64:67], v[224:227], v[184:187], v[64:67]
    ds_read_b128 v[160:163], v8 offset:4096
    v_mfma_f32_16x16x32_bf16 v[68:71], v[228:231], v[184:187], v[68:71]
    ds_read_b128 v[164:167], v8 offset:6144
    v_mfma_f32_16x16x32_bf16 v[72:75], v[232:235], v[184:187], v[72:75]
    ds_read_b128 v[168:171], v8 offset:8192
    v_mfma_f32_16x16x32_bf16 v[76:79], v[236:239], v[184:187], v[76:79]
    ds_read_b128 v[172:175], v8 offset:10240
    v_mfma_f32_16x16x32_bf16 v[80:83], v[192:195], v[188:191], v[80:83]
    ds_read_b128 v[176:179], v8 offset:12288
    v_mfma_f32_16x16x32_bf16 v[84:87], v[196:199], v[188:191], v[84:87]
    ds_read_b128 v[180:183], v8 offset:14336
    v_mfma_f32_16x16x32_bf16 v[88:91], v[200:203], v[188:191], v[88:91]
    v_mfma_f32_16x16x32_bf16 v[92:95], v[204:207], v[188:191], v[92:95]
    v_mfma_f32_16x16x32_bf16 v[96:99], v[208:211], v[188:191], v[96:99]
    v_mfma_f32_16x16x32_bf16 v[100:103], v[212:215], v[188:191], v[100:103]
    v_mfma_f32_16x16x32_bf16 v[104:107], v[216:219], v[188:191], v[104:107]
    v_mfma_f32_16x16x32_bf16 v[108:111], v[220:223], v[188:191], v[108:111]
    v_mfma_f32_16x16x32_bf16 v[112:115], v[224:227], v[188:191], v[112:115]
    v_mfma_f32_16x16x32_bf16 v[116:119], v[228:231], v[188:191], v[116:119]
    v_mfma_f32_16x16x32_bf16 v[120:123], v[232:235], v[188:191], v[120:123]
    v_mfma_f32_16x16x32_bf16 v[124:127], v[236:239], v[188:191], v[124:127]
    s_waitcnt lgkmcnt(0)
    v_mfma_f32_16x16x32_bf16 v[32:35], v[136:139], v[128:131], v[32:35]
    ds_read_b128 v[184:187], v4 offset:41984
    v_mfma_f32_16x16x32_bf16 v[36:39], v[140:143], v[128:131], v[36:39]
    ds_read_b128 v[188:191], v4 offset:44032
    v_mfma_f32_16x16x32_bf16 v[40:43], v[144:147], v[128:131], v[40:43]
    ds_read_b128 v[192:195], v7 offset:58368
    v_mfma_f32_16x16x32_bf16 v[44:47], v[148:151], v[128:131], v[44:47]
    ds_read_b128 v[196:199], v7 offset:60416
    v_mfma_f32_16x16x32_bf16 v[48:51], v[152:155], v[128:131], v[48:51]
    ds_read_b128 v[200:203], v7 offset:62464
    v_mfma_f32_16x16x32_bf16 v[52:55], v[156:159], v[128:131], v[52:55]
    ds_read_b128 v[204:207], v7 offset:64512
    v_mfma_f32_16x16x32_bf16 v[56:59], v[160:163], v[128:131], v[56:59]
    ds_read_b128 v[208:211], v8 offset:1024
    v_mfma_f32_16x16x32_bf16 v[60:63], v[164:167], v[128:131], v[60:63]
    ds_read_b128 v[212:215], v8 offset:3072
    v_mfma_f32_16x16x32_bf16 v[64:67], v[168:171], v[128:131], v[64:67]
    ds_read_b128 v[216:219], v8 offset:5120
    v_mfma_f32_16x16x32_bf16 v[68:71], v[172:175], v[128:131], v[68:71]
    ds_read_b128 v[220:223], v8 offset:7168
    v_mfma_f32_16x16x32_bf16 v[72:75], v[176:179], v[128:131], v[72:75]
    ds_read_b128 v[224:227], v8 offset:9216
    v_mfma_f32_16x16x32_bf16 v[76:79], v[180:183], v[128:131], v[76:79]
    ds_read_b128 v[228:231], v8 offset:11264
    v_mfma_f32_16x16x32_bf16 v[80:83], v[136:139], v[132:135], v[80:83]
    ds_read_b128 v[232:235], v8 offset:13312
    v_mfma_f32_16x16x32_bf16 v[84:87], v[140:143], v[132:135], v[84:87]
    ds_read_b128 v[236:239], v8 offset:15360
    v_mfma_f32_16x16x32_bf16 v[88:91], v[144:147], v[132:135], v[88:91]
    v_mfma_f32_16x16x32_bf16 v[92:95], v[148:151], v[132:135], v[92:95]
    v_mfma_f32_16x16x32_bf16 v[96:99], v[152:155], v[132:135], v[96:99]
    v_mfma_f32_16x16x32_bf16 v[100:103], v[156:159], v[132:135], v[100:103]
    v_mfma_f32_16x16x32_bf16 v[104:107], v[160:163], v[132:135], v[104:107]
    v_mfma_f32_16x16x32_bf16 v[108:111], v[164:167], v[132:135], v[108:111]
    v_mfma_f32_16x16x32_bf16 v[112:115], v[168:171], v[132:135], v[112:115]
    v_mfma_f32_16x16x32_bf16 v[116:119], v[172:175], v[132:135], v[116:119]
    v_mfma_f32_16x16x32_bf16 v[120:123], v[176:179], v[132:135], v[120:123]
    v_mfma_f32_16x16x32_bf16 v[124:127], v[180:183], v[132:135], v[124:127]
    s_waitcnt lgkmcnt(0)
    s_barrier
    v_mfma_f32_16x16x32_bf16 v[32:35], v[192:195], v[184:187], v[32:35]
    ds_read_b128 v[128:131], v5 offset:16384
    v_mfma_f32_16x16x32_bf16 v[36:39], v[196:199], v[184:187], v[36:39]
    ds_read_b128 v[132:135], v5 offset:18432
    v_mfma_f32_16x16x32_bf16 v[40:43], v[200:203], v[184:187], v[40:43]
    ds_read_b128 v[136:139], v8 offset:32768
    v_mfma_f32_16x16x32_bf16 v[44:47], v[204:207], v[184:187], v[44:47]
    ds_read_b128 v[140:143], v8 offset:34816
    v_mfma_f32_16x16x32_bf16 v[48:51], v[208:211], v[184:187], v[48:51]
    ds_read_b128 v[144:147], v8 offset:36864
    v_mfma_f32_16x16x32_bf16 v[52:55], v[212:215], v[184:187], v[52:55]
    ds_read_b128 v[148:151], v8 offset:38912
    v_mfma_f32_16x16x32_bf16 v[56:59], v[216:219], v[184:187], v[56:59]
    ds_read_b128 v[152:155], v8 offset:40960
    v_mfma_f32_16x16x32_bf16 v[60:63], v[220:223], v[184:187], v[60:63]
    ds_read_b128 v[156:159], v8 offset:43008
    v_mfma_f32_16x16x32_bf16 v[64:67], v[224:227], v[184:187], v[64:67]
    ds_read_b128 v[160:163], v8 offset:45056
    v_mfma_f32_16x16x32_bf16 v[68:71], v[228:231], v[184:187], v[68:71]
    ds_read_b128 v[164:167], v8 offset:47104
    v_mfma_f32_16x16x32_bf16 v[72:75], v[232:235], v[184:187], v[72:75]
    ds_read_b128 v[168:171], v8 offset:49152
    v_mfma_f32_16x16x32_bf16 v[76:79], v[236:239], v[184:187], v[76:79]
    ds_read_b128 v[172:175], v8 offset:51200
    v_mfma_f32_16x16x32_bf16 v[80:83], v[192:195], v[188:191], v[80:83]
    ds_read_b128 v[176:179], v8 offset:53248
    v_mfma_f32_16x16x32_bf16 v[84:87], v[196:199], v[188:191], v[84:87]
    ds_read_b128 v[180:183], v8 offset:55296
    v_mfma_f32_16x16x32_bf16 v[88:91], v[200:203], v[188:191], v[88:91]
    v_mfma_f32_16x16x32_bf16 v[92:95], v[204:207], v[188:191], v[92:95]
    v_mfma_f32_16x16x32_bf16 v[96:99], v[208:211], v[188:191], v[96:99]
    v_mfma_f32_16x16x32_bf16 v[100:103], v[212:215], v[188:191], v[100:103]
    v_mfma_f32_16x16x32_bf16 v[104:107], v[216:219], v[188:191], v[104:107]
    v_mfma_f32_16x16x32_bf16 v[108:111], v[220:223], v[188:191], v[108:111]
    v_mfma_f32_16x16x32_bf16 v[112:115], v[224:227], v[188:191], v[112:115]
    v_mfma_f32_16x16x32_bf16 v[116:119], v[228:231], v[188:191], v[116:119]
    v_mfma_f32_16x16x32_bf16 v[120:123], v[232:235], v[188:191], v[120:123]
    v_mfma_f32_16x16x32_bf16 v[124:127], v[236:239], v[188:191], v[124:127]
    s_waitcnt lgkmcnt(0)
    v_mfma_f32_16x16x32_bf16 v[32:35], v[136:139], v[128:131], v[32:35]
    ds_read_b128 v[184:187], v5 offset:17408
    v_mfma_f32_16x16x32_bf16 v[36:39], v[140:143], v[128:131], v[36:39]
    ds_read_b128 v[188:191], v5 offset:19456
    v_mfma_f32_16x16x32_bf16 v[40:43], v[144:147], v[128:131], v[40:43]
    ds_read_b128 v[192:195], v8 offset:33792
    v_mfma_f32_16x16x32_bf16 v[44:47], v[148:151], v[128:131], v[44:47]
    ds_read_b128 v[196:199], v8 offset:35840
    v_mfma_f32_16x16x32_bf16 v[48:51], v[152:155], v[128:131], v[48:51]
    ds_read_b128 v[200:203], v8 offset:37888
    v_mfma_f32_16x16x32_bf16 v[52:55], v[156:159], v[128:131], v[52:55]
    ds_read_b128 v[204:207], v8 offset:39936
    v_mfma_f32_16x16x32_bf16 v[56:59], v[160:163], v[128:131], v[56:59]
    ds_read_b128 v[208:211], v8 offset:41984
    v_mfma_f32_16x16x32_bf16 v[60:63], v[164:167], v[128:131], v[60:63]
    ds_read_b128 v[212:215], v8 offset:44032
    v_mfma_f32_16x16x32_bf16 v[64:67], v[168:171], v[128:131], v[64:67]
    ds_read_b128 v[216:219], v8 offset:46080
    v_mfma_f32_16x16x32_bf16 v[68:71], v[172:175], v[128:131], v[68:71]
    ds_read_b128 v[220:223], v8 offset:48128
    v_mfma_f32_16x16x32_bf16 v[72:75], v[176:179], v[128:131], v[72:75]
    ds_read_b128 v[224:227], v8 offset:50176
    v_mfma_f32_16x16x32_bf16 v[76:79], v[180:183], v[128:131], v[76:79]
    ds_read_b128 v[228:231], v8 offset:52224
    v_mfma_f32_16x16x32_bf16 v[80:83], v[136:139], v[132:135], v[80:83]
    ds_read_b128 v[232:235], v8 offset:54272
    v_mfma_f32_16x16x32_bf16 v[84:87], v[140:143], v[132:135], v[84:87]
    ds_read_b128 v[236:239], v8 offset:56320
    v_mfma_f32_16x16x32_bf16 v[88:91], v[144:147], v[132:135], v[88:91]
    v_mfma_f32_16x16x32_bf16 v[92:95], v[148:151], v[132:135], v[92:95]
    v_mfma_f32_16x16x32_bf16 v[96:99], v[152:155], v[132:135], v[96:99]
    v_mfma_f32_16x16x32_bf16 v[100:103], v[156:159], v[132:135], v[100:103]
    v_mfma_f32_16x16x32_bf16 v[104:107], v[160:163], v[132:135], v[104:107]
    v_mfma_f32_16x16x32_bf16 v[108:111], v[164:167], v[132:135], v[108:111]
    v_mfma_f32_16x16x32_bf16 v[112:115], v[168:171], v[132:135], v[112:115]
    v_mfma_f32_16x16x32_bf16 v[116:119], v[172:175], v[132:135], v[116:119]
    v_mfma_f32_16x16x32_bf16 v[120:123], v[176:179], v[132:135], v[120:123]
    v_mfma_f32_16x16x32_bf16 v[124:127], v[180:183], v[132:135], v[124:127]
    s_waitcnt lgkmcnt(0)
    s_barrier
    v_mfma_f32_16x16x32_bf16 v[32:35], v[192:195], v[184:187], v[32:35]
    ds_read_b128 v[128:131], v4 offset:0
    v_mfma_f32_16x16x32_bf16 v[36:39], v[196:199], v[184:187], v[36:39]
    ds_read_b128 v[132:135], v4 offset:2048
    v_mfma_f32_16x16x32_bf16 v[40:43], v[200:203], v[184:187], v[40:43]
    ds_read_b128 v[136:139], v7 offset:16384
    v_mfma_f32_16x16x32_bf16 v[44:47], v[204:207], v[184:187], v[44:47]
    ds_read_b128 v[140:143], v7 offset:18432
    v_mfma_f32_16x16x32_bf16 v[48:51], v[208:211], v[184:187], v[48:51]
    ds_read_b128 v[144:147], v7 offset:20480
    v_mfma_f32_16x16x32_bf16 v[52:55], v[212:215], v[184:187], v[52:55]
    ds_read_b128 v[148:151], v7 offset:22528
    v_mfma_f32_16x16x32_bf16 v[56:59], v[216:219], v[184:187], v[56:59]
    ds_read_b128 v[152:155], v7 offset:24576
    v_mfma_f32_16x16x32_bf16 v[60:63], v[220:223], v[184:187], v[60:63]
    ds_read_b128 v[156:159], v7 offset:26624
    v_mfma_f32_16x16x32_bf16 v[64:67], v[224:227], v[184:187], v[64:67]
    ds_read_b128 v[160:163], v7 offset:28672
    v_mfma_f32_16x16x32_bf16 v[68:71], v[228:231], v[184:187], v[68:71]
    ds_read_b128 v[164:167], v7 offset:30720
    v_mfma_f32_16x16x32_bf16 v[72:75], v[232:235], v[184:187], v[72:75]
    ds_read_b128 v[168:171], v7 offset:32768
    v_mfma_f32_16x16x32_bf16 v[76:79], v[236:239], v[184:187], v[76:79]
    ds_read_b128 v[172:175], v7 offset:34816
    v_mfma_f32_16x16x32_bf16 v[80:83], v[192:195], v[188:191], v[80:83]
    ds_read_b128 v[176:179], v7 offset:36864
    v_mfma_f32_16x16x32_bf16 v[84:87], v[196:199], v[188:191], v[84:87]
    ds_read_b128 v[180:183], v7 offset:38912
    v_mfma_f32_16x16x32_bf16 v[88:91], v[200:203], v[188:191], v[88:91]
    v_mfma_f32_16x16x32_bf16 v[92:95], v[204:207], v[188:191], v[92:95]
    v_mfma_f32_16x16x32_bf16 v[96:99], v[208:211], v[188:191], v[96:99]
    v_mfma_f32_16x16x32_bf16 v[100:103], v[212:215], v[188:191], v[100:103]
    v_mfma_f32_16x16x32_bf16 v[104:107], v[216:219], v[188:191], v[104:107]
    v_mfma_f32_16x16x32_bf16 v[108:111], v[220:223], v[188:191], v[108:111]
    v_mfma_f32_16x16x32_bf16 v[112:115], v[224:227], v[188:191], v[112:115]
    v_mfma_f32_16x16x32_bf16 v[116:119], v[228:231], v[188:191], v[116:119]
    v_mfma_f32_16x16x32_bf16 v[120:123], v[232:235], v[188:191], v[120:123]
    v_mfma_f32_16x16x32_bf16 v[124:127], v[236:239], v[188:191], v[124:127]
    s_waitcnt lgkmcnt(0)
    v_mfma_f32_16x16x32_bf16 v[32:35], v[136:139], v[128:131], v[32:35]
    ds_read_b128 v[184:187], v4 offset:1024
    v_mfma_f32_16x16x32_bf16 v[36:39], v[140:143], v[128:131], v[36:39]
    ds_read_b128 v[188:191], v4 offset:3072
    v_mfma_f32_16x16x32_bf16 v[40:43], v[144:147], v[128:131], v[40:43]
    ds_read_b128 v[192:195], v7 offset:17408
    v_mfma_f32_16x16x32_bf16 v[44:47], v[148:151], v[128:131], v[44:47]
    ds_read_b128 v[196:199], v7 offset:19456
    v_mfma_f32_16x16x32_bf16 v[48:51], v[152:155], v[128:131], v[48:51]
    ds_read_b128 v[200:203], v7 offset:21504
    v_mfma_f32_16x16x32_bf16 v[52:55], v[156:159], v[128:131], v[52:55]
    ds_read_b128 v[204:207], v7 offset:23552
    v_mfma_f32_16x16x32_bf16 v[56:59], v[160:163], v[128:131], v[56:59]
    ds_read_b128 v[208:211], v7 offset:25600
    v_mfma_f32_16x16x32_bf16 v[60:63], v[164:167], v[128:131], v[60:63]
    ds_read_b128 v[212:215], v7 offset:27648
    v_mfma_f32_16x16x32_bf16 v[64:67], v[168:171], v[128:131], v[64:67]
    ds_read_b128 v[216:219], v7 offset:29696
    v_mfma_f32_16x16x32_bf16 v[68:71], v[172:175], v[128:131], v[68:71]
    ds_read_b128 v[220:223], v7 offset:31744
    v_mfma_f32_16x16x32_bf16 v[72:75], v[176:179], v[128:131], v[72:75]
    ds_read_b128 v[224:227], v7 offset:33792
    v_mfma_f32_16x16x32_bf16 v[76:79], v[180:183], v[128:131], v[76:79]
    ds_read_b128 v[228:231], v7 offset:35840
    v_mfma_f32_16x16x32_bf16 v[80:83], v[136:139], v[132:135], v[80:83]
    ds_read_b128 v[232:235], v7 offset:37888
    v_mfma_f32_16x16x32_bf16 v[84:87], v[140:143], v[132:135], v[84:87]
    ds_read_b128 v[236:239], v7 offset:39936
    v_mfma_f32_16x16x32_bf16 v[88:91], v[144:147], v[132:135], v[88:91]
    v_mfma_f32_16x16x32_bf16 v[92:95], v[148:151], v[132:135], v[92:95]
    v_mfma_f32_16x16x32_bf16 v[96:99], v[152:155], v[132:135], v[96:99]
    v_mfma_f32_16x16x32_bf16 v[100:103], v[156:159], v[132:135], v[100:103]
    v_mfma_f32_16x16x32_bf16 v[104:107], v[160:163], v[132:135], v[104:107]
    v_mfma_f32_16x16x32_bf16 v[108:111], v[164:167], v[132:135], v[108:111]
    v_mfma_f32_16x16x32_bf16 v[112:115], v[168:171], v[132:135], v[112:115]
    v_mfma_f32_16x16x32_bf16 v[116:119], v[172:175], v[132:135], v[116:119]
    v_mfma_f32_16x16x32_bf16 v[120:123], v[176:179], v[132:135], v[120:123]
    v_mfma_f32_16x16x32_bf16 v[124:127], v[180:183], v[132:135], v[124:127]
    s_waitcnt lgkmcnt(0)
    v_mfma_f32_16x16x32_bf16 v[32:35], v[192:195], v[184:187], v[32:35]
    v_mfma_f32_16x16x32_bf16 v[36:39], v[196:199], v[184:187], v[36:39]
    v_mfma_f32_16x16x32_bf16 v[40:43], v[200:203], v[184:187], v[40:43]
    v_mfma_f32_16x16x32_bf16 v[44:47], v[204:207], v[184:187], v[44:47]
    v_mfma_f32_16x16x32_bf16 v[48:51], v[208:211], v[184:187], v[48:51]
    v_mfma_f32_16x16x32_bf16 v[52:55], v[212:215], v[184:187], v[52:55]
    v_mfma_f32_16x16x32_bf16 v[56:59], v[216:219], v[184:187], v[56:59]
    v_mfma_f32_16x16x32_bf16 v[60:63], v[220:223], v[184:187], v[60:63]
    v_mfma_f32_16x16x32_bf16 v[64:67], v[224:227], v[184:187], v[64:67]
    v_mfma_f32_16x16x32_bf16 v[68:71], v[228:231], v[184:187], v[68:71]
    v_mfma_f32_16x16x32_bf16 v[72:75], v[232:235], v[184:187], v[72:75]
    v_mfma_f32_16x16x32_bf16 v[76:79], v[236:239], v[184:187], v[76:79]
    v_mfma_f32_16x16x32_bf16 v[80:83], v[192:195], v[188:191], v[80:83]
    v_mfma_f32_16x16x32_bf16 v[84:87], v[196:199], v[188:191], v[84:87]
    v_mfma_f32_16x16x32_bf16 v[88:91], v[200:203], v[188:191], v[88:91]
    v_mfma_f32_16x16x32_bf16 v[92:95], v[204:207], v[188:191], v[92:95]
    v_mfma_f32_16x16x32_bf16 v[96:99], v[208:211], v[188:191], v[96:99]
    v_mfma_f32_16x16x32_bf16 v[100:103], v[212:215], v[188:191], v[100:103]
    v_mfma_f32_16x16x32_bf16 v[104:107], v[216:219], v[188:191], v[104:107]
    v_mfma_f32_16x16x32_bf16 v[108:111], v[220:223], v[188:191], v[108:111]
    v_mfma_f32_16x16x32_bf16 v[112:115], v[224:227], v[188:191], v[112:115]
    v_mfma_f32_16x16x32_bf16 v[116:119], v[228:231], v[188:191], v[116:119]
    v_mfma_f32_16x16x32_bf16 v[120:123], v[232:235], v[188:191], v[120:123]
    v_mfma_f32_16x16x32_bf16 v[124:127], v[236:239], v[188:191], v[124:127]
    v_lshrrev_b32 v2, 4, v1
    v_lshlrev_b32 v26, 4, v2
    v_add_u32 v26, 123904, v26
    ds_read_b128 v[128:131], v26 offset:0
    ds_read_b128 v[132:135], v26 offset:64
    ds_read_b128 v[136:139], v26 offset:128
    ds_read_b128 v[140:143], v26 offset:192
    ds_read_b128 v[144:147], v26 offset:256
    ds_read_b128 v[148:151], v26 offset:320
    ds_read_b128 v[152:155], v26 offset:384
    ds_read_b128 v[156:159], v26 offset:448
    ds_read_b128 v[160:163], v26 offset:512
    ds_read_b128 v[164:167], v26 offset:576
    ds_read_b128 v[168:171], v26 offset:640
    ds_read_b128 v[172:175], v26 offset:704
    v_and_b32 v27, 15, v1
    v_lshlrev_b32 v27, 3, v27
    s_lshl_b32 s17, s15, 8
    s_add_u32 s17, s17, 122880
    v_add_u32 v27, s17, v27
    ds_read_b64 v[10:11], v27 offset:0
    ds_read_b64 v[14:15], v27 offset:128
    s_lshl_b32 s17, s13, 3
    s_lshl_b32 s18, s15, 1
    s_add_u32 s17, s17, s18
    s_mul_i32 s17, s17, 48
    s_mul_i32 s18, s14, 3
    s_add_u32 s17, s17, s18
    s_lshl_b32 s17, s17, 10
    s_add_u32 s17, s17, 35651584
    s_add_u32 s18, s17, 49152
    s_waitcnt lgkmcnt(0)
    v_mul_f32 v12, 0xbfb8aa3b, v11
    v_mov_b32 v13, 1.0
    v_mul_f32 v16, 0xbfb8aa3b, v15
    v_mov_b32 v17, 1.0
    v_pk_fma_f32 v[32:33], v[10:11], v[128:129], v[32:33] op_sel_hi:[0,1,1] neg_lo:[1,0,0] neg_hi:[1,0,0]
    v_pk_mul_f32 v[32:33], v[12:13], v[32:33] op_sel_hi:[0,1]
    v_exp_f32 v32, v32
    v_exp_f32 v33, v33
    v_pk_fma_f32 v[40:41], v[10:11], v[136:137], v[40:41] op_sel_hi:[0,1,1] neg_lo:[1,0,0] neg_hi:[1,0,0]
    v_pk_mul_f32 v[40:41], v[10:11], v[40:41] op_sel:[1,0] op_sel_hi:[1,1]
    v_pk_add_f32 v[32:33], v[12:13], v[32:33] op_sel:[1,0] op_sel_hi:[1,1]
    v_rcp_f32 v32, v32
    v_rcp_f32 v33, v33
    v_pk_fma_f32 v[34:35], v[10:11], v[130:131], v[34:35] op_sel_hi:[0,1,1] neg_lo:[1,0,0] neg_hi:[1,0,0]
    v_pk_mul_f32 v[34:35], v[12:13], v[34:35] op_sel_hi:[0,1]
    v_exp_f32 v34, v34
    v_exp_f32 v35, v35
    v_pk_fma_f32 v[42:43], v[10:11], v[138:139], v[42:43] op_sel_hi:[0,1,1] neg_lo:[1,0,0] neg_hi:[1,0,0]
    v_pk_mul_f32 v[42:43], v[10:11], v[42:43] op_sel:[1,0] op_sel_hi:[1,1]
    v_pk_add_f32 v[34:35], v[12:13], v[34:35] op_sel:[1,0] op_sel_hi:[1,1]
    v_rcp_f32 v34, v34
    v_rcp_f32 v35, v35
    v_pk_mul_f32 v[40:41], v[40:41], v[32:33]
    v_pk_mul_f32 v[42:43], v[42:43], v[34:35]
    v_pk_fma_f32 v[36:37], v[10:11], v[132:133], v[36:37] op_sel_hi:[0,1,1] neg_lo:[1,0,0] neg_hi:[1,0,0]
    v_pk_mul_f32 v[36:37], v[12:13], v[36:37] op_sel_hi:[0,1]
    v_exp_f32 v36, v36
    v_exp_f32 v37, v37
    v_pk_fma_f32 v[44:45], v[10:11], v[140:141], v[44:45] op_sel_hi:[0,1,1] neg_lo:[1,0,0] neg_hi:[1,0,0]
    v_pk_mul_f32 v[44:45], v[10:11], v[44:45] op_sel:[1,0] op_sel_hi:[1,1]
    v_pk_add_f32 v[36:37], v[12:13], v[36:37] op_sel:[1,0] op_sel_hi:[1,1]
    v_rcp_f32 v36, v36
    v_rcp_f32 v37, v37
    v_pk_fma_f32 v[38:39], v[10:11], v[134:135], v[38:39] op_sel_hi:[0,1,1] neg_lo:[1,0,0] neg_hi:[1,0,0]
    v_pk_mul_f32 v[38:39], v[12:13], v[38:39] op_sel_hi:[0,1]
    v_exp_f32 v38, v38
    v_exp_f32 v39, v39
    v_pk_fma_f32 v[46:47], v[10:11], v[142:143], v[46:47] op_sel_hi:[0,1,1] neg_lo:[1,0,0] neg_hi:[1,0,0]
    v_pk_mul_f32 v[46:47], v[10:11], v[46:47] op_sel:[1,0] op_sel_hi:[1,1]
    v_pk_add_f32 v[38:39], v[12:13], v[38:39] op_sel:[1,0] op_sel_hi:[1,1]
    v_rcp_f32 v38, v38
    v_rcp_f32 v39, v39
    v_pk_mul_f32 v[44:45], v[44:45], v[36:37]
    v_pk_mul_f32 v[46:47], v[46:47], v[38:39]
    v_cvt_pk_bf16_f32 v32, v40, v41
    v_cvt_pk_bf16_f32 v33, v42, v43
    v_cvt_pk_bf16_f32 v34, v44, v45
    v_cvt_pk_bf16_f32 v35, v46, v47
    buffer_store_dwordx4 v[32:35], v3, s[4:7], s17 offen offset:0
    v_pk_fma_f32 v[48:49], v[10:11], v[144:145], v[48:49] op_sel_hi:[0,1,1] neg_lo:[1,0,0] neg_hi:[1,0,0]
    v_pk_mul_f32 v[48:49], v[12:13], v[48:49] op_sel_hi:[0,1]
    v_exp_f32 v48, v48
    v_exp_f32 v49, v49
    v_pk_fma_f32 v[56:57], v[10:11], v[152:153], v[56:57] op_sel_hi:[0,1,1] neg_lo:[1,0,0] neg_hi:[1,0,0]
    v_pk_mul_f32 v[56:57], v[10:11], v[56:57] op_sel:[1,0] op_sel_hi:[1,1]
    v_pk_add_f32 v[48:49], v[12:13], v[48:49] op_sel:[1,0] op_sel_hi:[1,1]
    v_rcp_f32 v48, v48
    v_rcp_f32 v49, v49
    v_pk_fma_f32 v[50:51], v[10:11], v[146:147], v[50:51] op_sel_hi:[0,1,1] neg_lo:[1,0,0] neg_hi:[1,0,0]
    v_pk_mul_f32 v[50:51], v[12:13], v[50:51] op_sel_hi:[0,1]
    v_exp_f32 v50, v50
    v_exp_f32 v51, v51
    v_pk_fma_f32 v[58:59], v[10:11], v[154:155], v[58:59] op_sel_hi:[0,1,1] neg_lo:[1,0,0] neg_hi:[1,0,0]
    v_pk_mul_f32 v[58:59], v[10:11], v[58:59] op_sel:[1,0] op_sel_hi:[1,1]
    v_pk_add_f32 v[50:51], v[12:13], v[50:51] op_sel:[1,0] op_sel_hi:[1,1]
    v_rcp_f32 v50, v50
    v_rcp_f32 v51, v51
    v_pk_mul_f32 v[56:57], v[56:57], v[48:49]
    v_pk_mul_f32 v[58:59], v[58:59], v[50:51]
    v_pk_fma_f32 v[52:53], v[10:11], v[148:149], v[52:53] op_sel_hi:[0,1,1] neg_lo:[1,0,0] neg_hi:[1,0,0]
    v_pk_mul_f32 v[52:53], v[12:13], v[52:53] op_sel_hi:[0,1]
    v_exp_f32 v52, v52
    v_exp_f32 v53, v53
    v_pk_fma_f32 v[60:61], v[10:11], v[156:157], v[60:61] op_sel_hi:[0,1,1] neg_lo:[1,0,0] neg_hi:[1,0,0]
    v_pk_mul_f32 v[60:61], v[10:11], v[60:61] op_sel:[1,0] op_sel_hi:[1,1]
    v_pk_add_f32 v[52:53], v[12:13], v[52:53] op_sel:[1,0] op_sel_hi:[1,1]
    v_rcp_f32 v52, v52
    v_rcp_f32 v53, v53
    v_pk_fma_f32 v[54:55], v[10:11], v[150:151], v[54:55] op_sel_hi:[0,1,1] neg_lo:[1,0,0] neg_hi:[1,0,0]
    v_pk_mul_f32 v[54:55], v[12:13], v[54:55] op_sel_hi:[0,1]
    v_exp_f32 v54, v54
    v_exp_f32 v55, v55
    v_pk_fma_f32 v[62:63], v[10:11], v[158:159], v[62:63] op_sel_hi:[0,1,1] neg_lo:[1,0,0] neg_hi:[1,0,0]
    v_pk_mul_f32 v[62:63], v[10:11], v[62:63] op_sel:[1,0] op_sel_hi:[1,1]
    v_pk_add_f32 v[54:55], v[12:13], v[54:55] op_sel:[1,0] op_sel_hi:[1,1]
    v_rcp_f32 v54, v54
    v_rcp_f32 v55, v55
    v_pk_mul_f32 v[60:61], v[60:61], v[52:53]
    v_pk_mul_f32 v[62:63], v[62:63], v[54:55]
    v_cvt_pk_bf16_f32 v48, v56, v57
    v_cvt_pk_bf16_f32 v49, v58, v59
    v_cvt_pk_bf16_f32 v50, v60, v61
    v_cvt_pk_bf16_f32 v51, v62, v63
    buffer_store_dwordx4 v[48:51], v3, s[4:7], s17 offen offset:1024
    v_pk_fma_f32 v[64:65], v[10:11], v[160:161], v[64:65] op_sel_hi:[0,1,1] neg_lo:[1,0,0] neg_hi:[1,0,0]
    v_pk_mul_f32 v[64:65], v[12:13], v[64:65] op_sel_hi:[0,1]
    v_exp_f32 v64, v64
    v_exp_f32 v65, v65
    v_pk_fma_f32 v[72:73], v[10:11], v[168:169], v[72:73] op_sel_hi:[0,1,1] neg_lo:[1,0,0] neg_hi:[1,0,0]
    v_pk_mul_f32 v[72:73], v[10:11], v[72:73] op_sel:[1,0] op_sel_hi:[1,1]
    v_pk_add_f32 v[64:65], v[12:13], v[64:65] op_sel:[1,0] op_sel_hi:[1,1]
    v_rcp_f32 v64, v64
    v_rcp_f32 v65, v65
    v_pk_fma_f32 v[66:67], v[10:11], v[162:163], v[66:67] op_sel_hi:[0,1,1] neg_lo:[1,0,0] neg_hi:[1,0,0]
    v_pk_mul_f32 v[66:67], v[12:13], v[66:67] op_sel_hi:[0,1]
    v_exp_f32 v66, v66
    v_exp_f32 v67, v67
    v_pk_fma_f32 v[74:75], v[10:11], v[170:171], v[74:75] op_sel_hi:[0,1,1] neg_lo:[1,0,0] neg_hi:[1,0,0]
    v_pk_mul_f32 v[74:75], v[10:11], v[74:75] op_sel:[1,0] op_sel_hi:[1,1]
    v_pk_add_f32 v[66:67], v[12:13], v[66:67] op_sel:[1,0] op_sel_hi:[1,1]
    v_rcp_f32 v66, v66
    v_rcp_f32 v67, v67
    v_pk_mul_f32 v[72:73], v[72:73], v[64:65]
    v_pk_mul_f32 v[74:75], v[74:75], v[66:67]
    v_pk_fma_f32 v[68:69], v[10:11], v[164:165], v[68:69] op_sel_hi:[0,1,1] neg_lo:[1,0,0] neg_hi:[1,0,0]
    v_pk_mul_f32 v[68:69], v[12:13], v[68:69] op_sel_hi:[0,1]
    v_exp_f32 v68, v68
    v_exp_f32 v69, v69
    v_pk_fma_f32 v[76:77], v[10:11], v[172:173], v[76:77] op_sel_hi:[0,1,1] neg_lo:[1,0,0] neg_hi:[1,0,0]
    v_pk_mul_f32 v[76:77], v[10:11], v[76:77] op_sel:[1,0] op_sel_hi:[1,1]
    v_pk_add_f32 v[68:69], v[12:13], v[68:69] op_sel:[1,0] op_sel_hi:[1,1]
    v_rcp_f32 v68, v68
    v_rcp_f32 v69, v69
    v_pk_fma_f32 v[70:71], v[10:11], v[166:167], v[70:71] op_sel_hi:[0,1,1] neg_lo:[1,0,0] neg_hi:[1,0,0]
    v_pk_mul_f32 v[70:71], v[12:13], v[70:71] op_sel_hi:[0,1]
    v_exp_f32 v70, v70
    v_exp_f32 v71, v71
    v_pk_fma_f32 v[78:79], v[10:11], v[174:175], v[78:79] op_sel_hi:[0,1,1] neg_lo:[1,0,0] neg_hi:[1,0,0]
    v_pk_mul_f32 v[78:79], v[10:11], v[78:79] op_sel:[1,0] op_sel_hi:[1,1]
    v_pk_add_f32 v[70:71], v[12:13], v[70:71] op_sel:[1,0] op_sel_hi:[1,1]
    v_rcp_f32 v70, v70
    v_rcp_f32 v71, v71
    v_pk_mul_f32 v[76:77], v[76:77], v[68:69]
    v_pk_mul_f32 v[78:79], v[78:79], v[70:71]
    v_cvt_pk_bf16_f32 v64, v72, v73
    v_cvt_pk_bf16_f32 v65, v74, v75
    v_cvt_pk_bf16_f32 v66, v76, v77
    v_cvt_pk_bf16_f32 v67, v78, v79
    buffer_store_dwordx4 v[64:67], v3, s[4:7], s17 offen offset:2048
    v_pk_fma_f32 v[80:81], v[14:15], v[128:129], v[80:81] op_sel_hi:[0,1,1] neg_lo:[1,0,0] neg_hi:[1,0,0]
    v_pk_mul_f32 v[80:81], v[16:17], v[80:81] op_sel_hi:[0,1]
    v_exp_f32 v80, v80
    v_exp_f32 v81, v81
    v_pk_fma_f32 v[88:89], v[14:15], v[136:137], v[88:89] op_sel_hi:[0,1,1] neg_lo:[1,0,0] neg_hi:[1,0,0]
    v_pk_mul_f32 v[88:89], v[14:15], v[88:89] op_sel:[1,0] op_sel_hi:[1,1]
    v_pk_add_f32 v[80:81], v[16:17], v[80:81] op_sel:[1,0] op_sel_hi:[1,1]
    v_rcp_f32 v80, v80
    v_rcp_f32 v81, v81
    v_pk_fma_f32 v[82:83], v[14:15], v[130:131], v[82:83] op_sel_hi:[0,1,1] neg_lo:[1,0,0] neg_hi:[1,0,0]
    v_pk_mul_f32 v[82:83], v[16:17], v[82:83] op_sel_hi:[0,1]
    v_exp_f32 v82, v82
    v_exp_f32 v83, v83
    v_pk_fma_f32 v[90:91], v[14:15], v[138:139], v[90:91] op_sel_hi:[0,1,1] neg_lo:[1,0,0] neg_hi:[1,0,0]
    v_pk_mul_f32 v[90:91], v[14:15], v[90:91] op_sel:[1,0] op_sel_hi:[1,1]
    v_pk_add_f32 v[82:83], v[16:17], v[82:83] op_sel:[1,0] op_sel_hi:[1,1]
    v_rcp_f32 v82, v82
    v_rcp_f32 v83, v83
    v_pk_mul_f32 v[88:89], v[88:89], v[80:81]
    v_pk_mul_f32 v[90:91], v[90:91], v[82:83]
    v_pk_fma_f32 v[84:85], v[14:15], v[132:133], v[84:85] op_sel_hi:[0,1,1] neg_lo:[1,0,0] neg_hi:[1,0,0]
    v_pk_mul_f32 v[84:85], v[16:17], v[84:85] op_sel_hi:[0,1]
    v_exp_f32 v84, v84
    v_exp_f32 v85, v85
    v_pk_fma_f32 v[92:93], v[14:15], v[140:141], v[92:93] op_sel_hi:[0,1,1] neg_lo:[1,0,0] neg_hi:[1,0,0]
    v_pk_mul_f32 v[92:93], v[14:15], v[92:93] op_sel:[1,0] op_sel_hi:[1,1]
    v_pk_add_f32 v[84:85], v[16:17], v[84:85] op_sel:[1,0] op_sel_hi:[1,1]
    v_rcp_f32 v84, v84
    v_rcp_f32 v85, v85
    v_pk_fma_f32 v[86:87], v[14:15], v[134:135], v[86:87] op_sel_hi:[0,1,1] neg_lo:[1,0,0] neg_hi:[1,0,0]
    v_pk_mul_f32 v[86:87], v[16:17], v[86:87] op_sel_hi:[0,1]
    v_exp_f32 v86, v86
    v_exp_f32 v87, v87
    v_pk_fma_f32 v[94:95], v[14:15], v[142:143], v[94:95] op_sel_hi:[0,1,1] neg_lo:[1,0,0] neg_hi:[1,0,0]
    v_pk_mul_f32 v[94:95], v[14:15], v[94:95] op_sel:[1,0] op_sel_hi:[1,1]
    v_pk_add_f32 v[86:87], v[16:17], v[86:87] op_sel:[1,0] op_sel_hi:[1,1]
    v_rcp_f32 v86, v86
    v_rcp_f32 v87, v87
    v_pk_mul_f32 v[92:93], v[92:93], v[84:85]
    v_pk_mul_f32 v[94:95], v[94:95], v[86:87]
    v_cvt_pk_bf16_f32 v80, v88, v89
    v_cvt_pk_bf16_f32 v81, v90, v91
    v_cvt_pk_bf16_f32 v82, v92, v93
    v_cvt_pk_bf16_f32 v83, v94, v95
    buffer_store_dwordx4 v[80:83], v3, s[4:7], s18 offen offset:0
    v_pk_fma_f32 v[96:97], v[14:15], v[144:145], v[96:97] op_sel_hi:[0,1,1] neg_lo:[1,0,0] neg_hi:[1,0,0]
    v_pk_mul_f32 v[96:97], v[16:17], v[96:97] op_sel_hi:[0,1]
    v_exp_f32 v96, v96
    v_exp_f32 v97, v97
    v_pk_fma_f32 v[104:105], v[14:15], v[152:153], v[104:105] op_sel_hi:[0,1,1] neg_lo:[1,0,0] neg_hi:[1,0,0]
    v_pk_mul_f32 v[104:105], v[14:15], v[104:105] op_sel:[1,0] op_sel_hi:[1,1]
    v_pk_add_f32 v[96:97], v[16:17], v[96:97] op_sel:[1,0] op_sel_hi:[1,1]
    v_rcp_f32 v96, v96
    v_rcp_f32 v97, v97
    v_pk_fma_f32 v[98:99], v[14:15], v[146:147], v[98:99] op_sel_hi:[0,1,1] neg_lo:[1,0,0] neg_hi:[1,0,0]
    v_pk_mul_f32 v[98:99], v[16:17], v[98:99] op_sel_hi:[0,1]
    v_exp_f32 v98, v98
    v_exp_f32 v99, v99
    v_pk_fma_f32 v[106:107], v[14:15], v[154:155], v[106:107] op_sel_hi:[0,1,1] neg_lo:[1,0,0] neg_hi:[1,0,0]
    v_pk_mul_f32 v[106:107], v[14:15], v[106:107] op_sel:[1,0] op_sel_hi:[1,1]
    v_pk_add_f32 v[98:99], v[16:17], v[98:99] op_sel:[1,0] op_sel_hi:[1,1]
    v_rcp_f32 v98, v98
    v_rcp_f32 v99, v99
    v_pk_mul_f32 v[104:105], v[104:105], v[96:97]
    v_pk_mul_f32 v[106:107], v[106:107], v[98:99]
    v_pk_fma_f32 v[100:101], v[14:15], v[148:149], v[100:101] op_sel_hi:[0,1,1] neg_lo:[1,0,0] neg_hi:[1,0,0]
    v_pk_mul_f32 v[100:101], v[16:17], v[100:101] op_sel_hi:[0,1]
    v_exp_f32 v100, v100
    v_exp_f32 v101, v101
    v_pk_fma_f32 v[108:109], v[14:15], v[156:157], v[108:109] op_sel_hi:[0,1,1] neg_lo:[1,0,0] neg_hi:[1,0,0]
    v_pk_mul_f32 v[108:109], v[14:15], v[108:109] op_sel:[1,0] op_sel_hi:[1,1]
    v_pk_add_f32 v[100:101], v[16:17], v[100:101] op_sel:[1,0] op_sel_hi:[1,1]
    v_rcp_f32 v100, v100
    v_rcp_f32 v101, v101
    v_pk_fma_f32 v[102:103], v[14:15], v[150:151], v[102:103] op_sel_hi:[0,1,1] neg_lo:[1,0,0] neg_hi:[1,0,0]
    v_pk_mul_f32 v[102:103], v[16:17], v[102:103] op_sel_hi:[0,1]
    v_exp_f32 v102, v102
    v_exp_f32 v103, v103
    v_pk_fma_f32 v[110:111], v[14:15], v[158:159], v[110:111] op_sel_hi:[0,1,1] neg_lo:[1,0,0] neg_hi:[1,0,0]
    v_pk_mul_f32 v[110:111], v[14:15], v[110:111] op_sel:[1,0] op_sel_hi:[1,1]
    v_pk_add_f32 v[102:103], v[16:17], v[102:103] op_sel:[1,0] op_sel_hi:[1,1]
    v_rcp_f32 v102, v102
    v_rcp_f32 v103, v103
    v_pk_mul_f32 v[108:109], v[108:109], v[100:101]
    v_pk_mul_f32 v[110:111], v[110:111], v[102:103]
    v_cvt_pk_bf16_f32 v96, v104, v105
    v_cvt_pk_bf16_f32 v97, v106, v107
    v_cvt_pk_bf16_f32 v98, v108, v109
    v_cvt_pk_bf16_f32 v99, v110, v111
    buffer_store_dwordx4 v[96:99], v3, s[4:7], s18 offen offset:1024
    v_pk_fma_f32 v[112:113], v[14:15], v[160:161], v[112:113] op_sel_hi:[0,1,1] neg_lo:[1,0,0] neg_hi:[1,0,0]
    v_pk_mul_f32 v[112:113], v[16:17], v[112:113] op_sel_hi:[0,1]
    v_exp_f32 v112, v112
    v_exp_f32 v113, v113
    v_pk_fma_f32 v[120:121], v[14:15], v[168:169], v[120:121] op_sel_hi:[0,1,1] neg_lo:[1,0,0] neg_hi:[1,0,0]
    v_pk_mul_f32 v[120:121], v[14:15], v[120:121] op_sel:[1,0] op_sel_hi:[1,1]
    v_pk_add_f32 v[112:113], v[16:17], v[112:113] op_sel:[1,0] op_sel_hi:[1,1]
    v_rcp_f32 v112, v112
    v_rcp_f32 v113, v113
    v_pk_fma_f32 v[114:115], v[14:15], v[162:163], v[114:115] op_sel_hi:[0,1,1] neg_lo:[1,0,0] neg_hi:[1,0,0]
    v_pk_mul_f32 v[114:115], v[16:17], v[114:115] op_sel_hi:[0,1]
    v_exp_f32 v114, v114
    v_exp_f32 v115, v115
    v_pk_fma_f32 v[122:123], v[14:15], v[170:171], v[122:123] op_sel_hi:[0,1,1] neg_lo:[1,0,0] neg_hi:[1,0,0]
    v_pk_mul_f32 v[122:123], v[14:15], v[122:123] op_sel:[1,0] op_sel_hi:[1,1]
    v_pk_add_f32 v[114:115], v[16:17], v[114:115] op_sel:[1,0] op_sel_hi:[1,1]
    v_rcp_f32 v114, v114
    v_rcp_f32 v115, v115
    v_pk_mul_f32 v[120:121], v[120:121], v[112:113]
    v_pk_mul_f32 v[122:123], v[122:123], v[114:115]
    v_pk_fma_f32 v[116:117], v[14:15], v[164:165], v[116:117] op_sel_hi:[0,1,1] neg_lo:[1,0,0] neg_hi:[1,0,0]
    v_pk_mul_f32 v[116:117], v[16:17], v[116:117] op_sel_hi:[0,1]
    v_exp_f32 v116, v116
    v_exp_f32 v117, v117
    v_pk_fma_f32 v[124:125], v[14:15], v[172:173], v[124:125] op_sel_hi:[0,1,1] neg_lo:[1,0,0] neg_hi:[1,0,0]
    v_pk_mul_f32 v[124:125], v[14:15], v[124:125] op_sel:[1,0] op_sel_hi:[1,1]
    v_pk_add_f32 v[116:117], v[16:17], v[116:117] op_sel:[1,0] op_sel_hi:[1,1]
    v_rcp_f32 v116, v116
    v_rcp_f32 v117, v117
    v_pk_fma_f32 v[118:119], v[14:15], v[166:167], v[118:119] op_sel_hi:[0,1,1] neg_lo:[1,0,0] neg_hi:[1,0,0]
    v_pk_mul_f32 v[118:119], v[16:17], v[118:119] op_sel_hi:[0,1]
    v_exp_f32 v118, v118
    v_exp_f32 v119, v119
    v_pk_fma_f32 v[126:127], v[14:15], v[174:175], v[126:127] op_sel_hi:[0,1,1] neg_lo:[1,0,0] neg_hi:[1,0,0]
    v_pk_mul_f32 v[126:127], v[14:15], v[126:127] op_sel:[1,0] op_sel_hi:[1,1]
    v_pk_add_f32 v[118:119], v[16:17], v[118:119] op_sel:[1,0] op_sel_hi:[1,1]
    v_rcp_f32 v118, v118
    v_rcp_f32 v119, v119
    v_pk_mul_f32 v[124:125], v[124:125], v[116:117]
    v_pk_mul_f32 v[126:127], v[126:127], v[118:119]
    v_cvt_pk_bf16_f32 v112, v120, v121
    v_cvt_pk_bf16_f32 v113, v122, v123
    v_cvt_pk_bf16_f32 v114, v124, v125
    v_cvt_pk_bf16_f32 v115, v126, v127
    buffer_store_dwordx4 v[112:115], v3, s[4:7], s18 offen offset:2048
    s_nop 3
gu2_kernel_end:
    s_endpgm

.text
.globl dn2_kernel
.p2align 8
.type dn2_kernel,@function
dn2_kernel:
    s_cmp_ge_u32 s2, 256
    s_cbranch_scc1 dn2_kernel_end
    s_load_dwordx2 s[4:5], s[0:1], 72
    s_load_dwordx2 s[8:9], s[0:1], 56
    v_lshrrev_b32 v2, 6, v0
    s_nop 0
    v_readfirstlane_b32 s12, v2
    v_and_b32 v1, 63, v0
    v_lshlrev_b32 v3, 4, v1
    s_and_b32 s17, s2, 7
    s_lshr_b32 s18, s2, 3
    s_and_b32 s19, s17, 1
    s_lshr_b32 s17, s17, 1
    s_mul_i32 s19, s19, 32
    s_add_u32 s18, s18, s19
    s_and_b32 s13, s18, 7
    s_lshl_b32 s17, s17, 3
    s_add_u32 s13, s13, s17
    s_lshr_b32 s14, s18, 3
    s_cmp_lt_u32 s12, 4
    s_cbranch_scc1 dn2_kernel_comp
    s_sub_u32 s12, s12, 4
    s_add_u32 s18, s12, 0
    s_mul_i32 s56, s18, 2048
    s_mul_i32 s20, s13, 4
    s_add_u32 s20, s20, s18
    s_mul_i32 s20, s20, 49152
    s_add_u32 s20, s20, 35651584
    s_mul_i32 s21, s14, 5
    s_add_u32 s21, s21, s18
    s_sub_u32 s21, s21, 4
    s_mul_i32 s21, s21, 49152
    s_add_u32 s21, s21, 7274496
    s_cmp_lt_u32 s18, 4
    s_cselect_b32 s24, s20, s21
    s_add_u32 s18, s12, 2
    s_mul_i32 s57, s18, 2048
    s_mul_i32 s20, s13, 4
    s_add_u32 s20, s20, s18
    s_mul_i32 s20, s20, 49152
    s_add_u32 s20, s20, 35651584
    s_mul_i32 s21, s14, 5
    s_add_u32 s21, s21, s18
    s_sub_u32 s21, s21, 4
    s_mul_i32 s21, s21, 49152
    s_add_u32 s21, s21, 7274496
    s_cmp_lt_u32 s18, 4
    s_cselect_b32 s25, s20, s21
    s_add_u32 s18, s12, 4
    s_mul_i32 s58, s18, 2048
    s_mul_i32 s20, s13, 4
    s_add_u32 s20, s20, s18
    s_mul_i32 s20, s20, 49152
    s_add_u32 s20, s20, 35651584
    s_mul_i32 s21, s14, 5
    s_add_u32 s21, s21, s18
    s_sub_u32 s21, s21, 4
    s_mul_i32 s21, s21, 49152
    s_add_u32 s21, s21, 7274496
    s_cmp_lt_u32 s18, 4
    s_cselect_b32 s26, s20, s21
    s_add_u32 s18, s12, 6
    s_mul_i32 s59, s18, 2048
    s_mul_i32 s20, s13, 4
    s_add_u32 s20, s20, s18
    s_mul_i32 s20, s20, 49152
    s_add_u32 s20, s20, 35651584
    s_mul_i32 s21, s14, 5
    s_add_u32 s21, s21, s18
    s_sub_u32 s21, s21, 4
    s_mul_i32 s21, s21, 49152
    s_add_u32 s21, s21, 7274496
    s_cmp_lt_u32 s18, 4
    s_cselect_b32 s27, s20, s21
    s_mov_b32 s18, 8
    s_mul_i32 s60, s18, 2048
    s_mul_i32 s20, s13, 4
    s_add_u32 s20, s20, s18
    s_mul_i32 s20, s20, 49152
    s_add_u32 s20, s20, 35651584
    s_mul_i32 s21, s14, 5
    s_add_u32 s21, s21, s18
    s_sub_u32 s21, s21, 4
    s_mul_i32 s21, s21, 49152
    s_add_u32 s21, s21, 7274496
    s_cmp_lt_u32 s18, 4
    s_cselect_b32 s28, s20, s21
    s_lshl_b32 s18, s12, 10
    s_add_u32 s28, s28, s18
    s_add_u32 s60, s60, s18
    s_waitcnt lgkmcnt(0)
    s_and_b32 s5, s5, 0xffff
    s_mov_b32 s6, 268435456
    s_mov_b32 s7, 0x00020000
    s_add_u32 m0, s56, 0
    s_add_u32 s22, s24, 0
    buffer_load_dwordx4 v3, s[4:7], s22 offen offset:0 lds
    buffer_load_dwordx4 v3, s[4:7], s22 offen offset:1024 lds
    s_add_u32 m0, s57, 0
    s_add_u32 s23, s25, 0
    buffer_load_dwordx4 v3, s[4:7], s23 offen offset:0 lds
    buffer_load_dwordx4 v3, s[4:7], s23 offen offset:1024 lds
    s_add_u32 m0, s58, 0
    s_add_u32 s22, s26, 0
    buffer_load_dwordx4 v3, s[4:7], s22 offen offset:0 lds
    buffer_load_dwordx4 v3, s[4:7], s22 offen offset:1024 lds
    s_add_u32 m0, s59, 0
    s_add_u32 s23, s27, 0
    buffer_load_dwordx4 v3, s[4:7], s23 offen offset:0 lds
    buffer_load_dwordx4 v3, s[4:7], s23 offen offset:1024 lds
    s_add_u32 m0, s60, 0
    s_add_u32 s22, s28, 0
    buffer_load_dwordx4 v3, s[4:7], s22 offen offset:0 lds
    s_add_u32 m0, s56, 18432
    s_add_u32 s22, s24, 2048
    buffer_load_dwordx4 v3, s[4:7], s22 offen offset:0 lds
    buffer_load_dwordx4 v3, s[4:7], s22 offen offset:1024 lds
    s_add_u32 m0, s57, 18432
    s_add_u32 s23, s25, 2048
    buffer_load_dwordx4 v3, s[4:7], s23 offen offset:0 lds
    buffer_load_dwordx4 v3, s[4:7], s23 offen offset:1024 lds
    s_add_u32 m0, s58, 18432
    s_add_u32 s22, s26, 2048
    buffer_load_dwordx4 v3, s[4:7], s22 offen offset:0 lds
    buffer_load_dwordx4 v3, s[4:7], s22 offen offset:1024 lds
    s_add_u32 m0, s59, 18432
    s_add_u32 s23, s27, 2048
    buffer_load_dwordx4 v3, s[4:7], s23 offen offset:0 lds
    buffer_load_dwordx4 v3, s[4:7], s23 offen offset:1024 lds
    s_add_u32 m0, s60, 18432
    s_add_u32 s22, s28, 2048
    buffer_load_dwordx4 v3, s[4:7], s22 offen offset:0 lds
    s_add_u32 m0, s56, 36864
    s_add_u32 s22, s24, 4096
    buffer_load_dwordx4 v3, s[4:7], s22 offen offset:0 lds
    buffer_load_dwordx4 v3, s[4:7], s22 offen offset:1024 lds
    s_add_u32 m0, s57, 36864
    s_add_u32 s23, s25, 4096
    buffer_load_dwordx4 v3, s[4:7], s23 offen offset:0 lds
    buffer_load_dwordx4 v3, s[4:7], s23 offen offset:1024 lds
    s_add_u32 m0, s58, 36864
    s_add_u32 s22, s26, 4096
    buffer_load_dwordx4 v3, s[4:7], s22 offen offset:0 lds
    buffer_load_dwordx4 v3, s[4:7], s22 offen offset:1024 lds
    s_add_u32 m0, s59, 36864
    s_add_u32 s23, s27, 4096
    buffer_load_dwordx4 v3, s[4:7], s23 offen offset:0 lds
    buffer_load_dwordx4 v3, s[4:7], s23 offen offset:1024 lds
    s_add_u32 m0, s60, 36864
    s_add_u32 s22, s28, 4096
    buffer_load_dwordx4 v3, s[4:7], s22 offen offset:0 lds
    s_waitcnt vmcnt(18)
    s_barrier
    s_add_u32 m0, s56, 55296
    s_add_u32 s22, s24, 6144
    buffer_load_dwordx4 v3, s[4:7], s22 offen offset:0 lds
    buffer_load_dwordx4 v3, s[4:7], s22 offen offset:1024 lds
    s_add_u32 m0, s57, 55296
    s_add_u32 s23, s25, 6144
    buffer_load_dwordx4 v3, s[4:7], s23 offen offset:0 lds
    buffer_load_dwordx4 v3, s[4:7], s23 offen offset:1024 lds
    s_add_u32 m0, s58, 55296
    s_add_u32 s22, s26, 6144
    buffer_load_dwordx4 v3, s[4:7], s22 offen offset:0 lds
    buffer_load_dwordx4 v3, s[4:7], s22 offen offset:1024 lds
    s_add_u32 m0, s59, 55296
    s_add_u32 s23, s27, 6144
    buffer_load_dwordx4 v3, s[4:7], s23 offen offset:0 lds
    buffer_load_dwordx4 v3, s[4:7], s23 offen offset:1024 lds
    s_add_u32 m0, s60, 55296
    s_add_u32 s22, s28, 6144
    buffer_load_dwordx4 v3, s[4:7], s22 offen offset:0 lds
    s_add_u32 m0, s56, 73728
    s_add_u32 s22, s24, 8192
    buffer_load_dwordx4 v3, s[4:7], s22 offen offset:0 lds
    buffer_load_dwordx4 v3, s[4:7], s22 offen offset:1024 lds
    s_add_u32 m0, s57, 73728
    s_add_u32 s23, s25, 8192
    buffer_load_dwordx4 v3, s[4:7], s23 offen offset:0 lds
    buffer_load_dwordx4 v3, s[4:7], s23 offen offset:1024 lds
    s_add_u32 m0, s58, 73728
    s_add_u32 s22, s26, 8192
    buffer_load_dwordx4 v3, s[4:7], s22 offen offset:0 lds
    buffer_load_dwordx4 v3, s[4:7], s22 offen offset:1024 lds
    s_add_u32 m0, s59, 73728
    s_add_u32 s23, s27, 8192
    buffer_load_dwordx4 v3, s[4:7], s23 offen offset:0 lds
    buffer_load_dwordx4 v3, s[4:7], s23 offen offset:1024 lds
    s_add_u32 m0, s60, 73728
    s_add_u32 s22, s28, 8192
    buffer_load_dwordx4 v3, s[4:7], s22 offen offset:0 lds
    s_add_u32 m0, s56, 92160
    s_add_u32 s22, s24, 10240
    buffer_load_dwordx4 v3, s[4:7], s22 offen offset:0 lds
    buffer_load_dwordx4 v3, s[4:7], s22 offen offset:1024 lds
    s_add_u32 m0, s57, 92160
    s_add_u32 s23, s25, 10240
    buffer_load_dwordx4 v3, s[4:7], s23 offen offset:0 lds
    buffer_load_dwordx4 v3, s[4:7], s23 offen offset:1024 lds
    s_add_u32 m0, s58, 92160
    s_add_u32 s22, s26, 10240
    buffer_load_dwordx4 v3, s[4:7], s22 offen offset:0 lds
    buffer_load_dwordx4 v3, s[4:7], s22 offen offset:1024 lds
    s_add_u32 m0, s59, 92160
    s_add_u32 s23, s27, 10240
    buffer_load_dwordx4 v3, s[4:7], s23 offen offset:0 lds
    buffer_load_dwordx4 v3, s[4:7], s23 offen offset:1024 lds
    s_add_u32 m0, s60, 92160
    s_add_u32 s22, s28, 10240
    buffer_load_dwordx4 v3, s[4:7], s22 offen offset:0 lds
    s_waitcnt vmcnt(36)
    s_barrier
    s_add_u32 m0, s56, 110592
    s_add_u32 s22, s24, 12288
    buffer_load_dwordx4 v3, s[4:7], s22 offen offset:0 lds
    buffer_load_dwordx4 v3, s[4:7], s22 offen offset:1024 lds
    s_add_u32 m0, s57, 110592
    s_add_u32 s23, s25, 12288
    buffer_load_dwordx4 v3, s[4:7], s23 offen offset:0 lds
    buffer_load_dwordx4 v3, s[4:7], s23 offen offset:1024 lds
    s_add_u32 m0, s58, 110592
    s_add_u32 s22, s26, 12288
    buffer_load_dwordx4 v3, s[4:7], s22 offen offset:0 lds
    buffer_load_dwordx4 v3, s[4:7], s22 offen offset:1024 lds
    s_add_u32 m0, s59, 110592
    s_add_u32 s23, s27, 12288
    buffer_load_dwordx4 v3, s[4:7], s23 offen offset:0 lds
    buffer_load_dwordx4 v3, s[4:7], s23 offen offset:1024 lds
    s_add_u32 m0, s60, 110592
    s_add_u32 s22, s28, 12288
    buffer_load_dwordx4 v3, s[4:7], s22 offen offset:0 lds
    s_add_u32 m0, s56, 129024
    s_add_u32 s22, s24, 14336
    buffer_load_dwordx4 v3, s[4:7], s22 offen offset:0 lds
    buffer_load_dwordx4 v3, s[4:7], s22 offen offset:1024 lds
    s_add_u32 m0, s57, 129024
    s_add_u32 s23, s25, 14336
    buffer_load_dwordx4 v3, s[4:7], s23 offen offset:0 lds
    buffer_load_dwordx4 v3, s[4:7], s23 offen offset:1024 lds
    s_add_u32 m0, s58, 129024
    s_add_u32 s22, s26, 14336
    buffer_load_dwordx4 v3, s[4:7], s22 offen offset:0 lds
    buffer_load_dwordx4 v3, s[4:7], s22 offen offset:1024 lds
    s_add_u32 m0, s59, 129024
    s_add_u32 s23, s27, 14336
    buffer_load_dwordx4 v3, s[4:7], s23 offen offset:0 lds
    buffer_load_dwordx4 v3, s[4:7], s23 offen offset:1024 lds
    s_add_u32 m0, s60, 129024
    s_add_u32 s22, s28, 14336
    buffer_load_dwordx4 v3, s[4:7], s22 offen offset:0 lds
    s_add_u32 m0, s56, 0
    s_add_u32 s22, s24, 16384
    buffer_load_dwordx4 v3, s[4:7], s22 offen offset:0 lds
    buffer_load_dwordx4 v3, s[4:7], s22 offen offset:1024 lds
    s_add_u32 m0, s57, 0
    s_add_u32 s23, s25, 16384
    buffer_load_dwordx4 v3, s[4:7], s23 offen offset:0 lds
    buffer_load_dwordx4 v3, s[4:7], s23 offen offset:1024 lds
    s_add_u32 m0, s58, 0
    s_add_u32 s22, s26, 16384
    buffer_load_dwordx4 v3, s[4:7], s22 offen offset:0 lds
    buffer_load_dwordx4 v3, s[4:7], s22 offen offset:1024 lds
    s_add_u32 m0, s59, 0
    s_add_u32 s23, s27, 16384
    buffer_load_dwordx4 v3, s[4:7], s23 offen offset:0 lds
    buffer_load_dwordx4 v3, s[4:7], s23 offen offset:1024 lds
    s_add_u32 m0, s60, 0
    s_add_u32 s22, s28, 16384
    buffer_load_dwordx4 v3, s[4:7], s22 offen offset:0 lds
    s_waitcnt vmcnt(54)
    s_barrier
    s_add_u32 m0, s56, 18432
    s_add_u32 s22, s24, 18432
    buffer_load_dwordx4 v3, s[4:7], s22 offen offset:0 lds
    buffer_load_dwordx4 v3, s[4:7], s22 offen offset:1024 lds
    s_add_u32 m0, s57, 18432
    s_add_u32 s23, s25, 18432
    buffer_load_dwordx4 v3, s[4:7], s23 offen offset:0 lds
    buffer_load_dwordx4 v3, s[4:7], s23 offen offset:1024 lds
    s_add_u32 m0, s58, 18432
    s_add_u32 s22, s26, 18432
    buffer_load_dwordx4 v3, s[4:7], s22 offen offset:0 lds
    buffer_load_dwordx4 v3, s[4:7], s22 offen offset:1024 lds
    s_add_u32 m0, s59, 18432
    s_add_u32 s23, s27, 18432
    buffer_load_dwordx4 v3, s[4:7], s23 offen offset:0 lds
    buffer_load_dwordx4 v3, s[4:7], s23 offen offset:1024 lds
    s_add_u32 m0, s60, 18432
    s_add_u32 s22, s28, 18432
    buffer_load_dwordx4 v3, s[4:7], s22 offen offset:0 lds
    s_waitcnt vmcnt(54)
    s_barrier
    s_add_u32 m0, s56, 36864
    s_add_u32 s22, s24, 20480
    buffer_load_dwordx4 v3, s[4:7], s22 offen offset:0 lds
    buffer_load_dwordx4 v3, s[4:7], s22 offen offset:1024 lds
    s_add_u32 m0, s57, 36864
    s_add_u32 s23, s25, 20480
    buffer_load_dwordx4 v3, s[4:7], s23 offen offset:0 lds
    buffer_load_dwordx4 v3, s[4:7], s23 offen offset:1024 lds
    s_add_u32 m0, s58, 36864
    s_add_u32 s22, s26, 20480
    buffer_load_dwordx4 v3, s[4:7], s22 offen offset:0 lds
    buffer_load_dwordx4 v3, s[4:7], s22 offen offset:1024 lds
    s_add_u32 m0, s59, 36864
    s_add_u32 s23, s27, 20480
    buffer_load_dwordx4 v3, s[4:7], s23 offen offset:0 lds
    buffer_load_dwordx4 v3, s[4:7], s23 offen offset:1024 lds
    s_add_u32 m0, s60, 36864
    s_add_u32 s22, s28, 20480
    buffer_load_dwordx4 v3, s[4:7], s22 offen offset:0 lds
    s_waitcnt vmcnt(54)
    s_barrier
    s_add_u32 m0, s56, 55296
    s_add_u32 s22, s24, 22528
    buffer_load_dwordx4 v3, s[4:7], s22 offen offset:0 lds
    buffer_load_dwordx4 v3, s[4:7], s22 offen offset:1024 lds
    s_add_u32 m0, s57, 55296
    s_add_u32 s23, s25, 22528
    buffer_load_dwordx4 v3, s[4:7], s23 offen offset:0 lds
    buffer_load_dwordx4 v3, s[4:7], s23 offen offset:1024 lds
    s_add_u32 m0, s58, 55296
    s_add_u32 s22, s26, 22528
    buffer_load_dwordx4 v3, s[4:7], s22 offen offset:0 lds
    buffer_load_dwordx4 v3, s[4:7], s22 offen offset:1024 lds
    s_add_u32 m0, s59, 55296
    s_add_u32 s23, s27, 22528
    buffer_load_dwordx4 v3, s[4:7], s23 offen offset:0 lds
    buffer_load_dwordx4 v3, s[4:7], s23 offen offset:1024 lds
    s_add_u32 m0, s60, 55296
    s_add_u32 s22, s28, 22528
    buffer_load_dwordx4 v3, s[4:7], s22 offen offset:0 lds
    s_waitcnt vmcnt(54)
    s_barrier
    s_add_u32 m0, s56, 73728
    s_add_u32 s22, s24, 24576
    buffer_load_dwordx4 v3, s[4:7], s22 offen offset:0 lds
    buffer_load_dwordx4 v3, s[4:7], s22 offen offset:1024 lds
    s_add_u32 m0, s57, 73728
    s_add_u32 s23, s25, 24576
    buffer_load_dwordx4 v3, s[4:7], s23 offen offset:0 lds
    buffer_load_dwordx4 v3, s[4:7], s23 offen offset:1024 lds
    s_add_u32 m0, s58, 73728
    s_add_u32 s22, s26, 24576
    buffer_load_dwordx4 v3, s[4:7], s22 offen offset:0 lds
    buffer_load_dwordx4 v3, s[4:7], s22 offen offset:1024 lds
    s_add_u32 m0, s59, 73728
    s_add_u32 s23, s27, 24576
    buffer_load_dwordx4 v3, s[4:7], s23 offen offset:0 lds
    buffer_load_dwordx4 v3, s[4:7], s23 offen offset:1024 lds
    s_add_u32 m0, s60, 73728
    s_add_u32 s22, s28, 24576
    buffer_load_dwordx4 v3, s[4:7], s22 offen offset:0 lds
    s_waitcnt vmcnt(54)
    s_barrier
    s_add_u32 m0, s56, 92160
    s_add_u32 s22, s24, 26624
    buffer_load_dwordx4 v3, s[4:7], s22 offen offset:0 lds
    buffer_load_dwordx4 v3, s[4:7], s22 offen offset:1024 lds
    s_add_u32 m0, s57, 92160
    s_add_u32 s23, s25, 26624
    buffer_load_dwordx4 v3, s[4:7], s23 offen offset:0 lds
    buffer_load_dwordx4 v3, s[4:7], s23 offen offset:1024 lds
    s_add_u32 m0, s58, 92160
    s_add_u32 s22, s26, 26624
    buffer_load_dwordx4 v3, s[4:7], s22 offen offset:0 lds
    buffer_load_dwordx4 v3, s[4:7], s22 offen offset:1024 lds
    s_add_u32 m0, s59, 92160
    s_add_u32 s23, s27, 26624
    buffer_load_dwordx4 v3, s[4:7], s23 offen offset:0 lds
    buffer_load_dwordx4 v3, s[4:7], s23 offen offset:1024 lds
    s_add_u32 m0, s60, 92160
    s_add_u32 s22, s28, 26624
    buffer_load_dwordx4 v3, s[4:7], s22 offen offset:0 lds
    s_waitcnt vmcnt(54)
    s_barrier
    s_add_u32 m0, s56, 110592
    s_add_u32 s22, s24, 28672
    buffer_load_dwordx4 v3, s[4:7], s22 offen offset:0 lds
    buffer_load_dwordx4 v3, s[4:7], s22 offen offset:1024 lds
    s_add_u32 m0, s57, 110592
    s_add_u32 s23, s25, 28672
    buffer_load_dwordx4 v3, s[4:7], s23 offen offset:0 lds
    buffer_load_dwordx4 v3, s[4:7], s23 offen offset:1024 lds
    s_add_u32 m0, s58, 110592
    s_add_u32 s22, s26, 28672
    buffer_load_dwordx4 v3, s[4:7], s22 offen offset:0 lds
    buffer_load_dwordx4 v3, s[4:7], s22 offen offset:1024 lds
    s_add_u32 m0, s59, 110592
    s_add_u32 s23, s27, 28672
    buffer_load_dwordx4 v3, s[4:7], s23 offen offset:0 lds
    buffer_load_dwordx4 v3, s[4:7], s23 offen offset:1024 lds
    s_add_u32 m0, s60, 110592
    s_add_u32 s22, s28, 28672
    buffer_load_dwordx4 v3, s[4:7], s22 offen offset:0 lds
    s_waitcnt vmcnt(54)
    s_barrier
    s_add_u32 m0, s56, 129024
    s_add_u32 s22, s24, 30720
    buffer_load_dwordx4 v3, s[4:7], s22 offen offset:0 lds
    buffer_load_dwordx4 v3, s[4:7], s22 offen offset:1024 lds
    s_add_u32 m0, s57, 129024
    s_add_u32 s23, s25, 30720
    buffer_load_dwordx4 v3, s[4:7], s23 offen offset:0 lds
    buffer_load_dwordx4 v3, s[4:7], s23 offen offset:1024 lds
    s_add_u32 m0, s58, 129024
    s_add_u32 s22, s26, 30720
    buffer_load_dwordx4 v3, s[4:7], s22 offen offset:0 lds
    buffer_load_dwordx4 v3, s[4:7], s22 offen offset:1024 lds
    s_add_u32 m0, s59, 129024
    s_add_u32 s23, s27, 30720
    buffer_load_dwordx4 v3, s[4:7], s23 offen offset:0 lds
    buffer_load_dwordx4 v3, s[4:7], s23 offen offset:1024 lds
    s_add_u32 m0, s60, 129024
    s_add_u32 s22, s28, 30720
    buffer_load_dwordx4 v3, s[4:7], s22 offen offset:0 lds
    s_waitcnt vmcnt(54)
    s_barrier
    s_add_u32 m0, s56, 0
    s_add_u32 s22, s24, 32768
    buffer_load_dwordx4 v3, s[4:7], s22 offen offset:0 lds
    buffer_load_dwordx4 v3, s[4:7], s22 offen offset:1024 lds
    s_add_u32 m0, s57, 0
    s_add_u32 s23, s25, 32768
    buffer_load_dwordx4 v3, s[4:7], s23 offen offset:0 lds
    buffer_load_dwordx4 v3, s[4:7], s23 offen offset:1024 lds
    s_add_u32 m0, s58, 0
    s_add_u32 s22, s26, 32768
    buffer_load_dwordx4 v3, s[4:7], s22 offen offset:0 lds
    buffer_load_dwordx4 v3, s[4:7], s22 offen offset:1024 lds
    s_add_u32 m0, s59, 0
    s_add_u32 s23, s27, 32768
    buffer_load_dwordx4 v3, s[4:7], s23 offen offset:0 lds
    buffer_load_dwordx4 v3, s[4:7], s23 offen offset:1024 lds
    s_add_u32 m0, s60, 0
    s_add_u32 s22, s28, 32768
    buffer_load_dwordx4 v3, s[4:7], s22 offen offset:0 lds
    s_waitcnt vmcnt(54)
    s_barrier
    s_add_u32 m0, s56, 18432
    s_add_u32 s22, s24, 34816
    buffer_load_dwordx4 v3, s[4:7], s22 offen offset:0 lds
    buffer_load_dwordx4 v3, s[4:7], s22 offen offset:1024 lds
    s_add_u32 m0, s57, 18432
    s_add_u32 s23, s25, 34816
    buffer_load_dwordx4 v3, s[4:7], s23 offen offset:0 lds
    buffer_load_dwordx4 v3, s[4:7], s23 offen offset:1024 lds
    s_add_u32 m0, s58, 18432
    s_add_u32 s22, s26, 34816
    buffer_load_dwordx4 v3, s[4:7], s22 offen offset:0 lds
    buffer_load_dwordx4 v3, s[4:7], s22 offen offset:1024 lds
    s_add_u32 m0, s59, 18432
    s_add_u32 s23, s27, 34816
    buffer_load_dwordx4 v3, s[4:7], s23 offen offset:0 lds
    buffer_load_dwordx4 v3, s[4:7], s23 offen offset:1024 lds
    s_add_u32 m0, s60, 18432
    s_add_u32 s22, s28, 34816
    buffer_load_dwordx4 v3, s[4:7], s22 offen offset:0 lds
    s_waitcnt vmcnt(54)
    s_barrier
    s_add_u32 m0, s56, 36864
    s_add_u32 s22, s24, 36864
    buffer_load_dwordx4 v3, s[4:7], s22 offen offset:0 lds
    buffer_load_dwordx4 v3, s[4:7], s22 offen offset:1024 lds
    s_add_u32 m0, s57, 36864
    s_add_u32 s23, s25, 36864
    buffer_load_dwordx4 v3, s[4:7], s23 offen offset:0 lds
    buffer_load_dwordx4 v3, s[4:7], s23 offen offset:1024 lds
    s_add_u32 m0, s58, 36864
    s_add_u32 s22, s26, 36864
    buffer_load_dwordx4 v3, s[4:7], s22 offen offset:0 lds
    buffer_load_dwordx4 v3, s[4:7], s22 offen offset:1024 lds
    s_add_u32 m0, s59, 36864
    s_add_u32 s23, s27, 36864
    buffer_load_dwordx4 v3, s[4:7], s23 offen offset:0 lds
    buffer_load_dwordx4 v3, s[4:7], s23 offen offset:1024 lds
    s_add_u32 m0, s60, 36864
    s_add_u32 s22, s28, 36864
    buffer_load_dwordx4 v3, s[4:7], s22 offen offset:0 lds
    s_waitcnt vmcnt(54)
    s_barrier
    s_add_u32 m0, s56, 55296
    s_add_u32 s22, s24, 38912
    buffer_load_dwordx4 v3, s[4:7], s22 offen offset:0 lds
    buffer_load_dwordx4 v3, s[4:7], s22 offen offset:1024 lds
    s_add_u32 m0, s57, 55296
    s_add_u32 s23, s25, 38912
    buffer_load_dwordx4 v3, s[4:7], s23 offen offset:0 lds
    buffer_load_dwordx4 v3, s[4:7], s23 offen offset:1024 lds
    s_add_u32 m0, s58, 55296
    s_add_u32 s22, s26, 38912
    buffer_load_dwordx4 v3, s[4:7], s22 offen offset:0 lds
    buffer_load_dwordx4 v3, s[4:7], s22 offen offset:1024 lds
    s_add_u32 m0, s59, 55296
    s_add_u32 s23, s27, 38912
    buffer_load_dwordx4 v3, s[4:7], s23 offen offset:0 lds
    buffer_load_dwordx4 v3, s[4:7], s23 offen offset:1024 lds
    s_add_u32 m0, s60, 55296
    s_add_u32 s22, s28, 38912
    buffer_load_dwordx4 v3, s[4:7], s22 offen offset:0 lds
    s_waitcnt vmcnt(54)
    s_barrier
    s_add_u32 m0, s56, 73728
    s_add_u32 s22, s24, 40960
    buffer_load_dwordx4 v3, s[4:7], s22 offen offset:0 lds
    buffer_load_dwordx4 v3, s[4:7], s22 offen offset:1024 lds
    s_add_u32 m0, s57, 73728
    s_add_u32 s23, s25, 40960
    buffer_load_dwordx4 v3, s[4:7], s23 offen offset:0 lds
    buffer_load_dwordx4 v3, s[4:7], s23 offen offset:1024 lds
    s_add_u32 m0, s58, 73728
    s_add_u32 s22, s26, 40960
    buffer_load_dwordx4 v3, s[4:7], s22 offen offset:0 lds
    buffer_load_dwordx4 v3, s[4:7], s22 offen offset:1024 lds
    s_add_u32 m0, s59, 73728
    s_add_u32 s23, s27, 40960
    buffer_load_dwordx4 v3, s[4:7], s23 offen offset:0 lds
    buffer_load_dwordx4 v3, s[4:7], s23 offen offset:1024 lds
    s_add_u32 m0, s60, 73728
    s_add_u32 s22, s28, 40960
    buffer_load_dwordx4 v3, s[4:7], s22 offen offset:0 lds
    s_waitcnt vmcnt(54)
    s_barrier
    s_add_u32 m0, s56, 92160
    s_add_u32 s22, s24, 43008
    buffer_load_dwordx4 v3, s[4:7], s22 offen offset:0 lds
    buffer_load_dwordx4 v3, s[4:7], s22 offen offset:1024 lds
    s_add_u32 m0, s57, 92160
    s_add_u32 s23, s25, 43008
    buffer_load_dwordx4 v3, s[4:7], s23 offen offset:0 lds
    buffer_load_dwordx4 v3, s[4:7], s23 offen offset:1024 lds
    s_add_u32 m0, s58, 92160
    s_add_u32 s22, s26, 43008
    buffer_load_dwordx4 v3, s[4:7], s22 offen offset:0 lds
    buffer_load_dwordx4 v3, s[4:7], s22 offen offset:1024 lds
    s_add_u32 m0, s59, 92160
    s_add_u32 s23, s27, 43008
    buffer_load_dwordx4 v3, s[4:7], s23 offen offset:0 lds
    buffer_load_dwordx4 v3, s[4:7], s23 offen offset:1024 lds
    s_add_u32 m0, s60, 92160
    s_add_u32 s22, s28, 43008
    buffer_load_dwordx4 v3, s[4:7], s22 offen offset:0 lds
    s_waitcnt vmcnt(54)
    s_barrier
    s_add_u32 m0, s56, 110592
    s_add_u32 s22, s24, 45056
    buffer_load_dwordx4 v3, s[4:7], s22 offen offset:0 lds
    buffer_load_dwordx4 v3, s[4:7], s22 offen offset:1024 lds
    s_add_u32 m0, s57, 110592
    s_add_u32 s23, s25, 45056
    buffer_load_dwordx4 v3, s[4:7], s23 offen offset:0 lds
    buffer_load_dwordx4 v3, s[4:7], s23 offen offset:1024 lds
    s_add_u32 m0, s58, 110592
    s_add_u32 s22, s26, 45056
    buffer_load_dwordx4 v3, s[4:7], s22 offen offset:0 lds
    buffer_load_dwordx4 v3, s[4:7], s22 offen offset:1024 lds
    s_add_u32 m0, s59, 110592
    s_add_u32 s23, s27, 45056
    buffer_load_dwordx4 v3, s[4:7], s23 offen offset:0 lds
    buffer_load_dwordx4 v3, s[4:7], s23 offen offset:1024 lds
    s_add_u32 m0, s60, 110592
    s_add_u32 s22, s28, 45056
    buffer_load_dwordx4 v3, s[4:7], s22 offen offset:0 lds
    s_waitcnt vmcnt(54)
    s_barrier
    s_add_u32 m0, s56, 129024
    s_add_u32 s22, s24, 47104
    buffer_load_dwordx4 v3, s[4:7], s22 offen offset:0 lds
    buffer_load_dwordx4 v3, s[4:7], s22 offen offset:1024 lds
    s_add_u32 m0, s57, 129024
    s_add_u32 s23, s25, 47104
    buffer_load_dwordx4 v3, s[4:7], s23 offen offset:0 lds
    buffer_load_dwordx4 v3, s[4:7], s23 offen offset:1024 lds
    s_add_u32 m0, s58, 129024
    s_add_u32 s22, s26, 47104
    buffer_load_dwordx4 v3, s[4:7], s22 offen offset:0 lds
    buffer_load_dwordx4 v3, s[4:7], s22 offen offset:1024 lds
    s_add_u32 m0, s59, 129024
    s_add_u32 s23, s27, 47104
    buffer_load_dwordx4 v3, s[4:7], s23 offen offset:0 lds
    buffer_load_dwordx4 v3, s[4:7], s23 offen offset:1024 lds
    s_add_u32 m0, s60, 129024
    s_add_u32 s22, s28, 47104
    buffer_load_dwordx4 v3, s[4:7], s22 offen offset:0 lds
    s_waitcnt vmcnt(54)
    s_barrier
    s_waitcnt vmcnt(45)
    s_barrier
    s_waitcnt vmcnt(36)
    s_barrier
    s_waitcnt vmcnt(27)
    s_barrier
    s_waitcnt vmcnt(18)
    s_barrier
    s_waitcnt vmcnt(9)
    s_barrier
    s_waitcnt vmcnt(0)
    s_barrier
    s_endpgm
dn2_kernel_comp:
    s_mov_b32 s15, s12
    s_mov_b32 s16, 0
    s_mul_i32 s17, s15, 2048
    s_mul_i32 s18, s16, 10240
    v_add_u32 v4, s17, v3
    v_add_u32 v7, s18, v3
    v_add_u32 v5, s17, v3
    v_add_u32 v8, s18, v3
    v_add_u32 v5, 65536, v5
    v_add_u32 v8, 65536, v8
    v_add_u32 v6, s17, v3
    v_add_u32 v9, s18, v3
    v_add_u32 v6, 131072, v6
    v_add_u32 v9, 131072, v9
    s_waitcnt lgkmcnt(0)
    s_and_b32 s5, s5, 0xffff
    s_mov_b32 s6, 268435456
    s_mov_b32 s7, 0x00020000
    s_and_b32 s9, s9, 0xffff
    s_mov_b32 s10, 2621440
    s_mov_b32 s11, 0x00020000
    s_lshl_b32 s17, s13, 2
    s_add_u32 s17, s17, s15
    s_mul_i32 s18, s14, 5
    s_add_u32 s19, s18, 0
    s_lshr_b32 s20, s19, 1
    s_and_b32 s21, s19, 1
    s_lshl_b32 s21, s21, 3
    s_mul_i32 s22, s17, 20
    s_add_u32 s22, s22, s20
    s_lshl_b32 s22, s22, 10
    s_add_u32 s40, s22, s21
    s_mul_i32 s22, s17, 20480
    s_lshl_b32 s20, s20, 6
    s_add_u32 s22, s22, s20
    s_add_u32 s46, s22, s21
    s_add_u32 s22, s40, 18874368
    buffer_load_dwordx2 v[10:11], v3, s[4:7], s22 offen
    s_add_u32 s19, s18, 1
    s_lshr_b32 s20, s19, 1
    s_and_b32 s21, s19, 1
    s_lshl_b32 s21, s21, 3
    s_mul_i32 s22, s17, 20
    s_add_u32 s22, s22, s20
    s_lshl_b32 s22, s22, 10
    s_add_u32 s41, s22, s21
    s_mul_i32 s22, s17, 20480
    s_lshl_b32 s20, s20, 6
    s_add_u32 s22, s22, s20
    s_add_u32 s47, s22, s21
    s_add_u32 s22, s41, 18874368
    buffer_load_dwordx2 v[12:13], v3, s[4:7], s22 offen
    s_add_u32 s19, s18, 2
    s_lshr_b32 s20, s19, 1
    s_and_b32 s21, s19, 1
    s_lshl_b32 s21, s21, 3
    s_mul_i32 s22, s17, 20
    s_add_u32 s22, s22, s20
    s_lshl_b32 s22, s22, 10
    s_add_u32 s42, s22, s21
    s_mul_i32 s22, s17, 20480
    s_lshl_b32 s20, s20, 6
    s_add_u32 s22, s22, s20
    s_add_u32 s48, s22, s21
    s_add_u32 s22, s42, 18874368
    buffer_load_dwordx2 v[14:15], v3, s[4:7], s22 offen
    s_add_u32 s19, s18, 3
    s_lshr_b32 s20, s19, 1
    s_and_b32 s21, s19, 1
    s_lshl_b32 s21, s21, 3
    s_mul_i32 s22, s17, 20
    s_add_u32 s22, s22, s20
    s_lshl_b32 s22, s22, 10
    s_add_u32 s43, s22, s21
    s_mul_i32 s22, s17, 20480
    s_lshl_b32 s20, s20, 6
    s_add_u32 s22, s22, s20
    s_add_u32 s49, s22, s21
    s_add_u32 s22, s43, 18874368
    buffer_load_dwordx2 v[16:17], v3, s[4:7], s22 offen
    s_add_u32 s19, s18, 4
    s_lshr_b32 s20, s19, 1
    s_and_b32 s21, s19, 1
    s_lshl_b32 s21, s21, 3
    s_mul_i32 s22, s17, 20
    s_add_u32 s22, s22, s20
    s_lshl_b32 s22, s22, 10
    s_add_u32 s44, s22, s21
    s_mul_i32 s22, s17, 20480
    s_lshl_b32 s20, s20, 6
    s_add_u32 s22, s22, s20
    s_add_u32 s50, s22, s21
    s_add_u32 s22, s44, 18874368
    buffer_load_dwordx2 v[18:19], v3, s[4:7], s22 offen
    s_waitcnt lgkmcnt(0)
    s_barrier
    ds_read_b128 v[52:55], v4 offset:0
    ds_read_b128 v[56:59], v7 offset:8192
    ds_read_b128 v[60:63], v7 offset:10240
    ds_read_b128 v[64:67], v7 offset:12288
    ds_read_b128 v[68:71], v7 offset:14336
    ds_read_b128 v[72:75], v7 offset:16384
    s_waitcnt lgkmcnt(0)
    v_mfma_f32_16x16x32_bf16 v[32:35], v[56:59], v[52:55], 0
    ds_read_b128 v[76:79], v4 offset:1024
    ds_read_b128 v[80:83], v7 offset:9216
    v_mfma_f32_16x16x32_bf16 v[36:39], v[60:63], v[52:55], 0
    ds_read_b128 v[84:87], v7 offset:11264
    ds_read_b128 v[88:91], v7 offset:13312
    v_mfma_f32_16x16x32_bf16 v[40:43], v[64:67], v[52:55], 0
    ds_read_b128 v[92:95], v7 offset:15360
    ds_read_b128 v[96:99], v7 offset:17408
    v_mfma_f32_16x16x32_bf16 v[44:47], v[68:71], v[52:55], 0
    v_mfma_f32_16x16x32_bf16 v[48:51], v[72:75], v[52:55], 0
    s_waitcnt lgkmcnt(0)
    s_barrier
    v_mfma_f32_16x16x32_bf16 v[32:35], v[80:83], v[76:79], v[32:35]
    ds_read_b128 v[52:55], v4 offset:18432
    ds_read_b128 v[56:59], v7 offset:26624
    v_mfma_f32_16x16x32_bf16 v[36:39], v[84:87], v[76:79], v[36:39]
    ds_read_b128 v[60:63], v7 offset:28672
    ds_read_b128 v[64:67], v7 offset:30720
    v_mfma_f32_16x16x32_bf16 v[40:43], v[88:91], v[76:79], v[40:43]
    ds_read_b128 v[68:71], v7 offset:32768
    ds_read_b128 v[72:75], v7 offset:34816
    v_mfma_f32_16x16x32_bf16 v[44:47], v[92:95], v[76:79], v[44:47]
    v_mfma_f32_16x16x32_bf16 v[48:51], v[96:99], v[76:79], v[48:51]
    s_waitcnt lgkmcnt(0)
    v_mfma_f32_16x16x32_bf16 v[32:35], v[56:59], v[52:55], v[32:35]
    ds_read_b128 v[76:79], v4 offset:19456
    ds_read_b128 v[80:83], v7 offset:27648
    v_mfma_f32_16x16x32_bf16 v[36:39], v[60:63], v[52:55], v[36:39]
    ds_read_b128 v[84:87], v7 offset:29696
    ds_read_b128 v[88:91], v7 offset:31744
    v_mfma_f32_16x16x32_bf16 v[40:43], v[64:67], v[52:55], v[40:43]
    ds_read_b128 v[92:95], v7 offset:33792
    ds_read_b128 v[96:99], v7 offset:35840
    v_mfma_f32_16x16x32_bf16 v[44:47], v[68:71], v[52:55], v[44:47]
    v_mfma_f32_16x16x32_bf16 v[48:51], v[72:75], v[52:55], v[48:51]
    s_waitcnt lgkmcnt(0)
    s_barrier
    v_mfma_f32_16x16x32_bf16 v[32:35], v[80:83], v[76:79], v[32:35]
    ds_read_b128 v[52:55], v4 offset:36864
    ds_read_b128 v[56:59], v7 offset:45056
    v_mfma_f32_16x16x32_bf16 v[36:39], v[84:87], v[76:79], v[36:39]
    ds_read_b128 v[60:63], v7 offset:47104
    ds_read_b128 v[64:67], v7 offset:49152
    v_mfma_f32_16x16x32_bf16 v[40:43], v[88:91], v[76:79], v[40:43]
    ds_read_b128 v[68:71], v7 offset:51200
    ds_read_b128 v[72:75], v7 offset:53248
    v_mfma_f32_16x16x32_bf16 v[44:47], v[92:95], v[76:79], v[44:47]
    v_mfma_f32_16x16x32_bf16 v[48:51], v[96:99], v[76:79], v[48:51]
    s_waitcnt lgkmcnt(0)
    v_mfma_f32_16x16x32_bf16 v[32:35], v[56:59], v[52:55], v[32:35]
    ds_read_b128 v[76:79], v4 offset:37888
    ds_read_b128 v[80:83], v7 offset:46080
    v_mfma_f32_16x16x32_bf16 v[36:39], v[60:63], v[52:55], v[36:39]
    ds_read_b128 v[84:87], v7 offset:48128
    ds_read_b128 v[88:91], v7 offset:50176
    v_mfma_f32_16x16x32_bf16 v[40:43], v[64:67], v[52:55], v[40:43]
    ds_read_b128 v[92:95], v7 offset:52224
    ds_read_b128 v[96:99], v7 offset:54272
    v_mfma_f32_16x16x32_bf16 v[44:47], v[68:71], v[52:55], v[44:47]
    v_mfma_f32_16x16x32_bf16 v[48:51], v[72:75], v[52:55], v[48:51]
    s_waitcnt lgkmcnt(0)
    s_barrier
    v_mfma_f32_16x16x32_bf16 v[32:35], v[80:83], v[76:79], v[32:35]
    ds_read_b128 v[52:55], v4 offset:55296
    ds_read_b128 v[56:59], v7 offset:63488
    v_mfma_f32_16x16x32_bf16 v[36:39], v[84:87], v[76:79], v[36:39]
    ds_read_b128 v[60:63], v8 offset:0
    ds_read_b128 v[64:67], v8 offset:2048
    v_mfma_f32_16x16x32_bf16 v[40:43], v[88:91], v[76:79], v[40:43]
    ds_read_b128 v[68:71], v8 offset:4096
    ds_read_b128 v[72:75], v8 offset:6144
    v_mfma_f32_16x16x32_bf16 v[44:47], v[92:95], v[76:79], v[44:47]
    v_mfma_f32_16x16x32_bf16 v[48:51], v[96:99], v[76:79], v[48:51]
    s_waitcnt lgkmcnt(0)
    v_mfma_f32_16x16x32_bf16 v[32:35], v[56:59], v[52:55], v[32:35]
    ds_read_b128 v[76:79], v4 offset:56320
    ds_read_b128 v[80:83], v7 offset:64512
    v_mfma_f32_16x16x32_bf16 v[36:39], v[60:63], v[52:55], v[36:39]
    ds_read_b128 v[84:87], v8 offset:1024
    ds_read_b128 v[88:91], v8 offset:3072
    v_mfma_f32_16x16x32_bf16 v[40:43], v[64:67], v[52:55], v[40:43]
    ds_read_b128 v[92:95], v8 offset:5120
    ds_read_b128 v[96:99], v8 offset:7168
    v_mfma_f32_16x16x32_bf16 v[44:47], v[68:71], v[52:55], v[44:47]
    v_mfma_f32_16x16x32_bf16 v[48:51], v[72:75], v[52:55], v[48:51]
    s_waitcnt lgkmcnt(0)
    s_barrier
    v_mfma_f32_16x16x32_bf16 v[32:35], v[80:83], v[76:79], v[32:35]
    ds_read_b128 v[52:55], v5 offset:8192
    ds_read_b128 v[56:59], v8 offset:16384
    v_mfma_f32_16x16x32_bf16 v[36:39], v[84:87], v[76:79], v[36:39]
    ds_read_b128 v[60:63], v8 offset:18432
    ds_read_b128 v[64:67], v8 offset:20480
    v_mfma_f32_16x16x32_bf16 v[40:43], v[88:91], v[76:79], v[40:43]
    ds_read_b128 v[68:71], v8 offset:22528
    ds_read_b128 v[72:75], v8 offset:24576
    v_mfma_f32_16x16x32_bf16 v[44:47], v[92:95], v[76:79], v[44:47]
    v_mfma_f32_16x16x32_bf16 v[48:51], v[96:99], v[76:79], v[48:51]
    s_waitcnt lgkmcnt(0)
    v_mfma_f32_16x16x32_bf16 v[32:35], v[56:59], v[52:55], v[32:35]
    ds_read_b128 v[76:79], v5 offset:9216
    ds_read_b128 v[80:83], v8 offset:17408
    v_mfma_f32_16x16x32_bf16 v[36:39], v[60:63], v[52:55], v[36:39]
    ds_read_b128 v[84:87], v8 offset:19456
    ds_read_b128 v[88:91], v8 offset:21504
    v_mfma_f32_16x16x32_bf16 v[40:43], v[64:67], v[52:55], v[40:43]
    ds_read_b128 v[92:95], v8 offset:23552
    ds_read_b128 v[96:99], v8 offset:25600
    v_mfma_f32_16x16x32_bf16 v[44:47], v[68:71], v[52:55], v[44:47]
    v_mfma_f32_16x16x32_bf16 v[48:51], v[72:75], v[52:55], v[48:51]
    s_waitcnt lgkmcnt(0)
    s_barrier
    v_mfma_f32_16x16x32_bf16 v[32:35], v[80:83], v[76:79], v[32:35]
    ds_read_b128 v[52:55], v5 offset:26624
    ds_read_b128 v[56:59], v8 offset:34816
    v_mfma_f32_16x16x32_bf16 v[36:39], v[84:87], v[76:79], v[36:39]
    ds_read_b128 v[60:63], v8 offset:36864
    ds_read_b128 v[64:67], v8 offset:38912
    v_mfma_f32_16x16x32_bf16 v[40:43], v[88:91], v[76:79], v[40:43]
    ds_read_b128 v[68:71], v8 offset:40960
    ds_read_b128 v[72:75], v8 offset:43008
    v_mfma_f32_16x16x32_bf16 v[44:47], v[92:95], v[76:79], v[44:47]
    v_mfma_f32_16x16x32_bf16 v[48:51], v[96:99], v[76:79], v[48:51]
    s_waitcnt lgkmcnt(0)
    v_mfma_f32_16x16x32_bf16 v[32:35], v[56:59], v[52:55], v[32:35]
    ds_read_b128 v[76:79], v5 offset:27648
    ds_read_b128 v[80:83], v8 offset:35840
    v_mfma_f32_16x16x32_bf16 v[36:39], v[60:63], v[52:55], v[36:39]
    ds_read_b128 v[84:87], v8 offset:37888
    ds_read_b128 v[88:91], v8 offset:39936
    v_mfma_f32_16x16x32_bf16 v[40:43], v[64:67], v[52:55], v[40:43]
    ds_read_b128 v[92:95], v8 offset:41984
    ds_read_b128 v[96:99], v8 offset:44032
    v_mfma_f32_16x16x32_bf16 v[44:47], v[68:71], v[52:55], v[44:47]
    v_mfma_f32_16x16x32_bf16 v[48:51], v[72:75], v[52:55], v[48:51]
    s_waitcnt lgkmcnt(0)
    s_barrier
    v_mfma_f32_16x16x32_bf16 v[32:35], v[80:83], v[76:79], v[32:35]
    ds_read_b128 v[52:55], v5 offset:45056
    ds_read_b128 v[56:59], v8 offset:53248
    v_mfma_f32_16x16x32_bf16 v[36:39], v[84:87], v[76:79], v[36:39]
    ds_read_b128 v[60:63], v8 offset:55296
    ds_read_b128 v[64:67], v8 offset:57344
    v_mfma_f32_16x16x32_bf16 v[40:43], v[88:91], v[76:79], v[40:43]
    ds_read_b128 v[68:71], v8 offset:59392
    ds_read_b128 v[72:75], v8 offset:61440
    v_mfma_f32_16x16x32_bf16 v[44:47], v[92:95], v[76:79], v[44:47]
    v_mfma_f32_16x16x32_bf16 v[48:51], v[96:99], v[76:79], v[48:51]
    s_waitcnt lgkmcnt(0)
    v_mfma_f32_16x16x32_bf16 v[32:35], v[56:59], v[52:55], v[32:35]
    ds_read_b128 v[76:79], v5 offset:46080
    ds_read_b128 v[80:83], v8 offset:54272
    v_mfma_f32_16x16x32_bf16 v[36:39], v[60:63], v[52:55], v[36:39]
    ds_read_b128 v[84:87], v8 offset:56320
    ds_read_b128 v[88:91], v8 offset:58368
    v_mfma_f32_16x16x32_bf16 v[40:43], v[64:67], v[52:55], v[40:43]
    ds_read_b128 v[92:95], v8 offset:60416
    ds_read_b128 v[96:99], v8 offset:62464
    v_mfma_f32_16x16x32_bf16 v[44:47], v[68:71], v[52:55], v[44:47]
    v_mfma_f32_16x16x32_bf16 v[48:51], v[72:75], v[52:55], v[48:51]
    s_waitcnt lgkmcnt(0)
    s_barrier
    v_mfma_f32_16x16x32_bf16 v[32:35], v[80:83], v[76:79], v[32:35]
    ds_read_b128 v[52:55], v5 offset:63488
    ds_read_b128 v[56:59], v9 offset:6144
    v_mfma_f32_16x16x32_bf16 v[36:39], v[84:87], v[76:79], v[36:39]
    ds_read_b128 v[60:63], v9 offset:8192
    ds_read_b128 v[64:67], v9 offset:10240
    v_mfma_f32_16x16x32_bf16 v[40:43], v[88:91], v[76:79], v[40:43]
    ds_read_b128 v[68:71], v9 offset:12288
    ds_read_b128 v[72:75], v9 offset:14336
    v_mfma_f32_16x16x32_bf16 v[44:47], v[92:95], v[76:79], v[44:47]
    v_mfma_f32_16x16x32_bf16 v[48:51], v[96:99], v[76:79], v[48:51]
    s_waitcnt lgkmcnt(0)
    v_mfma_f32_16x16x32_bf16 v[32:35], v[56:59], v[52:55], v[32:35]
    ds_read_b128 v[76:79], v5 offset:64512
    ds_read_b128 v[80:83], v9 offset:7168
    v_mfma_f32_16x16x32_bf16 v[36:39], v[60:63], v[52:55], v[36:39]
    ds_read_b128 v[84:87], v9 offset:9216
    ds_read_b128 v[88:91], v9 offset:11264
    v_mfma_f32_16x16x32_bf16 v[40:43], v[64:67], v[52:55], v[40:43]
    ds_read_b128 v[92:95], v9 offset:13312
    ds_read_b128 v[96:99], v9 offset:15360
    v_mfma_f32_16x16x32_bf16 v[44:47], v[68:71], v[52:55], v[44:47]
    v_mfma_f32_16x16x32_bf16 v[48:51], v[72:75], v[52:55], v[48:51]
    s_waitcnt lgkmcnt(0)
    s_barrier
    v_mfma_f32_16x16x32_bf16 v[32:35], v[80:83], v[76:79], v[32:35]
    ds_read_b128 v[52:55], v4 offset:0
    ds_read_b128 v[56:59], v7 offset:8192
    v_mfma_f32_16x16x32_bf16 v[36:39], v[84:87], v[76:79], v[36:39]
    ds_read_b128 v[60:63], v7 offset:10240
    ds_read_b128 v[64:67], v7 offset:12288
    v_mfma_f32_16x16x32_bf16 v[40:43], v[88:91], v[76:79], v[40:43]
    ds_read_b128 v[68:71], v7 offset:14336
    ds_read_b128 v[72:75], v7 offset:16384
    v_mfma_f32_16x16x32_bf16 v[44:47], v[92:95], v[76:79], v[44:47]
    v_mfma_f32_16x16x32_bf16 v[48:51], v[96:99], v[76:79], v[48:51]
    s_waitcnt lgkmcnt(0)
    v_mfma_f32_16x16x32_bf16 v[32:35], v[56:59], v[52:55], v[32:35]
    ds_read_b128 v[76:79], v4 offset:1024
    ds_read_b128 v[80:83], v7 offset:9216
    v_mfma_f32_16x16x32_bf16 v[36:39], v[60:63], v[52:55], v[36:39]
    ds_read_b128 v[84:87], v7 offset:11264
    ds_read_b128 v[88:91], v7 offset:13312
    v_mfma_f32_16x16x32_bf16 v[40:43], v[64:67], v[52:55], v[40:43]
    ds_read_b128 v[92:95], v7 offset:15360
    ds_read_b128 v[96:99], v7 offset:17408
    v_mfma_f32_16x16x32_bf16 v[44:47], v[68:71], v[52:55], v[44:47]
    v_mfma_f32_16x16x32_bf16 v[48:51], v[72:75], v[52:55], v[48:51]
    s_waitcnt lgkmcnt(0)
    s_barrier
    v_mfma_f32_16x16x32_bf16 v[32:35], v[80:83], v[76:79], v[32:35]
    ds_read_b128 v[52:55], v4 offset:18432
    ds_read_b128 v[56:59], v7 offset:26624
    v_mfma_f32_16x16x32_bf16 v[36:39], v[84:87], v[76:79], v[36:39]
    ds_read_b128 v[60:63], v7 offset:28672
    ds_read_b128 v[64:67], v7 offset:30720
    v_mfma_f32_16x16x32_bf16 v[40:43], v[88:91], v[76:79], v[40:43]
    ds_read_b128 v[68:71], v7 offset:32768
    ds_read_b128 v[72:75], v7 offset:34816
    v_mfma_f32_16x16x32_bf16 v[44:47], v[92:95], v[76:79], v[44:47]
    v_mfma_f32_16x16x32_bf16 v[48:51], v[96:99], v[76:79], v[48:51]
    s_waitcnt lgkmcnt(0)
    v_mfma_f32_16x16x32_bf16 v[32:35], v[56:59], v[52:55], v[32:35]
    ds_read_b128 v[76:79], v4 offset:19456
    ds_read_b128 v[80:83], v7 offset:27648
    v_mfma_f32_16x16x32_bf16 v[36:39], v[60:63], v[52:55], v[36:39]
    ds_read_b128 v[84:87], v7 offset:29696
    ds_read_b128 v[88:91], v7 offset:31744
    v_mfma_f32_16x16x32_bf16 v[40:43], v[64:67], v[52:55], v[40:43]
    ds_read_b128 v[92:95], v7 offset:33792
    ds_read_b128 v[96:99], v7 offset:35840
    v_mfma_f32_16x16x32_bf16 v[44:47], v[68:71], v[52:55], v[44:47]
    v_mfma_f32_16x16x32_bf16 v[48:51], v[72:75], v[52:55], v[48:51]
    s_waitcnt lgkmcnt(0)
    s_barrier
    v_mfma_f32_16x16x32_bf16 v[32:35], v[80:83], v[76:79], v[32:35]
    ds_read_b128 v[52:55], v4 offset:36864
    ds_read_b128 v[56:59], v7 offset:45056
    v_mfma_f32_16x16x32_bf16 v[36:39], v[84:87], v[76:79], v[36:39]
    ds_read_b128 v[60:63], v7 offset:47104
    ds_read_b128 v[64:67], v7 offset:49152
    v_mfma_f32_16x16x32_bf16 v[40:43], v[88:91], v[76:79], v[40:43]
    ds_read_b128 v[68:71], v7 offset:51200
    ds_read_b128 v[72:75], v7 offset:53248
    v_mfma_f32_16x16x32_bf16 v[44:47], v[92:95], v[76:79], v[44:47]
    v_mfma_f32_16x16x32_bf16 v[48:51], v[96:99], v[76:79], v[48:51]
    s_waitcnt lgkmcnt(0)
    v_mfma_f32_16x16x32_bf16 v[32:35], v[56:59], v[52:55], v[32:35]
    ds_read_b128 v[76:79], v4 offset:37888
    ds_read_b128 v[80:83], v7 offset:46080
    v_mfma_f32_16x16x32_bf16 v[36:39], v[60:63], v[52:55], v[36:39]
    ds_read_b128 v[84:87], v7 offset:48128
    ds_read_b128 v[88:91], v7 offset:50176
    v_mfma_f32_16x16x32_bf16 v[40:43], v[64:67], v[52:55], v[40:43]
    ds_read_b128 v[92:95], v7 offset:52224
    ds_read_b128 v[96:99], v7 offset:54272
    v_mfma_f32_16x16x32_bf16 v[44:47], v[68:71], v[52:55], v[44:47]
    v_mfma_f32_16x16x32_bf16 v[48:51], v[72:75], v[52:55], v[48:51]
    s_waitcnt lgkmcnt(0)
    s_barrier
    v_mfma_f32_16x16x32_bf16 v[32:35], v[80:83], v[76:79], v[32:35]
    ds_read_b128 v[52:55], v4 offset:55296
    ds_read_b128 v[56:59], v7 offset:63488
    v_mfma_f32_16x16x32_bf16 v[36:39], v[84:87], v[76:79], v[36:39]
    ds_read_b128 v[60:63], v8 offset:0
    ds_read_b128 v[64:67], v8 offset:2048
    v_mfma_f32_16x16x32_bf16 v[40:43], v[88:91], v[76:79], v[40:43]
    ds_read_b128 v[68:71], v8 offset:4096
    ds_read_b128 v[72:75], v8 offset:6144
    v_mfma_f32_16x16x32_bf16 v[44:47], v[92:95], v[76:79], v[44:47]
    v_mfma_f32_16x16x32_bf16 v[48:51], v[96:99], v[76:79], v[48:51]
    s_waitcnt lgkmcnt(0)
    v_mfma_f32_16x16x32_bf16 v[32:35], v[56:59], v[52:55], v[32:35]
    ds_read_b128 v[76:79], v4 offset:56320
    ds_read_b128 v[80:83], v7 offset:64512
    v_mfma_f32_16x16x32_bf16 v[36:39], v[60:63], v[52:55], v[36:39]
    ds_read_b128 v[84:87], v8 offset:1024
    ds_read_b128 v[88:91], v8 offset:3072
    v_mfma_f32_16x16x32_bf16 v[40:43], v[64:67], v[52:55], v[40:43]
    ds_read_b128 v[92:95], v8 offset:5120
    ds_read_b128 v[96:99], v8 offset:7168
    v_mfma_f32_16x16x32_bf16 v[44:47], v[68:71], v[52:55], v[44:47]
    v_mfma_f32_16x16x32_bf16 v[48:51], v[72:75], v[52:55], v[48:51]
    s_waitcnt lgkmcnt(0)
    s_barrier
    v_mfma_f32_16x16x32_bf16 v[32:35], v[80:83], v[76:79], v[32:35]
    ds_read_b128 v[52:55], v5 offset:8192
    ds_read_b128 v[56:59], v8 offset:16384
    v_mfma_f32_16x16x32_bf16 v[36:39], v[84:87], v[76:79], v[36:39]
    ds_read_b128 v[60:63], v8 offset:18432
    ds_read_b128 v[64:67], v8 offset:20480
    v_mfma_f32_16x16x32_bf16 v[40:43], v[88:91], v[76:79], v[40:43]
    ds_read_b128 v[68:71], v8 offset:22528
    ds_read_b128 v[72:75], v8 offset:24576
    v_mfma_f32_16x16x32_bf16 v[44:47], v[92:95], v[76:79], v[44:47]
    v_mfma_f32_16x16x32_bf16 v[48:51], v[96:99], v[76:79], v[48:51]
    s_waitcnt lgkmcnt(0)
    v_mfma_f32_16x16x32_bf16 v[32:35], v[56:59], v[52:55], v[32:35]
    ds_read_b128 v[76:79], v5 offset:9216
    ds_read_b128 v[80:83], v8 offset:17408
    v_mfma_f32_16x16x32_bf16 v[36:39], v[60:63], v[52:55], v[36:39]
    ds_read_b128 v[84:87], v8 offset:19456
    ds_read_b128 v[88:91], v8 offset:21504
    v_mfma_f32_16x16x32_bf16 v[40:43], v[64:67], v[52:55], v[40:43]
    ds_read_b128 v[92:95], v8 offset:23552
    ds_read_b128 v[96:99], v8 offset:25600
    v_mfma_f32_16x16x32_bf16 v[44:47], v[68:71], v[52:55], v[44:47]
    v_mfma_f32_16x16x32_bf16 v[48:51], v[72:75], v[52:55], v[48:51]
    s_waitcnt lgkmcnt(0)
    s_barrier
    v_mfma_f32_16x16x32_bf16 v[32:35], v[80:83], v[76:79], v[32:35]
    ds_read_b128 v[52:55], v5 offset:26624
    ds_read_b128 v[56:59], v8 offset:34816
    v_mfma_f32_16x16x32_bf16 v[36:39], v[84:87], v[76:79], v[36:39]
    ds_read_b128 v[60:63], v8 offset:36864
    ds_read_b128 v[64:67], v8 offset:38912
    v_mfma_f32_16x16x32_bf16 v[40:43], v[88:91], v[76:79], v[40:43]
    ds_read_b128 v[68:71], v8 offset:40960
    ds_read_b128 v[72:75], v8 offset:43008
    v_mfma_f32_16x16x32_bf16 v[44:47], v[92:95], v[76:79], v[44:47]
    v_mfma_f32_16x16x32_bf16 v[48:51], v[96:99], v[76:79], v[48:51]
    s_waitcnt lgkmcnt(0)
    v_mfma_f32_16x16x32_bf16 v[32:35], v[56:59], v[52:55], v[32:35]
    ds_read_b128 v[76:79], v5 offset:27648
    ds_read_b128 v[80:83], v8 offset:35840
    v_mfma_f32_16x16x32_bf16 v[36:39], v[60:63], v[52:55], v[36:39]
    ds_read_b128 v[84:87], v8 offset:37888
    ds_read_b128 v[88:91], v8 offset:39936
    v_mfma_f32_16x16x32_bf16 v[40:43], v[64:67], v[52:55], v[40:43]
    ds_read_b128 v[92:95], v8 offset:41984
    ds_read_b128 v[96:99], v8 offset:44032
    v_mfma_f32_16x16x32_bf16 v[44:47], v[68:71], v[52:55], v[44:47]
    v_mfma_f32_16x16x32_bf16 v[48:51], v[72:75], v[52:55], v[48:51]
    s_waitcnt lgkmcnt(0)
    s_barrier
    v_mfma_f32_16x16x32_bf16 v[32:35], v[80:83], v[76:79], v[32:35]
    ds_read_b128 v[52:55], v5 offset:45056
    ds_read_b128 v[56:59], v8 offset:53248
    v_mfma_f32_16x16x32_bf16 v[36:39], v[84:87], v[76:79], v[36:39]
    ds_read_b128 v[60:63], v8 offset:55296
    ds_read_b128 v[64:67], v8 offset:57344
    v_mfma_f32_16x16x32_bf16 v[40:43], v[88:91], v[76:79], v[40:43]
    ds_read_b128 v[68:71], v8 offset:59392
    ds_read_b128 v[72:75], v8 offset:61440
    v_mfma_f32_16x16x32_bf16 v[44:47], v[92:95], v[76:79], v[44:47]
    v_mfma_f32_16x16x32_bf16 v[48:51], v[96:99], v[76:79], v[48:51]
    s_waitcnt lgkmcnt(0)
    v_mfma_f32_16x16x32_bf16 v[32:35], v[56:59], v[52:55], v[32:35]
    ds_read_b128 v[76:79], v5 offset:46080
    ds_read_b128 v[80:83], v8 offset:54272
    v_mfma_f32_16x16x32_bf16 v[36:39], v[60:63], v[52:55], v[36:39]
    ds_read_b128 v[84:87], v8 offset:56320
    ds_read_b128 v[88:91], v8 offset:58368
    v_mfma_f32_16x16x32_bf16 v[40:43], v[64:67], v[52:55], v[40:43]
    ds_read_b128 v[92:95], v8 offset:60416
    ds_read_b128 v[96:99], v8 offset:62464
    v_mfma_f32_16x16x32_bf16 v[44:47], v[68:71], v[52:55], v[44:47]
    v_mfma_f32_16x16x32_bf16 v[48:51], v[72:75], v[52:55], v[48:51]
    s_waitcnt lgkmcnt(0)
    s_barrier
    v_mfma_f32_16x16x32_bf16 v[32:35], v[80:83], v[76:79], v[32:35]
    ds_read_b128 v[52:55], v5 offset:63488
    ds_read_b128 v[56:59], v9 offset:6144
    v_mfma_f32_16x16x32_bf16 v[36:39], v[84:87], v[76:79], v[36:39]
    ds_read_b128 v[60:63], v9 offset:8192
    ds_read_b128 v[64:67], v9 offset:10240
    v_mfma_f32_16x16x32_bf16 v[40:43], v[88:91], v[76:79], v[40:43]
    ds_read_b128 v[68:71], v9 offset:12288
    ds_read_b128 v[72:75], v9 offset:14336
    v_mfma_f32_16x16x32_bf16 v[44:47], v[92:95], v[76:79], v[44:47]
    v_mfma_f32_16x16x32_bf16 v[48:51], v[96:99], v[76:79], v[48:51]
    s_waitcnt lgkmcnt(0)
    v_mfma_f32_16x16x32_bf16 v[32:35], v[56:59], v[52:55], v[32:35]
    ds_read_b128 v[76:79], v5 offset:64512
    ds_read_b128 v[80:83], v9 offset:7168
    v_mfma_f32_16x16x32_bf16 v[36:39], v[60:63], v[52:55], v[36:39]
    ds_read_b128 v[84:87], v9 offset:9216
    ds_read_b128 v[88:91], v9 offset:11264
    v_mfma_f32_16x16x32_bf16 v[40:43], v[64:67], v[52:55], v[40:43]
    ds_read_b128 v[92:95], v9 offset:13312
    ds_read_b128 v[96:99], v9 offset:15360
    v_mfma_f32_16x16x32_bf16 v[44:47], v[68:71], v[52:55], v[44:47]
    v_mfma_f32_16x16x32_bf16 v[48:51], v[72:75], v[52:55], v[48:51]
    s_waitcnt lgkmcnt(0)
    s_barrier
    v_mfma_f32_16x16x32_bf16 v[32:35], v[80:83], v[76:79], v[32:35]
    ds_read_b128 v[52:55], v4 offset:0
    ds_read_b128 v[56:59], v7 offset:8192
    v_mfma_f32_16x16x32_bf16 v[36:39], v[84:87], v[76:79], v[36:39]
    ds_read_b128 v[60:63], v7 offset:10240
    ds_read_b128 v[64:67], v7 offset:12288
    v_mfma_f32_16x16x32_bf16 v[40:43], v[88:91], v[76:79], v[40:43]
    ds_read_b128 v[68:71], v7 offset:14336
    ds_read_b128 v[72:75], v7 offset:16384
    v_mfma_f32_16x16x32_bf16 v[44:47], v[92:95], v[76:79], v[44:47]
    v_mfma_f32_16x16x32_bf16 v[48:51], v[96:99], v[76:79], v[48:51]
    s_waitcnt lgkmcnt(0)
    v_mfma_f32_16x16x32_bf16 v[32:35], v[56:59], v[52:55], v[32:35]
    ds_read_b128 v[76:79], v4 offset:1024
    ds_read_b128 v[80:83], v7 offset:9216
    v_mfma_f32_16x16x32_bf16 v[36:39], v[60:63], v[52:55], v[36:39]
    ds_read_b128 v[84:87], v7 offset:11264
    ds_read_b128 v[88:91], v7 offset:13312
    v_mfma_f32_16x16x32_bf16 v[40:43], v[64:67], v[52:55], v[40:43]
    ds_read_b128 v[92:95], v7 offset:15360
    ds_read_b128 v[96:99], v7 offset:17408
    v_mfma_f32_16x16x32_bf16 v[44:47], v[68:71], v[52:55], v[44:47]
    v_mfma_f32_16x16x32_bf16 v[48:51], v[72:75], v[52:55], v[48:51]
    s_waitcnt lgkmcnt(0)
    s_barrier
    v_mfma_f32_16x16x32_bf16 v[32:35], v[80:83], v[76:79], v[32:35]
    ds_read_b128 v[52:55], v4 offset:18432
    ds_read_b128 v[56:59], v7 offset:26624
    v_mfma_f32_16x16x32_bf16 v[36:39], v[84:87], v[76:79], v[36:39]
    ds_read_b128 v[60:63], v7 offset:28672
    ds_read_b128 v[64:67], v7 offset:30720
    v_mfma_f32_16x16x32_bf16 v[40:43], v[88:91], v[76:79], v[40:43]
    ds_read_b128 v[68:71], v7 offset:32768
    ds_read_b128 v[72:75], v7 offset:34816
    v_mfma_f32_16x16x32_bf16 v[44:47], v[92:95], v[76:79], v[44:47]
    v_mfma_f32_16x16x32_bf16 v[48:51], v[96:99], v[76:79], v[48:51]
    s_waitcnt lgkmcnt(0)
    v_mfma_f32_16x16x32_bf16 v[32:35], v[56:59], v[52:55], v[32:35]
    ds_read_b128 v[76:79], v4 offset:19456
    ds_read_b128 v[80:83], v7 offset:27648
    v_mfma_f32_16x16x32_bf16 v[36:39], v[60:63], v[52:55], v[36:39]
    ds_read_b128 v[84:87], v7 offset:29696
    ds_read_b128 v[88:91], v7 offset:31744
    v_mfma_f32_16x16x32_bf16 v[40:43], v[64:67], v[52:55], v[40:43]
    ds_read_b128 v[92:95], v7 offset:33792
    ds_read_b128 v[96:99], v7 offset:35840
    v_mfma_f32_16x16x32_bf16 v[44:47], v[68:71], v[52:55], v[44:47]
    v_mfma_f32_16x16x32_bf16 v[48:51], v[72:75], v[52:55], v[48:51]
    s_waitcnt lgkmcnt(0)
    s_barrier
    v_mfma_f32_16x16x32_bf16 v[32:35], v[80:83], v[76:79], v[32:35]
    ds_read_b128 v[52:55], v4 offset:36864
    ds_read_b128 v[56:59], v7 offset:45056
    v_mfma_f32_16x16x32_bf16 v[36:39], v[84:87], v[76:79], v[36:39]
    ds_read_b128 v[60:63], v7 offset:47104
    ds_read_b128 v[64:67], v7 offset:49152
    v_mfma_f32_16x16x32_bf16 v[40:43], v[88:91], v[76:79], v[40:43]
    ds_read_b128 v[68:71], v7 offset:51200
    ds_read_b128 v[72:75], v7 offset:53248
    v_mfma_f32_16x16x32_bf16 v[44:47], v[92:95], v[76:79], v[44:47]
    v_mfma_f32_16x16x32_bf16 v[48:51], v[96:99], v[76:79], v[48:51]
    s_waitcnt lgkmcnt(0)
    v_mfma_f32_16x16x32_bf16 v[32:35], v[56:59], v[52:55], v[32:35]
    ds_read_b128 v[76:79], v4 offset:37888
    ds_read_b128 v[80:83], v7 offset:46080
    v_mfma_f32_16x16x32_bf16 v[36:39], v[60:63], v[52:55], v[36:39]
    ds_read_b128 v[84:87], v7 offset:48128
    ds_read_b128 v[88:91], v7 offset:50176
    v_mfma_f32_16x16x32_bf16 v[40:43], v[64:67], v[52:55], v[40:43]
    ds_read_b128 v[92:95], v7 offset:52224
    ds_read_b128 v[96:99], v7 offset:54272
    v_mfma_f32_16x16x32_bf16 v[44:47], v[68:71], v[52:55], v[44:47]
    v_mfma_f32_16x16x32_bf16 v[48:51], v[72:75], v[52:55], v[48:51]
    s_waitcnt lgkmcnt(0)
    s_barrier
    v_mfma_f32_16x16x32_bf16 v[32:35], v[80:83], v[76:79], v[32:35]
    ds_read_b128 v[52:55], v4 offset:55296
    ds_read_b128 v[56:59], v7 offset:63488
    v_mfma_f32_16x16x32_bf16 v[36:39], v[84:87], v[76:79], v[36:39]
    ds_read_b128 v[60:63], v8 offset:0
    ds_read_b128 v[64:67], v8 offset:2048
    v_mfma_f32_16x16x32_bf16 v[40:43], v[88:91], v[76:79], v[40:43]
    ds_read_b128 v[68:71], v8 offset:4096
    ds_read_b128 v[72:75], v8 offset:6144
    v_mfma_f32_16x16x32_bf16 v[44:47], v[92:95], v[76:79], v[44:47]
    v_mfma_f32_16x16x32_bf16 v[48:51], v[96:99], v[76:79], v[48:51]
    s_waitcnt lgkmcnt(0)
    v_mfma_f32_16x16x32_bf16 v[32:35], v[56:59], v[52:55], v[32:35]
    ds_read_b128 v[76:79], v4 offset:56320
    ds_read_b128 v[80:83], v7 offset:64512
    v_mfma_f32_16x16x32_bf16 v[36:39], v[60:63], v[52:55], v[36:39]
    ds_read_b128 v[84:87], v8 offset:1024
    ds_read_b128 v[88:91], v8 offset:3072
    v_mfma_f32_16x16x32_bf16 v[40:43], v[64:67], v[52:55], v[40:43]
    ds_read_b128 v[92:95], v8 offset:5120
    ds_read_b128 v[96:99], v8 offset:7168
    v_mfma_f32_16x16x32_bf16 v[44:47], v[68:71], v[52:55], v[44:47]
    v_mfma_f32_16x16x32_bf16 v[48:51], v[72:75], v[52:55], v[48:51]
    s_waitcnt lgkmcnt(0)
    s_barrier
    v_mfma_f32_16x16x32_bf16 v[32:35], v[80:83], v[76:79], v[32:35]
    ds_read_b128 v[52:55], v5 offset:8192
    ds_read_b128 v[56:59], v8 offset:16384
    v_mfma_f32_16x16x32_bf16 v[36:39], v[84:87], v[76:79], v[36:39]
    ds_read_b128 v[60:63], v8 offset:18432
    ds_read_b128 v[64:67], v8 offset:20480
    v_mfma_f32_16x16x32_bf16 v[40:43], v[88:91], v[76:79], v[40:43]
    ds_read_b128 v[68:71], v8 offset:22528
    ds_read_b128 v[72:75], v8 offset:24576
    v_mfma_f32_16x16x32_bf16 v[44:47], v[92:95], v[76:79], v[44:47]
    v_mfma_f32_16x16x32_bf16 v[48:51], v[96:99], v[76:79], v[48:51]
    s_waitcnt lgkmcnt(0)
    v_mfma_f32_16x16x32_bf16 v[32:35], v[56:59], v[52:55], v[32:35]
    ds_read_b128 v[76:79], v5 offset:9216
    ds_read_b128 v[80:83], v8 offset:17408
    v_mfma_f32_16x16x32_bf16 v[36:39], v[60:63], v[52:55], v[36:39]
    ds_read_b128 v[84:87], v8 offset:19456
    ds_read_b128 v[88:91], v8 offset:21504
    v_mfma_f32_16x16x32_bf16 v[40:43], v[64:67], v[52:55], v[40:43]
    ds_read_b128 v[92:95], v8 offset:23552
    ds_read_b128 v[96:99], v8 offset:25600
    v_mfma_f32_16x16x32_bf16 v[44:47], v[68:71], v[52:55], v[44:47]
    v_mfma_f32_16x16x32_bf16 v[48:51], v[72:75], v[52:55], v[48:51]
    s_waitcnt lgkmcnt(0)
    s_barrier
    v_mfma_f32_16x16x32_bf16 v[32:35], v[80:83], v[76:79], v[32:35]
    ds_read_b128 v[52:55], v5 offset:26624
    ds_read_b128 v[56:59], v8 offset:34816
    v_mfma_f32_16x16x32_bf16 v[36:39], v[84:87], v[76:79], v[36:39]
    ds_read_b128 v[60:63], v8 offset:36864
    ds_read_b128 v[64:67], v8 offset:38912
    v_mfma_f32_16x16x32_bf16 v[40:43], v[88:91], v[76:79], v[40:43]
    ds_read_b128 v[68:71], v8 offset:40960
    ds_read_b128 v[72:75], v8 offset:43008
    v_mfma_f32_16x16x32_bf16 v[44:47], v[92:95], v[76:79], v[44:47]
    v_mfma_f32_16x16x32_bf16 v[48:51], v[96:99], v[76:79], v[48:51]
    s_waitcnt lgkmcnt(0)
    v_mfma_f32_16x16x32_bf16 v[32:35], v[56:59], v[52:55], v[32:35]
    ds_read_b128 v[76:79], v5 offset:27648
    ds_read_b128 v[80:83], v8 offset:35840
    v_mfma_f32_16x16x32_bf16 v[36:39], v[60:63], v[52:55], v[36:39]
    ds_read_b128 v[84:87], v8 offset:37888
    ds_read_b128 v[88:91], v8 offset:39936
    v_mfma_f32_16x16x32_bf16 v[40:43], v[64:67], v[52:55], v[40:43]
    ds_read_b128 v[92:95], v8 offset:41984
    ds_read_b128 v[96:99], v8 offset:44032
    v_mfma_f32_16x16x32_bf16 v[44:47], v[68:71], v[52:55], v[44:47]
    v_mfma_f32_16x16x32_bf16 v[48:51], v[72:75], v[52:55], v[48:51]
    s_waitcnt lgkmcnt(0)
    s_barrier
    v_mfma_f32_16x16x32_bf16 v[32:35], v[80:83], v[76:79], v[32:35]
    ds_read_b128 v[52:55], v5 offset:45056
    ds_read_b128 v[56:59], v8 offset:53248
    v_mfma_f32_16x16x32_bf16 v[36:39], v[84:87], v[76:79], v[36:39]
    ds_read_b128 v[60:63], v8 offset:55296
    ds_read_b128 v[64:67], v8 offset:57344
    v_mfma_f32_16x16x32_bf16 v[40:43], v[88:91], v[76:79], v[40:43]
    ds_read_b128 v[68:71], v8 offset:59392
    ds_read_b128 v[72:75], v8 offset:61440
    v_mfma_f32_16x16x32_bf16 v[44:47], v[92:95], v[76:79], v[44:47]
    v_mfma_f32_16x16x32_bf16 v[48:51], v[96:99], v[76:79], v[48:51]
    s_waitcnt lgkmcnt(0)
    v_mfma_f32_16x16x32_bf16 v[32:35], v[56:59], v[52:55], v[32:35]
    ds_read_b128 v[76:79], v5 offset:46080
    ds_read_b128 v[80:83], v8 offset:54272
    v_mfma_f32_16x16x32_bf16 v[36:39], v[60:63], v[52:55], v[36:39]
    ds_read_b128 v[84:87], v8 offset:56320
    ds_read_b128 v[88:91], v8 offset:58368
    v_mfma_f32_16x16x32_bf16 v[40:43], v[64:67], v[52:55], v[40:43]
    ds_read_b128 v[92:95], v8 offset:60416
    ds_read_b128 v[96:99], v8 offset:62464
    v_mfma_f32_16x16x32_bf16 v[44:47], v[68:71], v[52:55], v[44:47]
    v_mfma_f32_16x16x32_bf16 v[48:51], v[72:75], v[52:55], v[48:51]
    s_waitcnt lgkmcnt(0)
    s_barrier
    v_mfma_f32_16x16x32_bf16 v[32:35], v[80:83], v[76:79], v[32:35]
    ds_read_b128 v[52:55], v5 offset:63488
    ds_read_b128 v[56:59], v9 offset:6144
    v_mfma_f32_16x16x32_bf16 v[36:39], v[84:87], v[76:79], v[36:39]
    ds_read_b128 v[60:63], v9 offset:8192
    ds_read_b128 v[64:67], v9 offset:10240
    v_mfma_f32_16x16x32_bf16 v[40:43], v[88:91], v[76:79], v[40:43]
    ds_read_b128 v[68:71], v9 offset:12288
    ds_read_b128 v[72:75], v9 offset:14336
    v_mfma_f32_16x16x32_bf16 v[44:47], v[92:95], v[76:79], v[44:47]
    v_mfma_f32_16x16x32_bf16 v[48:51], v[96:99], v[76:79], v[48:51]
    s_waitcnt lgkmcnt(0)
    v_mfma_f32_16x16x32_bf16 v[32:35], v[56:59], v[52:55], v[32:35]
    ds_read_b128 v[76:79], v5 offset:64512
    ds_read_b128 v[80:83], v9 offset:7168
    v_mfma_f32_16x16x32_bf16 v[36:39], v[60:63], v[52:55], v[36:39]
    ds_read_b128 v[84:87], v9 offset:9216
    ds_read_b128 v[88:91], v9 offset:11264
    v_mfma_f32_16x16x32_bf16 v[40:43], v[64:67], v[52:55], v[40:43]
    ds_read_b128 v[92:95], v9 offset:13312
    ds_read_b128 v[96:99], v9 offset:15360
    v_mfma_f32_16x16x32_bf16 v[44:47], v[68:71], v[52:55], v[44:47]
    v_mfma_f32_16x16x32_bf16 v[48:51], v[72:75], v[52:55], v[48:51]
    s_waitcnt lgkmcnt(0)
    v_mfma_f32_16x16x32_bf16 v[32:35], v[80:83], v[76:79], v[32:35]
    v_mfma_f32_16x16x32_bf16 v[36:39], v[84:87], v[76:79], v[36:39]
    v_mfma_f32_16x16x32_bf16 v[40:43], v[88:91], v[76:79], v[40:43]
    v_mfma_f32_16x16x32_bf16 v[44:47], v[92:95], v[76:79], v[44:47]
    v_mfma_f32_16x16x32_bf16 v[48:51], v[96:99], v[76:79], v[48:51]
    s_waitcnt vmcnt(0)
    v_mov_b32 v20, 0
    v_mov_b32 v21, 0
    v_and_b32 v24, 15, v1
    v_mul_u32_u24 v24, 1280, v24
    v_lshrrev_b32 v25, 4, v1
    v_lshlrev_b32 v25, 4, v25
    v_add_u32 v24, v24, v25
    v_cvt_pk_bf16_f32 v32, v32, v33
    v_cvt_pk_bf16_f32 v34, v34, v35
    v_and_b32 v33, 0xffff0000, v32
    v_lshlrev_b32 v32, 16, v32
    v_and_b32 v35, 0xffff0000, v34
    v_lshlrev_b32 v34, 16, v34
    v_lshlrev_b32 v22, 16, v10
    v_and_b32 v23, 0xffff0000, v10
    v_add_f32 v32, v32, v22
    v_add_f32 v33, v33, v23
    v_lshlrev_b32 v22, 16, v11
    v_and_b32 v23, 0xffff0000, v11
    v_add_f32 v34, v34, v22
    v_add_f32 v35, v35, v23
    v_cvt_pk_bf16_f32 v10, v32, v33
    v_cvt_pk_bf16_f32 v11, v34, v35
    buffer_store_dwordx2 v[10:11], v24, s[8:11], s46 offen
    v_cvt_pk_bf16_f32 v36, v36, v37
    v_cvt_pk_bf16_f32 v38, v38, v39
    v_and_b32 v37, 0xffff0000, v36
    v_lshlrev_b32 v36, 16, v36
    v_and_b32 v39, 0xffff0000, v38
    v_lshlrev_b32 v38, 16, v38
    v_lshlrev_b32 v22, 16, v12
    v_and_b32 v23, 0xffff0000, v12
    v_add_f32 v36, v36, v22
    v_add_f32 v37, v37, v23
    v_lshlrev_b32 v22, 16, v13
    v_and_b32 v23, 0xffff0000, v13
    v_add_f32 v38, v38, v22
    v_add_f32 v39, v39, v23
    v_cvt_pk_bf16_f32 v12, v36, v37
    v_cvt_pk_bf16_f32 v13, v38, v39
    buffer_store_dwordx2 v[12:13], v24, s[8:11], s47 offen
    v_cvt_pk_bf16_f32 v40, v40, v41
    v_cvt_pk_bf16_f32 v42, v42, v43
    v_and_b32 v41, 0xffff0000, v40
    v_lshlrev_b32 v40, 16, v40
    v_and_b32 v43, 0xffff0000, v42
    v_lshlrev_b32 v42, 16, v42
    v_lshlrev_b32 v22, 16, v14
    v_and_b32 v23, 0xffff0000, v14
    v_add_f32 v40, v40, v22
    v_add_f32 v41, v41, v23
    v_lshlrev_b32 v22, 16, v15
    v_and_b32 v23, 0xffff0000, v15
    v_add_f32 v42, v42, v22
    v_add_f32 v43, v43, v23
    v_cvt_pk_bf16_f32 v14, v40, v41
    v_cvt_pk_bf16_f32 v15, v42, v43
    buffer_store_dwordx2 v[14:15], v24, s[8:11], s48 offen
    v_cvt_pk_bf16_f32 v44, v44, v45
    v_cvt_pk_bf16_f32 v46, v46, v47
    v_and_b32 v45, 0xffff0000, v44
    v_lshlrev_b32 v44, 16, v44
    v_and_b32 v47, 0xffff0000, v46
    v_lshlrev_b32 v46, 16, v46
    v_lshlrev_b32 v22, 16, v16
    v_and_b32 v23, 0xffff0000, v16
    v_add_f32 v44, v44, v22
    v_add_f32 v45, v45, v23
    v_lshlrev_b32 v22, 16, v17
    v_and_b32 v23, 0xffff0000, v17
    v_add_f32 v46, v46, v22
    v_add_f32 v47, v47, v23
    v_cvt_pk_bf16_f32 v16, v44, v45
    v_cvt_pk_bf16_f32 v17, v46, v47
    buffer_store_dwordx2 v[16:17], v24, s[8:11], s49 offen
    v_cvt_pk_bf16_f32 v48, v48, v49
    v_cvt_pk_bf16_f32 v50, v50, v51
    v_and_b32 v49, 0xffff0000, v48
    v_lshlrev_b32 v48, 16, v48
    v_and_b32 v51, 0xffff0000, v50
    v_lshlrev_b32 v50, 16, v50
    v_lshlrev_b32 v22, 16, v18
    v_and_b32 v23, 0xffff0000, v18
    v_add_f32 v48, v48, v22
    v_add_f32 v49, v49, v23
    v_lshlrev_b32 v22, 16, v19
    v_and_b32 v23, 0xffff0000, v19
    v_add_f32 v50, v50, v22
    v_add_f32 v51, v51, v23
    v_cvt_pk_bf16_f32 v18, v48, v49
    v_cvt_pk_bf16_f32 v19, v50, v51
    buffer_store_dwordx2 v[18:19], v24, s[8:11], s50 offen
    s_nop 3
dn2_kernel_end:
    s_endpgm

.section .rodata,"a"
.p2align 6
.amdhsa_kernel prep_kernel
  .amdhsa_next_free_vgpr 128
  .amdhsa_next_free_sgpr 40
  .amdhsa_accum_offset 128
  .amdhsa_group_segment_fixed_size 0
  .amdhsa_kernarg_size 80
  .amdhsa_user_sgpr_count 2
  .amdhsa_user_sgpr_kernarg_segment_ptr 1
  .amdhsa_system_sgpr_workgroup_id_x 1
.end_amdhsa_kernel
.p2align 6
.amdhsa_kernel qkv1_kernel
  .amdhsa_next_free_vgpr 176
  .amdhsa_next_free_sgpr 100
  .amdhsa_accum_offset 176
  .amdhsa_group_segment_fixed_size 0
  .amdhsa_kernarg_size 80
  .amdhsa_user_sgpr_count 2
  .amdhsa_user_sgpr_kernarg_segment_ptr 1
  .amdhsa_system_sgpr_workgroup_id_x 1
.end_amdhsa_kernel
.p2align 6
.amdhsa_kernel attn1_kernel
  .amdhsa_next_free_vgpr 256
  .amdhsa_next_free_sgpr 100
  .amdhsa_accum_offset 256
  .amdhsa_group_segment_fixed_size 0
  .amdhsa_kernarg_size 80
  .amdhsa_user_sgpr_count 2
  .amdhsa_user_sgpr_kernarg_segment_ptr 1
  .amdhsa_system_sgpr_workgroup_id_x 1
.end_amdhsa_kernel
.p2align 6
.amdhsa_kernel attn_kernel
  .amdhsa_next_free_vgpr 256
  .amdhsa_next_free_sgpr 100
  .amdhsa_accum_offset 256
  .amdhsa_group_segment_fixed_size 0
  .amdhsa_kernarg_size 80
  .amdhsa_user_sgpr_count 2
  .amdhsa_user_sgpr_kernarg_segment_ptr 1
  .amdhsa_system_sgpr_workgroup_id_x 1
.end_amdhsa_kernel
.p2align 6
.amdhsa_kernel wo1_kernel
  .amdhsa_next_free_vgpr 104
  .amdhsa_next_free_sgpr 100
  .amdhsa_accum_offset 104
  .amdhsa_group_segment_fixed_size 0
  .amdhsa_kernarg_size 80
  .amdhsa_user_sgpr_count 2
  .amdhsa_user_sgpr_kernarg_segment_ptr 1
  .amdhsa_system_sgpr_workgroup_id_x 1
.end_amdhsa_kernel
.p2align 6
.amdhsa_kernel gu1_kernel
  .amdhsa_next_free_vgpr 240
  .amdhsa_next_free_sgpr 100
  .amdhsa_accum_offset 240
  .amdhsa_group_segment_fixed_size 0
  .amdhsa_kernarg_size 80
  .amdhsa_user_sgpr_count 2
  .amdhsa_user_sgpr_kernarg_segment_ptr 1
  .amdhsa_system_sgpr_workgroup_id_x 1
.end_amdhsa_kernel
.p2align 6
.amdhsa_kernel dn1_kernel
  .amdhsa_next_free_vgpr 104
  .amdhsa_next_free_sgpr 100
  .amdhsa_accum_offset 104
  .amdhsa_group_segment_fixed_size 0
  .amdhsa_kernarg_size 80
  .amdhsa_user_sgpr_count 2
  .amdhsa_user_sgpr_kernarg_segment_ptr 1
  .amdhsa_system_sgpr_workgroup_id_x 1
.end_amdhsa_kernel
.p2align 6
.amdhsa_kernel qkv2_kernel
  .amdhsa_next_free_vgpr 176
  .amdhsa_next_free_sgpr 100
  .amdhsa_accum_offset 176
  .amdhsa_group_segment_fixed_size 0
  .amdhsa_kernarg_size 80
  .amdhsa_user_sgpr_count 2
  .amdhsa_user_sgpr_kernarg_segment_ptr 1
  .amdhsa_system_sgpr_workgroup_id_x 1
.end_amdhsa_kernel
.p2align 6
.amdhsa_kernel wo2_kernel
  .amdhsa_next_free_vgpr 104
  .amdhsa_next_free_sgpr 100
  .amdhsa_accum_offset 104
  .amdhsa_group_segment_fixed_size 0
  .amdhsa_kernarg_size 80
  .amdhsa_user_sgpr_count 2
  .amdhsa_user_sgpr_kernarg_segment_ptr 1
  .amdhsa_system_sgpr_workgroup_id_x 1
.end_amdhsa_kernel
.p2align 6
.amdhsa_kernel gu2_kernel
  .amdhsa_next_free_vgpr 240
  .amdhsa_next_free_sgpr 100
  .amdhsa_accum_offset 240
  .amdhsa_group_segment_fixed_size 0
  .amdhsa_kernarg_size 80
  .amdhsa_user_sgpr_count 2
  .amdhsa_user_sgpr_kernarg_segment_ptr 1
  .amdhsa_system_sgpr_workgroup_id_x 1
.end_amdhsa_kernel
.p2align 6
.amdhsa_kernel dn2_kernel
  .amdhsa_next_free_vgpr 104
  .amdhsa_next_free_sgpr 100
  .amdhsa_accum_offset 104
  .amdhsa_group_segment_fixed_size 0
  .amdhsa_kernarg_size 80
  .amdhsa_user_sgpr_count 2
  .amdhsa_user_sgpr_kernarg_segment_ptr 1
  .amdhsa_system_sgpr_workgroup_id_x 1
.end_amdhsa_kernel
```
